```python
import torch

def _softmax(x, axis=-1):
    return torch.softmax(x, dim=axis)
def _gelu(x):
    return torch.nn.functional.gelu(x, approximate="tanh")
def _silu(x):
    return torch.nn.functional.silu(x)
def _sigmoid(x):
    return torch.sigmoid(x)
def _layernorm(x, axis=-1, eps=1e-5):
    m = x.mean(dim=axis, keepdim=True)
    v = x.var(dim=axis, keepdim=True, unbiased=False)
    return (x - m) / torch.sqrt(v + eps)
def _scatter_add(tgt, idx, src, axis=0):
    return tgt.clone().index_add_(axis, idx, src)
def _segment_sum(src, seg, n):
    out = torch.zeros((n,) + src.shape[1:], dtype=src.dtype)
    return out.index_add_(0, seg, src)
def _pad(x, pw):
    flat = tuple(v for pair in reversed(pw) for v in pair)
    return torch.nn.functional.pad(x, flat)

kernel_name = 'concat_heads__gqa_block_cached__mha_block_cached__near_ridge'

def setup_inputs():

    _w = (lambda a: (lambda t: t.to(torch.bfloat16) if t.is_floating_point() else t)(torch.as_tensor(a)))
    def _A_setup():
        B, Sq, D = 16, 64, 512
        Hq, Hkv, Sk, Dh = 32, 8, 512, 128
        assert Hq % Hkv == 0, (Hq, Hkv)
        return {
            "x": _w((lambda *s: torch.randn(*s, dtype=torch.bfloat16) * 0.8)(B, Sq, D)),
            "k_cache": _w((lambda *s: torch.randn(*s, dtype=torch.bfloat16) * 0.8)(B, Hkv, Sk, Dh)),
            "v_cache": _w((lambda *s: torch.randn(*s, dtype=torch.bfloat16) * 0.05)(B, Hkv, Sk, Dh)),
            "wq": _w((lambda *s: torch.randn(*s, dtype=torch.bfloat16) * 0.8)(D, Hq * Dh) * (D ** -0.5)),
            "wo": _w((lambda *s: torch.randn(*s, dtype=torch.bfloat16) * 0.05)(Hq * Dh, D) * ((Hq * Dh) ** -0.5)),
        }
    _A_in = _A_setup()

    def _B_setup():
        B, Sq, D = 16, 64, 512
        H, Sk, Dh = 32, 512, 128
        return {
            "x": _w((lambda *s: torch.randn(*s, dtype=torch.bfloat16) * 0.8)(B, Sq, D)),
            "k_cache": _w((lambda *s: torch.randn(*s, dtype=torch.bfloat16) * 0.8)(B, H, Sk, Dh)),
            "v_cache": _w((lambda *s: torch.randn(*s, dtype=torch.bfloat16) * 0.05)(B, H, Sk, Dh)),
            "wq": _w((lambda *s: torch.randn(*s, dtype=torch.bfloat16) * 0.8)(D, H * Dh) * (D ** -0.5)),
            "wo": _w((lambda *s: torch.randn(*s, dtype=torch.bfloat16) * 0.05)(H * Dh, D) * ((H * Dh) ** -0.5)),
        }
    _B_in = _B_setup()

    return {
        "A_x": _A_in["x"],
        "A_k_cache": _A_in["k_cache"],
        "A_v_cache": _A_in["v_cache"],
        "A_wq": _A_in["wq"],
        "A_wo": _A_in["wo"],
        "B_x": _B_in["x"],
        "B_k_cache": _B_in["k_cache"],
        "B_v_cache": _B_in["v_cache"],
        "B_wq": _B_in["wq"],
        "B_wo": _B_in["wo"],
    }

def reference(A_x, A_k_cache, A_v_cache, A_wq, A_wo, B_x, B_k_cache, B_v_cache, B_wq, B_wo):
    def _A_ref(x, k_cache, v_cache, wq, wo):
        B, Sq, D = x.shape
        Hq, Dh = 32, 128
        Hkv = k_cache.shape[1]
        rep = Hq // Hkv
        q = (lambda x, *d: x.permute(*d))((x @ wq).reshape(B, Sq, Hq, Dh), 0, 2, 1, 3)
        k = (lambda x, n, axis: torch.repeat_interleave(x, n, dim=axis))(k_cache, rep, axis=1)
        v = (lambda x, n, axis: torch.repeat_interleave(x, n, dim=axis))(v_cache, rep, axis=1)
        scores = torch.einsum("bhqd,bhkd->bhqk", q, k) * (Dh ** -0.5)
        p = _softmax(scores, axis=-1)
        o = torch.einsum("bhqk,bhkd->bhqd", p, v)
        return (lambda x, *d: x.permute(*d))(o, 0, 2, 1, 3).reshape(B, Sq, Hq * Dh) @ wo

    def _B_ref(x, k_cache, v_cache, wq, wo):
        B, Sq, D = x.shape
        H, Dh = 32, 128
        q = (lambda x, *d: x.permute(*d))((x @ wq).reshape(B, Sq, H, Dh), 0, 2, 1, 3)
        scores = torch.einsum("bhqd,bhkd->bhqk", q, k_cache) * (Dh ** -0.5)
        p = _softmax(scores, axis=-1)
        o = torch.einsum("bhqk,bhkd->bhqd", p, v_cache)
        return (lambda x, *d: x.permute(*d))(o, 0, 2, 1, 3).reshape(B, Sq, H * Dh) @ wo

    a = _A_ref(A_x, A_k_cache, A_v_cache, A_wq, A_wo)
    b = _B_ref(B_x, B_k_cache, B_v_cache, B_wq, B_wo)
    return torch.concatenate([a, b], axis=-1)
```

```asm
; @launch grid=(256,1,1) block=(512,1,1) lds=163840
.amdgcn_target "amdgcn-amd-amdhsa--gfx950"
.text
.globl concat_heads__gqa_block_cached__mha_block_cached__near_ridge_kernel
.p2align 8
.type concat_heads__gqa_block_cached__mha_block_cached__near_ridge_kernel,@function
concat_heads__gqa_block_cached__mha_block_cached__near_ridge_kernel:
  s_cmp_ge_u32 s2, 256
  s_cbranch_scc1 L_exit
  s_load_dwordx8 s[60:67], s[0:1], 0
  s_load_dwordx2 s[68:69], s[0:1], 32
  s_load_dwordx8 s[72:79], s[0:1], 40
  s_load_dwordx2 s[80:81], s[0:1], 72
  s_load_dwordx2 s[82:83], s[0:1], 96
  v_lshrrev_b32 v1, 6, v0
  s_and_b32 s4, s2, 7
  v_readfirstlane_b32 s3, v1
  s_bfe_u32 s5, s2, 0x10003
  s_lshr_b32 s6, s2, 4
  v_and_b32 v1, 63, v0
  v_lshlrev_b32 v18, 4, v1
  s_and_b32 s45, s3, 3
  s_bfe_u32 s46, s3, 0x10001
  s_and_b32 s47, s3, 1
  s_lshl_b32 s33, s45, 12
  s_lshl_b32 s34, s45, 13
  s_lshl_b32 s35, s45, 16
  s_lshl_b32 s37, s46, 17
  s_add_u32 s52, s37, 0x40000
  s_mul_i32 s42, s4, 0
  s_mul_i32 s43, s6, 1
  s_add_u32 s42, s42, s43
  s_and_b32 s42, s42, 15
  s_xor_b32 s43, s47, 1
  s_add_u32 s42, s42, s43
  s_lshl_b32 s42, s42, 13
  s_mov_b32 s49, s6
  s_mul_i32 s39, s46, 49152
  s_lshl_b32 s43, s47, 13
  s_add_u32 s39, s39, s43
  s_lshl_b32 s48, s6, 18
  s_add_u32 s48, s48, s35
  s_mov_b32 s41, 0x3e0293ee
  s_mov_b32 s53, 0x41000000
  s_waitcnt lgkmcnt(0)
  s_cmp_eq_u32 s5, 0
  s_cselect_b32 s60, s60, s72
  s_cselect_b32 s61, s61, s73
  s_cselect_b32 s62, s62, s74
  s_cselect_b32 s63, s63, s75
  s_cselect_b32 s64, s64, s76
  s_cselect_b32 s65, s65, s77
  s_cselect_b32 s66, s66, s78
  s_cselect_b32 s67, s67, s79
  s_cselect_b32 s68, s68, s80
  s_cselect_b32 s69, s69, s81
  s_cselect_b32 s7, 17, 19
  s_lshl_b32 s10, 1, s7
  s_lshl_b32 s43, s6, 16
  s_add_u32 s20, s60, s43
  s_addc_u32 s21, s61, 0
  s_and_b32 s21, s21, 0xffff
  s_mov_b32 s22, 0x10000
  s_mov_b32 s23, 0x20000
  s_lshl_b32 s43, s4, 10
  s_add_u32 s12, s66, s43
  s_addc_u32 s13, s67, 0
  s_and_b32 s13, s13, 0xffff
  s_sub_u32 s14, 0x400000, s43
  s_mov_b32 s15, 0x20000
  s_lshl_b32 s43, s6, 3
  s_add_u32 s43, s43, s4
  s_lshl_b32 s43, s43, s7
  s_bitcmp1_b32 s3, 0
  s_cselect_b32 s8, s64, s62
  s_cselect_b32 s9, s65, s63
  s_add_u32 s8, s8, s43
  s_addc_u32 s9, s9, 0
  s_and_b32 s9, s9, 0xffff
  s_mov_b32 s11, 0x20000
  s_lshl_b32 s43, s4, 19
  s_add_u32 s24, s68, s43
  s_addc_u32 s25, s69, 0
  s_and_b32 s25, s25, 0xffff
  s_mov_b32 s26, 0x80000
  s_mov_b32 s27, 0x20000
  s_lshl_b32 s43, s5, 4
  s_add_u32 s43, s43, s6
  s_lshl_b32 s43, s43, 3
  s_add_u32 s43, s43, s4
  s_lshl_b32 s43, s43, 16
  s_add_u32 s28, s82, s43
  s_addc_u32 s29, s83, 0
  s_and_b32 s29, s29, 0xffff
  s_mov_b32 s30, 0x10000
  s_mov_b32 s31, 0x20000
  s_cmp_eq_u32 s3, 0
  s_cbranch_scc0 L_nopf_45
  s_getpc_b64 s[58:59]
  s_lshr_b32 s43, s2, 3
  s_mul_i32 s43, s43, 2560
  v_lshlrev_b32 v3, 3, v18
  v_add_u32 v3, s43, v3
  v_cmp_gt_u32 vcc, 20, v1
  s_and_saveexec_b64 s[70:71], vcc
  global_load_dword v12, v3, s[58:59]
  s_mov_b64 exec, -1
L_nopf_45:
  s_cmp_eq_u32 s3, 1
  s_cbranch_scc0 L_noclr
  s_lshl_b32 s43, s2, 8
  s_add_u32 s43, s43, 33554432
  v_lshlrev_b32 v2, 2, v1
  v_add_u32 v2, s43, v2
  v_mov_b32 v3, 0
  s_mov_b64 exec, 0xff
  global_store_dword v2, v3, s[82:83] sc1
  s_mov_b64 exec, -1
L_noclr:
  s_load_dwordx2 s[70:71], s[0:1], 88
  s_cmp_eq_u32 s5, 0
  s_cbranch_scc1 L_A
  v_lshrrev_b32 v2, 5, v1
  v_and_b32 v3, 31, v1
  s_and_b32 s44, s3, 1
  s_lshl_b32 s44, s44, 3
  v_or_b32 v28, s44, v2
  v_xor_b32 v28, v28, v3
  v_lshlrev_b32 v29, 10, v2
  s_lshl_b32 s44, s49, 2
  v_xor_b32 v20, 0, v28
  v_add_u32 v20, s44, v20
  v_and_b32 v20, 63, v20
  v_lshl_add_u32 v20, v20, 4, v29
  v_xor_b32 v21, 2, v28
  v_add_u32 v21, s44, v21
  v_and_b32 v21, 63, v21
  v_lshl_add_u32 v21, v21, 4, v29
  v_add_u32 v21, 1024, v21
  v_xor_b32 v22, 4, v28
  v_add_u32 v22, s44, v22
  v_and_b32 v22, 63, v22
  v_lshl_add_u32 v22, v22, 4, v29
  v_add_u32 v22, 2048, v22
  v_xor_b32 v23, 6, v28
  v_add_u32 v23, s44, v23
  v_and_b32 v23, 63, v23
  v_lshl_add_u32 v23, v23, 4, v29
  v_add_u32 v23, 3072, v23
  s_lshl_b32 s43, s3, 12
  s_add_u32 m0, s43, 0
  s_lshl_b32 s43, s3, 13
  buffer_load_dwordx4 v20, s[20:23], s43 offen lds
  buffer_load_dwordx4 v21, s[20:23], s43 offen offset:1024 lds
  buffer_load_dwordx4 v22, s[20:23], s43 offen offset:2048 lds
  buffer_load_dwordx4 v23, s[20:23], s43 offen offset:3072 lds
  v_lshrrev_b32 v2, 5, v1
  v_and_b32 v3, 31, v1
  v_add_u32 v29, 0, v2
  v_lshlrev_b32 v29, 2, v29
  v_xor_b32 v29, v29, v3
  v_lshlrev_b32 v29, 4, v29
  v_lshl_add_u32 v29, v2, 13, v29
  v_add_u32 v8, 0, v29
  v_add_u32 v29, 2, v2
  v_lshlrev_b32 v29, 2, v29
  v_xor_b32 v29, v29, v3
  v_lshlrev_b32 v29, 4, v29
  v_lshl_add_u32 v29, v2, 13, v29
  v_add_u32 v9, 15360, v29
  v_add_u32 v29, 0, v2
  v_lshlrev_b32 v29, 2, v29
  v_xor_b32 v29, v29, v3
  v_lshlrev_b32 v29, 4, v29
  v_lshl_add_u32 v29, v2, 13, v29
  v_add_u32 v10, 30720, v29
  v_add_u32 v29, 2, v2
  v_lshlrev_b32 v29, 2, v29
  v_xor_b32 v29, v29, v3
  v_lshlrev_b32 v29, 4, v29
  v_lshl_add_u32 v29, v2, 13, v29
  v_add_u32 v11, 46080, v29
  s_cmp_lt_u32 s3, 4
  s_cbranch_scc1 L_BG0
L_code0:
L_BG1:
  s_setprio 2
  s_add_u32 s43, s48, 0
  s_add_u32 m0, s33, 32768
  s_and_b32 s43, s43, 0x3fffff
  buffer_load_dwordx4 v8, s[12:15], s43 offen lds
  buffer_load_dwordx4 v9, s[12:15], s43 offen offset:1024 lds
  buffer_load_dwordx4 v10, s[12:15], s43 offen offset:2048 lds
  buffer_load_dwordx4 v11, s[12:15], s43 offen offset:3072 lds
  s_add_u32 s43, s48, 262144
  s_add_u32 m0, s33, 81920
  s_and_b32 s43, s43, 0x3fffff
  buffer_load_dwordx4 v8, s[12:15], s43 offen lds
  buffer_load_dwordx4 v9, s[12:15], s43 offen offset:1024 lds
  buffer_load_dwordx4 v10, s[12:15], s43 offen offset:2048 lds
  buffer_load_dwordx4 v11, s[12:15], s43 offen offset:3072 lds
  v_lshrrev_b32 v2, 4, v1
  v_and_b32 v3, 15, v1
  v_lshlrev_b32 v19, 2, v2
  s_bitcmp1_b32 s3, 0
  s_cselect_b64 vcc, -1, 0
  v_add_u32 v29, 0, v2
  v_cndmask_b32 v29, v29, v19, vcc
  v_xor_b32 v29, v29, v3
  v_lshlrev_b32 v29, 4, v29
  v_lshl_add_u32 v4, v2, 8, v29
  v_add_u32 v29, 4, v2
  v_cndmask_b32 v29, v29, v19, vcc
  v_xor_b32 v29, v29, v3
  v_lshlrev_b32 v29, 4, v29
  v_lshl_add_u32 v5, v2, 8, v29
  v_add_u32 v29, 8, v2
  v_cndmask_b32 v29, v29, v19, vcc
  v_xor_b32 v29, v29, v3
  v_lshlrev_b32 v29, 4, v29
  v_lshl_add_u32 v6, v2, 8, v29
  v_add_u32 v29, 12, v2
  v_cndmask_b32 v29, v29, v19, vcc
  v_xor_b32 v29, v29, v3
  v_lshlrev_b32 v29, 4, v29
  v_lshl_add_u32 v7, v2, 8, v29
  v_and_b32 v2, 31, v1
  v_lshrrev_b32 v3, 5, v1
  v_and_b32 v19, 15, v1
  v_xor_b32 v19, v19, v3
  v_lshlrev_b32 v19, 4, v19
  v_lshl_add_u32 v13, v2, 8, v19
  v_lshl_add_u32 v19, v2, 9, v19
  s_lshl_b32 s43, s47, 14
  v_add_u32 v16, s43, v19
  v_bfe_u32 v32, v1, 4, 1
  v_bfe_u32 v33, v1, 2, 2
  v_and_b32 v34, 1, v1
  v_bfe_u32 v35, v1, 1, 1
  v_lshlrev_b32 v36, 1, v34
  v_or_b32 v36, v36, v35
  v_lshl_add_u32 v36, v32, 2, v36
  v_lshlrev_b32 v36, 3, v36
  v_lshl_add_u32 v36, v33, 6, v36
  v_lshlrev_b32 v37, 2, v3
  v_add_u32 v37, v37, v33
  v_lshl_add_u32 v14, v37, 8, v36
  v_lshlrev_b32 v37, 3, v3
  v_add_u32 v37, v37, v33
  v_lshl_add_u32 v38, v37, 9, v36
  s_lshl_b32 s43, s46, 8
  v_add_u32 v15, s43, v38
  v_lshlrev_b32 v36, 2, v34
  v_lshl_add_u32 v36, v32, 1, v36
  v_add_u32 v36, v36, v35
  v_lshlrev_b32 v36, 3, v36
  v_lshl_add_u32 v36, v33, 6, v36
  v_lshl_add_u32 v38, v37, 10, v36
  s_lshl_b32 s43, s46, 9
  v_add_u32 v17, s43, v38
  s_waitcnt vmcnt(4) lgkmcnt(0)
  s_barrier
  v_xor_b32 v2, 32, v16
  v_xor_b32 v3, 64, v16
  v_xor_b32 v24, 96, v16
  v_xor_b32 v25, 128, v16
  v_xor_b32 v26, 160, v16
  v_xor_b32 v27, 192, v16
  v_xor_b32 v28, 224, v16
  ds_read_b128 v[128:131], v16 offset:0
  ds_read_b128 v[132:135], v2 offset:0
  ds_read_b128 v[136:139], v3 offset:0
  ds_read_b128 v[140:143], v24 offset:0
  ds_read_b128 v[144:147], v25 offset:0
  ds_read_b128 v[148:151], v26 offset:0
  ds_read_b128 v[152:155], v27 offset:0
  ds_read_b128 v[156:159], v28 offset:0
  ds_read_b128 v[160:163], v16 offset:256
  ds_read_b128 v[164:167], v2 offset:256
  ds_read_b128 v[168:171], v3 offset:256
  ds_read_b128 v[172:175], v24 offset:256
  ds_read_b128 v[176:179], v25 offset:256
  ds_read_b128 v[180:183], v26 offset:256
  ds_read_b128 v[184:187], v27 offset:256
  s_waitcnt lgkmcnt(14)
  ds_read_b128 v[188:191], v28 offset:256
  s_add_u32 s43, s48, 524288
  s_add_u32 m0, s33, 147456
  s_and_b32 s43, s43, 0x3fffff
  buffer_load_dwordx4 v8, s[12:15], s43 offen lds
  buffer_load_dwordx4 v9, s[12:15], s43 offen offset:1024 lds
  buffer_load_dwordx4 v10, s[12:15], s43 offen offset:2048 lds
  buffer_load_dwordx4 v11, s[12:15], s43 offen offset:3072 lds
  s_add_u32 s43, s48, 786432
  s_add_u32 m0, s33, 131072
  s_and_b32 s43, s43, 0x3fffff
  buffer_load_dwordx4 v8, s[12:15], s43 offen lds
  buffer_load_dwordx4 v9, s[12:15], s43 offen offset:1024 lds
  buffer_load_dwordx4 v10, s[12:15], s43 offen offset:2048 lds
  buffer_load_dwordx4 v11, s[12:15], s43 offen offset:3072 lds
  v_xor_b32 v20, 0x200, v20
  v_xor_b32 v21, 0x200, v21
  v_xor_b32 v22, 0x200, v22
  v_xor_b32 v23, 0x200, v23
  s_lshl_b32 s43, s3, 12
  s_add_u32 m0, s43, 49152
  s_lshl_b32 s43, s3, 13
  buffer_load_dwordx4 v20, s[20:23], s43 offen lds
  buffer_load_dwordx4 v21, s[20:23], s43 offen offset:1024 lds
  buffer_load_dwordx4 v22, s[20:23], s43 offen offset:2048 lds
  buffer_load_dwordx4 v23, s[20:23], s43 offen offset:3072 lds
  s_waitcnt vmcnt(12) lgkmcnt(0)
  s_barrier
  s_add_u32 s43, s48, 1048576
  s_add_u32 m0, s33, 114688
  s_and_b32 s43, s43, 0x3fffff
  buffer_load_dwordx4 v8, s[12:15], s43 offen lds
  buffer_load_dwordx4 v9, s[12:15], s43 offen offset:1024 lds
  buffer_load_dwordx4 v10, s[12:15], s43 offen offset:2048 lds
  buffer_load_dwordx4 v11, s[12:15], s43 offen offset:3072 lds
  s_add_u32 s43, s48, 1310720
  s_add_u32 m0, s33, 98304
  s_and_b32 s43, s43, 0x3fffff
  buffer_load_dwordx4 v8, s[12:15], s43 offen lds
  buffer_load_dwordx4 v9, s[12:15], s43 offen offset:1024 lds
  buffer_load_dwordx4 v10, s[12:15], s43 offen offset:2048 lds
  buffer_load_dwordx4 v11, s[12:15], s43 offen offset:3072 lds
  s_add_u32 s43, s48, 1572864
  s_add_u32 m0, s33, 0
  s_and_b32 s43, s43, 0x3fffff
  buffer_load_dwordx4 v8, s[12:15], s43 offen lds
  buffer_load_dwordx4 v9, s[12:15], s43 offen offset:1024 lds
  buffer_load_dwordx4 v10, s[12:15], s43 offen offset:2048 lds
  buffer_load_dwordx4 v11, s[12:15], s43 offen offset:3072 lds
  s_waitcnt vmcnt(20) lgkmcnt(0)
  s_barrier
  s_waitcnt vmcnt(16) lgkmcnt(0)
  s_barrier
  s_waitcnt vmcnt(8) lgkmcnt(0)
  s_barrier
  v_xor_b32 v2, 32, v16
  v_xor_b32 v3, 64, v16
  v_xor_b32 v24, 96, v16
  v_xor_b32 v25, 128, v16
  v_xor_b32 v26, 160, v16
  v_xor_b32 v27, 192, v16
  v_xor_b32 v28, 224, v16
  ds_read_b128 v[192:195], v16 offset:49152
  ds_read_b128 v[196:199], v2 offset:49152
  ds_read_b128 v[200:203], v3 offset:49152
  ds_read_b128 v[204:207], v24 offset:49152
  ds_read_b128 v[208:211], v25 offset:49152
  ds_read_b128 v[212:215], v26 offset:49152
  ds_read_b128 v[216:219], v27 offset:49152
  ds_read_b128 v[220:223], v28 offset:49152
  ds_read_b128 v[224:227], v16 offset:49408
  ds_read_b128 v[228:231], v2 offset:49408
  ds_read_b128 v[232:235], v3 offset:49408
  ds_read_b128 v[236:239], v24 offset:49408
  ds_read_b128 v[240:243], v25 offset:49408
  ds_read_b128 v[244:247], v26 offset:49408
  ds_read_b128 v[248:251], v27 offset:49408
  s_waitcnt lgkmcnt(14)
  ds_read_b128 v[252:255], v28 offset:49408
  s_waitcnt lgkmcnt(0)
  s_waitcnt vmcnt(4) lgkmcnt(0)
  s_barrier
  s_add_u32 s43, s48, 1835008
  s_add_u32 m0, s33, 49152
  s_and_b32 s43, s43, 0x3fffff
  buffer_load_dwordx4 v8, s[12:15], s43 offen lds
  buffer_load_dwordx4 v9, s[12:15], s43 offen offset:1024 lds
  buffer_load_dwordx4 v10, s[12:15], s43 offen offset:2048 lds
  buffer_load_dwordx4 v11, s[12:15], s43 offen offset:3072 lds
  s_add_u32 s43, s48, 2097152
  s_add_u32 m0, s33, 16384
  s_and_b32 s43, s43, 0x3fffff
  buffer_load_dwordx4 v8, s[12:15], s43 offen lds
  buffer_load_dwordx4 v9, s[12:15], s43 offen offset:1024 lds
  buffer_load_dwordx4 v10, s[12:15], s43 offen offset:2048 lds
  buffer_load_dwordx4 v11, s[12:15], s43 offen offset:3072 lds
  s_add_u32 s43, s48, 2359296
  s_add_u32 m0, s33, 65536
  s_and_b32 s43, s43, 0x3fffff
  buffer_load_dwordx4 v8, s[12:15], s43 offen lds
  buffer_load_dwordx4 v9, s[12:15], s43 offen offset:1024 lds
  buffer_load_dwordx4 v10, s[12:15], s43 offen offset:2048 lds
  buffer_load_dwordx4 v11, s[12:15], s43 offen offset:3072 lds
  s_add_u32 s43, s48, 2621440
  s_add_u32 m0, s33, 32768
  s_and_b32 s43, s43, 0x3fffff
  buffer_load_dwordx4 v8, s[12:15], s43 offen lds
  buffer_load_dwordx4 v9, s[12:15], s43 offen offset:1024 lds
  buffer_load_dwordx4 v10, s[12:15], s43 offen offset:2048 lds
  buffer_load_dwordx4 v11, s[12:15], s43 offen offset:3072 lds
  s_waitcnt vmcnt(16) lgkmcnt(0)
  s_barrier
  s_add_u32 s43, s48, 2883584
  s_add_u32 m0, s33, 81920
  s_and_b32 s43, s43, 0x3fffff
  buffer_load_dwordx4 v8, s[12:15], s43 offen lds
  buffer_load_dwordx4 v9, s[12:15], s43 offen offset:1024 lds
  buffer_load_dwordx4 v10, s[12:15], s43 offen offset:2048 lds
  buffer_load_dwordx4 v11, s[12:15], s43 offen offset:3072 lds
  s_add_u32 s43, s48, 3145728
  s_add_u32 m0, s33, 147456
  s_and_b32 s43, s43, 0x3fffff
  buffer_load_dwordx4 v8, s[12:15], s43 offen lds
  buffer_load_dwordx4 v9, s[12:15], s43 offen offset:1024 lds
  buffer_load_dwordx4 v10, s[12:15], s43 offen offset:2048 lds
  buffer_load_dwordx4 v11, s[12:15], s43 offen offset:3072 lds
  s_add_u32 s43, s48, 3407872
  s_add_u32 m0, s33, 131072
  s_and_b32 s43, s43, 0x3fffff
  buffer_load_dwordx4 v8, s[12:15], s43 offen lds
  buffer_load_dwordx4 v9, s[12:15], s43 offen offset:1024 lds
  buffer_load_dwordx4 v10, s[12:15], s43 offen offset:2048 lds
  buffer_load_dwordx4 v11, s[12:15], s43 offen offset:3072 lds
  s_add_u32 s43, s48, 3670016
  s_add_u32 m0, s33, 114688
  s_and_b32 s43, s43, 0x3fffff
  buffer_load_dwordx4 v8, s[12:15], s43 offen lds
  buffer_load_dwordx4 v9, s[12:15], s43 offen offset:1024 lds
  buffer_load_dwordx4 v10, s[12:15], s43 offen offset:2048 lds
  buffer_load_dwordx4 v11, s[12:15], s43 offen offset:3072 lds
  s_waitcnt vmcnt(28) lgkmcnt(0)
  s_barrier
  s_add_u32 s43, s48, 3932160
  s_add_u32 m0, s33, 98304
  s_and_b32 s43, s43, 0x3fffff
  buffer_load_dwordx4 v8, s[12:15], s43 offen lds
  buffer_load_dwordx4 v9, s[12:15], s43 offen offset:1024 lds
  buffer_load_dwordx4 v10, s[12:15], s43 offen offset:2048 lds
  buffer_load_dwordx4 v11, s[12:15], s43 offen offset:3072 lds
  s_waitcnt vmcnt(28) lgkmcnt(0)
  s_barrier
  s_waitcnt vmcnt(24) lgkmcnt(0)
  s_barrier
  s_waitcnt vmcnt(20) lgkmcnt(0)
  s_barrier
  s_waitcnt vmcnt(16) lgkmcnt(0)
  s_barrier
  s_waitcnt vmcnt(12) lgkmcnt(0)
  s_barrier
  s_waitcnt vmcnt(8) lgkmcnt(0)
  s_barrier
  s_waitcnt vmcnt(4) lgkmcnt(0)
  s_barrier
  s_waitcnt vmcnt(0) lgkmcnt(0)
  s_barrier
  s_waitcnt lgkmcnt(0)
  s_barrier
  s_add_u32 s43, s48, 512
  s_add_u32 m0, s33, 147456
  s_and_b32 s43, s43, 0x3fffff
  buffer_load_dwordx4 v8, s[12:15], s43 offen lds
  buffer_load_dwordx4 v9, s[12:15], s43 offen offset:1024 lds
  buffer_load_dwordx4 v10, s[12:15], s43 offen offset:2048 lds
  buffer_load_dwordx4 v11, s[12:15], s43 offen offset:3072 lds
  s_waitcnt lgkmcnt(0)
  s_barrier
  s_add_u32 s43, s48, 262656
  s_add_u32 m0, s33, 131072
  s_and_b32 s43, s43, 0x3fffff
  buffer_load_dwordx4 v8, s[12:15], s43 offen lds
  buffer_load_dwordx4 v9, s[12:15], s43 offen offset:1024 lds
  buffer_load_dwordx4 v10, s[12:15], s43 offen offset:2048 lds
  buffer_load_dwordx4 v11, s[12:15], s43 offen offset:3072 lds
  s_add_u32 s43, s48, 524800
  s_add_u32 m0, s33, 114688
  s_and_b32 s43, s43, 0x3fffff
  buffer_load_dwordx4 v8, s[12:15], s43 offen lds
  buffer_load_dwordx4 v9, s[12:15], s43 offen offset:1024 lds
  buffer_load_dwordx4 v10, s[12:15], s43 offen offset:2048 lds
  buffer_load_dwordx4 v11, s[12:15], s43 offen offset:3072 lds
  s_waitcnt vmcnt(8) lgkmcnt(0)
  s_barrier
  v_add_u32 v20, 147456, v15
  v_xor_b32 v21, 64, v20
  v_xor_b32 v22, 128, v20
  v_xor_b32 v23, 192, v20
  ds_read_b64_tr_b16 v[32:33], v20 offset:0
  ds_read_b64_tr_b16 v[34:35], v20 offset:2048
  s_add_u32 s43, s48, 786944
  s_add_u32 m0, s33, 98304
  s_and_b32 s43, s43, 0x3fffff
  buffer_load_dwordx4 v8, s[12:15], s43 offen lds
  buffer_load_dwordx4 v9, s[12:15], s43 offen offset:1024 lds
  ds_read_b64_tr_b16 v[36:37], v21 offset:0
  ds_read_b64_tr_b16 v[38:39], v21 offset:2048
  buffer_load_dwordx4 v10, s[12:15], s43 offen offset:2048 lds
  buffer_load_dwordx4 v11, s[12:15], s43 offen offset:3072 lds
  ds_read_b64_tr_b16 v[40:41], v22 offset:0
  ds_read_b64_tr_b16 v[42:43], v22 offset:2048
  s_add_u32 m0, s39, 0
  s_add_u32 s43, s42, 16384
  s_and_b32 s43, s43, 0x1ffff
  s_add_u32 s43, s43, s37
  buffer_load_dwordx4 v4, s[8:11], s43 offen nt lds
  buffer_load_dwordx4 v5, s[8:11], s43 offen offset:1024 nt lds
  ds_read_b64_tr_b16 v[44:45], v23 offset:0
  ds_read_b64_tr_b16 v[46:47], v23 offset:2048
  buffer_load_dwordx4 v6, s[8:11], s43 offen offset:2048 nt lds
  buffer_load_dwordx4 v7, s[8:11], s43 offen offset:3072 nt lds
  ds_read_b64_tr_b16 v[48:49], v20 offset:8192
  ds_read_b64_tr_b16 v[50:51], v20 offset:10240
  s_add_u32 m0, s39, 4096
  s_add_u32 s43, s42, 20480
  s_and_b32 s43, s43, 0x1ffff
  s_add_u32 s43, s43, s37
  buffer_load_dwordx4 v4, s[8:11], s43 offen nt lds
  buffer_load_dwordx4 v5, s[8:11], s43 offen offset:1024 nt lds
  ds_read_b64_tr_b16 v[52:53], v21 offset:8192
  ds_read_b64_tr_b16 v[54:55], v21 offset:10240
  buffer_load_dwordx4 v6, s[8:11], s43 offen offset:2048 nt lds
  buffer_load_dwordx4 v7, s[8:11], s43 offen offset:3072 nt lds
  ds_read_b64_tr_b16 v[56:57], v22 offset:8192
  ds_read_b64_tr_b16 v[58:59], v22 offset:10240
  ds_read_b64_tr_b16 v[60:61], v23 offset:8192
  s_waitcnt lgkmcnt(14)
  ds_read_b64_tr_b16 v[62:63], v23 offset:10240
  s_waitcnt vmcnt(12) lgkmcnt(0)
  s_barrier
  v_add_u32 v20, 131072, v15
  v_xor_b32 v21, 64, v20
  v_xor_b32 v22, 128, v20
  v_xor_b32 v23, 192, v20
  v_mfma_f32_32x32x16_bf16 v[64:79], v[32:35], v[128:131], 0
  ds_read_b64_tr_b16 v[32:33], v20 offset:0
  ds_read_b64_tr_b16 v[34:35], v20 offset:2048
  s_add_u32 s43, s48, 1049088
  s_add_u32 m0, s33, 147456
  s_and_b32 s43, s43, 0x3fffff
  buffer_load_dwordx4 v8, s[12:15], s43 offen lds
  v_mfma_f32_32x32x16_bf16 v[80:95], v[36:39], v[128:131], 0
  ds_read_b64_tr_b16 v[36:37], v21 offset:0
  ds_read_b64_tr_b16 v[38:39], v21 offset:2048
  buffer_load_dwordx4 v9, s[12:15], s43 offen offset:1024 lds
  v_mfma_f32_32x32x16_bf16 v[96:111], v[40:43], v[128:131], 0
  ds_read_b64_tr_b16 v[40:41], v22 offset:0
  ds_read_b64_tr_b16 v[42:43], v22 offset:2048
  buffer_load_dwordx4 v10, s[12:15], s43 offen offset:2048 lds
  v_mfma_f32_32x32x16_bf16 v[112:127], v[44:47], v[128:131], 0
  ds_read_b64_tr_b16 v[44:45], v23 offset:0
  ds_read_b64_tr_b16 v[46:47], v23 offset:2048
  buffer_load_dwordx4 v11, s[12:15], s43 offen offset:3072 lds
  v_mfma_f32_32x32x16_bf16 v[64:79], v[48:51], v[132:135], v[64:79]
  ds_read_b64_tr_b16 v[48:49], v20 offset:8192
  ds_read_b64_tr_b16 v[50:51], v20 offset:10240
  s_add_u32 m0, s39, 16384
  s_add_u32 s43, s42, 24576
  s_and_b32 s43, s43, 0x1ffff
  s_add_u32 s43, s43, s37
  buffer_load_dwordx4 v4, s[8:11], s43 offen nt lds
  v_mfma_f32_32x32x16_bf16 v[80:95], v[52:55], v[132:135], v[80:95]
  ds_read_b64_tr_b16 v[52:53], v21 offset:8192
  ds_read_b64_tr_b16 v[54:55], v21 offset:10240
  buffer_load_dwordx4 v5, s[8:11], s43 offen offset:1024 nt lds
  v_mfma_f32_32x32x16_bf16 v[96:111], v[56:59], v[132:135], v[96:111]
  ds_read_b64_tr_b16 v[56:57], v22 offset:8192
  ds_read_b64_tr_b16 v[58:59], v22 offset:10240
  v_mfma_f32_32x32x16_bf16 v[112:127], v[60:63], v[132:135], v[112:127]
  ds_read_b64_tr_b16 v[60:61], v23 offset:8192
  s_waitcnt lgkmcnt(14)
  ds_read_b64_tr_b16 v[62:63], v23 offset:10240
  v_add_u32 v20, 114688, v15
  v_xor_b32 v21, 64, v20
  v_xor_b32 v22, 128, v20
  v_xor_b32 v23, 192, v20
  s_waitcnt lgkmcnt(14)
  v_mfma_f32_32x32x16_bf16 v[64:79], v[32:35], v[136:139], v[64:79]
  ds_read_b64_tr_b16 v[32:33], v20 offset:0
  s_waitcnt lgkmcnt(14)
  ds_read_b64_tr_b16 v[34:35], v20 offset:2048
  buffer_load_dwordx4 v6, s[8:11], s43 offen offset:2048 nt lds
  s_waitcnt lgkmcnt(14)
  v_mfma_f32_32x32x16_bf16 v[80:95], v[36:39], v[136:139], v[80:95]
  ds_read_b64_tr_b16 v[36:37], v21 offset:0
  s_waitcnt lgkmcnt(14)
  ds_read_b64_tr_b16 v[38:39], v21 offset:2048
  buffer_load_dwordx4 v7, s[8:11], s43 offen offset:3072 nt lds
  s_waitcnt lgkmcnt(14)
  v_mfma_f32_32x32x16_bf16 v[96:111], v[40:43], v[136:139], v[96:111]
  ds_read_b64_tr_b16 v[40:41], v22 offset:0
  s_waitcnt lgkmcnt(14)
  ds_read_b64_tr_b16 v[42:43], v22 offset:2048
  s_add_u32 m0, s39, 20480
  s_add_u32 s43, s42, 28672
  s_and_b32 s43, s43, 0x1ffff
  s_add_u32 s43, s43, s37
  buffer_load_dwordx4 v4, s[8:11], s43 offen nt lds
  s_waitcnt lgkmcnt(14)
  v_mfma_f32_32x32x16_bf16 v[112:127], v[44:47], v[136:139], v[112:127]
  ds_read_b64_tr_b16 v[44:45], v23 offset:0
  s_waitcnt lgkmcnt(14)
  ds_read_b64_tr_b16 v[46:47], v23 offset:2048
  buffer_load_dwordx4 v5, s[8:11], s43 offen offset:1024 nt lds
  s_waitcnt lgkmcnt(14)
  v_mfma_f32_32x32x16_bf16 v[64:79], v[48:51], v[140:143], v[64:79]
  ds_read_b64_tr_b16 v[48:49], v20 offset:8192
  s_waitcnt lgkmcnt(14)
  ds_read_b64_tr_b16 v[50:51], v20 offset:10240
  buffer_load_dwordx4 v6, s[8:11], s43 offen offset:2048 nt lds
  s_waitcnt lgkmcnt(14)
  v_mfma_f32_32x32x16_bf16 v[80:95], v[52:55], v[140:143], v[80:95]
  ds_read_b64_tr_b16 v[52:53], v21 offset:8192
  s_waitcnt lgkmcnt(14)
  ds_read_b64_tr_b16 v[54:55], v21 offset:10240
  buffer_load_dwordx4 v7, s[8:11], s43 offen offset:3072 nt lds
  s_waitcnt lgkmcnt(14)
  v_mfma_f32_32x32x16_bf16 v[96:111], v[56:59], v[140:143], v[96:111]
  ds_read_b64_tr_b16 v[56:57], v22 offset:8192
  s_waitcnt lgkmcnt(14)
  ds_read_b64_tr_b16 v[58:59], v22 offset:10240
  s_waitcnt lgkmcnt(14)
  v_mfma_f32_32x32x16_bf16 v[112:127], v[60:63], v[140:143], v[112:127]
  ds_read_b64_tr_b16 v[60:61], v23 offset:8192
  s_waitcnt lgkmcnt(14)
  ds_read_b64_tr_b16 v[62:63], v23 offset:10240
  s_waitcnt vmcnt(8) lgkmcnt(0)
  s_barrier
  v_add_u32 v20, 98304, v15
  v_xor_b32 v21, 64, v20
  v_xor_b32 v22, 128, v20
  v_xor_b32 v23, 192, v20
  v_mfma_f32_32x32x16_bf16 v[64:79], v[32:35], v[144:147], v[64:79]
  ds_read_b64_tr_b16 v[32:33], v20 offset:0
  ds_read_b64_tr_b16 v[34:35], v20 offset:2048
  s_add_u32 s43, s48, 1311232
  s_add_u32 m0, s33, 131072
  s_and_b32 s43, s43, 0x3fffff
  buffer_load_dwordx4 v8, s[12:15], s43 offen lds
  v_mfma_f32_32x32x16_bf16 v[80:95], v[36:39], v[144:147], v[80:95]
  ds_read_b64_tr_b16 v[36:37], v21 offset:0
  ds_read_b64_tr_b16 v[38:39], v21 offset:2048
  buffer_load_dwordx4 v9, s[12:15], s43 offen offset:1024 lds
  v_mfma_f32_32x32x16_bf16 v[96:111], v[40:43], v[144:147], v[96:111]
  ds_read_b64_tr_b16 v[40:41], v22 offset:0
  ds_read_b64_tr_b16 v[42:43], v22 offset:2048
  buffer_load_dwordx4 v10, s[12:15], s43 offen offset:2048 lds
  v_mfma_f32_32x32x16_bf16 v[112:127], v[44:47], v[144:147], v[112:127]
  ds_read_b64_tr_b16 v[44:45], v23 offset:0
  ds_read_b64_tr_b16 v[46:47], v23 offset:2048
  buffer_load_dwordx4 v11, s[12:15], s43 offen offset:3072 lds
  v_mfma_f32_32x32x16_bf16 v[64:79], v[48:51], v[148:151], v[64:79]
  ds_read_b64_tr_b16 v[48:49], v20 offset:8192
  ds_read_b64_tr_b16 v[50:51], v20 offset:10240
  s_add_u32 s43, s48, 1573376
  s_add_u32 m0, s33, 114688
  s_and_b32 s43, s43, 0x3fffff
  buffer_load_dwordx4 v8, s[12:15], s43 offen lds
  v_mfma_f32_32x32x16_bf16 v[80:95], v[52:55], v[148:151], v[80:95]
  ds_read_b64_tr_b16 v[52:53], v21 offset:8192
  ds_read_b64_tr_b16 v[54:55], v21 offset:10240
  buffer_load_dwordx4 v9, s[12:15], s43 offen offset:1024 lds
  v_mfma_f32_32x32x16_bf16 v[96:111], v[56:59], v[148:151], v[96:111]
  ds_read_b64_tr_b16 v[56:57], v22 offset:8192
  ds_read_b64_tr_b16 v[58:59], v22 offset:10240
  buffer_load_dwordx4 v10, s[12:15], s43 offen offset:2048 lds
  v_mfma_f32_32x32x16_bf16 v[112:127], v[60:63], v[148:151], v[112:127]
  ds_read_b64_tr_b16 v[60:61], v23 offset:8192
  s_waitcnt lgkmcnt(14)
  ds_read_b64_tr_b16 v[62:63], v23 offset:10240
  buffer_load_dwordx4 v11, s[12:15], s43 offen offset:3072 lds
  v_add_u32 v20, 147456, v15
  v_xor_b32 v21, 64, v20
  v_xor_b32 v22, 128, v20
  v_xor_b32 v23, 192, v20
  s_waitcnt lgkmcnt(14)
  v_mfma_f32_32x32x16_bf16 v[64:79], v[32:35], v[152:155], v[64:79]
  ds_read_b64_tr_b16 v[32:33], v20 offset:0
  s_waitcnt lgkmcnt(14)
  ds_read_b64_tr_b16 v[34:35], v20 offset:2048
  s_add_u32 m0, s39, 32768
  s_add_u32 s43, s42, 32768
  s_and_b32 s43, s43, 0x1ffff
  s_add_u32 s43, s43, s37
  buffer_load_dwordx4 v4, s[8:11], s43 offen nt lds
  s_waitcnt lgkmcnt(14)
  v_mfma_f32_32x32x16_bf16 v[80:95], v[36:39], v[152:155], v[80:95]
  ds_read_b64_tr_b16 v[36:37], v21 offset:0
  s_waitcnt lgkmcnt(14)
  ds_read_b64_tr_b16 v[38:39], v21 offset:2048
  buffer_load_dwordx4 v5, s[8:11], s43 offen offset:1024 nt lds
  s_waitcnt lgkmcnt(14)
  v_mfma_f32_32x32x16_bf16 v[96:111], v[40:43], v[152:155], v[96:111]
  ds_read_b64_tr_b16 v[40:41], v22 offset:0
  s_waitcnt lgkmcnt(14)
  ds_read_b64_tr_b16 v[42:43], v22 offset:2048
  buffer_load_dwordx4 v6, s[8:11], s43 offen offset:2048 nt lds
  s_waitcnt lgkmcnt(14)
  v_mfma_f32_32x32x16_bf16 v[112:127], v[44:47], v[152:155], v[112:127]
  ds_read_b64_tr_b16 v[44:45], v23 offset:0
  s_waitcnt lgkmcnt(14)
  ds_read_b64_tr_b16 v[46:47], v23 offset:2048
  buffer_load_dwordx4 v7, s[8:11], s43 offen offset:3072 nt lds
  s_waitcnt lgkmcnt(14)
  v_mfma_f32_32x32x16_bf16 v[64:79], v[48:51], v[156:159], v[64:79]
  ds_read_b64_tr_b16 v[48:49], v20 offset:8192
  s_waitcnt lgkmcnt(14)
  ds_read_b64_tr_b16 v[50:51], v20 offset:10240
  s_add_u32 m0, s39, 36864
  s_add_u32 s43, s42, 36864
  s_and_b32 s43, s43, 0x1ffff
  s_add_u32 s43, s43, s37
  buffer_load_dwordx4 v4, s[8:11], s43 offen nt lds
  s_waitcnt lgkmcnt(14)
  v_mfma_f32_32x32x16_bf16 v[80:95], v[52:55], v[156:159], v[80:95]
  ds_read_b64_tr_b16 v[52:53], v21 offset:8192
  s_waitcnt lgkmcnt(14)
  ds_read_b64_tr_b16 v[54:55], v21 offset:10240
  buffer_load_dwordx4 v5, s[8:11], s43 offen offset:1024 nt lds
  s_waitcnt lgkmcnt(14)
  v_mfma_f32_32x32x16_bf16 v[96:111], v[56:59], v[156:159], v[96:111]
  ds_read_b64_tr_b16 v[56:57], v22 offset:8192
  s_waitcnt lgkmcnt(14)
  ds_read_b64_tr_b16 v[58:59], v22 offset:10240
  buffer_load_dwordx4 v6, s[8:11], s43 offen offset:2048 nt lds
  s_waitcnt lgkmcnt(14)
  v_mfma_f32_32x32x16_bf16 v[112:127], v[60:63], v[156:159], v[112:127]
  ds_read_b64_tr_b16 v[60:61], v23 offset:8192
  s_waitcnt lgkmcnt(14)
  ds_read_b64_tr_b16 v[62:63], v23 offset:10240
  buffer_load_dwordx4 v7, s[8:11], s43 offen offset:3072 nt lds
  s_waitcnt vmcnt(8) lgkmcnt(0)
  s_barrier
  v_add_u32 v20, 131072, v15
  v_xor_b32 v21, 64, v20
  v_xor_b32 v22, 128, v20
  v_xor_b32 v23, 192, v20
  v_mfma_f32_32x32x16_bf16 v[64:79], v[32:35], v[160:163], v[64:79]
  ds_read_b64_tr_b16 v[32:33], v20 offset:0
  ds_read_b64_tr_b16 v[34:35], v20 offset:2048
  s_add_u32 s43, s48, 1835520
  s_add_u32 m0, s33, 147456
  s_and_b32 s43, s43, 0x3fffff
  buffer_load_dwordx4 v8, s[12:15], s43 offen lds
  v_mfma_f32_32x32x16_bf16 v[80:95], v[36:39], v[160:163], v[80:95]
  ds_read_b64_tr_b16 v[36:37], v21 offset:0
  ds_read_b64_tr_b16 v[38:39], v21 offset:2048
  buffer_load_dwordx4 v9, s[12:15], s43 offen offset:1024 lds
  v_mfma_f32_32x32x16_bf16 v[96:111], v[40:43], v[160:163], v[96:111]
  ds_read_b64_tr_b16 v[40:41], v22 offset:0
  ds_read_b64_tr_b16 v[42:43], v22 offset:2048
  buffer_load_dwordx4 v10, s[12:15], s43 offen offset:2048 lds
  v_mfma_f32_32x32x16_bf16 v[112:127], v[44:47], v[160:163], v[112:127]
  ds_read_b64_tr_b16 v[44:45], v23 offset:0
  ds_read_b64_tr_b16 v[46:47], v23 offset:2048
  buffer_load_dwordx4 v11, s[12:15], s43 offen offset:3072 lds
  v_mfma_f32_32x32x16_bf16 v[64:79], v[48:51], v[164:167], v[64:79]
  ds_read_b64_tr_b16 v[48:49], v20 offset:8192
  ds_read_b64_tr_b16 v[50:51], v20 offset:10240
  s_add_u32 s43, s48, 2097664
  s_add_u32 m0, s33, 98304
  s_and_b32 s43, s43, 0x3fffff
  buffer_load_dwordx4 v8, s[12:15], s43 offen lds
  v_mfma_f32_32x32x16_bf16 v[80:95], v[52:55], v[164:167], v[80:95]
  ds_read_b64_tr_b16 v[52:53], v21 offset:8192
  ds_read_b64_tr_b16 v[54:55], v21 offset:10240
  buffer_load_dwordx4 v9, s[12:15], s43 offen offset:1024 lds
  v_mfma_f32_32x32x16_bf16 v[96:111], v[56:59], v[164:167], v[96:111]
  ds_read_b64_tr_b16 v[56:57], v22 offset:8192
  ds_read_b64_tr_b16 v[58:59], v22 offset:10240
  buffer_load_dwordx4 v10, s[12:15], s43 offen offset:2048 lds
  v_mfma_f32_32x32x16_bf16 v[112:127], v[60:63], v[164:167], v[112:127]
  ds_read_b64_tr_b16 v[60:61], v23 offset:8192
  s_waitcnt lgkmcnt(14)
  ds_read_b64_tr_b16 v[62:63], v23 offset:10240
  buffer_load_dwordx4 v11, s[12:15], s43 offen offset:3072 lds
  v_add_u32 v20, 114688, v15
  v_xor_b32 v21, 64, v20
  v_xor_b32 v22, 128, v20
  v_xor_b32 v23, 192, v20
  s_waitcnt lgkmcnt(14)
  v_mfma_f32_32x32x16_bf16 v[64:79], v[32:35], v[168:171], v[64:79]
  ds_read_b64_tr_b16 v[32:33], v20 offset:0
  s_waitcnt lgkmcnt(14)
  ds_read_b64_tr_b16 v[34:35], v20 offset:2048
  s_add_u32 m0, s39, 0
  s_add_u32 s43, s42, 40960
  s_and_b32 s43, s43, 0x1ffff
  s_add_u32 s43, s43, s37
  buffer_load_dwordx4 v4, s[8:11], s43 offen nt lds
  s_waitcnt lgkmcnt(14)
  v_mfma_f32_32x32x16_bf16 v[80:95], v[36:39], v[168:171], v[80:95]
  ds_read_b64_tr_b16 v[36:37], v21 offset:0
  s_waitcnt lgkmcnt(14)
  ds_read_b64_tr_b16 v[38:39], v21 offset:2048
  buffer_load_dwordx4 v5, s[8:11], s43 offen offset:1024 nt lds
  s_waitcnt lgkmcnt(14)
  v_mfma_f32_32x32x16_bf16 v[96:111], v[40:43], v[168:171], v[96:111]
  ds_read_b64_tr_b16 v[40:41], v22 offset:0
  s_waitcnt lgkmcnt(14)
  ds_read_b64_tr_b16 v[42:43], v22 offset:2048
  buffer_load_dwordx4 v6, s[8:11], s43 offen offset:2048 nt lds
  s_waitcnt lgkmcnt(14)
  v_mfma_f32_32x32x16_bf16 v[112:127], v[44:47], v[168:171], v[112:127]
  ds_read_b64_tr_b16 v[44:45], v23 offset:0
  s_waitcnt lgkmcnt(14)
  ds_read_b64_tr_b16 v[46:47], v23 offset:2048
  buffer_load_dwordx4 v7, s[8:11], s43 offen offset:3072 nt lds
  s_waitcnt lgkmcnt(14)
  v_mfma_f32_32x32x16_bf16 v[64:79], v[48:51], v[172:175], v[64:79]
  ds_read_b64_tr_b16 v[48:49], v20 offset:8192
  s_waitcnt lgkmcnt(14)
  ds_read_b64_tr_b16 v[50:51], v20 offset:10240
  s_add_u32 m0, s39, 4096
  s_add_u32 s43, s42, 45056
  s_and_b32 s43, s43, 0x1ffff
  s_add_u32 s43, s43, s37
  buffer_load_dwordx4 v4, s[8:11], s43 offen nt lds
  s_waitcnt lgkmcnt(14)
  v_mfma_f32_32x32x16_bf16 v[80:95], v[52:55], v[172:175], v[80:95]
  ds_read_b64_tr_b16 v[52:53], v21 offset:8192
  s_waitcnt lgkmcnt(14)
  ds_read_b64_tr_b16 v[54:55], v21 offset:10240
  buffer_load_dwordx4 v5, s[8:11], s43 offen offset:1024 nt lds
  s_waitcnt lgkmcnt(14)
  v_mfma_f32_32x32x16_bf16 v[96:111], v[56:59], v[172:175], v[96:111]
  ds_read_b64_tr_b16 v[56:57], v22 offset:8192
  s_waitcnt lgkmcnt(14)
  ds_read_b64_tr_b16 v[58:59], v22 offset:10240
  buffer_load_dwordx4 v6, s[8:11], s43 offen offset:2048 nt lds
  s_waitcnt lgkmcnt(14)
  v_mfma_f32_32x32x16_bf16 v[112:127], v[60:63], v[172:175], v[112:127]
  ds_read_b64_tr_b16 v[60:61], v23 offset:8192
  s_waitcnt lgkmcnt(14)
  ds_read_b64_tr_b16 v[62:63], v23 offset:10240
  buffer_load_dwordx4 v7, s[8:11], s43 offen offset:3072 nt lds
  s_waitcnt vmcnt(8) lgkmcnt(0)
  s_barrier
  v_add_u32 v20, 147456, v15
  v_xor_b32 v21, 64, v20
  v_xor_b32 v22, 128, v20
  v_xor_b32 v23, 192, v20
  v_mfma_f32_32x32x16_bf16 v[64:79], v[32:35], v[176:179], v[64:79]
  ds_read_b64_tr_b16 v[32:33], v20 offset:0
  ds_read_b64_tr_b16 v[34:35], v20 offset:2048
  s_add_u32 s43, s48, 2359808
  s_add_u32 m0, s33, 131072
  s_and_b32 s43, s43, 0x3fffff
  buffer_load_dwordx4 v8, s[12:15], s43 offen lds
  v_mfma_f32_32x32x16_bf16 v[80:95], v[36:39], v[176:179], v[80:95]
  ds_read_b64_tr_b16 v[36:37], v21 offset:0
  ds_read_b64_tr_b16 v[38:39], v21 offset:2048
  buffer_load_dwordx4 v9, s[12:15], s43 offen offset:1024 lds
  v_mfma_f32_32x32x16_bf16 v[96:111], v[40:43], v[176:179], v[96:111]
  ds_read_b64_tr_b16 v[40:41], v22 offset:0
  ds_read_b64_tr_b16 v[42:43], v22 offset:2048
  buffer_load_dwordx4 v10, s[12:15], s43 offen offset:2048 lds
  v_mfma_f32_32x32x16_bf16 v[112:127], v[44:47], v[176:179], v[112:127]
  ds_read_b64_tr_b16 v[44:45], v23 offset:0
  ds_read_b64_tr_b16 v[46:47], v23 offset:2048
  buffer_load_dwordx4 v11, s[12:15], s43 offen offset:3072 lds
  v_mfma_f32_32x32x16_bf16 v[64:79], v[48:51], v[180:183], v[64:79]
  ds_read_b64_tr_b16 v[48:49], v20 offset:8192
  ds_read_b64_tr_b16 v[50:51], v20 offset:10240
  s_add_u32 s43, s48, 2621952
  s_add_u32 m0, s33, 114688
  s_and_b32 s43, s43, 0x3fffff
  buffer_load_dwordx4 v8, s[12:15], s43 offen lds
  v_mfma_f32_32x32x16_bf16 v[80:95], v[52:55], v[180:183], v[80:95]
  ds_read_b64_tr_b16 v[52:53], v21 offset:8192
  ds_read_b64_tr_b16 v[54:55], v21 offset:10240
  buffer_load_dwordx4 v9, s[12:15], s43 offen offset:1024 lds
  v_mfma_f32_32x32x16_bf16 v[96:111], v[56:59], v[180:183], v[96:111]
  ds_read_b64_tr_b16 v[56:57], v22 offset:8192
  ds_read_b64_tr_b16 v[58:59], v22 offset:10240
  buffer_load_dwordx4 v10, s[12:15], s43 offen offset:2048 lds
  v_mfma_f32_32x32x16_bf16 v[112:127], v[60:63], v[180:183], v[112:127]
  ds_read_b64_tr_b16 v[60:61], v23 offset:8192
  s_waitcnt lgkmcnt(14)
  ds_read_b64_tr_b16 v[62:63], v23 offset:10240
  buffer_load_dwordx4 v11, s[12:15], s43 offen offset:3072 lds
  v_add_u32 v20, 98304, v15
  v_xor_b32 v21, 64, v20
  v_xor_b32 v22, 128, v20
  v_xor_b32 v23, 192, v20
  s_waitcnt lgkmcnt(14)
  v_mfma_f32_32x32x16_bf16 v[64:79], v[32:35], v[184:187], v[64:79]
  ds_read_b64_tr_b16 v[32:33], v20 offset:0
  s_waitcnt lgkmcnt(14)
  ds_read_b64_tr_b16 v[34:35], v20 offset:2048
  s_add_u32 m0, s39, 16384
  s_add_u32 s43, s42, 49152
  s_and_b32 s43, s43, 0x1ffff
  s_add_u32 s43, s43, s37
  buffer_load_dwordx4 v4, s[8:11], s43 offen nt lds
  s_waitcnt lgkmcnt(14)
  v_mfma_f32_32x32x16_bf16 v[80:95], v[36:39], v[184:187], v[80:95]
  ds_read_b64_tr_b16 v[36:37], v21 offset:0
  s_waitcnt lgkmcnt(14)
  ds_read_b64_tr_b16 v[38:39], v21 offset:2048
  buffer_load_dwordx4 v5, s[8:11], s43 offen offset:1024 nt lds
  s_waitcnt lgkmcnt(14)
  v_mfma_f32_32x32x16_bf16 v[96:111], v[40:43], v[184:187], v[96:111]
  ds_read_b64_tr_b16 v[40:41], v22 offset:0
  s_waitcnt lgkmcnt(14)
  ds_read_b64_tr_b16 v[42:43], v22 offset:2048
  buffer_load_dwordx4 v6, s[8:11], s43 offen offset:2048 nt lds
  s_waitcnt lgkmcnt(14)
  v_mfma_f32_32x32x16_bf16 v[112:127], v[44:47], v[184:187], v[112:127]
  ds_read_b64_tr_b16 v[44:45], v23 offset:0
  s_waitcnt lgkmcnt(14)
  ds_read_b64_tr_b16 v[46:47], v23 offset:2048
  buffer_load_dwordx4 v7, s[8:11], s43 offen offset:3072 nt lds
  s_waitcnt lgkmcnt(14)
  v_mfma_f32_32x32x16_bf16 v[64:79], v[48:51], v[188:191], v[64:79]
  ds_read_b64_tr_b16 v[48:49], v20 offset:8192
  s_waitcnt lgkmcnt(14)
  ds_read_b64_tr_b16 v[50:51], v20 offset:10240
  s_add_u32 m0, s39, 20480
  s_add_u32 s43, s42, 53248
  s_and_b32 s43, s43, 0x1ffff
  s_add_u32 s43, s43, s37
  buffer_load_dwordx4 v4, s[8:11], s43 offen nt lds
  s_waitcnt lgkmcnt(14)
  v_mfma_f32_32x32x16_bf16 v[80:95], v[52:55], v[188:191], v[80:95]
  ds_read_b64_tr_b16 v[52:53], v21 offset:8192
  s_waitcnt lgkmcnt(14)
  ds_read_b64_tr_b16 v[54:55], v21 offset:10240
  buffer_load_dwordx4 v5, s[8:11], s43 offen offset:1024 nt lds
  s_waitcnt lgkmcnt(14)
  v_mfma_f32_32x32x16_bf16 v[96:111], v[56:59], v[188:191], v[96:111]
  ds_read_b64_tr_b16 v[56:57], v22 offset:8192
  s_waitcnt lgkmcnt(14)
  ds_read_b64_tr_b16 v[58:59], v22 offset:10240
  buffer_load_dwordx4 v6, s[8:11], s43 offen offset:2048 nt lds
  s_waitcnt lgkmcnt(14)
  v_mfma_f32_32x32x16_bf16 v[112:127], v[60:63], v[188:191], v[112:127]
  ds_read_b64_tr_b16 v[60:61], v23 offset:8192
  s_waitcnt lgkmcnt(14)
  ds_read_b64_tr_b16 v[62:63], v23 offset:10240
  buffer_load_dwordx4 v7, s[8:11], s43 offen offset:3072 nt lds
  s_waitcnt vmcnt(8) lgkmcnt(0)
  s_barrier
  v_add_u32 v20, 131072, v15
  v_xor_b32 v21, 64, v20
  v_xor_b32 v22, 128, v20
  v_xor_b32 v23, 192, v20
  v_mfma_f32_32x32x16_bf16 v[64:79], v[32:35], v[192:195], v[64:79]
  ds_read_b64_tr_b16 v[32:33], v20 offset:0
  ds_read_b64_tr_b16 v[34:35], v20 offset:2048
  s_add_u32 s43, s48, 2884096
  s_add_u32 m0, s33, 147456
  s_and_b32 s43, s43, 0x3fffff
  buffer_load_dwordx4 v8, s[12:15], s43 offen lds
  v_mfma_f32_32x32x16_bf16 v[80:95], v[36:39], v[192:195], v[80:95]
  ds_read_b64_tr_b16 v[36:37], v21 offset:0
  ds_read_b64_tr_b16 v[38:39], v21 offset:2048
  buffer_load_dwordx4 v9, s[12:15], s43 offen offset:1024 lds
  v_mfma_f32_32x32x16_bf16 v[96:111], v[40:43], v[192:195], v[96:111]
  ds_read_b64_tr_b16 v[40:41], v22 offset:0
  ds_read_b64_tr_b16 v[42:43], v22 offset:2048
  buffer_load_dwordx4 v10, s[12:15], s43 offen offset:2048 lds
  v_mfma_f32_32x32x16_bf16 v[112:127], v[44:47], v[192:195], v[112:127]
  ds_read_b64_tr_b16 v[44:45], v23 offset:0
  ds_read_b64_tr_b16 v[46:47], v23 offset:2048
  buffer_load_dwordx4 v11, s[12:15], s43 offen offset:3072 lds
  v_mfma_f32_32x32x16_bf16 v[64:79], v[48:51], v[196:199], v[64:79]
  ds_read_b64_tr_b16 v[48:49], v20 offset:8192
  ds_read_b64_tr_b16 v[50:51], v20 offset:10240
  s_add_u32 s43, s48, 3146240
  s_add_u32 m0, s33, 98304
  s_and_b32 s43, s43, 0x3fffff
  buffer_load_dwordx4 v8, s[12:15], s43 offen lds
  v_mfma_f32_32x32x16_bf16 v[80:95], v[52:55], v[196:199], v[80:95]
  ds_read_b64_tr_b16 v[52:53], v21 offset:8192
  ds_read_b64_tr_b16 v[54:55], v21 offset:10240
  buffer_load_dwordx4 v9, s[12:15], s43 offen offset:1024 lds
  v_mfma_f32_32x32x16_bf16 v[96:111], v[56:59], v[196:199], v[96:111]
  ds_read_b64_tr_b16 v[56:57], v22 offset:8192
  ds_read_b64_tr_b16 v[58:59], v22 offset:10240
  buffer_load_dwordx4 v10, s[12:15], s43 offen offset:2048 lds
  v_mfma_f32_32x32x16_bf16 v[112:127], v[60:63], v[196:199], v[112:127]
  ds_read_b64_tr_b16 v[60:61], v23 offset:8192
  s_waitcnt lgkmcnt(14)
  ds_read_b64_tr_b16 v[62:63], v23 offset:10240
  buffer_load_dwordx4 v11, s[12:15], s43 offen offset:3072 lds
  v_add_u32 v20, 114688, v15
  v_xor_b32 v21, 64, v20
  v_xor_b32 v22, 128, v20
  v_xor_b32 v23, 192, v20
  s_waitcnt lgkmcnt(14)
  v_mfma_f32_32x32x16_bf16 v[64:79], v[32:35], v[200:203], v[64:79]
  ds_read_b64_tr_b16 v[32:33], v20 offset:0
  s_waitcnt lgkmcnt(14)
  ds_read_b64_tr_b16 v[34:35], v20 offset:2048
  s_add_u32 m0, s39, 32768
  s_add_u32 s43, s42, 57344
  s_and_b32 s43, s43, 0x1ffff
  s_add_u32 s43, s43, s37
  buffer_load_dwordx4 v4, s[8:11], s43 offen nt lds
  s_waitcnt lgkmcnt(14)
  v_mfma_f32_32x32x16_bf16 v[80:95], v[36:39], v[200:203], v[80:95]
  ds_read_b64_tr_b16 v[36:37], v21 offset:0
  s_waitcnt lgkmcnt(14)
  ds_read_b64_tr_b16 v[38:39], v21 offset:2048
  buffer_load_dwordx4 v5, s[8:11], s43 offen offset:1024 nt lds
  s_waitcnt lgkmcnt(14)
  v_mfma_f32_32x32x16_bf16 v[96:111], v[40:43], v[200:203], v[96:111]
  ds_read_b64_tr_b16 v[40:41], v22 offset:0
  s_waitcnt lgkmcnt(14)
  ds_read_b64_tr_b16 v[42:43], v22 offset:2048
  buffer_load_dwordx4 v6, s[8:11], s43 offen offset:2048 nt lds
  s_waitcnt lgkmcnt(14)
  v_mfma_f32_32x32x16_bf16 v[112:127], v[44:47], v[200:203], v[112:127]
  ds_read_b64_tr_b16 v[44:45], v23 offset:0
  s_waitcnt lgkmcnt(14)
  ds_read_b64_tr_b16 v[46:47], v23 offset:2048
  buffer_load_dwordx4 v7, s[8:11], s43 offen offset:3072 nt lds
  s_waitcnt lgkmcnt(14)
  v_mfma_f32_32x32x16_bf16 v[64:79], v[48:51], v[204:207], v[64:79]
  ds_read_b64_tr_b16 v[48:49], v20 offset:8192
  s_waitcnt lgkmcnt(14)
  ds_read_b64_tr_b16 v[50:51], v20 offset:10240
  s_add_u32 m0, s39, 36864
  s_add_u32 s43, s42, 61440
  s_and_b32 s43, s43, 0x1ffff
  s_add_u32 s43, s43, s37
  buffer_load_dwordx4 v4, s[8:11], s43 offen nt lds
  s_waitcnt lgkmcnt(14)
  v_mfma_f32_32x32x16_bf16 v[80:95], v[52:55], v[204:207], v[80:95]
  ds_read_b64_tr_b16 v[52:53], v21 offset:8192
  s_waitcnt lgkmcnt(14)
  ds_read_b64_tr_b16 v[54:55], v21 offset:10240
  buffer_load_dwordx4 v5, s[8:11], s43 offen offset:1024 nt lds
  s_waitcnt lgkmcnt(14)
  v_mfma_f32_32x32x16_bf16 v[96:111], v[56:59], v[204:207], v[96:111]
  ds_read_b64_tr_b16 v[56:57], v22 offset:8192
  s_waitcnt lgkmcnt(14)
  ds_read_b64_tr_b16 v[58:59], v22 offset:10240
  buffer_load_dwordx4 v6, s[8:11], s43 offen offset:2048 nt lds
  s_waitcnt lgkmcnt(14)
  v_mfma_f32_32x32x16_bf16 v[112:127], v[60:63], v[204:207], v[112:127]
  ds_read_b64_tr_b16 v[60:61], v23 offset:8192
  s_waitcnt lgkmcnt(14)
  ds_read_b64_tr_b16 v[62:63], v23 offset:10240
  buffer_load_dwordx4 v7, s[8:11], s43 offen offset:3072 nt lds
  s_waitcnt vmcnt(8) lgkmcnt(0)
  s_barrier
  v_add_u32 v20, 147456, v15
  v_xor_b32 v21, 64, v20
  v_xor_b32 v22, 128, v20
  v_xor_b32 v23, 192, v20
  v_mfma_f32_32x32x16_bf16 v[64:79], v[32:35], v[208:211], v[64:79]
  ds_read_b64_tr_b16 v[32:33], v20 offset:0
  ds_read_b64_tr_b16 v[34:35], v20 offset:2048
  s_add_u32 s43, s48, 3408384
  s_add_u32 m0, s33, 131072
  s_and_b32 s43, s43, 0x3fffff
  buffer_load_dwordx4 v8, s[12:15], s43 offen lds
  v_mfma_f32_32x32x16_bf16 v[80:95], v[36:39], v[208:211], v[80:95]
  ds_read_b64_tr_b16 v[36:37], v21 offset:0
  ds_read_b64_tr_b16 v[38:39], v21 offset:2048
  buffer_load_dwordx4 v9, s[12:15], s43 offen offset:1024 lds
  v_mfma_f32_32x32x16_bf16 v[96:111], v[40:43], v[208:211], v[96:111]
  ds_read_b64_tr_b16 v[40:41], v22 offset:0
  ds_read_b64_tr_b16 v[42:43], v22 offset:2048
  buffer_load_dwordx4 v10, s[12:15], s43 offen offset:2048 lds
  v_mfma_f32_32x32x16_bf16 v[112:127], v[44:47], v[208:211], v[112:127]
  ds_read_b64_tr_b16 v[44:45], v23 offset:0
  ds_read_b64_tr_b16 v[46:47], v23 offset:2048
  buffer_load_dwordx4 v11, s[12:15], s43 offen offset:3072 lds
  v_mfma_f32_32x32x16_bf16 v[64:79], v[48:51], v[212:215], v[64:79]
  ds_read_b64_tr_b16 v[48:49], v20 offset:8192
  ds_read_b64_tr_b16 v[50:51], v20 offset:10240
  s_add_u32 s43, s48, 3670528
  s_add_u32 m0, s33, 114688
  s_and_b32 s43, s43, 0x3fffff
  buffer_load_dwordx4 v8, s[12:15], s43 offen lds
  v_mfma_f32_32x32x16_bf16 v[80:95], v[52:55], v[212:215], v[80:95]
  ds_read_b64_tr_b16 v[52:53], v21 offset:8192
  ds_read_b64_tr_b16 v[54:55], v21 offset:10240
  buffer_load_dwordx4 v9, s[12:15], s43 offen offset:1024 lds
  v_mfma_f32_32x32x16_bf16 v[96:111], v[56:59], v[212:215], v[96:111]
  ds_read_b64_tr_b16 v[56:57], v22 offset:8192
  ds_read_b64_tr_b16 v[58:59], v22 offset:10240
  buffer_load_dwordx4 v10, s[12:15], s43 offen offset:2048 lds
  v_mfma_f32_32x32x16_bf16 v[112:127], v[60:63], v[212:215], v[112:127]
  ds_read_b64_tr_b16 v[60:61], v23 offset:8192
  s_waitcnt lgkmcnt(14)
  ds_read_b64_tr_b16 v[62:63], v23 offset:10240
  buffer_load_dwordx4 v11, s[12:15], s43 offen offset:3072 lds
  v_add_u32 v20, 98304, v15
  v_xor_b32 v21, 64, v20
  v_xor_b32 v22, 128, v20
  v_xor_b32 v23, 192, v20
  s_waitcnt lgkmcnt(14)
  v_mfma_f32_32x32x16_bf16 v[64:79], v[32:35], v[216:219], v[64:79]
  ds_read_b64_tr_b16 v[32:33], v20 offset:0
  s_waitcnt lgkmcnt(14)
  ds_read_b64_tr_b16 v[34:35], v20 offset:2048
  s_add_u32 m0, s39, 0
  s_add_u32 s43, s42, 65536
  s_and_b32 s43, s43, 0x1ffff
  s_add_u32 s43, s43, s37
  buffer_load_dwordx4 v4, s[8:11], s43 offen nt lds
  s_waitcnt lgkmcnt(14)
  v_mfma_f32_32x32x16_bf16 v[80:95], v[36:39], v[216:219], v[80:95]
  ds_read_b64_tr_b16 v[36:37], v21 offset:0
  s_waitcnt lgkmcnt(14)
  ds_read_b64_tr_b16 v[38:39], v21 offset:2048
  buffer_load_dwordx4 v5, s[8:11], s43 offen offset:1024 nt lds
  s_waitcnt lgkmcnt(14)
  v_mfma_f32_32x32x16_bf16 v[96:111], v[40:43], v[216:219], v[96:111]
  ds_read_b64_tr_b16 v[40:41], v22 offset:0
  s_waitcnt lgkmcnt(14)
  ds_read_b64_tr_b16 v[42:43], v22 offset:2048
  buffer_load_dwordx4 v6, s[8:11], s43 offen offset:2048 nt lds
  s_waitcnt lgkmcnt(14)
  v_mfma_f32_32x32x16_bf16 v[112:127], v[44:47], v[216:219], v[112:127]
  ds_read_b64_tr_b16 v[44:45], v23 offset:0
  s_waitcnt lgkmcnt(14)
  ds_read_b64_tr_b16 v[46:47], v23 offset:2048
  buffer_load_dwordx4 v7, s[8:11], s43 offen offset:3072 nt lds
  s_waitcnt lgkmcnt(14)
  v_mfma_f32_32x32x16_bf16 v[64:79], v[48:51], v[220:223], v[64:79]
  ds_read_b64_tr_b16 v[48:49], v20 offset:8192
  s_waitcnt lgkmcnt(14)
  ds_read_b64_tr_b16 v[50:51], v20 offset:10240
  s_add_u32 m0, s39, 4096
  s_add_u32 s43, s42, 69632
  s_and_b32 s43, s43, 0x1ffff
  s_add_u32 s43, s43, s37
  buffer_load_dwordx4 v4, s[8:11], s43 offen nt lds
  s_waitcnt lgkmcnt(14)
  v_mfma_f32_32x32x16_bf16 v[80:95], v[52:55], v[220:223], v[80:95]
  ds_read_b64_tr_b16 v[52:53], v21 offset:8192
  s_waitcnt lgkmcnt(14)
  ds_read_b64_tr_b16 v[54:55], v21 offset:10240
  buffer_load_dwordx4 v5, s[8:11], s43 offen offset:1024 nt lds
  s_waitcnt lgkmcnt(14)
  v_mfma_f32_32x32x16_bf16 v[96:111], v[56:59], v[220:223], v[96:111]
  ds_read_b64_tr_b16 v[56:57], v22 offset:8192
  s_waitcnt lgkmcnt(14)
  ds_read_b64_tr_b16 v[58:59], v22 offset:10240
  buffer_load_dwordx4 v6, s[8:11], s43 offen offset:2048 nt lds
  s_waitcnt lgkmcnt(14)
  v_mfma_f32_32x32x16_bf16 v[112:127], v[60:63], v[220:223], v[112:127]
  ds_read_b64_tr_b16 v[60:61], v23 offset:8192
  s_waitcnt lgkmcnt(14)
  ds_read_b64_tr_b16 v[62:63], v23 offset:10240
  buffer_load_dwordx4 v7, s[8:11], s43 offen offset:3072 nt lds
  s_waitcnt vmcnt(8) lgkmcnt(0)
  s_barrier
  v_add_u32 v20, 131072, v15
  v_xor_b32 v21, 64, v20
  v_xor_b32 v22, 128, v20
  v_xor_b32 v23, 192, v20
  v_mfma_f32_32x32x16_bf16 v[64:79], v[32:35], v[224:227], v[64:79]
  ds_read_b64_tr_b16 v[32:33], v20 offset:0
  ds_read_b64_tr_b16 v[34:35], v20 offset:2048
  s_add_u32 s43, s48, 3932672
  s_add_u32 m0, s33, 147456
  s_and_b32 s43, s43, 0x3fffff
  buffer_load_dwordx4 v8, s[12:15], s43 offen lds
  v_mfma_f32_32x32x16_bf16 v[80:95], v[36:39], v[224:227], v[80:95]
  ds_read_b64_tr_b16 v[36:37], v21 offset:0
  ds_read_b64_tr_b16 v[38:39], v21 offset:2048
  buffer_load_dwordx4 v9, s[12:15], s43 offen offset:1024 lds
  v_mfma_f32_32x32x16_bf16 v[96:111], v[40:43], v[224:227], v[96:111]
  ds_read_b64_tr_b16 v[40:41], v22 offset:0
  ds_read_b64_tr_b16 v[42:43], v22 offset:2048
  buffer_load_dwordx4 v10, s[12:15], s43 offen offset:2048 lds
  v_mfma_f32_32x32x16_bf16 v[112:127], v[44:47], v[224:227], v[112:127]
  ds_read_b64_tr_b16 v[44:45], v23 offset:0
  ds_read_b64_tr_b16 v[46:47], v23 offset:2048
  buffer_load_dwordx4 v11, s[12:15], s43 offen offset:3072 lds
  v_mfma_f32_32x32x16_bf16 v[64:79], v[48:51], v[228:231], v[64:79]
  ds_read_b64_tr_b16 v[48:49], v20 offset:8192
  ds_read_b64_tr_b16 v[50:51], v20 offset:10240
  s_add_u32 m0, s39, 16384
  s_add_u32 s43, s42, 73728
  s_and_b32 s43, s43, 0x1ffff
  s_add_u32 s43, s43, s37
  buffer_load_dwordx4 v4, s[8:11], s43 offen nt lds
  v_mfma_f32_32x32x16_bf16 v[80:95], v[52:55], v[228:231], v[80:95]
  ds_read_b64_tr_b16 v[52:53], v21 offset:8192
  ds_read_b64_tr_b16 v[54:55], v21 offset:10240
  buffer_load_dwordx4 v5, s[8:11], s43 offen offset:1024 nt lds
  v_mfma_f32_32x32x16_bf16 v[96:111], v[56:59], v[228:231], v[96:111]
  ds_read_b64_tr_b16 v[56:57], v22 offset:8192
  ds_read_b64_tr_b16 v[58:59], v22 offset:10240
  v_mfma_f32_32x32x16_bf16 v[112:127], v[60:63], v[228:231], v[112:127]
  ds_read_b64_tr_b16 v[60:61], v23 offset:8192
  s_waitcnt lgkmcnt(14)
  ds_read_b64_tr_b16 v[62:63], v23 offset:10240
  v_add_u32 v20, 114688, v15
  v_xor_b32 v21, 64, v20
  v_xor_b32 v22, 128, v20
  v_xor_b32 v23, 192, v20
  s_waitcnt lgkmcnt(14)
  v_mfma_f32_32x32x16_bf16 v[64:79], v[32:35], v[232:235], v[64:79]
  ds_read_b64_tr_b16 v[32:33], v20 offset:0
  s_waitcnt lgkmcnt(14)
  ds_read_b64_tr_b16 v[34:35], v20 offset:2048
  buffer_load_dwordx4 v6, s[8:11], s43 offen offset:2048 nt lds
  s_waitcnt lgkmcnt(14)
  v_mfma_f32_32x32x16_bf16 v[80:95], v[36:39], v[232:235], v[80:95]
  ds_read_b64_tr_b16 v[36:37], v21 offset:0
  s_waitcnt lgkmcnt(14)
  ds_read_b64_tr_b16 v[38:39], v21 offset:2048
  buffer_load_dwordx4 v7, s[8:11], s43 offen offset:3072 nt lds
  s_waitcnt lgkmcnt(14)
  v_mfma_f32_32x32x16_bf16 v[96:111], v[40:43], v[232:235], v[96:111]
  ds_read_b64_tr_b16 v[40:41], v22 offset:0
  s_waitcnt lgkmcnt(14)
  ds_read_b64_tr_b16 v[42:43], v22 offset:2048
  s_add_u32 m0, s39, 20480
  s_add_u32 s43, s42, 77824
  s_and_b32 s43, s43, 0x1ffff
  s_add_u32 s43, s43, s37
  buffer_load_dwordx4 v4, s[8:11], s43 offen nt lds
  s_waitcnt lgkmcnt(14)
  v_mfma_f32_32x32x16_bf16 v[112:127], v[44:47], v[232:235], v[112:127]
  ds_read_b64_tr_b16 v[44:45], v23 offset:0
  s_waitcnt lgkmcnt(14)
  ds_read_b64_tr_b16 v[46:47], v23 offset:2048
  buffer_load_dwordx4 v5, s[8:11], s43 offen offset:1024 nt lds
  s_waitcnt lgkmcnt(14)
  v_mfma_f32_32x32x16_bf16 v[64:79], v[48:51], v[236:239], v[64:79]
  ds_read_b64_tr_b16 v[48:49], v20 offset:8192
  s_waitcnt lgkmcnt(14)
  ds_read_b64_tr_b16 v[50:51], v20 offset:10240
  buffer_load_dwordx4 v6, s[8:11], s43 offen offset:2048 nt lds
  s_waitcnt lgkmcnt(14)
  v_mfma_f32_32x32x16_bf16 v[80:95], v[52:55], v[236:239], v[80:95]
  ds_read_b64_tr_b16 v[52:53], v21 offset:8192
  s_waitcnt lgkmcnt(14)
  ds_read_b64_tr_b16 v[54:55], v21 offset:10240
  buffer_load_dwordx4 v7, s[8:11], s43 offen offset:3072 nt lds
  s_waitcnt lgkmcnt(14)
  v_mfma_f32_32x32x16_bf16 v[96:111], v[56:59], v[236:239], v[96:111]
  ds_read_b64_tr_b16 v[56:57], v22 offset:8192
  s_waitcnt lgkmcnt(14)
  ds_read_b64_tr_b16 v[58:59], v22 offset:10240
  s_waitcnt lgkmcnt(14)
  v_mfma_f32_32x32x16_bf16 v[112:127], v[60:63], v[236:239], v[112:127]
  ds_read_b64_tr_b16 v[60:61], v23 offset:8192
  s_waitcnt lgkmcnt(14)
  ds_read_b64_tr_b16 v[62:63], v23 offset:10240
  s_waitcnt vmcnt(8) lgkmcnt(0)
  s_barrier
  v_add_u32 v20, 147456, v15
  v_xor_b32 v21, 64, v20
  v_xor_b32 v22, 128, v20
  v_xor_b32 v23, 192, v20
  v_mfma_f32_32x32x16_bf16 v[64:79], v[32:35], v[240:243], v[64:79]
  ds_read_b64_tr_b16 v[32:33], v20 offset:0
  ds_read_b64_tr_b16 v[34:35], v20 offset:2048
  s_add_u32 m0, s39, 32768
  s_add_u32 s43, s42, 81920
  s_and_b32 s43, s43, 0x1ffff
  s_add_u32 s43, s43, s37
  buffer_load_dwordx4 v4, s[8:11], s43 offen nt lds
  v_mfma_f32_32x32x16_bf16 v[80:95], v[36:39], v[240:243], v[80:95]
  ds_read_b64_tr_b16 v[36:37], v21 offset:0
  ds_read_b64_tr_b16 v[38:39], v21 offset:2048
  buffer_load_dwordx4 v5, s[8:11], s43 offen offset:1024 nt lds
  v_mfma_f32_32x32x16_bf16 v[96:111], v[40:43], v[240:243], v[96:111]
  ds_read_b64_tr_b16 v[40:41], v22 offset:0
  ds_read_b64_tr_b16 v[42:43], v22 offset:2048
  buffer_load_dwordx4 v6, s[8:11], s43 offen offset:2048 nt lds
  v_mfma_f32_32x32x16_bf16 v[112:127], v[44:47], v[240:243], v[112:127]
  ds_read_b64_tr_b16 v[44:45], v23 offset:0
  ds_read_b64_tr_b16 v[46:47], v23 offset:2048
  buffer_load_dwordx4 v7, s[8:11], s43 offen offset:3072 nt lds
  v_mfma_f32_32x32x16_bf16 v[64:79], v[48:51], v[244:247], v[64:79]
  ds_read_b64_tr_b16 v[48:49], v20 offset:8192
  ds_read_b64_tr_b16 v[50:51], v20 offset:10240
  v_mfma_f32_32x32x16_bf16 v[80:95], v[52:55], v[244:247], v[80:95]
  ds_read_b64_tr_b16 v[52:53], v21 offset:8192
  ds_read_b64_tr_b16 v[54:55], v21 offset:10240
  v_mfma_f32_32x32x16_bf16 v[96:111], v[56:59], v[244:247], v[96:111]
  ds_read_b64_tr_b16 v[56:57], v22 offset:8192
  ds_read_b64_tr_b16 v[58:59], v22 offset:10240
  v_mfma_f32_32x32x16_bf16 v[112:127], v[60:63], v[244:247], v[112:127]
  ds_read_b64_tr_b16 v[60:61], v23 offset:8192
  s_waitcnt lgkmcnt(14)
  ds_read_b64_tr_b16 v[62:63], v23 offset:10240
  s_waitcnt lgkmcnt(14)
  v_mfma_f32_32x32x16_bf16 v[64:79], v[32:35], v[248:251], v[64:79]
  s_add_u32 m0, s39, 36864
  s_add_u32 s43, s42, 86016
  s_and_b32 s43, s43, 0x1ffff
  s_add_u32 s43, s43, s37
  buffer_load_dwordx4 v4, s[8:11], s43 offen nt lds
  s_waitcnt lgkmcnt(12)
  v_mfma_f32_32x32x16_bf16 v[80:95], v[36:39], v[248:251], v[80:95]
  buffer_load_dwordx4 v5, s[8:11], s43 offen offset:1024 nt lds
  s_waitcnt lgkmcnt(10)
  v_mfma_f32_32x32x16_bf16 v[96:111], v[40:43], v[248:251], v[96:111]
  buffer_load_dwordx4 v6, s[8:11], s43 offen offset:2048 nt lds
  s_waitcnt lgkmcnt(8)
  v_mfma_f32_32x32x16_bf16 v[112:127], v[44:47], v[248:251], v[112:127]
  buffer_load_dwordx4 v7, s[8:11], s43 offen offset:3072 nt lds
  s_waitcnt lgkmcnt(6)
  v_mfma_f32_32x32x16_bf16 v[64:79], v[48:51], v[252:255], v[64:79]
  s_waitcnt lgkmcnt(4)
  v_mfma_f32_32x32x16_bf16 v[80:95], v[52:55], v[252:255], v[80:95]
  s_waitcnt lgkmcnt(2)
  v_mfma_f32_32x32x16_bf16 v[96:111], v[56:59], v[252:255], v[96:111]
  s_waitcnt lgkmcnt(0)
  v_mfma_f32_32x32x16_bf16 v[112:127], v[60:63], v[252:255], v[112:127]
  s_waitcnt vmcnt(8) lgkmcnt(0)
  s_barrier
  s_add_u32 m0, s39, 0
  s_add_u32 s43, s42, 90112
  s_and_b32 s43, s43, 0x1ffff
  s_add_u32 s43, s43, s37
  buffer_load_dwordx4 v4, s[8:11], s43 offen nt lds
  buffer_load_dwordx4 v5, s[8:11], s43 offen offset:1024 nt lds
  buffer_load_dwordx4 v6, s[8:11], s43 offen offset:2048 nt lds
  buffer_load_dwordx4 v7, s[8:11], s43 offen offset:3072 nt lds
  s_add_u32 m0, s39, 4096
  s_add_u32 s43, s42, 94208
  s_and_b32 s43, s43, 0x1ffff
  s_add_u32 s43, s43, s37
  buffer_load_dwordx4 v4, s[8:11], s43 offen nt lds
  buffer_load_dwordx4 v5, s[8:11], s43 offen offset:1024 nt lds
  buffer_load_dwordx4 v6, s[8:11], s43 offen offset:2048 nt lds
  buffer_load_dwordx4 v7, s[8:11], s43 offen offset:3072 nt lds
  s_nop 7
  v_mov_b32 v36, s41
  s_nop 6
  v_pk_mul_f32 v[64:65], v[64:65], v[36:37] op_sel_hi:[1,0]
  v_pk_mul_f32 v[66:67], v[66:67], v[36:37] op_sel_hi:[1,0]
  v_cvt_pk_bf16_f32 v192, v64, v65
  v_pk_mul_f32 v[68:69], v[68:69], v[36:37] op_sel_hi:[1,0]
  v_cvt_pk_bf16_f32 v193, v66, v67
  v_pk_mul_f32 v[70:71], v[70:71], v[36:37] op_sel_hi:[1,0]
  v_cvt_pk_bf16_f32 v194, v68, v69
  v_pk_mul_f32 v[72:73], v[72:73], v[36:37] op_sel_hi:[1,0]
  v_cvt_pk_bf16_f32 v195, v70, v71
  v_pk_mul_f32 v[74:75], v[74:75], v[36:37] op_sel_hi:[1,0]
  v_cvt_pk_bf16_f32 v196, v72, v73
  v_pk_mul_f32 v[76:77], v[76:77], v[36:37] op_sel_hi:[1,0]
  v_cvt_pk_bf16_f32 v197, v74, v75
  v_pk_mul_f32 v[78:79], v[78:79], v[36:37] op_sel_hi:[1,0]
  v_cvt_pk_bf16_f32 v198, v76, v77
  v_pk_mul_f32 v[80:81], v[80:81], v[36:37] op_sel_hi:[1,0]
  v_cvt_pk_bf16_f32 v199, v78, v79
  v_pk_mul_f32 v[82:83], v[82:83], v[36:37] op_sel_hi:[1,0]
  v_cvt_pk_bf16_f32 v200, v80, v81
  v_pk_mul_f32 v[84:85], v[84:85], v[36:37] op_sel_hi:[1,0]
  v_cvt_pk_bf16_f32 v201, v82, v83
  v_pk_mul_f32 v[86:87], v[86:87], v[36:37] op_sel_hi:[1,0]
  v_cvt_pk_bf16_f32 v202, v84, v85
  v_pk_mul_f32 v[88:89], v[88:89], v[36:37] op_sel_hi:[1,0]
  v_cvt_pk_bf16_f32 v203, v86, v87
  v_pk_mul_f32 v[90:91], v[90:91], v[36:37] op_sel_hi:[1,0]
  v_cvt_pk_bf16_f32 v204, v88, v89
  v_pk_mul_f32 v[92:93], v[92:93], v[36:37] op_sel_hi:[1,0]
  v_cvt_pk_bf16_f32 v205, v90, v91
  v_pk_mul_f32 v[94:95], v[94:95], v[36:37] op_sel_hi:[1,0]
  v_cvt_pk_bf16_f32 v206, v92, v93
  v_pk_mul_f32 v[96:97], v[96:97], v[36:37] op_sel_hi:[1,0]
  v_cvt_pk_bf16_f32 v207, v94, v95
  v_pk_mul_f32 v[98:99], v[98:99], v[36:37] op_sel_hi:[1,0]
  v_cvt_pk_bf16_f32 v208, v96, v97
  v_pk_mul_f32 v[100:101], v[100:101], v[36:37] op_sel_hi:[1,0]
  v_cvt_pk_bf16_f32 v209, v98, v99
  v_pk_mul_f32 v[102:103], v[102:103], v[36:37] op_sel_hi:[1,0]
  v_cvt_pk_bf16_f32 v210, v100, v101
  v_pk_mul_f32 v[104:105], v[104:105], v[36:37] op_sel_hi:[1,0]
  v_cvt_pk_bf16_f32 v211, v102, v103
  v_pk_mul_f32 v[106:107], v[106:107], v[36:37] op_sel_hi:[1,0]
  v_cvt_pk_bf16_f32 v212, v104, v105
  v_pk_mul_f32 v[108:109], v[108:109], v[36:37] op_sel_hi:[1,0]
  v_cvt_pk_bf16_f32 v213, v106, v107
  v_pk_mul_f32 v[110:111], v[110:111], v[36:37] op_sel_hi:[1,0]
  v_cvt_pk_bf16_f32 v214, v108, v109
  v_pk_mul_f32 v[112:113], v[112:113], v[36:37] op_sel_hi:[1,0]
  v_cvt_pk_bf16_f32 v215, v110, v111
  v_pk_mul_f32 v[114:115], v[114:115], v[36:37] op_sel_hi:[1,0]
  v_cvt_pk_bf16_f32 v216, v112, v113
  v_pk_mul_f32 v[116:117], v[116:117], v[36:37] op_sel_hi:[1,0]
  v_cvt_pk_bf16_f32 v217, v114, v115
  v_pk_mul_f32 v[118:119], v[118:119], v[36:37] op_sel_hi:[1,0]
  v_cvt_pk_bf16_f32 v218, v116, v117
  v_pk_mul_f32 v[120:121], v[120:121], v[36:37] op_sel_hi:[1,0]
  v_cvt_pk_bf16_f32 v219, v118, v119
  v_pk_mul_f32 v[122:123], v[122:123], v[36:37] op_sel_hi:[1,0]
  v_cvt_pk_bf16_f32 v220, v120, v121
  v_pk_mul_f32 v[124:125], v[124:125], v[36:37] op_sel_hi:[1,0]
  v_cvt_pk_bf16_f32 v221, v122, v123
  v_pk_mul_f32 v[126:127], v[126:127], v[36:37] op_sel_hi:[1,0]
  v_cvt_pk_bf16_f32 v222, v124, v125
  v_cvt_pk_bf16_f32 v223, v126, v127
  s_waitcnt vmcnt(8) lgkmcnt(0)
  s_barrier
  s_add_u32 m0, s39, 16384
  s_add_u32 s43, s42, 98304
  s_and_b32 s43, s43, 0x1ffff
  s_add_u32 s43, s43, s37
  buffer_load_dwordx4 v4, s[8:11], s43 offen nt lds
  buffer_load_dwordx4 v5, s[8:11], s43 offen offset:1024 nt lds
  buffer_load_dwordx4 v6, s[8:11], s43 offen offset:2048 nt lds
  buffer_load_dwordx4 v7, s[8:11], s43 offen offset:3072 nt lds
  s_add_u32 m0, s39, 20480
  s_add_u32 s43, s42, 102400
  s_and_b32 s43, s43, 0x1ffff
  s_add_u32 s43, s43, s37
  buffer_load_dwordx4 v4, s[8:11], s43 offen nt lds
  buffer_load_dwordx4 v5, s[8:11], s43 offen offset:1024 nt lds
  buffer_load_dwordx4 v6, s[8:11], s43 offen offset:2048 nt lds
  buffer_load_dwordx4 v7, s[8:11], s43 offen offset:3072 nt lds
  s_waitcnt vmcnt(8) lgkmcnt(0)
  s_barrier
  s_add_u32 m0, s39, 32768
  s_add_u32 s43, s42, 106496
  s_and_b32 s43, s43, 0x1ffff
  s_add_u32 s43, s43, s37
  buffer_load_dwordx4 v4, s[8:11], s43 offen nt lds
  buffer_load_dwordx4 v5, s[8:11], s43 offen offset:1024 nt lds
  buffer_load_dwordx4 v6, s[8:11], s43 offen offset:2048 nt lds
  buffer_load_dwordx4 v7, s[8:11], s43 offen offset:3072 nt lds
  s_add_u32 m0, s39, 36864
  s_add_u32 s43, s42, 110592
  s_and_b32 s43, s43, 0x1ffff
  s_add_u32 s43, s43, s37
  buffer_load_dwordx4 v4, s[8:11], s43 offen nt lds
  buffer_load_dwordx4 v5, s[8:11], s43 offen offset:1024 nt lds
  buffer_load_dwordx4 v6, s[8:11], s43 offen offset:2048 nt lds
  buffer_load_dwordx4 v7, s[8:11], s43 offen offset:3072 nt lds
  s_waitcnt vmcnt(8) lgkmcnt(0)
  s_barrier
  s_add_u32 m0, s39, 0
  s_add_u32 s43, s42, 114688
  s_and_b32 s43, s43, 0x1ffff
  s_add_u32 s43, s43, s37
  buffer_load_dwordx4 v4, s[8:11], s43 offen nt lds
  buffer_load_dwordx4 v5, s[8:11], s43 offen offset:1024 nt lds
  buffer_load_dwordx4 v6, s[8:11], s43 offen offset:2048 nt lds
  buffer_load_dwordx4 v7, s[8:11], s43 offen offset:3072 nt lds
  s_add_u32 m0, s39, 4096
  s_add_u32 s43, s42, 118784
  s_and_b32 s43, s43, 0x1ffff
  s_add_u32 s43, s43, s37
  buffer_load_dwordx4 v4, s[8:11], s43 offen nt lds
  buffer_load_dwordx4 v5, s[8:11], s43 offen offset:1024 nt lds
  buffer_load_dwordx4 v6, s[8:11], s43 offen offset:2048 nt lds
  buffer_load_dwordx4 v7, s[8:11], s43 offen offset:3072 nt lds
  s_waitcnt vmcnt(8) lgkmcnt(0)
  s_barrier
  s_add_u32 m0, s39, 16384
  s_add_u32 s43, s42, 122880
  s_and_b32 s43, s43, 0x1ffff
  s_cmp_eq_u32 s47, 0
  s_cselect_b32 s44, s52, s37
  s_add_u32 s43, s43, s44
  buffer_load_dwordx4 v4, s[8:11], s43 offen nt lds
  buffer_load_dwordx4 v5, s[8:11], s43 offen offset:1024 nt lds
  buffer_load_dwordx4 v6, s[8:11], s43 offen offset:2048 nt lds
  buffer_load_dwordx4 v7, s[8:11], s43 offen offset:3072 nt lds
  s_add_u32 m0, s39, 20480
  s_add_u32 s43, s42, 126976
  s_and_b32 s43, s43, 0x1ffff
  s_cmp_eq_u32 s47, 0
  s_cselect_b32 s44, s52, s37
  s_add_u32 s43, s43, s44
  buffer_load_dwordx4 v4, s[8:11], s43 offen nt lds
  buffer_load_dwordx4 v5, s[8:11], s43 offen offset:1024 nt lds
  buffer_load_dwordx4 v6, s[8:11], s43 offen offset:2048 nt lds
  buffer_load_dwordx4 v7, s[8:11], s43 offen offset:3072 nt lds
  s_waitcnt vmcnt(8) lgkmcnt(0)
  s_barrier
  s_add_u32 m0, s39, 32768
  s_add_u32 s43, s42, 0
  s_and_b32 s43, s43, 0x1ffff
  s_add_u32 s43, s43, s52
  buffer_load_dwordx4 v4, s[8:11], s43 offen nt lds
  buffer_load_dwordx4 v5, s[8:11], s43 offen offset:1024 nt lds
  buffer_load_dwordx4 v6, s[8:11], s43 offen offset:2048 nt lds
  buffer_load_dwordx4 v7, s[8:11], s43 offen offset:3072 nt lds
  s_add_u32 m0, s39, 36864
  s_add_u32 s43, s42, 4096
  s_and_b32 s43, s43, 0x1ffff
  s_add_u32 s43, s43, s52
  buffer_load_dwordx4 v4, s[8:11], s43 offen nt lds
  buffer_load_dwordx4 v5, s[8:11], s43 offen offset:1024 nt lds
  buffer_load_dwordx4 v6, s[8:11], s43 offen offset:2048 nt lds
  buffer_load_dwordx4 v7, s[8:11], s43 offen offset:3072 nt lds
  s_waitcnt vmcnt(8) lgkmcnt(0)
  s_barrier
  s_add_u32 m0, s39, 0
  s_add_u32 s43, s42, 8192
  s_and_b32 s43, s43, 0x1ffff
  s_add_u32 s43, s43, s52
  buffer_load_dwordx4 v4, s[8:11], s43 offen nt lds
  buffer_load_dwordx4 v5, s[8:11], s43 offen offset:1024 nt lds
  buffer_load_dwordx4 v6, s[8:11], s43 offen offset:2048 nt lds
  buffer_load_dwordx4 v7, s[8:11], s43 offen offset:3072 nt lds
  s_add_u32 m0, s39, 4096
  s_add_u32 s43, s42, 12288
  s_and_b32 s43, s43, 0x1ffff
  s_add_u32 s43, s43, s52
  buffer_load_dwordx4 v4, s[8:11], s43 offen nt lds
  buffer_load_dwordx4 v5, s[8:11], s43 offen offset:1024 nt lds
  buffer_load_dwordx4 v6, s[8:11], s43 offen offset:2048 nt lds
  buffer_load_dwordx4 v7, s[8:11], s43 offen offset:3072 nt lds
  s_setprio 0
  s_mul_i32 s36, s46, 49152
  v_add_u32 v240, s36, v13
  v_add_u32 v248, s36, v14
  v_xor_b32 v241, 32, v240
  v_xor_b32 v242, 64, v240
  v_xor_b32 v243, 96, v240
  v_xor_b32 v244, 128, v240
  v_xor_b32 v245, 160, v240
  v_xor_b32 v246, 192, v240
  v_xor_b32 v247, 224, v240
  ds_read_b128 v[128:131], v240 offset:16384
  ds_read_b128 v[132:135], v241 offset:16384
  ds_read_b128 v[136:139], v242 offset:16384
  ds_read_b128 v[140:143], v243 offset:16384
  ds_read_b128 v[144:147], v244 offset:16384
  ds_read_b128 v[148:151], v245 offset:16384
  ds_read_b128 v[152:155], v246 offset:16384
  ds_read_b128 v[156:159], v247 offset:16384
  v_xor_b32 v249, 64, v248
  v_xor_b32 v250, 128, v248
  v_xor_b32 v251, 192, v248
  s_waitcnt lgkmcnt(7)
  v_mfma_f32_32x32x16_bf16 v[40:55], v[128:131], v[192:195], 0
  v_mov_b64 v[64:65], 0
  v_mov_b64 v[66:67], 0
  v_mov_b64 v[68:69], 0
  v_mov_b64 v[70:71], 0
  v_mov_b64 v[72:73], 0
  s_waitcnt lgkmcnt(6)
  v_mfma_f32_32x32x16_bf16 v[40:55], v[132:135], v[196:199], v[40:55]
  v_mov_b64 v[74:75], 0
  v_mov_b64 v[76:77], 0
  v_mov_b64 v[78:79], 0
  v_mov_b64 v[80:81], 0
  v_mov_b64 v[82:83], 0
  s_waitcnt lgkmcnt(5)
  v_mfma_f32_32x32x16_bf16 v[40:55], v[136:139], v[200:203], v[40:55]
  v_mov_b64 v[84:85], 0
  v_mov_b64 v[86:87], 0
  v_mov_b64 v[88:89], 0
  v_mov_b64 v[90:91], 0
  v_mov_b64 v[92:93], 0
  s_waitcnt lgkmcnt(4)
  v_mfma_f32_32x32x16_bf16 v[40:55], v[140:143], v[204:207], v[40:55]
  v_mov_b64 v[94:95], 0
  v_mov_b64 v[96:97], 0
  v_mov_b64 v[98:99], 0
  v_mov_b64 v[100:101], 0
  v_mov_b64 v[102:103], 0
  s_waitcnt lgkmcnt(3)
  v_mfma_f32_32x32x16_bf16 v[40:55], v[144:147], v[208:211], v[40:55]
  v_mov_b64 v[104:105], 0
  v_mov_b64 v[106:107], 0
  v_mov_b64 v[108:109], 0
  v_mov_b64 v[110:111], 0
  v_mov_b64 v[112:113], 0
  s_waitcnt lgkmcnt(2)
  v_mfma_f32_32x32x16_bf16 v[40:55], v[148:151], v[212:215], v[40:55]
  v_mov_b64 v[114:115], 0
  v_mov_b64 v[116:117], 0
  v_mov_b64 v[118:119], 0
  v_mov_b64 v[120:121], 0
  v_mov_b64 v[122:123], 0
  s_waitcnt lgkmcnt(1)
  v_mfma_f32_32x32x16_bf16 v[40:55], v[152:155], v[216:219], v[40:55]
  v_mov_b64 v[124:125], 0
  v_mov_b64 v[126:127], 0
  v_mov_b64 v[252:253], 0
  v_mov_b64 v[254:255], 0
  v_mov_b64 v[56:57], 0
  s_waitcnt lgkmcnt(0)
  v_mfma_f32_32x32x16_bf16 v[40:55], v[156:159], v[220:223], v[40:55]
  v_mov_b64 v[58:59], 0
  v_mov_b64 v[60:61], 0
  v_mov_b64 v[62:63], 0
  v_lshrrev_b32 v36, 2, v1
  v_lshrrev_b32 v37, 4, v1
  v_xor_b32 v36, v36, v37
  v_and_b32 v36, 1, v36
  v_and_b32 v37, 3, v1
  v_or_b32 v36, v36, v37
  v_cmp_eq_u32 vcc, 0, v36
  v_mov_b32 v37, 0x3f803f80
  s_nop 0
  v_cndmask_b32 v176, 0, v37, vcc
  v_cndmask_b32 v177, 0, v37, vcc
  v_cndmask_b32 v178, 0, v37, vcc
  v_cndmask_b32 v179, 0, v37, vcc
  s_nop 1
  v_max3_f32 v36, v40, v41, v42
  v_max3_f32 v37, v43, v44, v45
  v_max3_f32 v36, v36, v46, v47
  v_max3_f32 v37, v37, v48, v49
  v_max3_f32 v36, v36, v50, v51
  v_max3_f32 v37, v37, v52, v53
  v_max3_f32 v36, v36, v54, v55
  v_max_f32 v36, v36, v37
  v_mov_b32 v37, v36
  s_nop 1
  v_permlane32_swap_b32 v36, v37
  s_nop 1
  v_max_f32 v36, v36, v37
  v_sub_f32 v40, v40, v36
  v_sub_f32 v160, 0, v36
  v_sub_f32 v41, v41, v36
  v_sub_f32 v161, 0, v36
  v_sub_f32 v42, v42, v36
  v_sub_f32 v162, 0, v36
  v_sub_f32 v43, v43, v36
  v_sub_f32 v163, 0, v36
  v_sub_f32 v44, v44, v36
  v_sub_f32 v164, 0, v36
  v_sub_f32 v45, v45, v36
  v_sub_f32 v165, 0, v36
  v_sub_f32 v46, v46, v36
  v_sub_f32 v166, 0, v36
  v_sub_f32 v47, v47, v36
  v_sub_f32 v167, 0, v36
  v_sub_f32 v48, v48, v36
  v_sub_f32 v168, 0, v36
  v_sub_f32 v49, v49, v36
  v_sub_f32 v169, 0, v36
  v_sub_f32 v50, v50, v36
  v_sub_f32 v170, 0, v36
  v_sub_f32 v51, v51, v36
  v_sub_f32 v171, 0, v36
  v_sub_f32 v52, v52, v36
  v_sub_f32 v172, 0, v36
  v_sub_f32 v53, v53, v36
  v_sub_f32 v173, 0, v36
  v_sub_f32 v54, v54, v36
  v_sub_f32 v174, 0, v36
  v_sub_f32 v55, v55, v36
  v_sub_f32 v175, 0, v36
  s_waitcnt vmcnt(8) lgkmcnt(0)
  s_barrier
  s_mov_b32 s32, 0
L_attn_36:
  s_nop 7
  v_mfma_f32_32x32x16_bf16 v[64:79], v[128:131], v[56:59], v[64:79]
  ds_read_b128 v[128:131], v240 offset:32768
  v_max3_f32 v36, v40, v41, v42
  v_max3_f32 v37, v43, v44, v45
  v_max3_f32 v36, v36, v46, v47
  v_max3_f32 v37, v37, v48, v49
  v_mfma_f32_32x32x16_bf16 v[80:95], v[132:135], v[56:59], v[80:95]
  ds_read_b128 v[132:135], v241 offset:32768
  v_max3_f32 v36, v36, v50, v51
  v_max3_f32 v37, v37, v52, v53
  v_max3_f32 v36, v36, v54, v55
  v_max_f32 v36, v36, v37
  v_cmp_lt_f32 vcc, s53, v36
  s_cbranch_vccnz L_rare_37
  v_mfma_f32_32x32x16_bf16 v[96:111], v[136:139], v[56:59], v[96:111]
  ds_read_b128 v[136:139], v242 offset:32768
  v_exp_f32 v224, v40
  v_exp_f32 v225, v41
  v_mfma_f32_32x32x16_bf16 v[112:127], v[140:143], v[56:59], v[112:127]
  ds_read_b128 v[140:143], v243 offset:32768
  v_exp_f32 v226, v42
  v_exp_f32 v227, v43
  v_exp_f32 v228, v44
  v_mfma_f32_32x32x16_bf16 v[64:79], v[144:147], v[60:63], v[64:79]
  ds_read_b128 v[144:147], v244 offset:32768
  v_exp_f32 v229, v45
  v_exp_f32 v230, v46
  v_mfma_f32_32x32x16_bf16 v[80:95], v[148:151], v[60:63], v[80:95]
  ds_read_b128 v[148:151], v245 offset:32768
  v_exp_f32 v231, v47
  v_exp_f32 v232, v48
  v_exp_f32 v233, v49
  v_mfma_f32_32x32x16_bf16 v[96:111], v[152:155], v[60:63], v[96:111]
  ds_read_b128 v[152:155], v246 offset:32768
  v_exp_f32 v234, v50
  v_exp_f32 v235, v51
  v_mfma_f32_32x32x16_bf16 v[112:127], v[156:159], v[60:63], v[112:127]
  ds_read_b128 v[156:159], v247 offset:32768
  v_exp_f32 v236, v52
  v_exp_f32 v237, v53
  v_exp_f32 v238, v54
  v_exp_f32 v239, v55
L_back_38:
  s_waitcnt lgkmcnt(7)
  v_mfma_f32_32x32x16_bf16 v[40:55], v[128:131], v[192:195], v[160:175]
  ds_read_b64_tr_b16 v[128:129], v248 offset:40960
  ds_read_b64_tr_b16 v[130:131], v248 offset:43008
  v_cvt_pk_bf16_f32 v56, v224, v225
  v_cvt_pk_bf16_f32 v57, v226, v227
  v_cvt_pk_bf16_f32 v58, v228, v229
  s_waitcnt lgkmcnt(8)
  v_mfma_f32_32x32x16_bf16 v[40:55], v[132:135], v[196:199], v[40:55]
  ds_read_b64_tr_b16 v[132:133], v249 offset:40960
  ds_read_b64_tr_b16 v[134:135], v249 offset:43008
  v_cvt_pk_bf16_f32 v59, v230, v231
  v_cvt_pk_bf16_f32 v60, v232, v233
  v_cvt_pk_bf16_f32 v61, v234, v235
  s_waitcnt lgkmcnt(9)
  v_mfma_f32_32x32x16_bf16 v[40:55], v[136:139], v[200:203], v[40:55]
  ds_read_b64_tr_b16 v[136:137], v250 offset:40960
  ds_read_b64_tr_b16 v[138:139], v250 offset:43008
  v_cvt_pk_bf16_f32 v62, v236, v237
  v_cvt_pk_bf16_f32 v63, v238, v239
  s_waitcnt lgkmcnt(10)
  v_mfma_f32_32x32x16_bf16 v[40:55], v[140:143], v[204:207], v[40:55]
  ds_read_b64_tr_b16 v[140:141], v251 offset:40960
  ds_read_b64_tr_b16 v[142:143], v251 offset:43008
  s_waitcnt lgkmcnt(11)
  v_mfma_f32_32x32x16_bf16 v[40:55], v[144:147], v[208:211], v[40:55]
  ds_read_b64_tr_b16 v[144:145], v248 offset:45056
  ds_read_b64_tr_b16 v[146:147], v248 offset:47104
  v_mfma_f32_16x16x32_bf16 v[252:255], v[176:179], v[56:59], v[252:255]
  s_waitcnt lgkmcnt(12)
  v_mfma_f32_32x32x16_bf16 v[40:55], v[148:151], v[212:215], v[40:55]
  ds_read_b64_tr_b16 v[148:149], v249 offset:45056
  ds_read_b64_tr_b16 v[150:151], v249 offset:47104
  s_waitcnt lgkmcnt(13)
  v_mfma_f32_32x32x16_bf16 v[40:55], v[152:155], v[216:219], v[40:55]
  ds_read_b64_tr_b16 v[152:153], v250 offset:45056
  ds_read_b64_tr_b16 v[154:155], v250 offset:47104
  v_mfma_f32_16x16x32_bf16 v[252:255], v[176:179], v[60:63], v[252:255]
  s_waitcnt lgkmcnt(14)
  v_mfma_f32_32x32x16_bf16 v[40:55], v[156:159], v[220:223], v[40:55]
  ds_read_b64_tr_b16 v[156:157], v251 offset:45056
  s_waitcnt lgkmcnt(14)
  ds_read_b64_tr_b16 v[158:159], v251 offset:47104
  s_waitcnt vmcnt(0) lgkmcnt(0)
  s_barrier
  s_nop 7
  v_mfma_f32_32x32x16_bf16 v[64:79], v[128:131], v[56:59], v[64:79]
  ds_read_b128 v[128:131], v240 offset:0
  v_max3_f32 v36, v40, v41, v42
  v_max3_f32 v37, v43, v44, v45
  v_max3_f32 v36, v36, v46, v47
  v_max3_f32 v37, v37, v48, v49
  v_mfma_f32_32x32x16_bf16 v[80:95], v[132:135], v[56:59], v[80:95]
  ds_read_b128 v[132:135], v241 offset:0
  v_max3_f32 v36, v36, v50, v51
  v_max3_f32 v37, v37, v52, v53
  v_max3_f32 v36, v36, v54, v55
  v_max_f32 v36, v36, v37
  v_cmp_lt_f32 vcc, s53, v36
  s_cbranch_vccnz L_rare_39
  v_mfma_f32_32x32x16_bf16 v[96:111], v[136:139], v[56:59], v[96:111]
  ds_read_b128 v[136:139], v242 offset:0
  v_exp_f32 v224, v40
  v_exp_f32 v225, v41
  v_mfma_f32_32x32x16_bf16 v[112:127], v[140:143], v[56:59], v[112:127]
  ds_read_b128 v[140:143], v243 offset:0
  v_exp_f32 v226, v42
  v_exp_f32 v227, v43
  v_exp_f32 v228, v44
  v_mfma_f32_32x32x16_bf16 v[64:79], v[144:147], v[60:63], v[64:79]
  ds_read_b128 v[144:147], v244 offset:0
  v_exp_f32 v229, v45
  v_exp_f32 v230, v46
  v_mfma_f32_32x32x16_bf16 v[80:95], v[148:151], v[60:63], v[80:95]
  ds_read_b128 v[148:151], v245 offset:0
  v_exp_f32 v231, v47
  v_exp_f32 v232, v48
  v_exp_f32 v233, v49
  v_mfma_f32_32x32x16_bf16 v[96:111], v[152:155], v[60:63], v[96:111]
  ds_read_b128 v[152:155], v246 offset:0
  v_exp_f32 v234, v50
  v_exp_f32 v235, v51
  v_mfma_f32_32x32x16_bf16 v[112:127], v[156:159], v[60:63], v[112:127]
  ds_read_b128 v[156:159], v247 offset:0
  v_exp_f32 v236, v52
  v_exp_f32 v237, v53
  v_exp_f32 v238, v54
  v_exp_f32 v239, v55
L_back_40:
  s_waitcnt lgkmcnt(7)
  v_mfma_f32_32x32x16_bf16 v[40:55], v[128:131], v[192:195], v[160:175]
  ds_read_b64_tr_b16 v[128:129], v248 offset:8192
  ds_read_b64_tr_b16 v[130:131], v248 offset:10240
  v_cvt_pk_bf16_f32 v56, v224, v225
  v_cvt_pk_bf16_f32 v57, v226, v227
  v_cvt_pk_bf16_f32 v58, v228, v229
  s_waitcnt lgkmcnt(8)
  v_mfma_f32_32x32x16_bf16 v[40:55], v[132:135], v[196:199], v[40:55]
  ds_read_b64_tr_b16 v[132:133], v249 offset:8192
  ds_read_b64_tr_b16 v[134:135], v249 offset:10240
  v_cvt_pk_bf16_f32 v59, v230, v231
  v_cvt_pk_bf16_f32 v60, v232, v233
  v_cvt_pk_bf16_f32 v61, v234, v235
  s_waitcnt lgkmcnt(9)
  v_mfma_f32_32x32x16_bf16 v[40:55], v[136:139], v[200:203], v[40:55]
  ds_read_b64_tr_b16 v[136:137], v250 offset:8192
  ds_read_b64_tr_b16 v[138:139], v250 offset:10240
  v_cvt_pk_bf16_f32 v62, v236, v237
  v_cvt_pk_bf16_f32 v63, v238, v239
  s_waitcnt lgkmcnt(10)
  v_mfma_f32_32x32x16_bf16 v[40:55], v[140:143], v[204:207], v[40:55]
  ds_read_b64_tr_b16 v[140:141], v251 offset:8192
  ds_read_b64_tr_b16 v[142:143], v251 offset:10240
  s_waitcnt lgkmcnt(11)
  v_mfma_f32_32x32x16_bf16 v[40:55], v[144:147], v[208:211], v[40:55]
  ds_read_b64_tr_b16 v[144:145], v248 offset:12288
  ds_read_b64_tr_b16 v[146:147], v248 offset:14336
  v_mfma_f32_16x16x32_bf16 v[252:255], v[176:179], v[56:59], v[252:255]
  s_waitcnt lgkmcnt(12)
  v_mfma_f32_32x32x16_bf16 v[40:55], v[148:151], v[212:215], v[40:55]
  ds_read_b64_tr_b16 v[148:149], v249 offset:12288
  ds_read_b64_tr_b16 v[150:151], v249 offset:14336
  s_waitcnt lgkmcnt(13)
  v_mfma_f32_32x32x16_bf16 v[40:55], v[152:155], v[216:219], v[40:55]
  ds_read_b64_tr_b16 v[152:153], v250 offset:12288
  ds_read_b64_tr_b16 v[154:155], v250 offset:14336
  v_mfma_f32_16x16x32_bf16 v[252:255], v[176:179], v[60:63], v[252:255]
  s_waitcnt lgkmcnt(14)
  v_mfma_f32_32x32x16_bf16 v[40:55], v[156:159], v[220:223], v[40:55]
  ds_read_b64_tr_b16 v[156:157], v251 offset:12288
  s_waitcnt lgkmcnt(14)
  ds_read_b64_tr_b16 v[158:159], v251 offset:14336
  s_waitcnt vmcnt(0) lgkmcnt(0)
  s_barrier
  s_nop 7
  v_mfma_f32_32x32x16_bf16 v[64:79], v[128:131], v[56:59], v[64:79]
  ds_read_b128 v[128:131], v240 offset:16384
  v_max3_f32 v36, v40, v41, v42
  v_max3_f32 v37, v43, v44, v45
  v_max3_f32 v36, v36, v46, v47
  v_max3_f32 v37, v37, v48, v49
  v_mfma_f32_32x32x16_bf16 v[80:95], v[132:135], v[56:59], v[80:95]
  ds_read_b128 v[132:135], v241 offset:16384
  v_max3_f32 v36, v36, v50, v51
  v_max3_f32 v37, v37, v52, v53
  v_max3_f32 v36, v36, v54, v55
  v_max_f32 v36, v36, v37
  v_cmp_lt_f32 vcc, s53, v36
  s_cbranch_vccnz L_rare_41
  v_mfma_f32_32x32x16_bf16 v[96:111], v[136:139], v[56:59], v[96:111]
  ds_read_b128 v[136:139], v242 offset:16384
  v_exp_f32 v224, v40
  v_exp_f32 v225, v41
  v_mfma_f32_32x32x16_bf16 v[112:127], v[140:143], v[56:59], v[112:127]
  ds_read_b128 v[140:143], v243 offset:16384
  v_exp_f32 v226, v42
  v_exp_f32 v227, v43
  v_exp_f32 v228, v44
  v_mfma_f32_32x32x16_bf16 v[64:79], v[144:147], v[60:63], v[64:79]
  ds_read_b128 v[144:147], v244 offset:16384
  v_exp_f32 v229, v45
  v_exp_f32 v230, v46
  v_mfma_f32_32x32x16_bf16 v[80:95], v[148:151], v[60:63], v[80:95]
  ds_read_b128 v[148:151], v245 offset:16384
  v_exp_f32 v231, v47
  v_exp_f32 v232, v48
  v_exp_f32 v233, v49
  v_mfma_f32_32x32x16_bf16 v[96:111], v[152:155], v[60:63], v[96:111]
  ds_read_b128 v[152:155], v246 offset:16384
  v_exp_f32 v234, v50
  v_exp_f32 v235, v51
  v_mfma_f32_32x32x16_bf16 v[112:127], v[156:159], v[60:63], v[112:127]
  ds_read_b128 v[156:159], v247 offset:16384
  v_exp_f32 v236, v52
  v_exp_f32 v237, v53
  v_exp_f32 v238, v54
  v_exp_f32 v239, v55
L_back_42:
  s_waitcnt lgkmcnt(7)
  v_mfma_f32_32x32x16_bf16 v[40:55], v[128:131], v[192:195], v[160:175]
  ds_read_b64_tr_b16 v[128:129], v248 offset:24576
  ds_read_b64_tr_b16 v[130:131], v248 offset:26624
  v_cvt_pk_bf16_f32 v56, v224, v225
  v_cvt_pk_bf16_f32 v57, v226, v227
  v_cvt_pk_bf16_f32 v58, v228, v229
  s_waitcnt lgkmcnt(8)
  v_mfma_f32_32x32x16_bf16 v[40:55], v[132:135], v[196:199], v[40:55]
  ds_read_b64_tr_b16 v[132:133], v249 offset:24576
  ds_read_b64_tr_b16 v[134:135], v249 offset:26624
  v_cvt_pk_bf16_f32 v59, v230, v231
  v_cvt_pk_bf16_f32 v60, v232, v233
  v_cvt_pk_bf16_f32 v61, v234, v235
  s_waitcnt lgkmcnt(9)
  v_mfma_f32_32x32x16_bf16 v[40:55], v[136:139], v[200:203], v[40:55]
  ds_read_b64_tr_b16 v[136:137], v250 offset:24576
  ds_read_b64_tr_b16 v[138:139], v250 offset:26624
  v_cvt_pk_bf16_f32 v62, v236, v237
  v_cvt_pk_bf16_f32 v63, v238, v239
  s_waitcnt lgkmcnt(10)
  v_mfma_f32_32x32x16_bf16 v[40:55], v[140:143], v[204:207], v[40:55]
  ds_read_b64_tr_b16 v[140:141], v251 offset:24576
  ds_read_b64_tr_b16 v[142:143], v251 offset:26624
  s_waitcnt lgkmcnt(11)
  v_mfma_f32_32x32x16_bf16 v[40:55], v[144:147], v[208:211], v[40:55]
  ds_read_b64_tr_b16 v[144:145], v248 offset:28672
  ds_read_b64_tr_b16 v[146:147], v248 offset:30720
  v_mfma_f32_16x16x32_bf16 v[252:255], v[176:179], v[56:59], v[252:255]
  s_waitcnt lgkmcnt(12)
  v_mfma_f32_32x32x16_bf16 v[40:55], v[148:151], v[212:215], v[40:55]
  ds_read_b64_tr_b16 v[148:149], v249 offset:28672
  ds_read_b64_tr_b16 v[150:151], v249 offset:30720
  s_waitcnt lgkmcnt(13)
  v_mfma_f32_32x32x16_bf16 v[40:55], v[152:155], v[216:219], v[40:55]
  ds_read_b64_tr_b16 v[152:153], v250 offset:28672
  ds_read_b64_tr_b16 v[154:155], v250 offset:30720
  v_mfma_f32_16x16x32_bf16 v[252:255], v[176:179], v[60:63], v[252:255]
  s_waitcnt lgkmcnt(14)
  v_mfma_f32_32x32x16_bf16 v[40:55], v[156:159], v[220:223], v[40:55]
  ds_read_b64_tr_b16 v[156:157], v251 offset:28672
  s_waitcnt lgkmcnt(14)
  ds_read_b64_tr_b16 v[158:159], v251 offset:30720
  s_waitcnt vmcnt(0) lgkmcnt(0)
  s_barrier
  s_add_u32 s32, s32, 1
  s_cmp_lt_u32 s32, 5
  s_cbranch_scc1 L_attn_36
  s_nop 7
  v_mfma_f32_32x32x16_bf16 v[64:79], v[128:131], v[56:59], v[64:79]
  ds_read_b64_tr_b16 v[128:129], v248 offset:40960
  ds_read_b64_tr_b16 v[130:131], v248 offset:43008
  v_max3_f32 v36, v40, v41, v42
  v_max3_f32 v37, v43, v44, v45
  v_max3_f32 v36, v36, v46, v47
  v_max3_f32 v37, v37, v48, v49
  v_mfma_f32_32x32x16_bf16 v[80:95], v[132:135], v[56:59], v[80:95]
  ds_read_b64_tr_b16 v[132:133], v249 offset:40960
  ds_read_b64_tr_b16 v[134:135], v249 offset:43008
  v_max3_f32 v36, v36, v50, v51
  v_max3_f32 v37, v37, v52, v53
  v_max3_f32 v36, v36, v54, v55
  v_max_f32 v36, v36, v37
  v_cmp_lt_f32 vcc, s53, v36
  s_cbranch_vccnz L_rare_43
  v_mfma_f32_32x32x16_bf16 v[96:111], v[136:139], v[56:59], v[96:111]
  ds_read_b64_tr_b16 v[136:137], v250 offset:40960
  ds_read_b64_tr_b16 v[138:139], v250 offset:43008
  v_exp_f32 v224, v40
  v_exp_f32 v225, v41
  v_mfma_f32_32x32x16_bf16 v[112:127], v[140:143], v[56:59], v[112:127]
  ds_read_b64_tr_b16 v[140:141], v251 offset:40960
  ds_read_b64_tr_b16 v[142:143], v251 offset:43008
  v_exp_f32 v226, v42
  v_exp_f32 v227, v43
  v_exp_f32 v228, v44
  v_mfma_f32_32x32x16_bf16 v[64:79], v[144:147], v[60:63], v[64:79]
  ds_read_b64_tr_b16 v[144:145], v248 offset:45056
  ds_read_b64_tr_b16 v[146:147], v248 offset:47104
  v_exp_f32 v229, v45
  v_exp_f32 v230, v46
  v_mfma_f32_32x32x16_bf16 v[80:95], v[148:151], v[60:63], v[80:95]
  ds_read_b64_tr_b16 v[148:149], v249 offset:45056
  ds_read_b64_tr_b16 v[150:151], v249 offset:47104
  v_exp_f32 v231, v47
  v_exp_f32 v232, v48
  v_exp_f32 v233, v49
  v_mfma_f32_32x32x16_bf16 v[96:111], v[152:155], v[60:63], v[96:111]
  ds_read_b64_tr_b16 v[152:153], v250 offset:45056
  ds_read_b64_tr_b16 v[154:155], v250 offset:47104
  v_exp_f32 v234, v50
  v_exp_f32 v235, v51
  v_mfma_f32_32x32x16_bf16 v[112:127], v[156:159], v[60:63], v[112:127]
  ds_read_b64_tr_b16 v[156:157], v251 offset:45056
  s_waitcnt lgkmcnt(14)
  ds_read_b64_tr_b16 v[158:159], v251 offset:47104
  v_exp_f32 v236, v52
  v_exp_f32 v237, v53
  v_exp_f32 v238, v54
  v_exp_f32 v239, v55
L_back_44:
  v_cvt_pk_bf16_f32 v56, v224, v225
  v_cvt_pk_bf16_f32 v57, v226, v227
  v_cvt_pk_bf16_f32 v58, v228, v229
  v_cvt_pk_bf16_f32 v59, v230, v231
  v_cvt_pk_bf16_f32 v60, v232, v233
  v_cvt_pk_bf16_f32 v61, v234, v235
  v_cvt_pk_bf16_f32 v62, v236, v237
  v_cvt_pk_bf16_f32 v63, v238, v239
  s_nop 1
  v_mfma_f32_16x16x32_bf16 v[252:255], v[176:179], v[56:59], v[252:255]
  v_mfma_f32_16x16x32_bf16 v[252:255], v[176:179], v[60:63], v[252:255]
  s_waitcnt lgkmcnt(14)
  v_mfma_f32_32x32x16_bf16 v[64:79], v[128:131], v[56:59], v[64:79]
  s_waitcnt lgkmcnt(12)
  v_mfma_f32_32x32x16_bf16 v[80:95], v[132:135], v[56:59], v[80:95]
  s_waitcnt lgkmcnt(10)
  v_mfma_f32_32x32x16_bf16 v[96:111], v[136:139], v[56:59], v[96:111]
  s_waitcnt lgkmcnt(8)
  v_mfma_f32_32x32x16_bf16 v[112:127], v[140:143], v[56:59], v[112:127]
  s_waitcnt lgkmcnt(6)
  v_mfma_f32_32x32x16_bf16 v[64:79], v[144:147], v[60:63], v[64:79]
  s_waitcnt lgkmcnt(4)
  v_mfma_f32_32x32x16_bf16 v[80:95], v[148:151], v[60:63], v[80:95]
  s_waitcnt lgkmcnt(2)
  v_mfma_f32_32x32x16_bf16 v[96:111], v[152:155], v[60:63], v[96:111]
  s_waitcnt lgkmcnt(0)
  v_mfma_f32_32x32x16_bf16 v[112:127], v[156:159], v[60:63], v[112:127]
  s_nop 7
  v_rcp_f32 v36, v252
  s_nop 7
  v_pk_mul_f32 v[64:65], v[64:65], v[36:37] op_sel_hi:[1,0]
  v_pk_mul_f32 v[66:67], v[66:67], v[36:37] op_sel_hi:[1,0]
  v_cvt_pk_bf16_f32 v192, v64, v65
  v_pk_mul_f32 v[68:69], v[68:69], v[36:37] op_sel_hi:[1,0]
  v_cvt_pk_bf16_f32 v193, v66, v67
  v_pk_mul_f32 v[70:71], v[70:71], v[36:37] op_sel_hi:[1,0]
  v_cvt_pk_bf16_f32 v194, v68, v69
  v_pk_mul_f32 v[72:73], v[72:73], v[36:37] op_sel_hi:[1,0]
  v_cvt_pk_bf16_f32 v195, v70, v71
  v_pk_mul_f32 v[74:75], v[74:75], v[36:37] op_sel_hi:[1,0]
  v_cvt_pk_bf16_f32 v196, v72, v73
  v_pk_mul_f32 v[76:77], v[76:77], v[36:37] op_sel_hi:[1,0]
  v_cvt_pk_bf16_f32 v197, v74, v75
  v_pk_mul_f32 v[78:79], v[78:79], v[36:37] op_sel_hi:[1,0]
  v_cvt_pk_bf16_f32 v198, v76, v77
  v_pk_mul_f32 v[80:81], v[80:81], v[36:37] op_sel_hi:[1,0]
  v_cvt_pk_bf16_f32 v199, v78, v79
  v_pk_mul_f32 v[82:83], v[82:83], v[36:37] op_sel_hi:[1,0]
  v_cvt_pk_bf16_f32 v200, v80, v81
  v_pk_mul_f32 v[84:85], v[84:85], v[36:37] op_sel_hi:[1,0]
  v_cvt_pk_bf16_f32 v201, v82, v83
  v_pk_mul_f32 v[86:87], v[86:87], v[36:37] op_sel_hi:[1,0]
  v_cvt_pk_bf16_f32 v202, v84, v85
  v_pk_mul_f32 v[88:89], v[88:89], v[36:37] op_sel_hi:[1,0]
  v_cvt_pk_bf16_f32 v203, v86, v87
  v_pk_mul_f32 v[90:91], v[90:91], v[36:37] op_sel_hi:[1,0]
  v_cvt_pk_bf16_f32 v204, v88, v89
  v_pk_mul_f32 v[92:93], v[92:93], v[36:37] op_sel_hi:[1,0]
  v_cvt_pk_bf16_f32 v205, v90, v91
  v_pk_mul_f32 v[94:95], v[94:95], v[36:37] op_sel_hi:[1,0]
  v_cvt_pk_bf16_f32 v206, v92, v93
  v_pk_mul_f32 v[96:97], v[96:97], v[36:37] op_sel_hi:[1,0]
  v_cvt_pk_bf16_f32 v207, v94, v95
  v_pk_mul_f32 v[98:99], v[98:99], v[36:37] op_sel_hi:[1,0]
  v_cvt_pk_bf16_f32 v208, v96, v97
  v_pk_mul_f32 v[100:101], v[100:101], v[36:37] op_sel_hi:[1,0]
  v_cvt_pk_bf16_f32 v209, v98, v99
  v_pk_mul_f32 v[102:103], v[102:103], v[36:37] op_sel_hi:[1,0]
  v_cvt_pk_bf16_f32 v210, v100, v101
  v_pk_mul_f32 v[104:105], v[104:105], v[36:37] op_sel_hi:[1,0]
  v_cvt_pk_bf16_f32 v211, v102, v103
  v_pk_mul_f32 v[106:107], v[106:107], v[36:37] op_sel_hi:[1,0]
  v_cvt_pk_bf16_f32 v212, v104, v105
  v_pk_mul_f32 v[108:109], v[108:109], v[36:37] op_sel_hi:[1,0]
  v_cvt_pk_bf16_f32 v213, v106, v107
  v_pk_mul_f32 v[110:111], v[110:111], v[36:37] op_sel_hi:[1,0]
  v_cvt_pk_bf16_f32 v214, v108, v109
  v_pk_mul_f32 v[112:113], v[112:113], v[36:37] op_sel_hi:[1,0]
  v_cvt_pk_bf16_f32 v215, v110, v111
  v_pk_mul_f32 v[114:115], v[114:115], v[36:37] op_sel_hi:[1,0]
  v_cvt_pk_bf16_f32 v216, v112, v113
  v_pk_mul_f32 v[116:117], v[116:117], v[36:37] op_sel_hi:[1,0]
  v_cvt_pk_bf16_f32 v217, v114, v115
  v_pk_mul_f32 v[118:119], v[118:119], v[36:37] op_sel_hi:[1,0]
  v_cvt_pk_bf16_f32 v218, v116, v117
  v_pk_mul_f32 v[120:121], v[120:121], v[36:37] op_sel_hi:[1,0]
  v_cvt_pk_bf16_f32 v219, v118, v119
  v_pk_mul_f32 v[122:123], v[122:123], v[36:37] op_sel_hi:[1,0]
  v_cvt_pk_bf16_f32 v220, v120, v121
  v_pk_mul_f32 v[124:125], v[124:125], v[36:37] op_sel_hi:[1,0]
  v_cvt_pk_bf16_f32 v221, v122, v123
  v_pk_mul_f32 v[126:127], v[126:127], v[36:37] op_sel_hi:[1,0]
  v_cvt_pk_bf16_f32 v222, v124, v125
  v_cvt_pk_bf16_f32 v223, v126, v127
  v_add_u32 v28, s39, v18
  ds_write_b128 v28, v[192:195] offset:16384
  ds_write_b128 v28, v[196:199] offset:17408
  ds_write_b128 v28, v[200:203] offset:18432
  ds_write_b128 v28, v[204:207] offset:19456
  ds_write_b128 v28, v[208:211] offset:20480
  ds_write_b128 v28, v[212:215] offset:21504
  ds_write_b128 v28, v[216:219] offset:22528
  ds_write_b128 v28, v[220:223] offset:23552
  s_waitcnt lgkmcnt(0)
  s_barrier
  s_setprio 2
  v_lshrrev_b32 v2, 9, v18
  v_lshlrev_b32 v2, 17, v2
  v_xor_b32 v3, 0, v18
  v_add_u32 v8, v3, v2
  v_xor_b32 v3, 64, v18
  v_add_u32 v9, v3, v2
  v_xor_b32 v3, 128, v18
  v_add_u32 v10, v3, v2
  v_xor_b32 v3, 192, v18
  v_add_u32 v11, v3, v2
  v_xor_b32 v8, 0x20000, v8
  v_xor_b32 v9, 0x20000, v9
  v_xor_b32 v10, 0x20000, v10
  v_xor_b32 v11, 0x20000, v11
  s_add_u32 m0, s33, 81920
  s_add_u32 s43, s33, 32768
  buffer_load_dwordx4 v8, s[24:27], s43 offen lds
  buffer_load_dwordx4 v9, s[24:27], s43 offen offset:1024 lds
  buffer_load_dwordx4 v10, s[24:27], s43 offen offset:2048 lds
  buffer_load_dwordx4 v11, s[24:27], s43 offen offset:3072 lds
  s_add_u32 m0, s33, 49152
  s_add_u32 s43, s33, 49152
  buffer_load_dwordx4 v8, s[24:27], s43 offen lds
  buffer_load_dwordx4 v9, s[24:27], s43 offen offset:1024 lds
  buffer_load_dwordx4 v10, s[24:27], s43 offen offset:2048 lds
  buffer_load_dwordx4 v11, s[24:27], s43 offen offset:3072 lds
  s_add_u32 m0, s33, 32768
  s_add_u32 s43, s33, 65536
  buffer_load_dwordx4 v8, s[24:27], s43 offen lds
  buffer_load_dwordx4 v9, s[24:27], s43 offen offset:1024 lds
  buffer_load_dwordx4 v10, s[24:27], s43 offen offset:2048 lds
  buffer_load_dwordx4 v11, s[24:27], s43 offen offset:3072 lds
  s_waitcnt lgkmcnt(0)
  s_barrier
  s_add_u32 m0, s33, 0
  s_add_u32 s43, s33, 81920
  buffer_load_dwordx4 v8, s[24:27], s43 offen lds
  buffer_load_dwordx4 v9, s[24:27], s43 offen offset:1024 lds
  buffer_load_dwordx4 v10, s[24:27], s43 offen offset:2048 lds
  buffer_load_dwordx4 v11, s[24:27], s43 offen offset:3072 lds
  s_waitcnt lgkmcnt(0)
  s_barrier
  s_add_u32 m0, s33, 147456
  s_add_u32 s43, s33, 98304
  buffer_load_dwordx4 v8, s[24:27], s43 offen lds
  buffer_load_dwordx4 v9, s[24:27], s43 offen offset:1024 lds
  buffer_load_dwordx4 v10, s[24:27], s43 offen offset:2048 lds
  buffer_load_dwordx4 v11, s[24:27], s43 offen offset:3072 lds
  s_waitcnt lgkmcnt(0)
  s_barrier
  s_add_u32 m0, s33, 131072
  s_add_u32 s43, s33, 114688
  buffer_load_dwordx4 v8, s[24:27], s43 offen lds
  buffer_load_dwordx4 v9, s[24:27], s43 offen offset:1024 lds
  buffer_load_dwordx4 v10, s[24:27], s43 offen offset:2048 lds
  buffer_load_dwordx4 v11, s[24:27], s43 offen offset:3072 lds
  s_waitcnt vmcnt(20) lgkmcnt(0)
  s_barrier
  v_xor_b32 v8, 0x20000, v8
  v_xor_b32 v9, 0x20000, v9
  v_xor_b32 v10, 0x20000, v10
  v_xor_b32 v11, 0x20000, v11
  s_add_u32 m0, s33, 114688
  s_add_u32 s43, s33, 262144
  buffer_load_dwordx4 v8, s[24:27], s43 offen lds
  buffer_load_dwordx4 v9, s[24:27], s43 offen offset:1024 lds
  buffer_load_dwordx4 v10, s[24:27], s43 offen offset:2048 lds
  buffer_load_dwordx4 v11, s[24:27], s43 offen offset:3072 lds
  s_waitcnt vmcnt(20) lgkmcnt(0)
  s_barrier
  s_add_u32 m0, s33, 98304
  s_add_u32 s43, s33, 278528
  buffer_load_dwordx4 v8, s[24:27], s43 offen lds
  buffer_load_dwordx4 v9, s[24:27], s43 offen offset:1024 lds
  buffer_load_dwordx4 v10, s[24:27], s43 offen offset:2048 lds
  buffer_load_dwordx4 v11, s[24:27], s43 offen offset:3072 lds
  s_waitcnt vmcnt(20) lgkmcnt(0)
  s_barrier
  s_add_u32 m0, s33, 81920
  s_add_u32 s43, s33, 294912
  buffer_load_dwordx4 v8, s[24:27], s43 offen lds
  buffer_load_dwordx4 v9, s[24:27], s43 offen offset:1024 lds
  buffer_load_dwordx4 v10, s[24:27], s43 offen offset:2048 lds
  buffer_load_dwordx4 v11, s[24:27], s43 offen offset:3072 lds
  s_waitcnt vmcnt(20) lgkmcnt(0)
  s_barrier
  s_add_u32 m0, s33, 49152
  s_add_u32 s43, s33, 311296
  buffer_load_dwordx4 v8, s[24:27], s43 offen lds
  buffer_load_dwordx4 v9, s[24:27], s43 offen offset:1024 lds
  buffer_load_dwordx4 v10, s[24:27], s43 offen offset:2048 lds
  buffer_load_dwordx4 v11, s[24:27], s43 offen offset:3072 lds
  s_waitcnt vmcnt(20) lgkmcnt(0)
  s_barrier
  s_add_u32 m0, s33, 32768
  s_add_u32 s43, s33, 327680
  buffer_load_dwordx4 v8, s[24:27], s43 offen lds
  buffer_load_dwordx4 v9, s[24:27], s43 offen offset:1024 lds
  buffer_load_dwordx4 v10, s[24:27], s43 offen offset:2048 lds
  buffer_load_dwordx4 v11, s[24:27], s43 offen offset:3072 lds
  s_waitcnt vmcnt(20) lgkmcnt(0)
  s_barrier
  s_add_u32 m0, s33, 0
  s_add_u32 s43, s33, 344064
  buffer_load_dwordx4 v8, s[24:27], s43 offen lds
  buffer_load_dwordx4 v9, s[24:27], s43 offen offset:1024 lds
  buffer_load_dwordx4 v10, s[24:27], s43 offen offset:2048 lds
  buffer_load_dwordx4 v11, s[24:27], s43 offen offset:3072 lds
  s_waitcnt vmcnt(20) lgkmcnt(0)
  s_barrier
  s_add_u32 m0, s33, 147456
  s_add_u32 s43, s33, 360448
  buffer_load_dwordx4 v8, s[24:27], s43 offen lds
  buffer_load_dwordx4 v9, s[24:27], s43 offen offset:1024 lds
  buffer_load_dwordx4 v10, s[24:27], s43 offen offset:2048 lds
  buffer_load_dwordx4 v11, s[24:27], s43 offen offset:3072 lds
  s_waitcnt vmcnt(20) lgkmcnt(0)
  s_barrier
  s_add_u32 m0, s33, 131072
  s_add_u32 s43, s33, 376832
  buffer_load_dwordx4 v8, s[24:27], s43 offen lds
  buffer_load_dwordx4 v9, s[24:27], s43 offen offset:1024 lds
  buffer_load_dwordx4 v10, s[24:27], s43 offen offset:2048 lds
  buffer_load_dwordx4 v11, s[24:27], s43 offen offset:3072 lds
  s_waitcnt vmcnt(20) lgkmcnt(0)
  s_barrier
  v_xor_b32 v8, 0x20000, v8
  v_xor_b32 v9, 0x20000, v9
  v_xor_b32 v10, 0x20000, v10
  v_xor_b32 v11, 0x20000, v11
  s_add_u32 m0, s33, 114688
  s_add_u32 s43, s33, 262144
  buffer_load_dwordx4 v8, s[24:27], s43 offen lds
  buffer_load_dwordx4 v9, s[24:27], s43 offen offset:1024 lds
  buffer_load_dwordx4 v10, s[24:27], s43 offen offset:2048 lds
  buffer_load_dwordx4 v11, s[24:27], s43 offen offset:3072 lds
  s_add_u32 m0, s33, 65536
  s_add_u32 s43, s33, 278528
  buffer_load_dwordx4 v8, s[24:27], s43 offen lds
  buffer_load_dwordx4 v9, s[24:27], s43 offen offset:1024 lds
  buffer_load_dwordx4 v10, s[24:27], s43 offen offset:2048 lds
  buffer_load_dwordx4 v11, s[24:27], s43 offen offset:3072 lds
  s_add_u32 m0, s33, 16384
  s_add_u32 s43, s33, 294912
  buffer_load_dwordx4 v8, s[24:27], s43 offen lds
  buffer_load_dwordx4 v9, s[24:27], s43 offen offset:1024 lds
  buffer_load_dwordx4 v10, s[24:27], s43 offen offset:2048 lds
  buffer_load_dwordx4 v11, s[24:27], s43 offen offset:3072 lds
  s_waitcnt vmcnt(28) lgkmcnt(0)
  s_barrier
  s_add_u32 m0, s33, 98304
  s_add_u32 s43, s33, 311296
  buffer_load_dwordx4 v8, s[24:27], s43 offen lds
  buffer_load_dwordx4 v9, s[24:27], s43 offen offset:1024 lds
  buffer_load_dwordx4 v10, s[24:27], s43 offen offset:2048 lds
  buffer_load_dwordx4 v11, s[24:27], s43 offen offset:3072 lds
  s_waitcnt vmcnt(28) lgkmcnt(0)
  s_barrier
  s_add_u32 m0, s33, 81920
  s_add_u32 s43, s33, 327680
  buffer_load_dwordx4 v8, s[24:27], s43 offen lds
  buffer_load_dwordx4 v9, s[24:27], s43 offen offset:1024 lds
  buffer_load_dwordx4 v10, s[24:27], s43 offen offset:2048 lds
  buffer_load_dwordx4 v11, s[24:27], s43 offen offset:3072 lds
  s_waitcnt vmcnt(28) lgkmcnt(0)
  s_barrier
  s_add_u32 m0, s33, 49152
  s_add_u32 s43, s33, 344064
  buffer_load_dwordx4 v8, s[24:27], s43 offen lds
  buffer_load_dwordx4 v9, s[24:27], s43 offen offset:1024 lds
  buffer_load_dwordx4 v10, s[24:27], s43 offen offset:2048 lds
  buffer_load_dwordx4 v11, s[24:27], s43 offen offset:3072 lds
  s_waitcnt vmcnt(28) lgkmcnt(0)
  s_barrier
  s_add_u32 m0, s33, 32768
  s_add_u32 s43, s33, 360448
  buffer_load_dwordx4 v8, s[24:27], s43 offen lds
  buffer_load_dwordx4 v9, s[24:27], s43 offen offset:1024 lds
  buffer_load_dwordx4 v10, s[24:27], s43 offen offset:2048 lds
  buffer_load_dwordx4 v11, s[24:27], s43 offen offset:3072 lds
  s_waitcnt vmcnt(28) lgkmcnt(0)
  s_barrier
  s_add_u32 m0, s33, 0
  s_add_u32 s43, s33, 376832
  buffer_load_dwordx4 v8, s[24:27], s43 offen lds
  buffer_load_dwordx4 v9, s[24:27], s43 offen offset:1024 lds
  buffer_load_dwordx4 v10, s[24:27], s43 offen offset:2048 lds
  buffer_load_dwordx4 v11, s[24:27], s43 offen offset:3072 lds
  s_waitcnt vmcnt(28) lgkmcnt(0)
  s_barrier
  s_waitcnt vmcnt(0) lgkmcnt(0)
  s_barrier
  s_branch L_final
L_rare_37:
  s_waitcnt lgkmcnt(0)
  v_mfma_f32_32x32x16_bf16 v[96:111], v[136:139], v[56:59], v[96:111]
  ds_read_b128 v[136:139], v242 offset:32768
  v_mfma_f32_32x32x16_bf16 v[112:127], v[140:143], v[56:59], v[112:127]
  ds_read_b128 v[140:143], v243 offset:32768
  v_mfma_f32_32x32x16_bf16 v[64:79], v[144:147], v[60:63], v[64:79]
  ds_read_b128 v[144:147], v244 offset:32768
  v_mfma_f32_32x32x16_bf16 v[80:95], v[148:151], v[60:63], v[80:95]
  ds_read_b128 v[148:151], v245 offset:32768
  v_mfma_f32_32x32x16_bf16 v[96:111], v[152:155], v[60:63], v[96:111]
  ds_read_b128 v[152:155], v246 offset:32768
  v_mfma_f32_32x32x16_bf16 v[112:127], v[156:159], v[60:63], v[112:127]
  ds_read_b128 v[156:159], v247 offset:32768
  v_mov_b32 v37, v36
  s_nop 1
  v_permlane32_swap_b32 v36, v37
  s_nop 1
  v_max3_f32 v36, v36, v37, 0
  v_sub_f32 v37, 0, v36
  v_exp_f32 v37, v37
  v_sub_f32 v224, v40, v36
  v_sub_f32 v160, v160, v36
  v_sub_f32 v225, v41, v36
  v_sub_f32 v161, v161, v36
  v_sub_f32 v226, v42, v36
  v_sub_f32 v162, v162, v36
  v_sub_f32 v227, v43, v36
  v_sub_f32 v163, v163, v36
  v_sub_f32 v228, v44, v36
  v_sub_f32 v164, v164, v36
  v_sub_f32 v229, v45, v36
  v_sub_f32 v165, v165, v36
  v_sub_f32 v230, v46, v36
  v_sub_f32 v166, v166, v36
  v_sub_f32 v231, v47, v36
  v_sub_f32 v167, v167, v36
  v_sub_f32 v232, v48, v36
  v_sub_f32 v168, v168, v36
  v_sub_f32 v233, v49, v36
  v_sub_f32 v169, v169, v36
  v_sub_f32 v234, v50, v36
  v_sub_f32 v170, v170, v36
  v_sub_f32 v235, v51, v36
  v_sub_f32 v171, v171, v36
  v_sub_f32 v236, v52, v36
  v_sub_f32 v172, v172, v36
  v_sub_f32 v237, v53, v36
  v_sub_f32 v173, v173, v36
  v_sub_f32 v238, v54, v36
  v_sub_f32 v174, v174, v36
  v_sub_f32 v239, v55, v36
  v_sub_f32 v175, v175, v36
  v_exp_f32 v224, v224
  v_exp_f32 v225, v225
  v_exp_f32 v226, v226
  v_exp_f32 v227, v227
  v_exp_f32 v228, v228
  v_exp_f32 v229, v229
  v_exp_f32 v230, v230
  v_exp_f32 v231, v231
  v_exp_f32 v232, v232
  v_exp_f32 v233, v233
  v_exp_f32 v234, v234
  v_exp_f32 v235, v235
  v_exp_f32 v236, v236
  v_exp_f32 v237, v237
  v_exp_f32 v238, v238
  v_exp_f32 v239, v239
  v_mul_f32 v252, v252, v37
  v_mul_f32 v64, v64, v37
  v_mul_f32 v65, v65, v37
  v_mul_f32 v66, v66, v37
  v_mul_f32 v67, v67, v37
  v_mul_f32 v68, v68, v37
  v_mul_f32 v69, v69, v37
  v_mul_f32 v70, v70, v37
  v_mul_f32 v71, v71, v37
  v_mul_f32 v72, v72, v37
  v_mul_f32 v73, v73, v37
  v_mul_f32 v74, v74, v37
  v_mul_f32 v75, v75, v37
  v_mul_f32 v76, v76, v37
  v_mul_f32 v77, v77, v37
  v_mul_f32 v78, v78, v37
  v_mul_f32 v79, v79, v37
  v_mul_f32 v80, v80, v37
  v_mul_f32 v81, v81, v37
  v_mul_f32 v82, v82, v37
  v_mul_f32 v83, v83, v37
  v_mul_f32 v84, v84, v37
  v_mul_f32 v85, v85, v37
  v_mul_f32 v86, v86, v37
  v_mul_f32 v87, v87, v37
  v_mul_f32 v88, v88, v37
  v_mul_f32 v89, v89, v37
  v_mul_f32 v90, v90, v37
  v_mul_f32 v91, v91, v37
  v_mul_f32 v92, v92, v37
  v_mul_f32 v93, v93, v37
  v_mul_f32 v94, v94, v37
  v_mul_f32 v95, v95, v37
  v_mul_f32 v96, v96, v37
  v_mul_f32 v97, v97, v37
  v_mul_f32 v98, v98, v37
  v_mul_f32 v99, v99, v37
  v_mul_f32 v100, v100, v37
  v_mul_f32 v101, v101, v37
  v_mul_f32 v102, v102, v37
  v_mul_f32 v103, v103, v37
  v_mul_f32 v104, v104, v37
  v_mul_f32 v105, v105, v37
  v_mul_f32 v106, v106, v37
  v_mul_f32 v107, v107, v37
  v_mul_f32 v108, v108, v37
  v_mul_f32 v109, v109, v37
  v_mul_f32 v110, v110, v37
  v_mul_f32 v111, v111, v37
  v_mul_f32 v112, v112, v37
  v_mul_f32 v113, v113, v37
  v_mul_f32 v114, v114, v37
  v_mul_f32 v115, v115, v37
  v_mul_f32 v116, v116, v37
  v_mul_f32 v117, v117, v37
  v_mul_f32 v118, v118, v37
  v_mul_f32 v119, v119, v37
  v_mul_f32 v120, v120, v37
  v_mul_f32 v121, v121, v37
  v_mul_f32 v122, v122, v37
  v_mul_f32 v123, v123, v37
  v_mul_f32 v124, v124, v37
  v_mul_f32 v125, v125, v37
  v_mul_f32 v126, v126, v37
  v_mul_f32 v127, v127, v37
  s_waitcnt lgkmcnt(0)
  s_branch L_back_38
L_rare_39:
  s_waitcnt lgkmcnt(0)
  v_mfma_f32_32x32x16_bf16 v[96:111], v[136:139], v[56:59], v[96:111]
  ds_read_b128 v[136:139], v242 offset:0
  v_mfma_f32_32x32x16_bf16 v[112:127], v[140:143], v[56:59], v[112:127]
  ds_read_b128 v[140:143], v243 offset:0
  v_mfma_f32_32x32x16_bf16 v[64:79], v[144:147], v[60:63], v[64:79]
  ds_read_b128 v[144:147], v244 offset:0
  v_mfma_f32_32x32x16_bf16 v[80:95], v[148:151], v[60:63], v[80:95]
  ds_read_b128 v[148:151], v245 offset:0
  v_mfma_f32_32x32x16_bf16 v[96:111], v[152:155], v[60:63], v[96:111]
  ds_read_b128 v[152:155], v246 offset:0
  v_mfma_f32_32x32x16_bf16 v[112:127], v[156:159], v[60:63], v[112:127]
  ds_read_b128 v[156:159], v247 offset:0
  v_mov_b32 v37, v36
  s_nop 1
  v_permlane32_swap_b32 v36, v37
  s_nop 1
  v_max3_f32 v36, v36, v37, 0
  v_sub_f32 v37, 0, v36
  v_exp_f32 v37, v37
  v_sub_f32 v224, v40, v36
  v_sub_f32 v160, v160, v36
  v_sub_f32 v225, v41, v36
  v_sub_f32 v161, v161, v36
  v_sub_f32 v226, v42, v36
  v_sub_f32 v162, v162, v36
  v_sub_f32 v227, v43, v36
  v_sub_f32 v163, v163, v36
  v_sub_f32 v228, v44, v36
  v_sub_f32 v164, v164, v36
  v_sub_f32 v229, v45, v36
  v_sub_f32 v165, v165, v36
  v_sub_f32 v230, v46, v36
  v_sub_f32 v166, v166, v36
  v_sub_f32 v231, v47, v36
  v_sub_f32 v167, v167, v36
  v_sub_f32 v232, v48, v36
  v_sub_f32 v168, v168, v36
  v_sub_f32 v233, v49, v36
  v_sub_f32 v169, v169, v36
  v_sub_f32 v234, v50, v36
  v_sub_f32 v170, v170, v36
  v_sub_f32 v235, v51, v36
  v_sub_f32 v171, v171, v36
  v_sub_f32 v236, v52, v36
  v_sub_f32 v172, v172, v36
  v_sub_f32 v237, v53, v36
  v_sub_f32 v173, v173, v36
  v_sub_f32 v238, v54, v36
  v_sub_f32 v174, v174, v36
  v_sub_f32 v239, v55, v36
  v_sub_f32 v175, v175, v36
  v_exp_f32 v224, v224
  v_exp_f32 v225, v225
  v_exp_f32 v226, v226
  v_exp_f32 v227, v227
  v_exp_f32 v228, v228
  v_exp_f32 v229, v229
  v_exp_f32 v230, v230
  v_exp_f32 v231, v231
  v_exp_f32 v232, v232
  v_exp_f32 v233, v233
  v_exp_f32 v234, v234
  v_exp_f32 v235, v235
  v_exp_f32 v236, v236
  v_exp_f32 v237, v237
  v_exp_f32 v238, v238
  v_exp_f32 v239, v239
  v_mul_f32 v252, v252, v37
  v_mul_f32 v64, v64, v37
  v_mul_f32 v65, v65, v37
  v_mul_f32 v66, v66, v37
  v_mul_f32 v67, v67, v37
  v_mul_f32 v68, v68, v37
  v_mul_f32 v69, v69, v37
  v_mul_f32 v70, v70, v37
  v_mul_f32 v71, v71, v37
  v_mul_f32 v72, v72, v37
  v_mul_f32 v73, v73, v37
  v_mul_f32 v74, v74, v37
  v_mul_f32 v75, v75, v37
  v_mul_f32 v76, v76, v37
  v_mul_f32 v77, v77, v37
  v_mul_f32 v78, v78, v37
  v_mul_f32 v79, v79, v37
  v_mul_f32 v80, v80, v37
  v_mul_f32 v81, v81, v37
  v_mul_f32 v82, v82, v37
  v_mul_f32 v83, v83, v37
  v_mul_f32 v84, v84, v37
  v_mul_f32 v85, v85, v37
  v_mul_f32 v86, v86, v37
  v_mul_f32 v87, v87, v37
  v_mul_f32 v88, v88, v37
  v_mul_f32 v89, v89, v37
  v_mul_f32 v90, v90, v37
  v_mul_f32 v91, v91, v37
  v_mul_f32 v92, v92, v37
  v_mul_f32 v93, v93, v37
  v_mul_f32 v94, v94, v37
  v_mul_f32 v95, v95, v37
  v_mul_f32 v96, v96, v37
  v_mul_f32 v97, v97, v37
  v_mul_f32 v98, v98, v37
  v_mul_f32 v99, v99, v37
  v_mul_f32 v100, v100, v37
  v_mul_f32 v101, v101, v37
  v_mul_f32 v102, v102, v37
  v_mul_f32 v103, v103, v37
  v_mul_f32 v104, v104, v37
  v_mul_f32 v105, v105, v37
  v_mul_f32 v106, v106, v37
  v_mul_f32 v107, v107, v37
  v_mul_f32 v108, v108, v37
  v_mul_f32 v109, v109, v37
  v_mul_f32 v110, v110, v37
  v_mul_f32 v111, v111, v37
  v_mul_f32 v112, v112, v37
  v_mul_f32 v113, v113, v37
  v_mul_f32 v114, v114, v37
  v_mul_f32 v115, v115, v37
  v_mul_f32 v116, v116, v37
  v_mul_f32 v117, v117, v37
  v_mul_f32 v118, v118, v37
  v_mul_f32 v119, v119, v37
  v_mul_f32 v120, v120, v37
  v_mul_f32 v121, v121, v37
  v_mul_f32 v122, v122, v37
  v_mul_f32 v123, v123, v37
  v_mul_f32 v124, v124, v37
  v_mul_f32 v125, v125, v37
  v_mul_f32 v126, v126, v37
  v_mul_f32 v127, v127, v37
  s_waitcnt lgkmcnt(0)
  s_branch L_back_40
L_rare_41:
  s_waitcnt lgkmcnt(0)
  v_mfma_f32_32x32x16_bf16 v[96:111], v[136:139], v[56:59], v[96:111]
  ds_read_b128 v[136:139], v242 offset:16384
  v_mfma_f32_32x32x16_bf16 v[112:127], v[140:143], v[56:59], v[112:127]
  ds_read_b128 v[140:143], v243 offset:16384
  v_mfma_f32_32x32x16_bf16 v[64:79], v[144:147], v[60:63], v[64:79]
  ds_read_b128 v[144:147], v244 offset:16384
  v_mfma_f32_32x32x16_bf16 v[80:95], v[148:151], v[60:63], v[80:95]
  ds_read_b128 v[148:151], v245 offset:16384
  v_mfma_f32_32x32x16_bf16 v[96:111], v[152:155], v[60:63], v[96:111]
  ds_read_b128 v[152:155], v246 offset:16384
  v_mfma_f32_32x32x16_bf16 v[112:127], v[156:159], v[60:63], v[112:127]
  ds_read_b128 v[156:159], v247 offset:16384
  v_mov_b32 v37, v36
  s_nop 1
  v_permlane32_swap_b32 v36, v37
  s_nop 1
  v_max3_f32 v36, v36, v37, 0
  v_sub_f32 v37, 0, v36
  v_exp_f32 v37, v37
  v_sub_f32 v224, v40, v36
  v_sub_f32 v160, v160, v36
  v_sub_f32 v225, v41, v36
  v_sub_f32 v161, v161, v36
  v_sub_f32 v226, v42, v36
  v_sub_f32 v162, v162, v36
  v_sub_f32 v227, v43, v36
  v_sub_f32 v163, v163, v36
  v_sub_f32 v228, v44, v36
  v_sub_f32 v164, v164, v36
  v_sub_f32 v229, v45, v36
  v_sub_f32 v165, v165, v36
  v_sub_f32 v230, v46, v36
  v_sub_f32 v166, v166, v36
  v_sub_f32 v231, v47, v36
  v_sub_f32 v167, v167, v36
  v_sub_f32 v232, v48, v36
  v_sub_f32 v168, v168, v36
  v_sub_f32 v233, v49, v36
  v_sub_f32 v169, v169, v36
  v_sub_f32 v234, v50, v36
  v_sub_f32 v170, v170, v36
  v_sub_f32 v235, v51, v36
  v_sub_f32 v171, v171, v36
  v_sub_f32 v236, v52, v36
  v_sub_f32 v172, v172, v36
  v_sub_f32 v237, v53, v36
  v_sub_f32 v173, v173, v36
  v_sub_f32 v238, v54, v36
  v_sub_f32 v174, v174, v36
  v_sub_f32 v239, v55, v36
  v_sub_f32 v175, v175, v36
  v_exp_f32 v224, v224
  v_exp_f32 v225, v225
  v_exp_f32 v226, v226
  v_exp_f32 v227, v227
  v_exp_f32 v228, v228
  v_exp_f32 v229, v229
  v_exp_f32 v230, v230
  v_exp_f32 v231, v231
  v_exp_f32 v232, v232
  v_exp_f32 v233, v233
  v_exp_f32 v234, v234
  v_exp_f32 v235, v235
  v_exp_f32 v236, v236
  v_exp_f32 v237, v237
  v_exp_f32 v238, v238
  v_exp_f32 v239, v239
  v_mul_f32 v252, v252, v37
  v_mul_f32 v64, v64, v37
  v_mul_f32 v65, v65, v37
  v_mul_f32 v66, v66, v37
  v_mul_f32 v67, v67, v37
  v_mul_f32 v68, v68, v37
  v_mul_f32 v69, v69, v37
  v_mul_f32 v70, v70, v37
  v_mul_f32 v71, v71, v37
  v_mul_f32 v72, v72, v37
  v_mul_f32 v73, v73, v37
  v_mul_f32 v74, v74, v37
  v_mul_f32 v75, v75, v37
  v_mul_f32 v76, v76, v37
  v_mul_f32 v77, v77, v37
  v_mul_f32 v78, v78, v37
  v_mul_f32 v79, v79, v37
  v_mul_f32 v80, v80, v37
  v_mul_f32 v81, v81, v37
  v_mul_f32 v82, v82, v37
  v_mul_f32 v83, v83, v37
  v_mul_f32 v84, v84, v37
  v_mul_f32 v85, v85, v37
  v_mul_f32 v86, v86, v37
  v_mul_f32 v87, v87, v37
  v_mul_f32 v88, v88, v37
  v_mul_f32 v89, v89, v37
  v_mul_f32 v90, v90, v37
  v_mul_f32 v91, v91, v37
  v_mul_f32 v92, v92, v37
  v_mul_f32 v93, v93, v37
  v_mul_f32 v94, v94, v37
  v_mul_f32 v95, v95, v37
  v_mul_f32 v96, v96, v37
  v_mul_f32 v97, v97, v37
  v_mul_f32 v98, v98, v37
  v_mul_f32 v99, v99, v37
  v_mul_f32 v100, v100, v37
  v_mul_f32 v101, v101, v37
  v_mul_f32 v102, v102, v37
  v_mul_f32 v103, v103, v37
  v_mul_f32 v104, v104, v37
  v_mul_f32 v105, v105, v37
  v_mul_f32 v106, v106, v37
  v_mul_f32 v107, v107, v37
  v_mul_f32 v108, v108, v37
  v_mul_f32 v109, v109, v37
  v_mul_f32 v110, v110, v37
  v_mul_f32 v111, v111, v37
  v_mul_f32 v112, v112, v37
  v_mul_f32 v113, v113, v37
  v_mul_f32 v114, v114, v37
  v_mul_f32 v115, v115, v37
  v_mul_f32 v116, v116, v37
  v_mul_f32 v117, v117, v37
  v_mul_f32 v118, v118, v37
  v_mul_f32 v119, v119, v37
  v_mul_f32 v120, v120, v37
  v_mul_f32 v121, v121, v37
  v_mul_f32 v122, v122, v37
  v_mul_f32 v123, v123, v37
  v_mul_f32 v124, v124, v37
  v_mul_f32 v125, v125, v37
  v_mul_f32 v126, v126, v37
  v_mul_f32 v127, v127, v37
  s_waitcnt lgkmcnt(0)
  s_branch L_back_42
L_rare_43:
  s_waitcnt lgkmcnt(0)
  v_mfma_f32_32x32x16_bf16 v[96:111], v[136:139], v[56:59], v[96:111]
  ds_read_b64_tr_b16 v[136:137], v250 offset:40960
  ds_read_b64_tr_b16 v[138:139], v250 offset:43008
  v_mfma_f32_32x32x16_bf16 v[112:127], v[140:143], v[56:59], v[112:127]
  ds_read_b64_tr_b16 v[140:141], v251 offset:40960
  ds_read_b64_tr_b16 v[142:143], v251 offset:43008
  v_mfma_f32_32x32x16_bf16 v[64:79], v[144:147], v[60:63], v[64:79]
  ds_read_b64_tr_b16 v[144:145], v248 offset:45056
  ds_read_b64_tr_b16 v[146:147], v248 offset:47104
  v_mfma_f32_32x32x16_bf16 v[80:95], v[148:151], v[60:63], v[80:95]
  ds_read_b64_tr_b16 v[148:149], v249 offset:45056
  ds_read_b64_tr_b16 v[150:151], v249 offset:47104
  v_mfma_f32_32x32x16_bf16 v[96:111], v[152:155], v[60:63], v[96:111]
  ds_read_b64_tr_b16 v[152:153], v250 offset:45056
  ds_read_b64_tr_b16 v[154:155], v250 offset:47104
  v_mfma_f32_32x32x16_bf16 v[112:127], v[156:159], v[60:63], v[112:127]
  ds_read_b64_tr_b16 v[156:157], v251 offset:45056
  ds_read_b64_tr_b16 v[158:159], v251 offset:47104
  v_mov_b32 v37, v36
  s_nop 1
  v_permlane32_swap_b32 v36, v37
  s_nop 1
  v_max3_f32 v36, v36, v37, 0
  v_sub_f32 v37, 0, v36
  v_exp_f32 v37, v37
  v_sub_f32 v224, v40, v36
  v_sub_f32 v160, v160, v36
  v_sub_f32 v225, v41, v36
  v_sub_f32 v161, v161, v36
  v_sub_f32 v226, v42, v36
  v_sub_f32 v162, v162, v36
  v_sub_f32 v227, v43, v36
  v_sub_f32 v163, v163, v36
  v_sub_f32 v228, v44, v36
  v_sub_f32 v164, v164, v36
  v_sub_f32 v229, v45, v36
  v_sub_f32 v165, v165, v36
  v_sub_f32 v230, v46, v36
  v_sub_f32 v166, v166, v36
  v_sub_f32 v231, v47, v36
  v_sub_f32 v167, v167, v36
  v_sub_f32 v232, v48, v36
  v_sub_f32 v168, v168, v36
  v_sub_f32 v233, v49, v36
  v_sub_f32 v169, v169, v36
  v_sub_f32 v234, v50, v36
  v_sub_f32 v170, v170, v36
  v_sub_f32 v235, v51, v36
  v_sub_f32 v171, v171, v36
  v_sub_f32 v236, v52, v36
  v_sub_f32 v172, v172, v36
  v_sub_f32 v237, v53, v36
  v_sub_f32 v173, v173, v36
  v_sub_f32 v238, v54, v36
  v_sub_f32 v174, v174, v36
  v_sub_f32 v239, v55, v36
  v_sub_f32 v175, v175, v36
  v_exp_f32 v224, v224
  v_exp_f32 v225, v225
  v_exp_f32 v226, v226
  v_exp_f32 v227, v227
  v_exp_f32 v228, v228
  v_exp_f32 v229, v229
  v_exp_f32 v230, v230
  v_exp_f32 v231, v231
  v_exp_f32 v232, v232
  v_exp_f32 v233, v233
  v_exp_f32 v234, v234
  v_exp_f32 v235, v235
  v_exp_f32 v236, v236
  v_exp_f32 v237, v237
  v_exp_f32 v238, v238
  v_exp_f32 v239, v239
  v_mul_f32 v252, v252, v37
  v_mul_f32 v64, v64, v37
  v_mul_f32 v65, v65, v37
  v_mul_f32 v66, v66, v37
  v_mul_f32 v67, v67, v37
  v_mul_f32 v68, v68, v37
  v_mul_f32 v69, v69, v37
  v_mul_f32 v70, v70, v37
  v_mul_f32 v71, v71, v37
  v_mul_f32 v72, v72, v37
  v_mul_f32 v73, v73, v37
  v_mul_f32 v74, v74, v37
  v_mul_f32 v75, v75, v37
  v_mul_f32 v76, v76, v37
  v_mul_f32 v77, v77, v37
  v_mul_f32 v78, v78, v37
  v_mul_f32 v79, v79, v37
  v_mul_f32 v80, v80, v37
  v_mul_f32 v81, v81, v37
  v_mul_f32 v82, v82, v37
  v_mul_f32 v83, v83, v37
  v_mul_f32 v84, v84, v37
  v_mul_f32 v85, v85, v37
  v_mul_f32 v86, v86, v37
  v_mul_f32 v87, v87, v37
  v_mul_f32 v88, v88, v37
  v_mul_f32 v89, v89, v37
  v_mul_f32 v90, v90, v37
  v_mul_f32 v91, v91, v37
  v_mul_f32 v92, v92, v37
  v_mul_f32 v93, v93, v37
  v_mul_f32 v94, v94, v37
  v_mul_f32 v95, v95, v37
  v_mul_f32 v96, v96, v37
  v_mul_f32 v97, v97, v37
  v_mul_f32 v98, v98, v37
  v_mul_f32 v99, v99, v37
  v_mul_f32 v100, v100, v37
  v_mul_f32 v101, v101, v37
  v_mul_f32 v102, v102, v37
  v_mul_f32 v103, v103, v37
  v_mul_f32 v104, v104, v37
  v_mul_f32 v105, v105, v37
  v_mul_f32 v106, v106, v37
  v_mul_f32 v107, v107, v37
  v_mul_f32 v108, v108, v37
  v_mul_f32 v109, v109, v37
  v_mul_f32 v110, v110, v37
  v_mul_f32 v111, v111, v37
  v_mul_f32 v112, v112, v37
  v_mul_f32 v113, v113, v37
  v_mul_f32 v114, v114, v37
  v_mul_f32 v115, v115, v37
  v_mul_f32 v116, v116, v37
  v_mul_f32 v117, v117, v37
  v_mul_f32 v118, v118, v37
  v_mul_f32 v119, v119, v37
  v_mul_f32 v120, v120, v37
  v_mul_f32 v121, v121, v37
  v_mul_f32 v122, v122, v37
  v_mul_f32 v123, v123, v37
  v_mul_f32 v124, v124, v37
  v_mul_f32 v125, v125, v37
  v_mul_f32 v126, v126, v37
  v_mul_f32 v127, v127, v37
  s_waitcnt lgkmcnt(0)
  s_branch L_back_44
L_BG0:
  s_load_dwordx2 s[58:59], s[0:1], 80
  v_mov_b32 v2, 0
  s_mov_b64 exec, 1
  s_sub_u32 s43, s10, 4
  buffer_load_dword v12, v2, s[8:11], 0 offen
  buffer_load_dword v12, v2, s[8:11], s43 offen
  s_lshl_b32 s43, s45, 17
  buffer_load_dword v12, v2, s[24:27], s43 offen
  buffer_load_dword v12, v2, s[28:31], 0 offen sc1
  s_lshl_b32 s43, s6, 17
  v_mov_b32 v3, s43
  s_waitcnt lgkmcnt(0)
  global_load_dword v12, v3, s[58:59]
  s_mov_b64 exec, -1
  v_lshrrev_b32 v2, 4, v1
  v_and_b32 v3, 15, v1
  v_lshlrev_b32 v19, 2, v2
  s_bitcmp1_b32 s3, 0
  s_cselect_b64 vcc, -1, 0
  v_add_u32 v29, 0, v2
  v_cndmask_b32 v29, v29, v19, vcc
  v_xor_b32 v29, v29, v3
  v_lshlrev_b32 v29, 4, v29
  v_lshl_add_u32 v4, v2, 8, v29
  v_add_u32 v29, 4, v2
  v_cndmask_b32 v29, v29, v19, vcc
  v_xor_b32 v29, v29, v3
  v_lshlrev_b32 v29, 4, v29
  v_lshl_add_u32 v5, v2, 8, v29
  v_add_u32 v29, 8, v2
  v_cndmask_b32 v29, v29, v19, vcc
  v_xor_b32 v29, v29, v3
  v_lshlrev_b32 v29, 4, v29
  v_lshl_add_u32 v6, v2, 8, v29
  v_add_u32 v29, 12, v2
  v_cndmask_b32 v29, v29, v19, vcc
  v_xor_b32 v29, v29, v3
  v_lshlrev_b32 v29, 4, v29
  v_lshl_add_u32 v7, v2, 8, v29
  v_and_b32 v2, 31, v1
  v_lshrrev_b32 v3, 5, v1
  v_and_b32 v19, 15, v1
  v_xor_b32 v19, v19, v3
  v_lshlrev_b32 v19, 4, v19
  v_lshl_add_u32 v13, v2, 8, v19
  v_lshl_add_u32 v19, v2, 9, v19
  s_lshl_b32 s43, s47, 14
  v_add_u32 v16, s43, v19
  v_bfe_u32 v32, v1, 4, 1
  v_bfe_u32 v33, v1, 2, 2
  v_and_b32 v34, 1, v1
  v_bfe_u32 v35, v1, 1, 1
  v_lshlrev_b32 v36, 1, v34
  v_or_b32 v36, v36, v35
  v_lshl_add_u32 v36, v32, 2, v36
  v_lshlrev_b32 v36, 3, v36
  v_lshl_add_u32 v36, v33, 6, v36
  v_lshlrev_b32 v37, 2, v3
  v_add_u32 v37, v37, v33
  v_lshl_add_u32 v14, v37, 8, v36
  v_lshlrev_b32 v37, 3, v3
  v_add_u32 v37, v37, v33
  v_lshl_add_u32 v38, v37, 9, v36
  s_lshl_b32 s43, s46, 8
  v_add_u32 v15, s43, v38
  v_lshlrev_b32 v36, 2, v34
  v_lshl_add_u32 v36, v32, 1, v36
  v_add_u32 v36, v36, v35
  v_lshlrev_b32 v36, 3, v36
  v_lshl_add_u32 v36, v33, 6, v36
  v_lshl_add_u32 v38, v37, 10, v36
  s_lshl_b32 s43, s46, 9
  v_add_u32 v17, s43, v38
  s_waitcnt vmcnt(5) lgkmcnt(0)
  s_barrier
  v_xor_b32 v2, 32, v16
  v_xor_b32 v3, 64, v16
  v_xor_b32 v24, 96, v16
  v_xor_b32 v25, 128, v16
  v_xor_b32 v26, 160, v16
  v_xor_b32 v27, 192, v16
  v_xor_b32 v28, 224, v16
  ds_read_b128 v[128:131], v16 offset:0
  ds_read_b128 v[132:135], v2 offset:0
  ds_read_b128 v[136:139], v3 offset:0
  ds_read_b128 v[140:143], v24 offset:0
  ds_read_b128 v[144:147], v25 offset:0
  ds_read_b128 v[148:151], v26 offset:0
  ds_read_b128 v[152:155], v27 offset:0
  ds_read_b128 v[156:159], v28 offset:0
  ds_read_b128 v[160:163], v16 offset:256
  ds_read_b128 v[164:167], v2 offset:256
  ds_read_b128 v[168:171], v3 offset:256
  ds_read_b128 v[172:175], v24 offset:256
  ds_read_b128 v[176:179], v25 offset:256
  ds_read_b128 v[180:183], v26 offset:256
  ds_read_b128 v[184:187], v27 offset:256
  s_waitcnt lgkmcnt(14)
  ds_read_b128 v[188:191], v28 offset:256
  v_xor_b32 v20, 0x200, v20
  v_xor_b32 v21, 0x200, v21
  v_xor_b32 v22, 0x200, v22
  v_xor_b32 v23, 0x200, v23
  s_lshl_b32 s43, s3, 12
  s_add_u32 m0, s43, 49152
  s_lshl_b32 s43, s3, 13
  buffer_load_dwordx4 v20, s[20:23], s43 offen lds
  buffer_load_dwordx4 v21, s[20:23], s43 offen offset:1024 lds
  buffer_load_dwordx4 v22, s[20:23], s43 offen offset:2048 lds
  buffer_load_dwordx4 v23, s[20:23], s43 offen offset:3072 lds
  v_add_u32 v20, 32768, v15
  v_xor_b32 v21, 64, v20
  v_xor_b32 v22, 128, v20
  v_xor_b32 v23, 192, v20
  s_waitcnt lgkmcnt(14)
  ds_read_b64_tr_b16 v[32:33], v20 offset:0
  s_waitcnt lgkmcnt(14)
  ds_read_b64_tr_b16 v[34:35], v20 offset:2048
  s_waitcnt lgkmcnt(14)
  ds_read_b64_tr_b16 v[36:37], v21 offset:0
  s_waitcnt lgkmcnt(14)
  ds_read_b64_tr_b16 v[38:39], v21 offset:2048
  s_waitcnt lgkmcnt(14)
  ds_read_b64_tr_b16 v[40:41], v22 offset:0
  s_waitcnt lgkmcnt(14)
  ds_read_b64_tr_b16 v[42:43], v22 offset:2048
  s_waitcnt lgkmcnt(14)
  ds_read_b64_tr_b16 v[44:45], v23 offset:0
  s_waitcnt lgkmcnt(14)
  ds_read_b64_tr_b16 v[46:47], v23 offset:2048
  s_waitcnt lgkmcnt(14)
  ds_read_b64_tr_b16 v[48:49], v20 offset:8192
  s_waitcnt lgkmcnt(14)
  ds_read_b64_tr_b16 v[50:51], v20 offset:10240
  s_waitcnt lgkmcnt(14)
  ds_read_b64_tr_b16 v[52:53], v21 offset:8192
  s_waitcnt lgkmcnt(14)
  ds_read_b64_tr_b16 v[54:55], v21 offset:10240
  s_waitcnt lgkmcnt(14)
  ds_read_b64_tr_b16 v[56:57], v22 offset:8192
  s_waitcnt lgkmcnt(14)
  ds_read_b64_tr_b16 v[58:59], v22 offset:10240
  s_waitcnt lgkmcnt(14)
  ds_read_b64_tr_b16 v[60:61], v23 offset:8192
  s_waitcnt lgkmcnt(14)
  ds_read_b64_tr_b16 v[62:63], v23 offset:10240
  s_waitcnt lgkmcnt(0)
  s_barrier
  s_mul_i32 s36, s46, 49152
  v_add_u32 v20, 81920, v15
  v_xor_b32 v21, 64, v20
  v_xor_b32 v22, 128, v20
  v_xor_b32 v23, 192, v20
  v_mfma_f32_32x32x16_bf16 v[64:79], v[32:35], v[128:131], 0
  ds_read_b64_tr_b16 v[32:33], v20 offset:0
  ds_read_b64_tr_b16 v[34:35], v20 offset:2048
  v_mfma_f32_32x32x16_bf16 v[80:95], v[36:39], v[128:131], 0
  ds_read_b64_tr_b16 v[36:37], v21 offset:0
  ds_read_b64_tr_b16 v[38:39], v21 offset:2048
  v_mfma_f32_32x32x16_bf16 v[96:111], v[40:43], v[128:131], 0
  ds_read_b64_tr_b16 v[40:41], v22 offset:0
  ds_read_b64_tr_b16 v[42:43], v22 offset:2048
  v_mfma_f32_32x32x16_bf16 v[112:127], v[44:47], v[128:131], 0
  ds_read_b64_tr_b16 v[44:45], v23 offset:0
  ds_read_b64_tr_b16 v[46:47], v23 offset:2048
  v_mfma_f32_32x32x16_bf16 v[64:79], v[48:51], v[132:135], v[64:79]
  ds_read_b64_tr_b16 v[48:49], v20 offset:8192
  ds_read_b64_tr_b16 v[50:51], v20 offset:10240
  v_mfma_f32_32x32x16_bf16 v[80:95], v[52:55], v[132:135], v[80:95]
  ds_read_b64_tr_b16 v[52:53], v21 offset:8192
  ds_read_b64_tr_b16 v[54:55], v21 offset:10240
  v_mfma_f32_32x32x16_bf16 v[96:111], v[56:59], v[132:135], v[96:111]
  ds_read_b64_tr_b16 v[56:57], v22 offset:8192
  ds_read_b64_tr_b16 v[58:59], v22 offset:10240
  v_mfma_f32_32x32x16_bf16 v[112:127], v[60:63], v[132:135], v[112:127]
  ds_read_b64_tr_b16 v[60:61], v23 offset:8192
  s_waitcnt lgkmcnt(14)
  ds_read_b64_tr_b16 v[62:63], v23 offset:10240
  s_barrier
  v_add_u32 v20, 147456, v15
  v_xor_b32 v21, 64, v20
  v_xor_b32 v22, 128, v20
  v_xor_b32 v23, 192, v20
  s_waitcnt lgkmcnt(14)
  v_mfma_f32_32x32x16_bf16 v[64:79], v[32:35], v[136:139], v[64:79]
  ds_read_b64_tr_b16 v[32:33], v20 offset:0
  s_waitcnt lgkmcnt(14)
  ds_read_b64_tr_b16 v[34:35], v20 offset:2048
  s_waitcnt lgkmcnt(14)
  v_mfma_f32_32x32x16_bf16 v[80:95], v[36:39], v[136:139], v[80:95]
  ds_read_b64_tr_b16 v[36:37], v21 offset:0
  s_waitcnt lgkmcnt(14)
  ds_read_b64_tr_b16 v[38:39], v21 offset:2048
  s_waitcnt lgkmcnt(14)
  v_mfma_f32_32x32x16_bf16 v[96:111], v[40:43], v[136:139], v[96:111]
  ds_read_b64_tr_b16 v[40:41], v22 offset:0
  s_waitcnt lgkmcnt(14)
  ds_read_b64_tr_b16 v[42:43], v22 offset:2048
  s_waitcnt lgkmcnt(14)
  v_mfma_f32_32x32x16_bf16 v[112:127], v[44:47], v[136:139], v[112:127]
  ds_read_b64_tr_b16 v[44:45], v23 offset:0
  s_waitcnt lgkmcnt(14)
  ds_read_b64_tr_b16 v[46:47], v23 offset:2048
  s_waitcnt lgkmcnt(14)
  v_mfma_f32_32x32x16_bf16 v[64:79], v[48:51], v[140:143], v[64:79]
  ds_read_b64_tr_b16 v[48:49], v20 offset:8192
  s_waitcnt lgkmcnt(14)
  ds_read_b64_tr_b16 v[50:51], v20 offset:10240
  s_waitcnt lgkmcnt(14)
  v_mfma_f32_32x32x16_bf16 v[80:95], v[52:55], v[140:143], v[80:95]
  ds_read_b64_tr_b16 v[52:53], v21 offset:8192
  s_waitcnt lgkmcnt(14)
  ds_read_b64_tr_b16 v[54:55], v21 offset:10240
  s_waitcnt lgkmcnt(14)
  v_mfma_f32_32x32x16_bf16 v[96:111], v[56:59], v[140:143], v[96:111]
  ds_read_b64_tr_b16 v[56:57], v22 offset:8192
  s_waitcnt lgkmcnt(14)
  ds_read_b64_tr_b16 v[58:59], v22 offset:10240
  s_waitcnt lgkmcnt(14)
  v_mfma_f32_32x32x16_bf16 v[112:127], v[60:63], v[140:143], v[112:127]
  ds_read_b64_tr_b16 v[60:61], v23 offset:8192
  s_waitcnt lgkmcnt(14)
  ds_read_b64_tr_b16 v[62:63], v23 offset:10240
  s_barrier
  v_add_u32 v20, 131072, v15
  v_xor_b32 v21, 64, v20
  v_xor_b32 v22, 128, v20
  v_xor_b32 v23, 192, v20
  s_waitcnt lgkmcnt(14)
  v_mfma_f32_32x32x16_bf16 v[64:79], v[32:35], v[144:147], v[64:79]
  ds_read_b64_tr_b16 v[32:33], v20 offset:0
  s_waitcnt lgkmcnt(14)
  ds_read_b64_tr_b16 v[34:35], v20 offset:2048
  s_waitcnt lgkmcnt(14)
  v_mfma_f32_32x32x16_bf16 v[80:95], v[36:39], v[144:147], v[80:95]
  ds_read_b64_tr_b16 v[36:37], v21 offset:0
  s_waitcnt lgkmcnt(14)
  ds_read_b64_tr_b16 v[38:39], v21 offset:2048
  s_waitcnt lgkmcnt(14)
  v_mfma_f32_32x32x16_bf16 v[96:111], v[40:43], v[144:147], v[96:111]
  ds_read_b64_tr_b16 v[40:41], v22 offset:0
  s_waitcnt lgkmcnt(14)
  ds_read_b64_tr_b16 v[42:43], v22 offset:2048
  s_waitcnt lgkmcnt(14)
  v_mfma_f32_32x32x16_bf16 v[112:127], v[44:47], v[144:147], v[112:127]
  ds_read_b64_tr_b16 v[44:45], v23 offset:0
  s_waitcnt lgkmcnt(14)
  ds_read_b64_tr_b16 v[46:47], v23 offset:2048
  s_waitcnt lgkmcnt(14)
  v_mfma_f32_32x32x16_bf16 v[64:79], v[48:51], v[148:151], v[64:79]
  ds_read_b64_tr_b16 v[48:49], v20 offset:8192
  s_waitcnt lgkmcnt(14)
  ds_read_b64_tr_b16 v[50:51], v20 offset:10240
  s_waitcnt lgkmcnt(14)
  v_mfma_f32_32x32x16_bf16 v[80:95], v[52:55], v[148:151], v[80:95]
  ds_read_b64_tr_b16 v[52:53], v21 offset:8192
  s_waitcnt lgkmcnt(14)
  ds_read_b64_tr_b16 v[54:55], v21 offset:10240
  s_waitcnt lgkmcnt(14)
  v_mfma_f32_32x32x16_bf16 v[96:111], v[56:59], v[148:151], v[96:111]
  ds_read_b64_tr_b16 v[56:57], v22 offset:8192
  s_waitcnt lgkmcnt(14)
  ds_read_b64_tr_b16 v[58:59], v22 offset:10240
  s_waitcnt lgkmcnt(14)
  v_mfma_f32_32x32x16_bf16 v[112:127], v[60:63], v[148:151], v[112:127]
  ds_read_b64_tr_b16 v[60:61], v23 offset:8192
  s_waitcnt lgkmcnt(14)
  ds_read_b64_tr_b16 v[62:63], v23 offset:10240
  s_waitcnt vmcnt(0)
  s_barrier
  v_xor_b32 v2, 32, v16
  v_xor_b32 v3, 64, v16
  v_xor_b32 v24, 96, v16
  v_xor_b32 v25, 128, v16
  v_xor_b32 v26, 160, v16
  v_xor_b32 v27, 192, v16
  v_xor_b32 v28, 224, v16
  s_waitcnt lgkmcnt(14)
  ds_read_b128 v[192:195], v16 offset:49152
  s_waitcnt lgkmcnt(14)
  ds_read_b128 v[196:199], v2 offset:49152
  s_waitcnt lgkmcnt(14)
  ds_read_b128 v[200:203], v3 offset:49152
  s_waitcnt lgkmcnt(14)
  ds_read_b128 v[204:207], v24 offset:49152
  s_waitcnt lgkmcnt(14)
  ds_read_b128 v[208:211], v25 offset:49152
  s_waitcnt lgkmcnt(14)
  ds_read_b128 v[212:215], v26 offset:49152
  s_waitcnt lgkmcnt(14)
  ds_read_b128 v[216:219], v27 offset:49152
  s_waitcnt lgkmcnt(14)
  ds_read_b128 v[220:223], v28 offset:49152
  s_waitcnt lgkmcnt(14)
  ds_read_b128 v[224:227], v16 offset:49408
  s_waitcnt lgkmcnt(14)
  ds_read_b128 v[228:231], v2 offset:49408
  s_waitcnt lgkmcnt(14)
  ds_read_b128 v[232:235], v3 offset:49408
  s_waitcnt lgkmcnt(14)
  ds_read_b128 v[236:239], v24 offset:49408
  s_waitcnt lgkmcnt(14)
  ds_read_b128 v[240:243], v25 offset:49408
  s_waitcnt lgkmcnt(14)
  ds_read_b128 v[244:247], v26 offset:49408
  s_waitcnt lgkmcnt(14)
  ds_read_b128 v[248:251], v27 offset:49408
  s_waitcnt lgkmcnt(14)
  ds_read_b128 v[252:255], v28 offset:49408
  v_add_u32 v20, 114688, v15
  v_xor_b32 v21, 64, v20
  v_xor_b32 v22, 128, v20
  v_xor_b32 v23, 192, v20
  v_mfma_f32_32x32x16_bf16 v[64:79], v[32:35], v[152:155], v[64:79]
  s_waitcnt lgkmcnt(14)
  ds_read_b64_tr_b16 v[32:33], v20 offset:0
  s_waitcnt lgkmcnt(14)
  ds_read_b64_tr_b16 v[34:35], v20 offset:2048
  v_mfma_f32_32x32x16_bf16 v[80:95], v[36:39], v[152:155], v[80:95]
  s_waitcnt lgkmcnt(14)
  ds_read_b64_tr_b16 v[36:37], v21 offset:0
  s_waitcnt lgkmcnt(14)
  ds_read_b64_tr_b16 v[38:39], v21 offset:2048
  v_mfma_f32_32x32x16_bf16 v[96:111], v[40:43], v[152:155], v[96:111]
  s_waitcnt lgkmcnt(14)
  ds_read_b64_tr_b16 v[40:41], v22 offset:0
  s_waitcnt lgkmcnt(14)
  ds_read_b64_tr_b16 v[42:43], v22 offset:2048
  v_mfma_f32_32x32x16_bf16 v[112:127], v[44:47], v[152:155], v[112:127]
  s_waitcnt lgkmcnt(14)
  ds_read_b64_tr_b16 v[44:45], v23 offset:0
  s_waitcnt lgkmcnt(14)
  ds_read_b64_tr_b16 v[46:47], v23 offset:2048
  v_mfma_f32_32x32x16_bf16 v[64:79], v[48:51], v[156:159], v[64:79]
  s_waitcnt lgkmcnt(14)
  ds_read_b64_tr_b16 v[48:49], v20 offset:8192
  s_waitcnt lgkmcnt(14)
  ds_read_b64_tr_b16 v[50:51], v20 offset:10240
  v_mfma_f32_32x32x16_bf16 v[80:95], v[52:55], v[156:159], v[80:95]
  s_waitcnt lgkmcnt(14)
  ds_read_b64_tr_b16 v[52:53], v21 offset:8192
  s_waitcnt lgkmcnt(14)
  ds_read_b64_tr_b16 v[54:55], v21 offset:10240
  v_mfma_f32_32x32x16_bf16 v[96:111], v[56:59], v[156:159], v[96:111]
  s_waitcnt lgkmcnt(14)
  ds_read_b64_tr_b16 v[56:57], v22 offset:8192
  s_waitcnt lgkmcnt(14)
  ds_read_b64_tr_b16 v[58:59], v22 offset:10240
  v_mfma_f32_32x32x16_bf16 v[112:127], v[60:63], v[156:159], v[112:127]
  s_waitcnt lgkmcnt(14)
  ds_read_b64_tr_b16 v[60:61], v23 offset:8192
  s_waitcnt lgkmcnt(14)
  ds_read_b64_tr_b16 v[62:63], v23 offset:10240
  s_barrier
  v_add_u32 v20, 98304, v15
  v_xor_b32 v21, 64, v20
  v_xor_b32 v22, 128, v20
  v_xor_b32 v23, 192, v20
  s_waitcnt lgkmcnt(14)
  v_mfma_f32_32x32x16_bf16 v[64:79], v[32:35], v[160:163], v[64:79]
  ds_read_b64_tr_b16 v[32:33], v20 offset:0
  s_waitcnt lgkmcnt(14)
  ds_read_b64_tr_b16 v[34:35], v20 offset:2048
  s_waitcnt lgkmcnt(14)
  v_mfma_f32_32x32x16_bf16 v[80:95], v[36:39], v[160:163], v[80:95]
  ds_read_b64_tr_b16 v[36:37], v21 offset:0
  s_waitcnt lgkmcnt(14)
  ds_read_b64_tr_b16 v[38:39], v21 offset:2048
  s_waitcnt lgkmcnt(14)
  v_mfma_f32_32x32x16_bf16 v[96:111], v[40:43], v[160:163], v[96:111]
  ds_read_b64_tr_b16 v[40:41], v22 offset:0
  s_waitcnt lgkmcnt(14)
  ds_read_b64_tr_b16 v[42:43], v22 offset:2048
  s_waitcnt lgkmcnt(14)
  v_mfma_f32_32x32x16_bf16 v[112:127], v[44:47], v[160:163], v[112:127]
  ds_read_b64_tr_b16 v[44:45], v23 offset:0
  s_waitcnt lgkmcnt(14)
  ds_read_b64_tr_b16 v[46:47], v23 offset:2048
  s_waitcnt lgkmcnt(14)
  v_mfma_f32_32x32x16_bf16 v[64:79], v[48:51], v[164:167], v[64:79]
  ds_read_b64_tr_b16 v[48:49], v20 offset:8192
  s_waitcnt lgkmcnt(14)
  ds_read_b64_tr_b16 v[50:51], v20 offset:10240
  s_waitcnt lgkmcnt(14)
  v_mfma_f32_32x32x16_bf16 v[80:95], v[52:55], v[164:167], v[80:95]
  ds_read_b64_tr_b16 v[52:53], v21 offset:8192
  s_waitcnt lgkmcnt(14)
  ds_read_b64_tr_b16 v[54:55], v21 offset:10240
  s_waitcnt lgkmcnt(14)
  v_mfma_f32_32x32x16_bf16 v[96:111], v[56:59], v[164:167], v[96:111]
  ds_read_b64_tr_b16 v[56:57], v22 offset:8192
  s_waitcnt lgkmcnt(14)
  ds_read_b64_tr_b16 v[58:59], v22 offset:10240
  s_waitcnt lgkmcnt(14)
  v_mfma_f32_32x32x16_bf16 v[112:127], v[60:63], v[164:167], v[112:127]
  ds_read_b64_tr_b16 v[60:61], v23 offset:8192
  s_waitcnt lgkmcnt(14)
  ds_read_b64_tr_b16 v[62:63], v23 offset:10240
  s_barrier
  v_add_u32 v20, 0, v15
  v_xor_b32 v21, 64, v20
  v_xor_b32 v22, 128, v20
  v_xor_b32 v23, 192, v20
  s_waitcnt lgkmcnt(14)
  v_mfma_f32_32x32x16_bf16 v[64:79], v[32:35], v[168:171], v[64:79]
  ds_read_b64_tr_b16 v[32:33], v20 offset:0
  s_waitcnt lgkmcnt(14)
  ds_read_b64_tr_b16 v[34:35], v20 offset:2048
  s_waitcnt lgkmcnt(14)
  v_mfma_f32_32x32x16_bf16 v[80:95], v[36:39], v[168:171], v[80:95]
  ds_read_b64_tr_b16 v[36:37], v21 offset:0
  s_waitcnt lgkmcnt(14)
  ds_read_b64_tr_b16 v[38:39], v21 offset:2048
  s_waitcnt lgkmcnt(14)
  v_mfma_f32_32x32x16_bf16 v[96:111], v[40:43], v[168:171], v[96:111]
  ds_read_b64_tr_b16 v[40:41], v22 offset:0
  s_waitcnt lgkmcnt(14)
  ds_read_b64_tr_b16 v[42:43], v22 offset:2048
  s_waitcnt lgkmcnt(14)
  v_mfma_f32_32x32x16_bf16 v[112:127], v[44:47], v[168:171], v[112:127]
  ds_read_b64_tr_b16 v[44:45], v23 offset:0
  s_waitcnt lgkmcnt(14)
  ds_read_b64_tr_b16 v[46:47], v23 offset:2048
  s_waitcnt lgkmcnt(14)
  v_mfma_f32_32x32x16_bf16 v[64:79], v[48:51], v[172:175], v[64:79]
  ds_read_b64_tr_b16 v[48:49], v20 offset:8192
  s_waitcnt lgkmcnt(14)
  ds_read_b64_tr_b16 v[50:51], v20 offset:10240
  s_waitcnt lgkmcnt(14)
  v_mfma_f32_32x32x16_bf16 v[80:95], v[52:55], v[172:175], v[80:95]
  ds_read_b64_tr_b16 v[52:53], v21 offset:8192
  s_waitcnt lgkmcnt(14)
  ds_read_b64_tr_b16 v[54:55], v21 offset:10240
  s_waitcnt lgkmcnt(14)
  v_mfma_f32_32x32x16_bf16 v[96:111], v[56:59], v[172:175], v[96:111]
  ds_read_b64_tr_b16 v[56:57], v22 offset:8192
  s_waitcnt lgkmcnt(14)
  ds_read_b64_tr_b16 v[58:59], v22 offset:10240
  s_waitcnt lgkmcnt(14)
  v_mfma_f32_32x32x16_bf16 v[112:127], v[60:63], v[172:175], v[112:127]
  ds_read_b64_tr_b16 v[60:61], v23 offset:8192
  s_waitcnt lgkmcnt(14)
  ds_read_b64_tr_b16 v[62:63], v23 offset:10240
  s_barrier
  v_add_u32 v20, 49152, v15
  v_xor_b32 v21, 64, v20
  v_xor_b32 v22, 128, v20
  v_xor_b32 v23, 192, v20
  s_waitcnt lgkmcnt(14)
  v_mfma_f32_32x32x16_bf16 v[64:79], v[32:35], v[176:179], v[64:79]
  ds_read_b64_tr_b16 v[32:33], v20 offset:0
  s_waitcnt lgkmcnt(14)
  ds_read_b64_tr_b16 v[34:35], v20 offset:2048
  s_waitcnt lgkmcnt(14)
  v_mfma_f32_32x32x16_bf16 v[80:95], v[36:39], v[176:179], v[80:95]
  ds_read_b64_tr_b16 v[36:37], v21 offset:0
  s_waitcnt lgkmcnt(14)
  ds_read_b64_tr_b16 v[38:39], v21 offset:2048
  s_waitcnt lgkmcnt(14)
  v_mfma_f32_32x32x16_bf16 v[96:111], v[40:43], v[176:179], v[96:111]
  ds_read_b64_tr_b16 v[40:41], v22 offset:0
  s_waitcnt lgkmcnt(14)
  ds_read_b64_tr_b16 v[42:43], v22 offset:2048
  s_waitcnt lgkmcnt(14)
  v_mfma_f32_32x32x16_bf16 v[112:127], v[44:47], v[176:179], v[112:127]
  ds_read_b64_tr_b16 v[44:45], v23 offset:0
  s_waitcnt lgkmcnt(14)
  ds_read_b64_tr_b16 v[46:47], v23 offset:2048
  s_waitcnt lgkmcnt(14)
  v_mfma_f32_32x32x16_bf16 v[64:79], v[48:51], v[180:183], v[64:79]
  ds_read_b64_tr_b16 v[48:49], v20 offset:8192
  s_waitcnt lgkmcnt(14)
  ds_read_b64_tr_b16 v[50:51], v20 offset:10240
  s_waitcnt lgkmcnt(14)
  v_mfma_f32_32x32x16_bf16 v[80:95], v[52:55], v[180:183], v[80:95]
  ds_read_b64_tr_b16 v[52:53], v21 offset:8192
  s_waitcnt lgkmcnt(14)
  ds_read_b64_tr_b16 v[54:55], v21 offset:10240
  s_waitcnt lgkmcnt(14)
  v_mfma_f32_32x32x16_bf16 v[96:111], v[56:59], v[180:183], v[96:111]
  ds_read_b64_tr_b16 v[56:57], v22 offset:8192
  s_waitcnt lgkmcnt(14)
  ds_read_b64_tr_b16 v[58:59], v22 offset:10240
  s_waitcnt lgkmcnt(14)
  v_mfma_f32_32x32x16_bf16 v[112:127], v[60:63], v[180:183], v[112:127]
  ds_read_b64_tr_b16 v[60:61], v23 offset:8192
  s_waitcnt lgkmcnt(14)
  ds_read_b64_tr_b16 v[62:63], v23 offset:10240
  s_barrier
  v_add_u32 v20, 16384, v15
  v_xor_b32 v21, 64, v20
  v_xor_b32 v22, 128, v20
  v_xor_b32 v23, 192, v20
  s_waitcnt lgkmcnt(14)
  v_mfma_f32_32x32x16_bf16 v[64:79], v[32:35], v[184:187], v[64:79]
  ds_read_b64_tr_b16 v[32:33], v20 offset:0
  s_waitcnt lgkmcnt(14)
  ds_read_b64_tr_b16 v[34:35], v20 offset:2048
  s_waitcnt lgkmcnt(14)
  v_mfma_f32_32x32x16_bf16 v[80:95], v[36:39], v[184:187], v[80:95]
  ds_read_b64_tr_b16 v[36:37], v21 offset:0
  s_waitcnt lgkmcnt(14)
  ds_read_b64_tr_b16 v[38:39], v21 offset:2048
  s_waitcnt lgkmcnt(14)
  v_mfma_f32_32x32x16_bf16 v[96:111], v[40:43], v[184:187], v[96:111]
  ds_read_b64_tr_b16 v[40:41], v22 offset:0
  s_waitcnt lgkmcnt(14)
  ds_read_b64_tr_b16 v[42:43], v22 offset:2048
  s_waitcnt lgkmcnt(14)
  v_mfma_f32_32x32x16_bf16 v[112:127], v[44:47], v[184:187], v[112:127]
  ds_read_b64_tr_b16 v[44:45], v23 offset:0
  s_waitcnt lgkmcnt(14)
  ds_read_b64_tr_b16 v[46:47], v23 offset:2048
  s_waitcnt lgkmcnt(14)
  v_mfma_f32_32x32x16_bf16 v[64:79], v[48:51], v[188:191], v[64:79]
  ds_read_b64_tr_b16 v[48:49], v20 offset:8192
  s_waitcnt lgkmcnt(14)
  ds_read_b64_tr_b16 v[50:51], v20 offset:10240
  s_waitcnt lgkmcnt(14)
  v_mfma_f32_32x32x16_bf16 v[80:95], v[52:55], v[188:191], v[80:95]
  ds_read_b64_tr_b16 v[52:53], v21 offset:8192
  s_waitcnt lgkmcnt(14)
  ds_read_b64_tr_b16 v[54:55], v21 offset:10240
  s_waitcnt lgkmcnt(14)
  v_mfma_f32_32x32x16_bf16 v[96:111], v[56:59], v[188:191], v[96:111]
  ds_read_b64_tr_b16 v[56:57], v22 offset:8192
  s_waitcnt lgkmcnt(14)
  ds_read_b64_tr_b16 v[58:59], v22 offset:10240
  s_waitcnt lgkmcnt(14)
  v_mfma_f32_32x32x16_bf16 v[112:127], v[60:63], v[188:191], v[112:127]
  ds_read_b64_tr_b16 v[60:61], v23 offset:8192
  s_waitcnt lgkmcnt(14)
  ds_read_b64_tr_b16 v[62:63], v23 offset:10240
  s_barrier
  v_add_u32 v20, 65536, v15
  v_xor_b32 v21, 64, v20
  v_xor_b32 v22, 128, v20
  v_xor_b32 v23, 192, v20
  s_waitcnt lgkmcnt(14)
  v_mfma_f32_32x32x16_bf16 v[64:79], v[32:35], v[192:195], v[64:79]
  ds_read_b64_tr_b16 v[32:33], v20 offset:0
  s_waitcnt lgkmcnt(14)
  ds_read_b64_tr_b16 v[34:35], v20 offset:2048
  s_add_u32 m0, s39, 0
  s_add_u32 s43, s42, 122880
  s_and_b32 s43, s43, 0x1ffff
  s_add_u32 s43, s43, s37
  s_cmp_eq_u32 s47, 0
  s_cselect_b64 exec, -1, 1
  buffer_load_dwordx4 v4, s[8:11], s43 offen nt lds
  buffer_load_dwordx4 v5, s[8:11], s43 offen offset:1024 nt lds
  buffer_load_dwordx4 v6, s[8:11], s43 offen offset:2048 nt lds
  buffer_load_dwordx4 v7, s[8:11], s43 offen offset:3072 nt lds
  s_mov_b64 exec, -1
  s_waitcnt lgkmcnt(14)
  v_mfma_f32_32x32x16_bf16 v[80:95], v[36:39], v[192:195], v[80:95]
  ds_read_b64_tr_b16 v[36:37], v21 offset:0
  s_waitcnt lgkmcnt(14)
  ds_read_b64_tr_b16 v[38:39], v21 offset:2048
  s_waitcnt lgkmcnt(14)
  v_mfma_f32_32x32x16_bf16 v[96:111], v[40:43], v[192:195], v[96:111]
  ds_read_b64_tr_b16 v[40:41], v22 offset:0
  s_waitcnt lgkmcnt(14)
  ds_read_b64_tr_b16 v[42:43], v22 offset:2048
  s_waitcnt lgkmcnt(14)
  v_mfma_f32_32x32x16_bf16 v[112:127], v[44:47], v[192:195], v[112:127]
  ds_read_b64_tr_b16 v[44:45], v23 offset:0
  s_waitcnt lgkmcnt(14)
  ds_read_b64_tr_b16 v[46:47], v23 offset:2048
  s_waitcnt lgkmcnt(14)
  v_mfma_f32_32x32x16_bf16 v[64:79], v[48:51], v[196:199], v[64:79]
  ds_read_b64_tr_b16 v[48:49], v20 offset:8192
  s_waitcnt lgkmcnt(14)
  ds_read_b64_tr_b16 v[50:51], v20 offset:10240
  s_waitcnt lgkmcnt(14)
  v_mfma_f32_32x32x16_bf16 v[80:95], v[52:55], v[196:199], v[80:95]
  ds_read_b64_tr_b16 v[52:53], v21 offset:8192
  s_waitcnt lgkmcnt(14)
  ds_read_b64_tr_b16 v[54:55], v21 offset:10240
  s_waitcnt lgkmcnt(14)
  v_mfma_f32_32x32x16_bf16 v[96:111], v[56:59], v[196:199], v[96:111]
  ds_read_b64_tr_b16 v[56:57], v22 offset:8192
  s_waitcnt lgkmcnt(14)
  ds_read_b64_tr_b16 v[58:59], v22 offset:10240
  s_waitcnt lgkmcnt(14)
  v_mfma_f32_32x32x16_bf16 v[112:127], v[60:63], v[196:199], v[112:127]
  ds_read_b64_tr_b16 v[60:61], v23 offset:8192
  s_waitcnt lgkmcnt(14)
  ds_read_b64_tr_b16 v[62:63], v23 offset:10240
  s_barrier
  v_add_u32 v20, 32768, v15
  v_xor_b32 v21, 64, v20
  v_xor_b32 v22, 128, v20
  v_xor_b32 v23, 192, v20
  s_waitcnt lgkmcnt(14)
  v_mfma_f32_32x32x16_bf16 v[64:79], v[32:35], v[200:203], v[64:79]
  ds_read_b64_tr_b16 v[32:33], v20 offset:0
  s_waitcnt lgkmcnt(14)
  ds_read_b64_tr_b16 v[34:35], v20 offset:2048
  s_add_u32 m0, s39, 4096
  s_add_u32 s43, s42, 126976
  s_and_b32 s43, s43, 0x1ffff
  s_add_u32 s43, s43, s37
  s_cmp_eq_u32 s47, 0
  s_cselect_b64 exec, -1, 1
  buffer_load_dwordx4 v4, s[8:11], s43 offen nt lds
  buffer_load_dwordx4 v5, s[8:11], s43 offen offset:1024 nt lds
  buffer_load_dwordx4 v6, s[8:11], s43 offen offset:2048 nt lds
  buffer_load_dwordx4 v7, s[8:11], s43 offen offset:3072 nt lds
  s_mov_b64 exec, -1
  s_waitcnt lgkmcnt(14)
  v_mfma_f32_32x32x16_bf16 v[80:95], v[36:39], v[200:203], v[80:95]
  ds_read_b64_tr_b16 v[36:37], v21 offset:0
  s_waitcnt lgkmcnt(14)
  ds_read_b64_tr_b16 v[38:39], v21 offset:2048
  s_waitcnt lgkmcnt(14)
  v_mfma_f32_32x32x16_bf16 v[96:111], v[40:43], v[200:203], v[96:111]
  ds_read_b64_tr_b16 v[40:41], v22 offset:0
  s_waitcnt lgkmcnt(14)
  ds_read_b64_tr_b16 v[42:43], v22 offset:2048
  s_waitcnt lgkmcnt(14)
  v_mfma_f32_32x32x16_bf16 v[112:127], v[44:47], v[200:203], v[112:127]
  ds_read_b64_tr_b16 v[44:45], v23 offset:0
  s_waitcnt lgkmcnt(14)
  ds_read_b64_tr_b16 v[46:47], v23 offset:2048
  s_waitcnt lgkmcnt(14)
  v_mfma_f32_32x32x16_bf16 v[64:79], v[48:51], v[204:207], v[64:79]
  ds_read_b64_tr_b16 v[48:49], v20 offset:8192
  s_waitcnt lgkmcnt(14)
  ds_read_b64_tr_b16 v[50:51], v20 offset:10240
  s_waitcnt lgkmcnt(14)
  v_mfma_f32_32x32x16_bf16 v[80:95], v[52:55], v[204:207], v[80:95]
  ds_read_b64_tr_b16 v[52:53], v21 offset:8192
  s_waitcnt lgkmcnt(14)
  ds_read_b64_tr_b16 v[54:55], v21 offset:10240
  s_waitcnt lgkmcnt(14)
  v_mfma_f32_32x32x16_bf16 v[96:111], v[56:59], v[204:207], v[96:111]
  ds_read_b64_tr_b16 v[56:57], v22 offset:8192
  s_waitcnt lgkmcnt(14)
  ds_read_b64_tr_b16 v[58:59], v22 offset:10240
  s_waitcnt lgkmcnt(14)
  v_mfma_f32_32x32x16_bf16 v[112:127], v[60:63], v[204:207], v[112:127]
  ds_read_b64_tr_b16 v[60:61], v23 offset:8192
  s_waitcnt lgkmcnt(14)
  ds_read_b64_tr_b16 v[62:63], v23 offset:10240
  s_barrier
  v_add_u32 v20, 81920, v15
  v_xor_b32 v21, 64, v20
  v_xor_b32 v22, 128, v20
  v_xor_b32 v23, 192, v20
  s_waitcnt lgkmcnt(14)
  v_mfma_f32_32x32x16_bf16 v[64:79], v[32:35], v[208:211], v[64:79]
  ds_read_b64_tr_b16 v[32:33], v20 offset:0
  s_waitcnt lgkmcnt(14)
  ds_read_b64_tr_b16 v[34:35], v20 offset:2048
  s_add_u32 m0, s39, 16384
  s_add_u32 s43, s42, 0
  s_and_b32 s43, s43, 0x1ffff
  s_add_u32 s43, s43, s37
  buffer_load_dwordx4 v4, s[8:11], s43 offen nt lds
  s_waitcnt lgkmcnt(14)
  v_mfma_f32_32x32x16_bf16 v[80:95], v[36:39], v[208:211], v[80:95]
  ds_read_b64_tr_b16 v[36:37], v21 offset:0
  s_waitcnt lgkmcnt(14)
  ds_read_b64_tr_b16 v[38:39], v21 offset:2048
  buffer_load_dwordx4 v5, s[8:11], s43 offen offset:1024 nt lds
  s_waitcnt lgkmcnt(14)
  v_mfma_f32_32x32x16_bf16 v[96:111], v[40:43], v[208:211], v[96:111]
  ds_read_b64_tr_b16 v[40:41], v22 offset:0
  s_waitcnt lgkmcnt(14)
  ds_read_b64_tr_b16 v[42:43], v22 offset:2048
  buffer_load_dwordx4 v6, s[8:11], s43 offen offset:2048 nt lds
  s_waitcnt lgkmcnt(14)
  v_mfma_f32_32x32x16_bf16 v[112:127], v[44:47], v[208:211], v[112:127]
  ds_read_b64_tr_b16 v[44:45], v23 offset:0
  s_waitcnt lgkmcnt(14)
  ds_read_b64_tr_b16 v[46:47], v23 offset:2048
  buffer_load_dwordx4 v7, s[8:11], s43 offen offset:3072 nt lds
  s_waitcnt lgkmcnt(14)
  v_mfma_f32_32x32x16_bf16 v[64:79], v[48:51], v[212:215], v[64:79]
  ds_read_b64_tr_b16 v[48:49], v20 offset:8192
  s_waitcnt lgkmcnt(14)
  ds_read_b64_tr_b16 v[50:51], v20 offset:10240
  s_waitcnt lgkmcnt(14)
  v_mfma_f32_32x32x16_bf16 v[80:95], v[52:55], v[212:215], v[80:95]
  ds_read_b64_tr_b16 v[52:53], v21 offset:8192
  s_waitcnt lgkmcnt(14)
  ds_read_b64_tr_b16 v[54:55], v21 offset:10240
  s_waitcnt lgkmcnt(14)
  v_mfma_f32_32x32x16_bf16 v[96:111], v[56:59], v[212:215], v[96:111]
  ds_read_b64_tr_b16 v[56:57], v22 offset:8192
  s_waitcnt lgkmcnt(14)
  ds_read_b64_tr_b16 v[58:59], v22 offset:10240
  s_waitcnt lgkmcnt(14)
  v_mfma_f32_32x32x16_bf16 v[112:127], v[60:63], v[212:215], v[112:127]
  ds_read_b64_tr_b16 v[60:61], v23 offset:8192
  s_waitcnt lgkmcnt(14)
  ds_read_b64_tr_b16 v[62:63], v23 offset:10240
  s_barrier
  v_add_u32 v20, 147456, v15
  v_xor_b32 v21, 64, v20
  v_xor_b32 v22, 128, v20
  v_xor_b32 v23, 192, v20
  s_waitcnt lgkmcnt(14)
  v_mfma_f32_32x32x16_bf16 v[64:79], v[32:35], v[216:219], v[64:79]
  ds_read_b64_tr_b16 v[32:33], v20 offset:0
  s_waitcnt lgkmcnt(14)
  ds_read_b64_tr_b16 v[34:35], v20 offset:2048
  s_add_u32 m0, s39, 20480
  s_add_u32 s43, s42, 4096
  s_and_b32 s43, s43, 0x1ffff
  s_add_u32 s43, s43, s37
  buffer_load_dwordx4 v4, s[8:11], s43 offen nt lds
  s_waitcnt lgkmcnt(14)
  v_mfma_f32_32x32x16_bf16 v[80:95], v[36:39], v[216:219], v[80:95]
  ds_read_b64_tr_b16 v[36:37], v21 offset:0
  s_waitcnt lgkmcnt(14)
  ds_read_b64_tr_b16 v[38:39], v21 offset:2048
  buffer_load_dwordx4 v5, s[8:11], s43 offen offset:1024 nt lds
  s_waitcnt lgkmcnt(14)
  v_mfma_f32_32x32x16_bf16 v[96:111], v[40:43], v[216:219], v[96:111]
  ds_read_b64_tr_b16 v[40:41], v22 offset:0
  s_waitcnt lgkmcnt(14)
  ds_read_b64_tr_b16 v[42:43], v22 offset:2048
  buffer_load_dwordx4 v6, s[8:11], s43 offen offset:2048 nt lds
  s_waitcnt lgkmcnt(14)
  v_mfma_f32_32x32x16_bf16 v[112:127], v[44:47], v[216:219], v[112:127]
  ds_read_b64_tr_b16 v[44:45], v23 offset:0
  s_waitcnt lgkmcnt(14)
  ds_read_b64_tr_b16 v[46:47], v23 offset:2048
  buffer_load_dwordx4 v7, s[8:11], s43 offen offset:3072 nt lds
  s_waitcnt lgkmcnt(14)
  v_mfma_f32_32x32x16_bf16 v[64:79], v[48:51], v[220:223], v[64:79]
  ds_read_b64_tr_b16 v[48:49], v20 offset:8192
  s_waitcnt lgkmcnt(14)
  ds_read_b64_tr_b16 v[50:51], v20 offset:10240
  s_waitcnt lgkmcnt(14)
  v_mfma_f32_32x32x16_bf16 v[80:95], v[52:55], v[220:223], v[80:95]
  ds_read_b64_tr_b16 v[52:53], v21 offset:8192
  s_waitcnt lgkmcnt(14)
  ds_read_b64_tr_b16 v[54:55], v21 offset:10240
  s_waitcnt lgkmcnt(14)
  v_mfma_f32_32x32x16_bf16 v[96:111], v[56:59], v[220:223], v[96:111]
  ds_read_b64_tr_b16 v[56:57], v22 offset:8192
  s_waitcnt lgkmcnt(14)
  ds_read_b64_tr_b16 v[58:59], v22 offset:10240
  s_waitcnt lgkmcnt(14)
  v_mfma_f32_32x32x16_bf16 v[112:127], v[60:63], v[220:223], v[112:127]
  ds_read_b64_tr_b16 v[60:61], v23 offset:8192
  s_waitcnt lgkmcnt(14)
  ds_read_b64_tr_b16 v[62:63], v23 offset:10240
  s_barrier
  v_add_u32 v20, 131072, v15
  v_xor_b32 v21, 64, v20
  v_xor_b32 v22, 128, v20
  v_xor_b32 v23, 192, v20
  s_waitcnt lgkmcnt(14)
  v_mfma_f32_32x32x16_bf16 v[64:79], v[32:35], v[224:227], v[64:79]
  ds_read_b64_tr_b16 v[32:33], v20 offset:0
  s_waitcnt lgkmcnt(14)
  ds_read_b64_tr_b16 v[34:35], v20 offset:2048
  s_add_u32 m0, s39, 32768
  s_add_u32 s43, s42, 8192
  s_and_b32 s43, s43, 0x1ffff
  s_add_u32 s43, s43, s37
  buffer_load_dwordx4 v4, s[8:11], s43 offen nt lds
  s_waitcnt lgkmcnt(14)
  v_mfma_f32_32x32x16_bf16 v[80:95], v[36:39], v[224:227], v[80:95]
  ds_read_b64_tr_b16 v[36:37], v21 offset:0
  s_waitcnt lgkmcnt(14)
  ds_read_b64_tr_b16 v[38:39], v21 offset:2048
  buffer_load_dwordx4 v5, s[8:11], s43 offen offset:1024 nt lds
  s_waitcnt lgkmcnt(14)
  v_mfma_f32_32x32x16_bf16 v[96:111], v[40:43], v[224:227], v[96:111]
  ds_read_b64_tr_b16 v[40:41], v22 offset:0
  s_waitcnt lgkmcnt(14)
  ds_read_b64_tr_b16 v[42:43], v22 offset:2048
  buffer_load_dwordx4 v6, s[8:11], s43 offen offset:2048 nt lds
  s_waitcnt lgkmcnt(14)
  v_mfma_f32_32x32x16_bf16 v[112:127], v[44:47], v[224:227], v[112:127]
  ds_read_b64_tr_b16 v[44:45], v23 offset:0
  s_waitcnt lgkmcnt(14)
  ds_read_b64_tr_b16 v[46:47], v23 offset:2048
  buffer_load_dwordx4 v7, s[8:11], s43 offen offset:3072 nt lds
  s_waitcnt lgkmcnt(14)
  v_mfma_f32_32x32x16_bf16 v[64:79], v[48:51], v[228:231], v[64:79]
  ds_read_b64_tr_b16 v[48:49], v20 offset:8192
  s_waitcnt lgkmcnt(14)
  ds_read_b64_tr_b16 v[50:51], v20 offset:10240
  s_waitcnt lgkmcnt(14)
  v_mfma_f32_32x32x16_bf16 v[80:95], v[52:55], v[228:231], v[80:95]
  ds_read_b64_tr_b16 v[52:53], v21 offset:8192
  s_waitcnt lgkmcnt(14)
  ds_read_b64_tr_b16 v[54:55], v21 offset:10240
  s_waitcnt lgkmcnt(14)
  v_mfma_f32_32x32x16_bf16 v[96:111], v[56:59], v[228:231], v[96:111]
  ds_read_b64_tr_b16 v[56:57], v22 offset:8192
  s_waitcnt lgkmcnt(14)
  ds_read_b64_tr_b16 v[58:59], v22 offset:10240
  s_waitcnt lgkmcnt(14)
  v_mfma_f32_32x32x16_bf16 v[112:127], v[60:63], v[228:231], v[112:127]
  ds_read_b64_tr_b16 v[60:61], v23 offset:8192
  s_waitcnt lgkmcnt(14)
  ds_read_b64_tr_b16 v[62:63], v23 offset:10240
  s_barrier
  v_add_u32 v20, 114688, v15
  v_xor_b32 v21, 64, v20
  v_xor_b32 v22, 128, v20
  v_xor_b32 v23, 192, v20
  s_waitcnt lgkmcnt(14)
  v_mfma_f32_32x32x16_bf16 v[64:79], v[32:35], v[232:235], v[64:79]
  ds_read_b64_tr_b16 v[32:33], v20 offset:0
  s_waitcnt lgkmcnt(14)
  ds_read_b64_tr_b16 v[34:35], v20 offset:2048
  s_add_u32 m0, s39, 36864
  s_add_u32 s43, s42, 12288
  s_and_b32 s43, s43, 0x1ffff
  s_add_u32 s43, s43, s37
  buffer_load_dwordx4 v4, s[8:11], s43 offen nt lds
  s_waitcnt lgkmcnt(14)
  v_mfma_f32_32x32x16_bf16 v[80:95], v[36:39], v[232:235], v[80:95]
  ds_read_b64_tr_b16 v[36:37], v21 offset:0
  s_waitcnt lgkmcnt(14)
  ds_read_b64_tr_b16 v[38:39], v21 offset:2048
  buffer_load_dwordx4 v5, s[8:11], s43 offen offset:1024 nt lds
  s_waitcnt lgkmcnt(14)
  v_mfma_f32_32x32x16_bf16 v[96:111], v[40:43], v[232:235], v[96:111]
  ds_read_b64_tr_b16 v[40:41], v22 offset:0
  s_waitcnt lgkmcnt(14)
  ds_read_b64_tr_b16 v[42:43], v22 offset:2048
  buffer_load_dwordx4 v6, s[8:11], s43 offen offset:2048 nt lds
  s_waitcnt lgkmcnt(14)
  v_mfma_f32_32x32x16_bf16 v[112:127], v[44:47], v[232:235], v[112:127]
  ds_read_b64_tr_b16 v[44:45], v23 offset:0
  s_waitcnt lgkmcnt(14)
  ds_read_b64_tr_b16 v[46:47], v23 offset:2048
  buffer_load_dwordx4 v7, s[8:11], s43 offen offset:3072 nt lds
  s_waitcnt lgkmcnt(14)
  v_mfma_f32_32x32x16_bf16 v[64:79], v[48:51], v[236:239], v[64:79]
  ds_read_b64_tr_b16 v[48:49], v20 offset:8192
  s_waitcnt lgkmcnt(14)
  ds_read_b64_tr_b16 v[50:51], v20 offset:10240
  s_waitcnt lgkmcnt(14)
  v_mfma_f32_32x32x16_bf16 v[80:95], v[52:55], v[236:239], v[80:95]
  ds_read_b64_tr_b16 v[52:53], v21 offset:8192
  s_waitcnt lgkmcnt(14)
  ds_read_b64_tr_b16 v[54:55], v21 offset:10240
  s_waitcnt lgkmcnt(14)
  v_mfma_f32_32x32x16_bf16 v[96:111], v[56:59], v[236:239], v[96:111]
  ds_read_b64_tr_b16 v[56:57], v22 offset:8192
  s_waitcnt lgkmcnt(14)
  ds_read_b64_tr_b16 v[58:59], v22 offset:10240
  s_waitcnt lgkmcnt(14)
  v_mfma_f32_32x32x16_bf16 v[112:127], v[60:63], v[236:239], v[112:127]
  ds_read_b64_tr_b16 v[60:61], v23 offset:8192
  s_waitcnt lgkmcnt(14)
  ds_read_b64_tr_b16 v[62:63], v23 offset:10240
  s_barrier
  v_add_u32 v20, 98304, v15
  v_xor_b32 v21, 64, v20
  v_xor_b32 v22, 128, v20
  v_xor_b32 v23, 192, v20
  s_waitcnt lgkmcnt(14)
  v_mfma_f32_32x32x16_bf16 v[64:79], v[32:35], v[240:243], v[64:79]
  ds_read_b64_tr_b16 v[32:33], v20 offset:0
  s_waitcnt lgkmcnt(14)
  ds_read_b64_tr_b16 v[34:35], v20 offset:2048
  s_waitcnt lgkmcnt(14)
  v_mfma_f32_32x32x16_bf16 v[80:95], v[36:39], v[240:243], v[80:95]
  ds_read_b64_tr_b16 v[36:37], v21 offset:0
  s_waitcnt lgkmcnt(14)
  ds_read_b64_tr_b16 v[38:39], v21 offset:2048
  s_waitcnt lgkmcnt(14)
  v_mfma_f32_32x32x16_bf16 v[96:111], v[40:43], v[240:243], v[96:111]
  ds_read_b64_tr_b16 v[40:41], v22 offset:0
  s_waitcnt lgkmcnt(14)
  ds_read_b64_tr_b16 v[42:43], v22 offset:2048
  s_waitcnt lgkmcnt(14)
  v_mfma_f32_32x32x16_bf16 v[112:127], v[44:47], v[240:243], v[112:127]
  ds_read_b64_tr_b16 v[44:45], v23 offset:0
  s_waitcnt lgkmcnt(14)
  ds_read_b64_tr_b16 v[46:47], v23 offset:2048
  s_waitcnt lgkmcnt(14)
  v_mfma_f32_32x32x16_bf16 v[64:79], v[48:51], v[244:247], v[64:79]
  ds_read_b64_tr_b16 v[48:49], v20 offset:8192
  s_waitcnt lgkmcnt(14)
  ds_read_b64_tr_b16 v[50:51], v20 offset:10240
  s_waitcnt lgkmcnt(14)
  v_mfma_f32_32x32x16_bf16 v[80:95], v[52:55], v[244:247], v[80:95]
  ds_read_b64_tr_b16 v[52:53], v21 offset:8192
  s_waitcnt lgkmcnt(14)
  ds_read_b64_tr_b16 v[54:55], v21 offset:10240
  s_waitcnt lgkmcnt(14)
  v_mfma_f32_32x32x16_bf16 v[96:111], v[56:59], v[244:247], v[96:111]
  ds_read_b64_tr_b16 v[56:57], v22 offset:8192
  s_waitcnt lgkmcnt(14)
  ds_read_b64_tr_b16 v[58:59], v22 offset:10240
  s_waitcnt lgkmcnt(14)
  v_mfma_f32_32x32x16_bf16 v[112:127], v[60:63], v[244:247], v[112:127]
  ds_read_b64_tr_b16 v[60:61], v23 offset:8192
  s_waitcnt lgkmcnt(14)
  ds_read_b64_tr_b16 v[62:63], v23 offset:10240
  s_barrier
  s_waitcnt lgkmcnt(14)
  v_mfma_f32_32x32x16_bf16 v[64:79], v[32:35], v[248:251], v[64:79]
  s_waitcnt lgkmcnt(12)
  v_mfma_f32_32x32x16_bf16 v[80:95], v[36:39], v[248:251], v[80:95]
  s_waitcnt lgkmcnt(10)
  v_mfma_f32_32x32x16_bf16 v[96:111], v[40:43], v[248:251], v[96:111]
  s_waitcnt lgkmcnt(8)
  v_mfma_f32_32x32x16_bf16 v[112:127], v[44:47], v[248:251], v[112:127]
  s_waitcnt lgkmcnt(6)
  v_mfma_f32_32x32x16_bf16 v[64:79], v[48:51], v[252:255], v[64:79]
  s_waitcnt lgkmcnt(4)
  v_mfma_f32_32x32x16_bf16 v[80:95], v[52:55], v[252:255], v[80:95]
  s_waitcnt lgkmcnt(2)
  v_mfma_f32_32x32x16_bf16 v[96:111], v[56:59], v[252:255], v[96:111]
  s_waitcnt lgkmcnt(0)
  v_mfma_f32_32x32x16_bf16 v[112:127], v[60:63], v[252:255], v[112:127]
  s_waitcnt vmcnt(16)
  s_barrier
  s_nop 7
  v_mov_b32 v36, s41
  s_nop 6
  v_pk_mul_f32 v[64:65], v[64:65], v[36:37] op_sel_hi:[1,0]
  v_pk_mul_f32 v[66:67], v[66:67], v[36:37] op_sel_hi:[1,0]
  v_cvt_pk_bf16_f32 v192, v64, v65
  v_pk_mul_f32 v[68:69], v[68:69], v[36:37] op_sel_hi:[1,0]
  v_cvt_pk_bf16_f32 v193, v66, v67
  v_pk_mul_f32 v[70:71], v[70:71], v[36:37] op_sel_hi:[1,0]
  v_cvt_pk_bf16_f32 v194, v68, v69
  v_pk_mul_f32 v[72:73], v[72:73], v[36:37] op_sel_hi:[1,0]
  v_cvt_pk_bf16_f32 v195, v70, v71
  v_pk_mul_f32 v[74:75], v[74:75], v[36:37] op_sel_hi:[1,0]
  v_cvt_pk_bf16_f32 v196, v72, v73
  v_pk_mul_f32 v[76:77], v[76:77], v[36:37] op_sel_hi:[1,0]
  v_cvt_pk_bf16_f32 v197, v74, v75
  v_pk_mul_f32 v[78:79], v[78:79], v[36:37] op_sel_hi:[1,0]
  v_cvt_pk_bf16_f32 v198, v76, v77
  v_pk_mul_f32 v[80:81], v[80:81], v[36:37] op_sel_hi:[1,0]
  v_cvt_pk_bf16_f32 v199, v78, v79
  v_pk_mul_f32 v[82:83], v[82:83], v[36:37] op_sel_hi:[1,0]
  v_cvt_pk_bf16_f32 v200, v80, v81
  v_pk_mul_f32 v[84:85], v[84:85], v[36:37] op_sel_hi:[1,0]
  v_cvt_pk_bf16_f32 v201, v82, v83
  v_pk_mul_f32 v[86:87], v[86:87], v[36:37] op_sel_hi:[1,0]
  v_cvt_pk_bf16_f32 v202, v84, v85
  v_pk_mul_f32 v[88:89], v[88:89], v[36:37] op_sel_hi:[1,0]
  v_cvt_pk_bf16_f32 v203, v86, v87
  v_pk_mul_f32 v[90:91], v[90:91], v[36:37] op_sel_hi:[1,0]
  v_cvt_pk_bf16_f32 v204, v88, v89
  v_pk_mul_f32 v[92:93], v[92:93], v[36:37] op_sel_hi:[1,0]
  v_cvt_pk_bf16_f32 v205, v90, v91
  v_pk_mul_f32 v[94:95], v[94:95], v[36:37] op_sel_hi:[1,0]
  v_cvt_pk_bf16_f32 v206, v92, v93
  v_pk_mul_f32 v[96:97], v[96:97], v[36:37] op_sel_hi:[1,0]
  v_cvt_pk_bf16_f32 v207, v94, v95
  v_pk_mul_f32 v[98:99], v[98:99], v[36:37] op_sel_hi:[1,0]
  v_cvt_pk_bf16_f32 v208, v96, v97
  v_pk_mul_f32 v[100:101], v[100:101], v[36:37] op_sel_hi:[1,0]
  v_cvt_pk_bf16_f32 v209, v98, v99
  v_pk_mul_f32 v[102:103], v[102:103], v[36:37] op_sel_hi:[1,0]
  v_cvt_pk_bf16_f32 v210, v100, v101
  v_pk_mul_f32 v[104:105], v[104:105], v[36:37] op_sel_hi:[1,0]
  v_cvt_pk_bf16_f32 v211, v102, v103
  v_pk_mul_f32 v[106:107], v[106:107], v[36:37] op_sel_hi:[1,0]
  v_cvt_pk_bf16_f32 v212, v104, v105
  v_pk_mul_f32 v[108:109], v[108:109], v[36:37] op_sel_hi:[1,0]
  v_cvt_pk_bf16_f32 v213, v106, v107
  v_pk_mul_f32 v[110:111], v[110:111], v[36:37] op_sel_hi:[1,0]
  v_cvt_pk_bf16_f32 v214, v108, v109
  v_pk_mul_f32 v[112:113], v[112:113], v[36:37] op_sel_hi:[1,0]
  v_cvt_pk_bf16_f32 v215, v110, v111
  v_pk_mul_f32 v[114:115], v[114:115], v[36:37] op_sel_hi:[1,0]
  v_cvt_pk_bf16_f32 v216, v112, v113
  v_pk_mul_f32 v[116:117], v[116:117], v[36:37] op_sel_hi:[1,0]
  v_cvt_pk_bf16_f32 v217, v114, v115
  v_pk_mul_f32 v[118:119], v[118:119], v[36:37] op_sel_hi:[1,0]
  v_cvt_pk_bf16_f32 v218, v116, v117
  v_pk_mul_f32 v[120:121], v[120:121], v[36:37] op_sel_hi:[1,0]
  v_cvt_pk_bf16_f32 v219, v118, v119
  v_pk_mul_f32 v[122:123], v[122:123], v[36:37] op_sel_hi:[1,0]
  v_cvt_pk_bf16_f32 v220, v120, v121
  v_pk_mul_f32 v[124:125], v[124:125], v[36:37] op_sel_hi:[1,0]
  v_cvt_pk_bf16_f32 v221, v122, v123
  v_pk_mul_f32 v[126:127], v[126:127], v[36:37] op_sel_hi:[1,0]
  v_cvt_pk_bf16_f32 v222, v124, v125
  v_cvt_pk_bf16_f32 v223, v126, v127
  v_add_u32 v240, s36, v13
  v_add_u32 v248, s36, v14
  v_xor_b32 v241, 32, v240
  v_xor_b32 v242, 64, v240
  v_xor_b32 v243, 96, v240
  v_xor_b32 v244, 128, v240
  v_xor_b32 v245, 160, v240
  v_xor_b32 v246, 192, v240
  v_xor_b32 v247, 224, v240
  ds_read_b128 v[128:131], v240 offset:0
  ds_read_b128 v[132:135], v241 offset:0
  ds_read_b128 v[136:139], v242 offset:0
  ds_read_b128 v[140:143], v243 offset:0
  ds_read_b128 v[144:147], v244 offset:0
  ds_read_b128 v[148:151], v245 offset:0
  ds_read_b128 v[152:155], v246 offset:0
  ds_read_b128 v[156:159], v247 offset:0
  v_xor_b32 v249, 64, v248
  v_xor_b32 v250, 128, v248
  v_xor_b32 v251, 192, v248
  s_waitcnt lgkmcnt(7)
  v_mfma_f32_32x32x16_bf16 v[40:55], v[128:131], v[192:195], 0
  v_mov_b64 v[64:65], 0
  v_mov_b64 v[66:67], 0
  v_mov_b64 v[68:69], 0
  v_mov_b64 v[70:71], 0
  v_mov_b64 v[72:73], 0
  s_waitcnt lgkmcnt(6)
  v_mfma_f32_32x32x16_bf16 v[40:55], v[132:135], v[196:199], v[40:55]
  v_mov_b64 v[74:75], 0
  v_mov_b64 v[76:77], 0
  v_mov_b64 v[78:79], 0
  v_mov_b64 v[80:81], 0
  v_mov_b64 v[82:83], 0
  s_waitcnt lgkmcnt(5)
  v_mfma_f32_32x32x16_bf16 v[40:55], v[136:139], v[200:203], v[40:55]
  v_mov_b64 v[84:85], 0
  v_mov_b64 v[86:87], 0
  v_mov_b64 v[88:89], 0
  v_mov_b64 v[90:91], 0
  v_mov_b64 v[92:93], 0
  s_waitcnt lgkmcnt(4)
  v_mfma_f32_32x32x16_bf16 v[40:55], v[140:143], v[204:207], v[40:55]
  v_mov_b64 v[94:95], 0
  v_mov_b64 v[96:97], 0
  v_mov_b64 v[98:99], 0
  v_mov_b64 v[100:101], 0
  v_mov_b64 v[102:103], 0
  s_waitcnt lgkmcnt(3)
  v_mfma_f32_32x32x16_bf16 v[40:55], v[144:147], v[208:211], v[40:55]
  v_mov_b64 v[104:105], 0
  v_mov_b64 v[106:107], 0
  v_mov_b64 v[108:109], 0
  v_mov_b64 v[110:111], 0
  v_mov_b64 v[112:113], 0
  s_waitcnt lgkmcnt(2)
  v_mfma_f32_32x32x16_bf16 v[40:55], v[148:151], v[212:215], v[40:55]
  v_mov_b64 v[114:115], 0
  v_mov_b64 v[116:117], 0
  v_mov_b64 v[118:119], 0
  v_mov_b64 v[120:121], 0
  v_mov_b64 v[122:123], 0
  s_waitcnt lgkmcnt(1)
  v_mfma_f32_32x32x16_bf16 v[40:55], v[152:155], v[216:219], v[40:55]
  v_mov_b64 v[124:125], 0
  v_mov_b64 v[126:127], 0
  v_mov_b64 v[252:253], 0
  v_mov_b64 v[254:255], 0
  v_mov_b64 v[56:57], 0
  s_waitcnt lgkmcnt(0)
  v_mfma_f32_32x32x16_bf16 v[40:55], v[156:159], v[220:223], v[40:55]
  v_mov_b64 v[58:59], 0
  v_mov_b64 v[60:61], 0
  v_mov_b64 v[62:63], 0
  v_lshrrev_b32 v36, 2, v1
  v_lshrrev_b32 v37, 4, v1
  v_xor_b32 v36, v36, v37
  v_and_b32 v36, 1, v36
  v_and_b32 v37, 3, v1
  v_or_b32 v36, v36, v37
  v_cmp_eq_u32 vcc, 0, v36
  v_mov_b32 v37, 0x3f803f80
  s_nop 0
  v_cndmask_b32 v176, 0, v37, vcc
  v_cndmask_b32 v177, 0, v37, vcc
  v_cndmask_b32 v178, 0, v37, vcc
  v_cndmask_b32 v179, 0, v37, vcc
  s_nop 1
  v_max3_f32 v36, v40, v41, v42
  v_max3_f32 v37, v43, v44, v45
  v_max3_f32 v36, v36, v46, v47
  v_max3_f32 v37, v37, v48, v49
  v_max3_f32 v36, v36, v50, v51
  v_max3_f32 v37, v37, v52, v53
  v_max3_f32 v36, v36, v54, v55
  v_max_f32 v36, v36, v37
  v_mov_b32 v37, v36
  s_nop 1
  v_permlane32_swap_b32 v36, v37
  s_nop 1
  v_max_f32 v36, v36, v37
  v_sub_f32 v40, v40, v36
  v_sub_f32 v160, 0, v36
  v_sub_f32 v41, v41, v36
  v_sub_f32 v161, 0, v36
  v_sub_f32 v42, v42, v36
  v_sub_f32 v162, 0, v36
  v_sub_f32 v43, v43, v36
  v_sub_f32 v163, 0, v36
  v_sub_f32 v44, v44, v36
  v_sub_f32 v164, 0, v36
  v_sub_f32 v45, v45, v36
  v_sub_f32 v165, 0, v36
  v_sub_f32 v46, v46, v36
  v_sub_f32 v166, 0, v36
  v_sub_f32 v47, v47, v36
  v_sub_f32 v167, 0, v36
  v_sub_f32 v48, v48, v36
  v_sub_f32 v168, 0, v36
  v_sub_f32 v49, v49, v36
  v_sub_f32 v169, 0, v36
  v_sub_f32 v50, v50, v36
  v_sub_f32 v170, 0, v36
  v_sub_f32 v51, v51, v36
  v_sub_f32 v171, 0, v36
  v_sub_f32 v52, v52, v36
  v_sub_f32 v172, 0, v36
  v_sub_f32 v53, v53, v36
  v_sub_f32 v173, 0, v36
  v_sub_f32 v54, v54, v36
  v_sub_f32 v174, 0, v36
  v_sub_f32 v55, v55, v36
  v_sub_f32 v175, 0, v36
  s_waitcnt vmcnt(8) lgkmcnt(0)
  s_barrier
  s_mov_b32 s32, 0
L_attn_26:
  s_nop 7
  v_mfma_f32_32x32x16_bf16 v[64:79], v[128:131], v[56:59], v[64:79]
  ds_read_b128 v[128:131], v240 offset:16384
  v_max3_f32 v36, v40, v41, v42
  v_max3_f32 v37, v43, v44, v45
  v_max3_f32 v36, v36, v46, v47
  v_max3_f32 v37, v37, v48, v49
  v_mfma_f32_32x32x16_bf16 v[80:95], v[132:135], v[56:59], v[80:95]
  ds_read_b128 v[132:135], v241 offset:16384
  v_max3_f32 v36, v36, v50, v51
  v_max3_f32 v37, v37, v52, v53
  v_max3_f32 v36, v36, v54, v55
  v_max_f32 v36, v36, v37
  v_cmp_lt_f32 vcc, s53, v36
  s_cbranch_vccnz L_rare_27
  v_mfma_f32_32x32x16_bf16 v[96:111], v[136:139], v[56:59], v[96:111]
  ds_read_b128 v[136:139], v242 offset:16384
  v_exp_f32 v224, v40
  v_exp_f32 v225, v41
  v_mfma_f32_32x32x16_bf16 v[112:127], v[140:143], v[56:59], v[112:127]
  ds_read_b128 v[140:143], v243 offset:16384
  v_exp_f32 v226, v42
  v_exp_f32 v227, v43
  v_exp_f32 v228, v44
  v_mfma_f32_32x32x16_bf16 v[64:79], v[144:147], v[60:63], v[64:79]
  ds_read_b128 v[144:147], v244 offset:16384
  v_exp_f32 v229, v45
  v_exp_f32 v230, v46
  v_mfma_f32_32x32x16_bf16 v[80:95], v[148:151], v[60:63], v[80:95]
  ds_read_b128 v[148:151], v245 offset:16384
  v_exp_f32 v231, v47
  v_exp_f32 v232, v48
  v_exp_f32 v233, v49
  v_mfma_f32_32x32x16_bf16 v[96:111], v[152:155], v[60:63], v[96:111]
  ds_read_b128 v[152:155], v246 offset:16384
  v_exp_f32 v234, v50
  v_exp_f32 v235, v51
  v_mfma_f32_32x32x16_bf16 v[112:127], v[156:159], v[60:63], v[112:127]
  ds_read_b128 v[156:159], v247 offset:16384
  v_exp_f32 v236, v52
  v_exp_f32 v237, v53
  v_exp_f32 v238, v54
  v_exp_f32 v239, v55
L_back_28:
  s_waitcnt lgkmcnt(7)
  v_mfma_f32_32x32x16_bf16 v[40:55], v[128:131], v[192:195], v[160:175]
  ds_read_b64_tr_b16 v[128:129], v248 offset:24576
  ds_read_b64_tr_b16 v[130:131], v248 offset:26624
  v_cvt_pk_bf16_f32 v56, v224, v225
  v_cvt_pk_bf16_f32 v57, v226, v227
  v_cvt_pk_bf16_f32 v58, v228, v229
  s_waitcnt lgkmcnt(8)
  v_mfma_f32_32x32x16_bf16 v[40:55], v[132:135], v[196:199], v[40:55]
  ds_read_b64_tr_b16 v[132:133], v249 offset:24576
  ds_read_b64_tr_b16 v[134:135], v249 offset:26624
  v_cvt_pk_bf16_f32 v59, v230, v231
  v_cvt_pk_bf16_f32 v60, v232, v233
  v_cvt_pk_bf16_f32 v61, v234, v235
  s_waitcnt lgkmcnt(9)
  v_mfma_f32_32x32x16_bf16 v[40:55], v[136:139], v[200:203], v[40:55]
  ds_read_b64_tr_b16 v[136:137], v250 offset:24576
  ds_read_b64_tr_b16 v[138:139], v250 offset:26624
  v_cvt_pk_bf16_f32 v62, v236, v237
  v_cvt_pk_bf16_f32 v63, v238, v239
  s_waitcnt lgkmcnt(10)
  v_mfma_f32_32x32x16_bf16 v[40:55], v[140:143], v[204:207], v[40:55]
  ds_read_b64_tr_b16 v[140:141], v251 offset:24576
  ds_read_b64_tr_b16 v[142:143], v251 offset:26624
  s_waitcnt lgkmcnt(11)
  v_mfma_f32_32x32x16_bf16 v[40:55], v[144:147], v[208:211], v[40:55]
  ds_read_b64_tr_b16 v[144:145], v248 offset:28672
  ds_read_b64_tr_b16 v[146:147], v248 offset:30720
  v_mfma_f32_16x16x32_bf16 v[252:255], v[176:179], v[56:59], v[252:255]
  s_waitcnt lgkmcnt(12)
  v_mfma_f32_32x32x16_bf16 v[40:55], v[148:151], v[212:215], v[40:55]
  ds_read_b64_tr_b16 v[148:149], v249 offset:28672
  ds_read_b64_tr_b16 v[150:151], v249 offset:30720
  s_waitcnt lgkmcnt(13)
  v_mfma_f32_32x32x16_bf16 v[40:55], v[152:155], v[216:219], v[40:55]
  ds_read_b64_tr_b16 v[152:153], v250 offset:28672
  ds_read_b64_tr_b16 v[154:155], v250 offset:30720
  v_mfma_f32_16x16x32_bf16 v[252:255], v[176:179], v[60:63], v[252:255]
  s_waitcnt lgkmcnt(14)
  v_mfma_f32_32x32x16_bf16 v[40:55], v[156:159], v[220:223], v[40:55]
  ds_read_b64_tr_b16 v[156:157], v251 offset:28672
  s_waitcnt lgkmcnt(14)
  ds_read_b64_tr_b16 v[158:159], v251 offset:30720
  s_waitcnt vmcnt(0) lgkmcnt(0)
  s_barrier
  s_nop 7
  v_mfma_f32_32x32x16_bf16 v[64:79], v[128:131], v[56:59], v[64:79]
  ds_read_b128 v[128:131], v240 offset:32768
  v_max3_f32 v36, v40, v41, v42
  v_max3_f32 v37, v43, v44, v45
  v_max3_f32 v36, v36, v46, v47
  v_max3_f32 v37, v37, v48, v49
  v_mfma_f32_32x32x16_bf16 v[80:95], v[132:135], v[56:59], v[80:95]
  ds_read_b128 v[132:135], v241 offset:32768
  v_max3_f32 v36, v36, v50, v51
  v_max3_f32 v37, v37, v52, v53
  v_max3_f32 v36, v36, v54, v55
  v_max_f32 v36, v36, v37
  v_cmp_lt_f32 vcc, s53, v36
  s_cbranch_vccnz L_rare_29
  v_mfma_f32_32x32x16_bf16 v[96:111], v[136:139], v[56:59], v[96:111]
  ds_read_b128 v[136:139], v242 offset:32768
  v_exp_f32 v224, v40
  v_exp_f32 v225, v41
  v_mfma_f32_32x32x16_bf16 v[112:127], v[140:143], v[56:59], v[112:127]
  ds_read_b128 v[140:143], v243 offset:32768
  v_exp_f32 v226, v42
  v_exp_f32 v227, v43
  v_exp_f32 v228, v44
  v_mfma_f32_32x32x16_bf16 v[64:79], v[144:147], v[60:63], v[64:79]
  ds_read_b128 v[144:147], v244 offset:32768
  v_exp_f32 v229, v45
  v_exp_f32 v230, v46
  v_mfma_f32_32x32x16_bf16 v[80:95], v[148:151], v[60:63], v[80:95]
  ds_read_b128 v[148:151], v245 offset:32768
  v_exp_f32 v231, v47
  v_exp_f32 v232, v48
  v_exp_f32 v233, v49
  v_mfma_f32_32x32x16_bf16 v[96:111], v[152:155], v[60:63], v[96:111]
  ds_read_b128 v[152:155], v246 offset:32768
  v_exp_f32 v234, v50
  v_exp_f32 v235, v51
  v_mfma_f32_32x32x16_bf16 v[112:127], v[156:159], v[60:63], v[112:127]
  ds_read_b128 v[156:159], v247 offset:32768
  v_exp_f32 v236, v52
  v_exp_f32 v237, v53
  v_exp_f32 v238, v54
  v_exp_f32 v239, v55
L_back_30:
  s_waitcnt lgkmcnt(7)
  v_mfma_f32_32x32x16_bf16 v[40:55], v[128:131], v[192:195], v[160:175]
  ds_read_b64_tr_b16 v[128:129], v248 offset:40960
  ds_read_b64_tr_b16 v[130:131], v248 offset:43008
  v_cvt_pk_bf16_f32 v56, v224, v225
  v_cvt_pk_bf16_f32 v57, v226, v227
  v_cvt_pk_bf16_f32 v58, v228, v229
  s_waitcnt lgkmcnt(8)
  v_mfma_f32_32x32x16_bf16 v[40:55], v[132:135], v[196:199], v[40:55]
  ds_read_b64_tr_b16 v[132:133], v249 offset:40960
  ds_read_b64_tr_b16 v[134:135], v249 offset:43008
  v_cvt_pk_bf16_f32 v59, v230, v231
  v_cvt_pk_bf16_f32 v60, v232, v233
  v_cvt_pk_bf16_f32 v61, v234, v235
  s_waitcnt lgkmcnt(9)
  v_mfma_f32_32x32x16_bf16 v[40:55], v[136:139], v[200:203], v[40:55]
  ds_read_b64_tr_b16 v[136:137], v250 offset:40960
  ds_read_b64_tr_b16 v[138:139], v250 offset:43008
  v_cvt_pk_bf16_f32 v62, v236, v237
  v_cvt_pk_bf16_f32 v63, v238, v239
  s_waitcnt lgkmcnt(10)
  v_mfma_f32_32x32x16_bf16 v[40:55], v[140:143], v[204:207], v[40:55]
  ds_read_b64_tr_b16 v[140:141], v251 offset:40960
  ds_read_b64_tr_b16 v[142:143], v251 offset:43008
  s_waitcnt lgkmcnt(11)
  v_mfma_f32_32x32x16_bf16 v[40:55], v[144:147], v[208:211], v[40:55]
  ds_read_b64_tr_b16 v[144:145], v248 offset:45056
  ds_read_b64_tr_b16 v[146:147], v248 offset:47104
  v_mfma_f32_16x16x32_bf16 v[252:255], v[176:179], v[56:59], v[252:255]
  s_waitcnt lgkmcnt(12)
  v_mfma_f32_32x32x16_bf16 v[40:55], v[148:151], v[212:215], v[40:55]
  ds_read_b64_tr_b16 v[148:149], v249 offset:45056
  ds_read_b64_tr_b16 v[150:151], v249 offset:47104
  s_waitcnt lgkmcnt(13)
  v_mfma_f32_32x32x16_bf16 v[40:55], v[152:155], v[216:219], v[40:55]
  ds_read_b64_tr_b16 v[152:153], v250 offset:45056
  ds_read_b64_tr_b16 v[154:155], v250 offset:47104
  v_mfma_f32_16x16x32_bf16 v[252:255], v[176:179], v[60:63], v[252:255]
  s_waitcnt lgkmcnt(14)
  v_mfma_f32_32x32x16_bf16 v[40:55], v[156:159], v[220:223], v[40:55]
  ds_read_b64_tr_b16 v[156:157], v251 offset:45056
  s_waitcnt lgkmcnt(14)
  ds_read_b64_tr_b16 v[158:159], v251 offset:47104
  s_waitcnt vmcnt(0) lgkmcnt(0)
  s_barrier
  s_nop 7
  v_mfma_f32_32x32x16_bf16 v[64:79], v[128:131], v[56:59], v[64:79]
  ds_read_b128 v[128:131], v240 offset:0
  v_max3_f32 v36, v40, v41, v42
  v_max3_f32 v37, v43, v44, v45
  v_max3_f32 v36, v36, v46, v47
  v_max3_f32 v37, v37, v48, v49
  v_mfma_f32_32x32x16_bf16 v[80:95], v[132:135], v[56:59], v[80:95]
  ds_read_b128 v[132:135], v241 offset:0
  v_max3_f32 v36, v36, v50, v51
  v_max3_f32 v37, v37, v52, v53
  v_max3_f32 v36, v36, v54, v55
  v_max_f32 v36, v36, v37
  v_cmp_lt_f32 vcc, s53, v36
  s_cbranch_vccnz L_rare_31
  v_mfma_f32_32x32x16_bf16 v[96:111], v[136:139], v[56:59], v[96:111]
  ds_read_b128 v[136:139], v242 offset:0
  v_exp_f32 v224, v40
  v_exp_f32 v225, v41
  v_mfma_f32_32x32x16_bf16 v[112:127], v[140:143], v[56:59], v[112:127]
  ds_read_b128 v[140:143], v243 offset:0
  v_exp_f32 v226, v42
  v_exp_f32 v227, v43
  v_exp_f32 v228, v44
  v_mfma_f32_32x32x16_bf16 v[64:79], v[144:147], v[60:63], v[64:79]
  ds_read_b128 v[144:147], v244 offset:0
  v_exp_f32 v229, v45
  v_exp_f32 v230, v46
  v_mfma_f32_32x32x16_bf16 v[80:95], v[148:151], v[60:63], v[80:95]
  ds_read_b128 v[148:151], v245 offset:0
  v_exp_f32 v231, v47
  v_exp_f32 v232, v48
  v_exp_f32 v233, v49
  v_mfma_f32_32x32x16_bf16 v[96:111], v[152:155], v[60:63], v[96:111]
  ds_read_b128 v[152:155], v246 offset:0
  v_exp_f32 v234, v50
  v_exp_f32 v235, v51
  v_mfma_f32_32x32x16_bf16 v[112:127], v[156:159], v[60:63], v[112:127]
  ds_read_b128 v[156:159], v247 offset:0
  v_exp_f32 v236, v52
  v_exp_f32 v237, v53
  v_exp_f32 v238, v54
  v_exp_f32 v239, v55
L_back_32:
  s_waitcnt lgkmcnt(7)
  v_mfma_f32_32x32x16_bf16 v[40:55], v[128:131], v[192:195], v[160:175]
  ds_read_b64_tr_b16 v[128:129], v248 offset:8192
  ds_read_b64_tr_b16 v[130:131], v248 offset:10240
  v_cvt_pk_bf16_f32 v56, v224, v225
  v_cvt_pk_bf16_f32 v57, v226, v227
  v_cvt_pk_bf16_f32 v58, v228, v229
  s_waitcnt lgkmcnt(8)
  v_mfma_f32_32x32x16_bf16 v[40:55], v[132:135], v[196:199], v[40:55]
  ds_read_b64_tr_b16 v[132:133], v249 offset:8192
  ds_read_b64_tr_b16 v[134:135], v249 offset:10240
  v_cvt_pk_bf16_f32 v59, v230, v231
  v_cvt_pk_bf16_f32 v60, v232, v233
  v_cvt_pk_bf16_f32 v61, v234, v235
  s_waitcnt lgkmcnt(9)
  v_mfma_f32_32x32x16_bf16 v[40:55], v[136:139], v[200:203], v[40:55]
  ds_read_b64_tr_b16 v[136:137], v250 offset:8192
  ds_read_b64_tr_b16 v[138:139], v250 offset:10240
  v_cvt_pk_bf16_f32 v62, v236, v237
  v_cvt_pk_bf16_f32 v63, v238, v239
  s_waitcnt lgkmcnt(10)
  v_mfma_f32_32x32x16_bf16 v[40:55], v[140:143], v[204:207], v[40:55]
  ds_read_b64_tr_b16 v[140:141], v251 offset:8192
  ds_read_b64_tr_b16 v[142:143], v251 offset:10240
  s_waitcnt lgkmcnt(11)
  v_mfma_f32_32x32x16_bf16 v[40:55], v[144:147], v[208:211], v[40:55]
  ds_read_b64_tr_b16 v[144:145], v248 offset:12288
  ds_read_b64_tr_b16 v[146:147], v248 offset:14336
  v_mfma_f32_16x16x32_bf16 v[252:255], v[176:179], v[56:59], v[252:255]
  s_waitcnt lgkmcnt(12)
  v_mfma_f32_32x32x16_bf16 v[40:55], v[148:151], v[212:215], v[40:55]
  ds_read_b64_tr_b16 v[148:149], v249 offset:12288
  ds_read_b64_tr_b16 v[150:151], v249 offset:14336
  s_waitcnt lgkmcnt(13)
  v_mfma_f32_32x32x16_bf16 v[40:55], v[152:155], v[216:219], v[40:55]
  ds_read_b64_tr_b16 v[152:153], v250 offset:12288
  ds_read_b64_tr_b16 v[154:155], v250 offset:14336
  v_mfma_f32_16x16x32_bf16 v[252:255], v[176:179], v[60:63], v[252:255]
  s_waitcnt lgkmcnt(14)
  v_mfma_f32_32x32x16_bf16 v[40:55], v[156:159], v[220:223], v[40:55]
  ds_read_b64_tr_b16 v[156:157], v251 offset:12288
  s_waitcnt lgkmcnt(14)
  ds_read_b64_tr_b16 v[158:159], v251 offset:14336
  s_waitcnt vmcnt(0) lgkmcnt(0)
  s_barrier
  s_add_u32 s32, s32, 1
  s_cmp_lt_u32 s32, 5
  s_cbranch_scc1 L_attn_26
  s_cmp_eq_u32 s3, 1
  s_cbranch_scc0 L_cc_33
  s_lshr_b32 s43, s2, 3
  s_lshl_b32 s43, s43, 2
  v_mov_b32 v2, s43
  v_mov_b32 v3, 1
  s_mov_b64 exec, 1
  global_atomic_add v2, v3, s[70:71]
  s_mov_b64 exec, -1
L_cc_33:
  s_nop 7
  v_mfma_f32_32x32x16_bf16 v[64:79], v[128:131], v[56:59], v[64:79]
  ds_read_b64_tr_b16 v[128:129], v248 offset:24576
  ds_read_b64_tr_b16 v[130:131], v248 offset:26624
  v_max3_f32 v36, v40, v41, v42
  v_max3_f32 v37, v43, v44, v45
  v_max3_f32 v36, v36, v46, v47
  v_max3_f32 v37, v37, v48, v49
  v_mfma_f32_32x32x16_bf16 v[80:95], v[132:135], v[56:59], v[80:95]
  ds_read_b64_tr_b16 v[132:133], v249 offset:24576
  ds_read_b64_tr_b16 v[134:135], v249 offset:26624
  v_max3_f32 v36, v36, v50, v51
  v_max3_f32 v37, v37, v52, v53
  v_max3_f32 v36, v36, v54, v55
  v_max_f32 v36, v36, v37
  v_cmp_lt_f32 vcc, s53, v36
  s_cbranch_vccnz L_rare_34
  v_mfma_f32_32x32x16_bf16 v[96:111], v[136:139], v[56:59], v[96:111]
  ds_read_b64_tr_b16 v[136:137], v250 offset:24576
  ds_read_b64_tr_b16 v[138:139], v250 offset:26624
  v_exp_f32 v224, v40
  v_exp_f32 v225, v41
  v_mfma_f32_32x32x16_bf16 v[112:127], v[140:143], v[56:59], v[112:127]
  ds_read_b64_tr_b16 v[140:141], v251 offset:24576
  ds_read_b64_tr_b16 v[142:143], v251 offset:26624
  v_exp_f32 v226, v42
  v_exp_f32 v227, v43
  v_exp_f32 v228, v44
  v_mfma_f32_32x32x16_bf16 v[64:79], v[144:147], v[60:63], v[64:79]
  ds_read_b64_tr_b16 v[144:145], v248 offset:28672
  ds_read_b64_tr_b16 v[146:147], v248 offset:30720
  v_exp_f32 v229, v45
  v_exp_f32 v230, v46
  v_mfma_f32_32x32x16_bf16 v[80:95], v[148:151], v[60:63], v[80:95]
  ds_read_b64_tr_b16 v[148:149], v249 offset:28672
  ds_read_b64_tr_b16 v[150:151], v249 offset:30720
  v_exp_f32 v231, v47
  v_exp_f32 v232, v48
  v_exp_f32 v233, v49
  v_mfma_f32_32x32x16_bf16 v[96:111], v[152:155], v[60:63], v[96:111]
  ds_read_b64_tr_b16 v[152:153], v250 offset:28672
  ds_read_b64_tr_b16 v[154:155], v250 offset:30720
  v_exp_f32 v234, v50
  v_exp_f32 v235, v51
  v_mfma_f32_32x32x16_bf16 v[112:127], v[156:159], v[60:63], v[112:127]
  ds_read_b64_tr_b16 v[156:157], v251 offset:28672
  s_waitcnt lgkmcnt(14)
  ds_read_b64_tr_b16 v[158:159], v251 offset:30720
  v_exp_f32 v236, v52
  v_exp_f32 v237, v53
  v_exp_f32 v238, v54
  v_exp_f32 v239, v55
L_back_35:
  v_cvt_pk_bf16_f32 v56, v224, v225
  v_cvt_pk_bf16_f32 v57, v226, v227
  v_cvt_pk_bf16_f32 v58, v228, v229
  v_cvt_pk_bf16_f32 v59, v230, v231
  v_cvt_pk_bf16_f32 v60, v232, v233
  v_cvt_pk_bf16_f32 v61, v234, v235
  v_cvt_pk_bf16_f32 v62, v236, v237
  v_cvt_pk_bf16_f32 v63, v238, v239
  s_nop 1
  v_mfma_f32_16x16x32_bf16 v[252:255], v[176:179], v[56:59], v[252:255]
  v_mfma_f32_16x16x32_bf16 v[252:255], v[176:179], v[60:63], v[252:255]
  s_waitcnt lgkmcnt(14)
  v_mfma_f32_32x32x16_bf16 v[64:79], v[128:131], v[56:59], v[64:79]
  s_waitcnt lgkmcnt(12)
  v_mfma_f32_32x32x16_bf16 v[80:95], v[132:135], v[56:59], v[80:95]
  s_waitcnt lgkmcnt(10)
  v_mfma_f32_32x32x16_bf16 v[96:111], v[136:139], v[56:59], v[96:111]
  s_waitcnt lgkmcnt(8)
  v_mfma_f32_32x32x16_bf16 v[112:127], v[140:143], v[56:59], v[112:127]
  s_waitcnt lgkmcnt(6)
  v_mfma_f32_32x32x16_bf16 v[64:79], v[144:147], v[60:63], v[64:79]
  s_waitcnt lgkmcnt(4)
  v_mfma_f32_32x32x16_bf16 v[80:95], v[148:151], v[60:63], v[80:95]
  s_waitcnt lgkmcnt(2)
  v_mfma_f32_32x32x16_bf16 v[96:111], v[152:155], v[60:63], v[96:111]
  s_waitcnt lgkmcnt(0)
  v_mfma_f32_32x32x16_bf16 v[112:127], v[156:159], v[60:63], v[112:127]
  s_waitcnt lgkmcnt(0)
  s_barrier
  s_nop 7
  v_rcp_f32 v36, v252
  s_nop 7
  s_add_u32 m0, s39, 16384
  s_add_u32 s43, s42, 16384
  s_and_b32 s43, s43, 0x1ffff
  s_add_u32 s43, s43, s52
  buffer_load_dwordx4 v4, s[8:11], s43 offen nt lds
  v_pk_mul_f32 v[64:65], v[64:65], v[36:37] op_sel_hi:[1,0]
  v_pk_mul_f32 v[66:67], v[66:67], v[36:37] op_sel_hi:[1,0]
  v_cvt_pk_bf16_f32 v192, v64, v65
  buffer_load_dwordx4 v5, s[8:11], s43 offen offset:1024 nt lds
  v_pk_mul_f32 v[68:69], v[68:69], v[36:37] op_sel_hi:[1,0]
  v_cvt_pk_bf16_f32 v193, v66, v67
  v_pk_mul_f32 v[70:71], v[70:71], v[36:37] op_sel_hi:[1,0]
  v_cvt_pk_bf16_f32 v194, v68, v69
  buffer_load_dwordx4 v6, s[8:11], s43 offen offset:2048 nt lds
  v_pk_mul_f32 v[72:73], v[72:73], v[36:37] op_sel_hi:[1,0]
  v_cvt_pk_bf16_f32 v195, v70, v71
  v_pk_mul_f32 v[74:75], v[74:75], v[36:37] op_sel_hi:[1,0]
  v_cvt_pk_bf16_f32 v196, v72, v73
  buffer_load_dwordx4 v7, s[8:11], s43 offen offset:3072 nt lds
  v_pk_mul_f32 v[76:77], v[76:77], v[36:37] op_sel_hi:[1,0]
  v_cvt_pk_bf16_f32 v197, v74, v75
  v_pk_mul_f32 v[78:79], v[78:79], v[36:37] op_sel_hi:[1,0]
  v_cvt_pk_bf16_f32 v198, v76, v77
  s_add_u32 m0, s39, 20480
  s_add_u32 s43, s42, 20480
  s_and_b32 s43, s43, 0x1ffff
  s_add_u32 s43, s43, s52
  buffer_load_dwordx4 v4, s[8:11], s43 offen nt lds
  v_pk_mul_f32 v[80:81], v[80:81], v[36:37] op_sel_hi:[1,0]
  v_cvt_pk_bf16_f32 v199, v78, v79
  v_pk_mul_f32 v[82:83], v[82:83], v[36:37] op_sel_hi:[1,0]
  v_cvt_pk_bf16_f32 v200, v80, v81
  buffer_load_dwordx4 v5, s[8:11], s43 offen offset:1024 nt lds
  v_pk_mul_f32 v[84:85], v[84:85], v[36:37] op_sel_hi:[1,0]
  v_cvt_pk_bf16_f32 v201, v82, v83
  v_pk_mul_f32 v[86:87], v[86:87], v[36:37] op_sel_hi:[1,0]
  v_cvt_pk_bf16_f32 v202, v84, v85
  buffer_load_dwordx4 v6, s[8:11], s43 offen offset:2048 nt lds
  v_pk_mul_f32 v[88:89], v[88:89], v[36:37] op_sel_hi:[1,0]
  v_cvt_pk_bf16_f32 v203, v86, v87
  v_pk_mul_f32 v[90:91], v[90:91], v[36:37] op_sel_hi:[1,0]
  v_cvt_pk_bf16_f32 v204, v88, v89
  buffer_load_dwordx4 v7, s[8:11], s43 offen offset:3072 nt lds
  v_pk_mul_f32 v[92:93], v[92:93], v[36:37] op_sel_hi:[1,0]
  v_cvt_pk_bf16_f32 v205, v90, v91
  v_pk_mul_f32 v[94:95], v[94:95], v[36:37] op_sel_hi:[1,0]
  v_cvt_pk_bf16_f32 v206, v92, v93
  v_pk_mul_f32 v[96:97], v[96:97], v[36:37] op_sel_hi:[1,0]
  v_cvt_pk_bf16_f32 v207, v94, v95
  v_pk_mul_f32 v[98:99], v[98:99], v[36:37] op_sel_hi:[1,0]
  v_cvt_pk_bf16_f32 v208, v96, v97
  v_pk_mul_f32 v[100:101], v[100:101], v[36:37] op_sel_hi:[1,0]
  v_cvt_pk_bf16_f32 v209, v98, v99
  v_pk_mul_f32 v[102:103], v[102:103], v[36:37] op_sel_hi:[1,0]
  v_cvt_pk_bf16_f32 v210, v100, v101
  v_pk_mul_f32 v[104:105], v[104:105], v[36:37] op_sel_hi:[1,0]
  v_cvt_pk_bf16_f32 v211, v102, v103
  v_pk_mul_f32 v[106:107], v[106:107], v[36:37] op_sel_hi:[1,0]
  v_cvt_pk_bf16_f32 v212, v104, v105
  v_pk_mul_f32 v[108:109], v[108:109], v[36:37] op_sel_hi:[1,0]
  v_cvt_pk_bf16_f32 v213, v106, v107
  v_pk_mul_f32 v[110:111], v[110:111], v[36:37] op_sel_hi:[1,0]
  v_cvt_pk_bf16_f32 v214, v108, v109
  v_pk_mul_f32 v[112:113], v[112:113], v[36:37] op_sel_hi:[1,0]
  v_cvt_pk_bf16_f32 v215, v110, v111
  v_pk_mul_f32 v[114:115], v[114:115], v[36:37] op_sel_hi:[1,0]
  v_cvt_pk_bf16_f32 v216, v112, v113
  v_pk_mul_f32 v[116:117], v[116:117], v[36:37] op_sel_hi:[1,0]
  v_cvt_pk_bf16_f32 v217, v114, v115
  v_pk_mul_f32 v[118:119], v[118:119], v[36:37] op_sel_hi:[1,0]
  v_cvt_pk_bf16_f32 v218, v116, v117
  v_pk_mul_f32 v[120:121], v[120:121], v[36:37] op_sel_hi:[1,0]
  v_cvt_pk_bf16_f32 v219, v118, v119
  v_pk_mul_f32 v[122:123], v[122:123], v[36:37] op_sel_hi:[1,0]
  v_cvt_pk_bf16_f32 v220, v120, v121
  v_pk_mul_f32 v[124:125], v[124:125], v[36:37] op_sel_hi:[1,0]
  v_cvt_pk_bf16_f32 v221, v122, v123
  v_pk_mul_f32 v[126:127], v[126:127], v[36:37] op_sel_hi:[1,0]
  v_cvt_pk_bf16_f32 v222, v124, v125
  v_cvt_pk_bf16_f32 v223, v126, v127
  s_add_u32 s43, s34, 131072
  v_add_u32 v28, s43, v18
  v_xor_b32 v29, 0x4000, v28
  ds_write_b128 v28, v[192:195] offset:0
  ds_write_b128 v28, v[196:199] offset:1024
  ds_write_b128 v28, v[200:203] offset:2048
  ds_write_b128 v28, v[204:207] offset:3072
  ds_write_b128 v28, v[208:211] offset:4096
  ds_write_b128 v28, v[212:215] offset:5120
  ds_write_b128 v28, v[216:219] offset:6144
  ds_write_b128 v28, v[220:223] offset:7168
  s_waitcnt lgkmcnt(0)
  s_barrier
  ds_read_b128 v[224:227], v29 offset:0
  ds_read_b128 v[228:231], v29 offset:1024
  ds_read_b128 v[232:235], v29 offset:2048
  ds_read_b128 v[236:239], v29 offset:3072
  ds_read_b128 v[240:243], v29 offset:4096
  ds_read_b128 v[244:247], v29 offset:5120
  ds_read_b128 v[248:251], v29 offset:6144
  ds_read_b128 v[252:255], v29 offset:7168
  s_add_u32 m0, s39, 32768
  s_add_u32 s43, s42, 24576
  s_and_b32 s43, s43, 0x1ffff
  s_add_u32 s43, s43, s52
  buffer_load_dwordx4 v4, s[8:11], s43 offen nt lds
  buffer_load_dwordx4 v5, s[8:11], s43 offen offset:1024 nt lds
  buffer_load_dwordx4 v6, s[8:11], s43 offen offset:2048 nt lds
  buffer_load_dwordx4 v7, s[8:11], s43 offen offset:3072 nt lds
  s_add_u32 m0, s39, 36864
  s_add_u32 s43, s42, 28672
  s_and_b32 s43, s43, 0x1ffff
  s_add_u32 s43, s43, s52
  buffer_load_dwordx4 v4, s[8:11], s43 offen nt lds
  buffer_load_dwordx4 v5, s[8:11], s43 offen offset:1024 nt lds
  buffer_load_dwordx4 v6, s[8:11], s43 offen offset:2048 nt lds
  buffer_load_dwordx4 v7, s[8:11], s43 offen offset:3072 nt lds
  s_waitcnt vmcnt(8) lgkmcnt(0)
  s_barrier
  s_add_u32 m0, s39, 0
  s_add_u32 s43, s42, 32768
  s_and_b32 s43, s43, 0x1ffff
  s_add_u32 s43, s43, s52
  buffer_load_dwordx4 v4, s[8:11], s43 offen nt lds
  buffer_load_dwordx4 v5, s[8:11], s43 offen offset:1024 nt lds
  buffer_load_dwordx4 v6, s[8:11], s43 offen offset:2048 nt lds
  buffer_load_dwordx4 v7, s[8:11], s43 offen offset:3072 nt lds
  s_add_u32 m0, s39, 4096
  s_add_u32 s43, s42, 36864
  s_and_b32 s43, s43, 0x1ffff
  s_add_u32 s43, s43, s52
  buffer_load_dwordx4 v4, s[8:11], s43 offen nt lds
  buffer_load_dwordx4 v5, s[8:11], s43 offen offset:1024 nt lds
  buffer_load_dwordx4 v6, s[8:11], s43 offen offset:2048 nt lds
  buffer_load_dwordx4 v7, s[8:11], s43 offen offset:3072 nt lds
  s_waitcnt vmcnt(8) lgkmcnt(0)
  s_barrier
  s_add_u32 m0, s39, 16384
  s_add_u32 s43, s42, 40960
  s_and_b32 s43, s43, 0x1ffff
  s_add_u32 s43, s43, s52
  buffer_load_dwordx4 v4, s[8:11], s43 offen nt lds
  buffer_load_dwordx4 v5, s[8:11], s43 offen offset:1024 nt lds
  buffer_load_dwordx4 v6, s[8:11], s43 offen offset:2048 nt lds
  buffer_load_dwordx4 v7, s[8:11], s43 offen offset:3072 nt lds
  s_add_u32 m0, s39, 20480
  s_add_u32 s43, s42, 45056
  s_and_b32 s43, s43, 0x1ffff
  s_add_u32 s43, s43, s52
  buffer_load_dwordx4 v4, s[8:11], s43 offen nt lds
  buffer_load_dwordx4 v5, s[8:11], s43 offen offset:1024 nt lds
  buffer_load_dwordx4 v6, s[8:11], s43 offen offset:2048 nt lds
  buffer_load_dwordx4 v7, s[8:11], s43 offen offset:3072 nt lds
  s_waitcnt vmcnt(8) lgkmcnt(0)
  s_barrier
  s_add_u32 m0, s39, 32768
  s_add_u32 s43, s42, 49152
  s_and_b32 s43, s43, 0x1ffff
  s_add_u32 s43, s43, s52
  buffer_load_dwordx4 v4, s[8:11], s43 offen nt lds
  buffer_load_dwordx4 v5, s[8:11], s43 offen offset:1024 nt lds
  buffer_load_dwordx4 v6, s[8:11], s43 offen offset:2048 nt lds
  buffer_load_dwordx4 v7, s[8:11], s43 offen offset:3072 nt lds
  s_add_u32 m0, s39, 36864
  s_add_u32 s43, s42, 53248
  s_and_b32 s43, s43, 0x1ffff
  s_add_u32 s43, s43, s52
  buffer_load_dwordx4 v4, s[8:11], s43 offen nt lds
  buffer_load_dwordx4 v5, s[8:11], s43 offen offset:1024 nt lds
  buffer_load_dwordx4 v6, s[8:11], s43 offen offset:2048 nt lds
  buffer_load_dwordx4 v7, s[8:11], s43 offen offset:3072 nt lds
  s_waitcnt vmcnt(8) lgkmcnt(0)
  s_barrier
  s_add_u32 m0, s39, 0
  s_add_u32 s43, s42, 57344
  s_and_b32 s43, s43, 0x1ffff
  s_add_u32 s43, s43, s52
  buffer_load_dwordx4 v4, s[8:11], s43 offen nt lds
  buffer_load_dwordx4 v5, s[8:11], s43 offen offset:1024 nt lds
  buffer_load_dwordx4 v6, s[8:11], s43 offen offset:2048 nt lds
  buffer_load_dwordx4 v7, s[8:11], s43 offen offset:3072 nt lds
  s_add_u32 m0, s39, 4096
  s_add_u32 s43, s42, 61440
  s_and_b32 s43, s43, 0x1ffff
  s_add_u32 s43, s43, s52
  buffer_load_dwordx4 v4, s[8:11], s43 offen nt lds
  buffer_load_dwordx4 v5, s[8:11], s43 offen offset:1024 nt lds
  buffer_load_dwordx4 v6, s[8:11], s43 offen offset:2048 nt lds
  buffer_load_dwordx4 v7, s[8:11], s43 offen offset:3072 nt lds
  s_waitcnt vmcnt(8) lgkmcnt(0)
  s_barrier
  s_add_u32 m0, s39, 16384
  s_add_u32 s43, s42, 65536
  s_and_b32 s43, s43, 0x1ffff
  s_add_u32 s43, s43, s52
  buffer_load_dwordx4 v4, s[8:11], s43 offen nt lds
  buffer_load_dwordx4 v5, s[8:11], s43 offen offset:1024 nt lds
  buffer_load_dwordx4 v6, s[8:11], s43 offen offset:2048 nt lds
  buffer_load_dwordx4 v7, s[8:11], s43 offen offset:3072 nt lds
  s_add_u32 m0, s39, 20480
  s_add_u32 s43, s42, 69632
  s_and_b32 s43, s43, 0x1ffff
  s_add_u32 s43, s43, s52
  buffer_load_dwordx4 v4, s[8:11], s43 offen nt lds
  buffer_load_dwordx4 v5, s[8:11], s43 offen offset:1024 nt lds
  buffer_load_dwordx4 v6, s[8:11], s43 offen offset:2048 nt lds
  buffer_load_dwordx4 v7, s[8:11], s43 offen offset:3072 nt lds
  s_waitcnt vmcnt(8) lgkmcnt(0)
  s_barrier
  s_add_u32 m0, s39, 32768
  s_add_u32 s43, s42, 73728
  s_and_b32 s43, s43, 0x1ffff
  s_add_u32 s43, s43, s52
  buffer_load_dwordx4 v4, s[8:11], s43 offen nt lds
  buffer_load_dwordx4 v5, s[8:11], s43 offen offset:1024 nt lds
  buffer_load_dwordx4 v6, s[8:11], s43 offen offset:2048 nt lds
  buffer_load_dwordx4 v7, s[8:11], s43 offen offset:3072 nt lds
  s_add_u32 m0, s39, 36864
  s_add_u32 s43, s42, 77824
  s_and_b32 s43, s43, 0x1ffff
  s_add_u32 s43, s43, s52
  buffer_load_dwordx4 v4, s[8:11], s43 offen nt lds
  buffer_load_dwordx4 v5, s[8:11], s43 offen offset:1024 nt lds
  buffer_load_dwordx4 v6, s[8:11], s43 offen offset:2048 nt lds
  buffer_load_dwordx4 v7, s[8:11], s43 offen offset:3072 nt lds
  s_waitcnt vmcnt(8) lgkmcnt(0)
  s_barrier
  s_add_u32 m0, s39, 0
  s_add_u32 s43, s42, 81920
  s_and_b32 s43, s43, 0x1ffff
  s_add_u32 s43, s43, s52
  buffer_load_dwordx4 v4, s[8:11], s43 offen nt lds
  buffer_load_dwordx4 v5, s[8:11], s43 offen offset:1024 nt lds
  buffer_load_dwordx4 v6, s[8:11], s43 offen offset:2048 nt lds
  buffer_load_dwordx4 v7, s[8:11], s43 offen offset:3072 nt lds
  s_add_u32 m0, s39, 4096
  s_add_u32 s43, s42, 86016
  s_and_b32 s43, s43, 0x1ffff
  s_add_u32 s43, s43, s52
  buffer_load_dwordx4 v4, s[8:11], s43 offen nt lds
  buffer_load_dwordx4 v5, s[8:11], s43 offen offset:1024 nt lds
  buffer_load_dwordx4 v6, s[8:11], s43 offen offset:2048 nt lds
  buffer_load_dwordx4 v7, s[8:11], s43 offen offset:3072 nt lds
  s_waitcnt vmcnt(8) lgkmcnt(0)
  s_barrier
  s_add_u32 m0, s39, 16384
  s_add_u32 s43, s42, 90112
  s_and_b32 s43, s43, 0x1ffff
  s_add_u32 s43, s43, s52
  buffer_load_dwordx4 v4, s[8:11], s43 offen nt lds
  buffer_load_dwordx4 v5, s[8:11], s43 offen offset:1024 nt lds
  buffer_load_dwordx4 v6, s[8:11], s43 offen offset:2048 nt lds
  buffer_load_dwordx4 v7, s[8:11], s43 offen offset:3072 nt lds
  s_add_u32 m0, s39, 20480
  s_add_u32 s43, s42, 94208
  s_and_b32 s43, s43, 0x1ffff
  s_add_u32 s43, s43, s52
  buffer_load_dwordx4 v4, s[8:11], s43 offen nt lds
  buffer_load_dwordx4 v5, s[8:11], s43 offen offset:1024 nt lds
  buffer_load_dwordx4 v6, s[8:11], s43 offen offset:2048 nt lds
  buffer_load_dwordx4 v7, s[8:11], s43 offen offset:3072 nt lds
  s_waitcnt vmcnt(8) lgkmcnt(0)
  s_barrier
  s_add_u32 m0, s39, 32768
  s_add_u32 s43, s42, 98304
  s_and_b32 s43, s43, 0x1ffff
  s_add_u32 s43, s43, s52
  buffer_load_dwordx4 v4, s[8:11], s43 offen nt lds
  buffer_load_dwordx4 v5, s[8:11], s43 offen offset:1024 nt lds
  buffer_load_dwordx4 v6, s[8:11], s43 offen offset:2048 nt lds
  buffer_load_dwordx4 v7, s[8:11], s43 offen offset:3072 nt lds
  s_add_u32 m0, s39, 36864
  s_add_u32 s43, s42, 102400
  s_and_b32 s43, s43, 0x1ffff
  s_add_u32 s43, s43, s52
  buffer_load_dwordx4 v4, s[8:11], s43 offen nt lds
  buffer_load_dwordx4 v5, s[8:11], s43 offen offset:1024 nt lds
  buffer_load_dwordx4 v6, s[8:11], s43 offen offset:2048 nt lds
  buffer_load_dwordx4 v7, s[8:11], s43 offen offset:3072 nt lds
  s_waitcnt vmcnt(8) lgkmcnt(0)
  s_barrier
  s_add_u32 m0, s39, 0
  s_add_u32 s43, s42, 106496
  s_and_b32 s43, s43, 0x1ffff
  s_add_u32 s43, s43, s52
  buffer_load_dwordx4 v4, s[8:11], s43 offen nt lds
  buffer_load_dwordx4 v5, s[8:11], s43 offen offset:1024 nt lds
  buffer_load_dwordx4 v6, s[8:11], s43 offen offset:2048 nt lds
  buffer_load_dwordx4 v7, s[8:11], s43 offen offset:3072 nt lds
  s_add_u32 m0, s39, 4096
  s_add_u32 s43, s42, 110592
  s_and_b32 s43, s43, 0x1ffff
  s_add_u32 s43, s43, s52
  buffer_load_dwordx4 v4, s[8:11], s43 offen nt lds
  buffer_load_dwordx4 v5, s[8:11], s43 offen offset:1024 nt lds
  buffer_load_dwordx4 v6, s[8:11], s43 offen offset:2048 nt lds
  buffer_load_dwordx4 v7, s[8:11], s43 offen offset:3072 nt lds
  s_waitcnt vmcnt(8) lgkmcnt(0)
  s_barrier
  s_add_u32 m0, s39, 16384
  s_add_u32 s43, s42, 114688
  s_and_b32 s43, s43, 0x1ffff
  s_add_u32 s43, s43, s52
  buffer_load_dwordx4 v4, s[8:11], s43 offen nt lds
  buffer_load_dwordx4 v5, s[8:11], s43 offen offset:1024 nt lds
  buffer_load_dwordx4 v6, s[8:11], s43 offen offset:2048 nt lds
  buffer_load_dwordx4 v7, s[8:11], s43 offen offset:3072 nt lds
  s_add_u32 m0, s39, 20480
  s_add_u32 s43, s42, 118784
  s_and_b32 s43, s43, 0x1ffff
  s_add_u32 s43, s43, s52
  buffer_load_dwordx4 v4, s[8:11], s43 offen nt lds
  buffer_load_dwordx4 v5, s[8:11], s43 offen offset:1024 nt lds
  buffer_load_dwordx4 v6, s[8:11], s43 offen offset:2048 nt lds
  buffer_load_dwordx4 v7, s[8:11], s43 offen offset:3072 nt lds
  s_waitcnt vmcnt(8) lgkmcnt(0)
  s_barrier
  v_lshrrev_b32 v2, 9, v18
  v_lshlrev_b32 v2, 17, v2
  v_xor_b32 v3, 0, v18
  v_add_u32 v8, v3, v2
  v_xor_b32 v3, 64, v18
  v_add_u32 v9, v3, v2
  v_xor_b32 v3, 128, v18
  v_add_u32 v10, v3, v2
  v_xor_b32 v3, 192, v18
  v_add_u32 v11, v3, v2
  s_add_u32 m0, s33, 147456
  s_add_u32 s43, s33, 0
  buffer_load_dwordx4 v8, s[24:27], s43 offen lds
  buffer_load_dwordx4 v9, s[24:27], s43 offen offset:1024 lds
  buffer_load_dwordx4 v10, s[24:27], s43 offen offset:2048 lds
  buffer_load_dwordx4 v11, s[24:27], s43 offen offset:3072 lds
  s_add_u32 m0, s33, 131072
  s_add_u32 s43, s33, 16384
  buffer_load_dwordx4 v8, s[24:27], s43 offen lds
  buffer_load_dwordx4 v9, s[24:27], s43 offen offset:1024 lds
  buffer_load_dwordx4 v10, s[24:27], s43 offen offset:2048 lds
  buffer_load_dwordx4 v11, s[24:27], s43 offen offset:3072 lds
  s_add_u32 m0, s33, 114688
  s_add_u32 s43, s33, 32768
  buffer_load_dwordx4 v8, s[24:27], s43 offen lds
  buffer_load_dwordx4 v9, s[24:27], s43 offen offset:1024 lds
  buffer_load_dwordx4 v10, s[24:27], s43 offen offset:2048 lds
  buffer_load_dwordx4 v11, s[24:27], s43 offen offset:3072 lds
  s_add_u32 m0, s33, 98304
  s_add_u32 s43, s33, 49152
  buffer_load_dwordx4 v8, s[24:27], s43 offen lds
  buffer_load_dwordx4 v9, s[24:27], s43 offen offset:1024 lds
  buffer_load_dwordx4 v10, s[24:27], s43 offen offset:2048 lds
  buffer_load_dwordx4 v11, s[24:27], s43 offen offset:3072 lds
  s_add_u32 m0, s39, 32768
  s_add_u32 s43, s42, 122880
  s_and_b32 s43, s43, 0x1ffff
  s_add_u32 s43, s43, s52
  s_cmp_eq_u32 s47, 0
  s_cselect_b64 exec, 1, -1
  buffer_load_dwordx4 v4, s[8:11], s43 offen nt lds
  buffer_load_dwordx4 v5, s[8:11], s43 offen offset:1024 nt lds
  buffer_load_dwordx4 v6, s[8:11], s43 offen offset:2048 nt lds
  buffer_load_dwordx4 v7, s[8:11], s43 offen offset:3072 nt lds
  s_mov_b64 exec, -1
  s_add_u32 m0, s39, 36864
  s_add_u32 s43, s42, 126976
  s_and_b32 s43, s43, 0x1ffff
  s_add_u32 s43, s43, s52
  s_cmp_eq_u32 s47, 0
  s_cselect_b64 exec, 1, -1
  buffer_load_dwordx4 v4, s[8:11], s43 offen nt lds
  buffer_load_dwordx4 v5, s[8:11], s43 offen offset:1024 nt lds
  buffer_load_dwordx4 v6, s[8:11], s43 offen offset:2048 nt lds
  buffer_load_dwordx4 v7, s[8:11], s43 offen offset:3072 nt lds
  s_mov_b64 exec, -1
  s_waitcnt vmcnt(8) lgkmcnt(0)
  s_barrier
  v_add_u32 v20, 147456, v17
  v_xor_b32 v21, 64, v20
  v_xor_b32 v22, 128, v20
  v_xor_b32 v23, 192, v20
  ds_read_b64_tr_b16 v[32:33], v20 offset:0
  ds_read_b64_tr_b16 v[34:35], v20 offset:4096
  s_add_u32 m0, s33, 49152
  s_add_u32 s43, s33, 65536
  buffer_load_dwordx4 v8, s[24:27], s43 offen lds
  ds_read_b64_tr_b16 v[36:37], v21 offset:0
  ds_read_b64_tr_b16 v[38:39], v21 offset:4096
  buffer_load_dwordx4 v9, s[24:27], s43 offen offset:1024 lds
  ds_read_b64_tr_b16 v[40:41], v22 offset:0
  ds_read_b64_tr_b16 v[42:43], v22 offset:4096
  ds_read_b64_tr_b16 v[44:45], v23 offset:0
  ds_read_b64_tr_b16 v[46:47], v23 offset:4096
  ds_read_b64_tr_b16 v[48:49], v20 offset:256
  ds_read_b64_tr_b16 v[50:51], v20 offset:4352
  ds_read_b64_tr_b16 v[52:53], v21 offset:256
  ds_read_b64_tr_b16 v[54:55], v21 offset:4352
  ds_read_b64_tr_b16 v[56:57], v22 offset:256
  ds_read_b64_tr_b16 v[58:59], v22 offset:4352
  ds_read_b64_tr_b16 v[60:61], v23 offset:256
  s_waitcnt lgkmcnt(14)
  ds_read_b64_tr_b16 v[62:63], v23 offset:4352
  v_add_u32 v20, 131072, v17
  v_xor_b32 v21, 64, v20
  v_xor_b32 v22, 128, v20
  v_xor_b32 v23, 192, v20
  s_waitcnt lgkmcnt(14)
  v_mfma_f32_32x32x16_bf16 v[64:79], v[32:35], v[192:195], 0
  ds_read_b64_tr_b16 v[32:33], v20 offset:0
  s_waitcnt lgkmcnt(14)
  ds_read_b64_tr_b16 v[34:35], v20 offset:4096
  buffer_load_dwordx4 v10, s[24:27], s43 offen offset:2048 lds
  s_waitcnt lgkmcnt(14)
  v_mfma_f32_32x32x16_bf16 v[80:95], v[36:39], v[192:195], 0
  ds_read_b64_tr_b16 v[36:37], v21 offset:0
  s_waitcnt lgkmcnt(14)
  ds_read_b64_tr_b16 v[38:39], v21 offset:4096
  buffer_load_dwordx4 v11, s[24:27], s43 offen offset:3072 lds
  s_waitcnt lgkmcnt(14)
  v_mfma_f32_32x32x16_bf16 v[96:111], v[40:43], v[192:195], 0
  ds_read_b64_tr_b16 v[40:41], v22 offset:0
  s_waitcnt lgkmcnt(14)
  ds_read_b64_tr_b16 v[42:43], v22 offset:4096
  s_waitcnt lgkmcnt(14)
  v_mfma_f32_32x32x16_bf16 v[112:127], v[44:47], v[192:195], 0
  ds_read_b64_tr_b16 v[44:45], v23 offset:0
  s_waitcnt lgkmcnt(14)
  ds_read_b64_tr_b16 v[46:47], v23 offset:4096
  s_waitcnt lgkmcnt(14)
  v_mfma_f32_32x32x16_bf16 v[128:143], v[48:51], v[192:195], 0
  ds_read_b64_tr_b16 v[48:49], v20 offset:256
  s_waitcnt lgkmcnt(14)
  ds_read_b64_tr_b16 v[50:51], v20 offset:4352
  s_waitcnt lgkmcnt(14)
  v_mfma_f32_32x32x16_bf16 v[144:159], v[52:55], v[192:195], 0
  ds_read_b64_tr_b16 v[52:53], v21 offset:256
  s_waitcnt lgkmcnt(14)
  ds_read_b64_tr_b16 v[54:55], v21 offset:4352
  s_waitcnt lgkmcnt(14)
  v_mfma_f32_32x32x16_bf16 v[160:175], v[56:59], v[192:195], 0
  ds_read_b64_tr_b16 v[56:57], v22 offset:256
  s_waitcnt lgkmcnt(14)
  ds_read_b64_tr_b16 v[58:59], v22 offset:4352
  s_waitcnt lgkmcnt(14)
  v_mfma_f32_32x32x16_bf16 v[176:191], v[60:63], v[192:195], 0
  ds_read_b64_tr_b16 v[60:61], v23 offset:256
  s_waitcnt lgkmcnt(14)
  ds_read_b64_tr_b16 v[62:63], v23 offset:4352
  v_add_u32 v20, 114688, v17
  v_xor_b32 v21, 64, v20
  v_xor_b32 v22, 128, v20
  v_xor_b32 v23, 192, v20
  s_waitcnt lgkmcnt(14)
  v_mfma_f32_32x32x16_bf16 v[64:79], v[32:35], v[196:199], v[64:79]
  ds_read_b64_tr_b16 v[32:33], v20 offset:0
  s_waitcnt lgkmcnt(14)
  ds_read_b64_tr_b16 v[34:35], v20 offset:4096
  s_add_u32 m0, s33, 0
  s_add_u32 s43, s33, 81920
  buffer_load_dwordx4 v8, s[24:27], s43 offen lds
  s_waitcnt lgkmcnt(14)
  v_mfma_f32_32x32x16_bf16 v[80:95], v[36:39], v[196:199], v[80:95]
  ds_read_b64_tr_b16 v[36:37], v21 offset:0
  s_waitcnt lgkmcnt(14)
  ds_read_b64_tr_b16 v[38:39], v21 offset:4096
  buffer_load_dwordx4 v9, s[24:27], s43 offen offset:1024 lds
  s_waitcnt lgkmcnt(14)
  v_mfma_f32_32x32x16_bf16 v[96:111], v[40:43], v[196:199], v[96:111]
  ds_read_b64_tr_b16 v[40:41], v22 offset:0
  s_waitcnt lgkmcnt(14)
  ds_read_b64_tr_b16 v[42:43], v22 offset:4096
  s_waitcnt lgkmcnt(14)
  v_mfma_f32_32x32x16_bf16 v[112:127], v[44:47], v[196:199], v[112:127]
  ds_read_b64_tr_b16 v[44:45], v23 offset:0
  s_waitcnt lgkmcnt(14)
  ds_read_b64_tr_b16 v[46:47], v23 offset:4096
  s_waitcnt lgkmcnt(14)
  v_mfma_f32_32x32x16_bf16 v[128:143], v[48:51], v[196:199], v[128:143]
  ds_read_b64_tr_b16 v[48:49], v20 offset:256
  s_waitcnt lgkmcnt(14)
  ds_read_b64_tr_b16 v[50:51], v20 offset:4352
  s_waitcnt lgkmcnt(14)
  v_mfma_f32_32x32x16_bf16 v[144:159], v[52:55], v[196:199], v[144:159]
  ds_read_b64_tr_b16 v[52:53], v21 offset:256
  s_waitcnt lgkmcnt(14)
  ds_read_b64_tr_b16 v[54:55], v21 offset:4352
  s_waitcnt lgkmcnt(14)
  v_mfma_f32_32x32x16_bf16 v[160:175], v[56:59], v[196:199], v[160:175]
  ds_read_b64_tr_b16 v[56:57], v22 offset:256
  s_waitcnt lgkmcnt(14)
  ds_read_b64_tr_b16 v[58:59], v22 offset:4352
  s_waitcnt lgkmcnt(14)
  v_mfma_f32_32x32x16_bf16 v[176:191], v[60:63], v[196:199], v[176:191]
  ds_read_b64_tr_b16 v[60:61], v23 offset:256
  s_waitcnt lgkmcnt(14)
  ds_read_b64_tr_b16 v[62:63], v23 offset:4352
  v_add_u32 v20, 98304, v17
  v_xor_b32 v21, 64, v20
  v_xor_b32 v22, 128, v20
  v_xor_b32 v23, 192, v20
  s_waitcnt lgkmcnt(14)
  v_mfma_f32_32x32x16_bf16 v[64:79], v[32:35], v[200:203], v[64:79]
  ds_read_b64_tr_b16 v[32:33], v20 offset:0
  s_waitcnt lgkmcnt(14)
  ds_read_b64_tr_b16 v[34:35], v20 offset:4096
  buffer_load_dwordx4 v10, s[24:27], s43 offen offset:2048 lds
  s_waitcnt lgkmcnt(14)
  v_mfma_f32_32x32x16_bf16 v[80:95], v[36:39], v[200:203], v[80:95]
  ds_read_b64_tr_b16 v[36:37], v21 offset:0
  s_waitcnt lgkmcnt(14)
  ds_read_b64_tr_b16 v[38:39], v21 offset:4096
  buffer_load_dwordx4 v11, s[24:27], s43 offen offset:3072 lds
  s_waitcnt lgkmcnt(14)
  v_mfma_f32_32x32x16_bf16 v[96:111], v[40:43], v[200:203], v[96:111]
  ds_read_b64_tr_b16 v[40:41], v22 offset:0
  s_waitcnt lgkmcnt(14)
  ds_read_b64_tr_b16 v[42:43], v22 offset:4096
  s_waitcnt lgkmcnt(14)
  v_mfma_f32_32x32x16_bf16 v[112:127], v[44:47], v[200:203], v[112:127]
  ds_read_b64_tr_b16 v[44:45], v23 offset:0
  s_waitcnt lgkmcnt(14)
  ds_read_b64_tr_b16 v[46:47], v23 offset:4096
  s_waitcnt lgkmcnt(14)
  v_mfma_f32_32x32x16_bf16 v[128:143], v[48:51], v[200:203], v[128:143]
  ds_read_b64_tr_b16 v[48:49], v20 offset:256
  s_waitcnt lgkmcnt(14)
  ds_read_b64_tr_b16 v[50:51], v20 offset:4352
  s_waitcnt lgkmcnt(14)
  v_mfma_f32_32x32x16_bf16 v[144:159], v[52:55], v[200:203], v[144:159]
  ds_read_b64_tr_b16 v[52:53], v21 offset:256
  s_waitcnt lgkmcnt(14)
  ds_read_b64_tr_b16 v[54:55], v21 offset:4352
  s_waitcnt lgkmcnt(14)
  v_mfma_f32_32x32x16_bf16 v[160:175], v[56:59], v[200:203], v[160:175]
  ds_read_b64_tr_b16 v[56:57], v22 offset:256
  s_waitcnt lgkmcnt(14)
  ds_read_b64_tr_b16 v[58:59], v22 offset:4352
  s_waitcnt lgkmcnt(14)
  v_mfma_f32_32x32x16_bf16 v[176:191], v[60:63], v[200:203], v[176:191]
  ds_read_b64_tr_b16 v[60:61], v23 offset:256
  s_waitcnt lgkmcnt(14)
  ds_read_b64_tr_b16 v[62:63], v23 offset:4352
  s_waitcnt vmcnt(0) lgkmcnt(0)
  s_barrier
  v_add_u32 v20, 49152, v17
  v_xor_b32 v21, 64, v20
  v_xor_b32 v22, 128, v20
  v_xor_b32 v23, 192, v20
  v_mfma_f32_32x32x16_bf16 v[64:79], v[32:35], v[204:207], v[64:79]
  ds_read_b64_tr_b16 v[32:33], v20 offset:0
  ds_read_b64_tr_b16 v[34:35], v20 offset:4096
  s_add_u32 m0, s33, 147456
  s_add_u32 s43, s33, 98304
  buffer_load_dwordx4 v8, s[24:27], s43 offen lds
  v_mfma_f32_32x32x16_bf16 v[80:95], v[36:39], v[204:207], v[80:95]
  ds_read_b64_tr_b16 v[36:37], v21 offset:0
  ds_read_b64_tr_b16 v[38:39], v21 offset:4096
  buffer_load_dwordx4 v9, s[24:27], s43 offen offset:1024 lds
  v_mfma_f32_32x32x16_bf16 v[96:111], v[40:43], v[204:207], v[96:111]
  ds_read_b64_tr_b16 v[40:41], v22 offset:0
  ds_read_b64_tr_b16 v[42:43], v22 offset:4096
  buffer_load_dwordx4 v10, s[24:27], s43 offen offset:2048 lds
  v_mfma_f32_32x32x16_bf16 v[112:127], v[44:47], v[204:207], v[112:127]
  ds_read_b64_tr_b16 v[44:45], v23 offset:0
  ds_read_b64_tr_b16 v[46:47], v23 offset:4096
  buffer_load_dwordx4 v11, s[24:27], s43 offen offset:3072 lds
  v_mfma_f32_32x32x16_bf16 v[128:143], v[48:51], v[204:207], v[128:143]
  ds_read_b64_tr_b16 v[48:49], v20 offset:256
  ds_read_b64_tr_b16 v[50:51], v20 offset:4352
  s_add_u32 m0, s33, 131072
  s_add_u32 s43, s33, 114688
  buffer_load_dwordx4 v8, s[24:27], s43 offen lds
  v_mfma_f32_32x32x16_bf16 v[144:159], v[52:55], v[204:207], v[144:159]
  ds_read_b64_tr_b16 v[52:53], v21 offset:256
  ds_read_b64_tr_b16 v[54:55], v21 offset:4352
  buffer_load_dwordx4 v9, s[24:27], s43 offen offset:1024 lds
  v_mfma_f32_32x32x16_bf16 v[160:175], v[56:59], v[204:207], v[160:175]
  ds_read_b64_tr_b16 v[56:57], v22 offset:256
  ds_read_b64_tr_b16 v[58:59], v22 offset:4352
  buffer_load_dwordx4 v10, s[24:27], s43 offen offset:2048 lds
  v_mfma_f32_32x32x16_bf16 v[176:191], v[60:63], v[204:207], v[176:191]
  ds_read_b64_tr_b16 v[60:61], v23 offset:256
  s_waitcnt lgkmcnt(14)
  ds_read_b64_tr_b16 v[62:63], v23 offset:4352
  buffer_load_dwordx4 v11, s[24:27], s43 offen offset:3072 lds
  v_add_u32 v20, 0, v17
  v_xor_b32 v21, 64, v20
  v_xor_b32 v22, 128, v20
  v_xor_b32 v23, 192, v20
  s_waitcnt lgkmcnt(14)
  v_mfma_f32_32x32x16_bf16 v[64:79], v[32:35], v[208:211], v[64:79]
  ds_read_b64_tr_b16 v[32:33], v20 offset:0
  s_waitcnt lgkmcnt(14)
  ds_read_b64_tr_b16 v[34:35], v20 offset:4096
  v_xor_b32 v8, 0x20000, v8
  v_xor_b32 v9, 0x20000, v9
  v_xor_b32 v10, 0x20000, v10
  v_xor_b32 v11, 0x20000, v11
  s_add_u32 m0, s33, 114688
  s_add_u32 s43, s33, 0
  buffer_load_dwordx4 v8, s[24:27], s43 offen lds
  s_waitcnt lgkmcnt(14)
  v_mfma_f32_32x32x16_bf16 v[80:95], v[36:39], v[208:211], v[80:95]
  ds_read_b64_tr_b16 v[36:37], v21 offset:0
  s_waitcnt lgkmcnt(14)
  ds_read_b64_tr_b16 v[38:39], v21 offset:4096
  buffer_load_dwordx4 v9, s[24:27], s43 offen offset:1024 lds
  s_waitcnt lgkmcnt(14)
  v_mfma_f32_32x32x16_bf16 v[96:111], v[40:43], v[208:211], v[96:111]
  ds_read_b64_tr_b16 v[40:41], v22 offset:0
  s_waitcnt lgkmcnt(14)
  ds_read_b64_tr_b16 v[42:43], v22 offset:4096
  buffer_load_dwordx4 v10, s[24:27], s43 offen offset:2048 lds
  s_waitcnt lgkmcnt(14)
  v_mfma_f32_32x32x16_bf16 v[112:127], v[44:47], v[208:211], v[112:127]
  ds_read_b64_tr_b16 v[44:45], v23 offset:0
  s_waitcnt lgkmcnt(14)
  ds_read_b64_tr_b16 v[46:47], v23 offset:4096
  buffer_load_dwordx4 v11, s[24:27], s43 offen offset:3072 lds
  s_waitcnt lgkmcnt(14)
  v_mfma_f32_32x32x16_bf16 v[128:143], v[48:51], v[208:211], v[128:143]
  ds_read_b64_tr_b16 v[48:49], v20 offset:256
  s_waitcnt lgkmcnt(14)
  ds_read_b64_tr_b16 v[50:51], v20 offset:4352
  s_add_u32 m0, s33, 98304
  s_add_u32 s43, s33, 16384
  buffer_load_dwordx4 v8, s[24:27], s43 offen lds
  s_waitcnt lgkmcnt(14)
  v_mfma_f32_32x32x16_bf16 v[144:159], v[52:55], v[208:211], v[144:159]
  ds_read_b64_tr_b16 v[52:53], v21 offset:256
  s_waitcnt lgkmcnt(14)
  ds_read_b64_tr_b16 v[54:55], v21 offset:4352
  buffer_load_dwordx4 v9, s[24:27], s43 offen offset:1024 lds
  s_waitcnt lgkmcnt(14)
  v_mfma_f32_32x32x16_bf16 v[160:175], v[56:59], v[208:211], v[160:175]
  ds_read_b64_tr_b16 v[56:57], v22 offset:256
  s_waitcnt lgkmcnt(14)
  ds_read_b64_tr_b16 v[58:59], v22 offset:4352
  buffer_load_dwordx4 v10, s[24:27], s43 offen offset:2048 lds
  s_waitcnt lgkmcnt(14)
  v_mfma_f32_32x32x16_bf16 v[176:191], v[60:63], v[208:211], v[176:191]
  ds_read_b64_tr_b16 v[60:61], v23 offset:256
  s_waitcnt lgkmcnt(14)
  ds_read_b64_tr_b16 v[62:63], v23 offset:4352
  buffer_load_dwordx4 v11, s[24:27], s43 offen offset:3072 lds
  s_waitcnt vmcnt(12)
  s_barrier
  v_add_u32 v20, 147456, v17
  v_xor_b32 v21, 64, v20
  v_xor_b32 v22, 128, v20
  v_xor_b32 v23, 192, v20
  s_waitcnt lgkmcnt(14)
  v_mfma_f32_32x32x16_bf16 v[64:79], v[32:35], v[212:215], v[64:79]
  ds_read_b64_tr_b16 v[32:33], v20 offset:0
  s_waitcnt lgkmcnt(14)
  ds_read_b64_tr_b16 v[34:35], v20 offset:4096
  s_waitcnt lgkmcnt(14)
  v_mfma_f32_32x32x16_bf16 v[80:95], v[36:39], v[212:215], v[80:95]
  ds_read_b64_tr_b16 v[36:37], v21 offset:0
  s_waitcnt lgkmcnt(14)
  ds_read_b64_tr_b16 v[38:39], v21 offset:4096
  s_waitcnt lgkmcnt(14)
  v_mfma_f32_32x32x16_bf16 v[96:111], v[40:43], v[212:215], v[96:111]
  ds_read_b64_tr_b16 v[40:41], v22 offset:0
  s_waitcnt lgkmcnt(14)
  ds_read_b64_tr_b16 v[42:43], v22 offset:4096
  s_waitcnt lgkmcnt(14)
  v_mfma_f32_32x32x16_bf16 v[112:127], v[44:47], v[212:215], v[112:127]
  ds_read_b64_tr_b16 v[44:45], v23 offset:0
  s_waitcnt lgkmcnt(14)
  ds_read_b64_tr_b16 v[46:47], v23 offset:4096
  s_waitcnt lgkmcnt(14)
  v_mfma_f32_32x32x16_bf16 v[128:143], v[48:51], v[212:215], v[128:143]
  ds_read_b64_tr_b16 v[48:49], v20 offset:256
  s_waitcnt lgkmcnt(14)
  ds_read_b64_tr_b16 v[50:51], v20 offset:4352
  s_waitcnt lgkmcnt(14)
  v_mfma_f32_32x32x16_bf16 v[144:159], v[52:55], v[212:215], v[144:159]
  ds_read_b64_tr_b16 v[52:53], v21 offset:256
  s_waitcnt lgkmcnt(14)
  ds_read_b64_tr_b16 v[54:55], v21 offset:4352
  s_waitcnt lgkmcnt(14)
  v_mfma_f32_32x32x16_bf16 v[160:175], v[56:59], v[212:215], v[160:175]
  ds_read_b64_tr_b16 v[56:57], v22 offset:256
  s_waitcnt lgkmcnt(14)
  ds_read_b64_tr_b16 v[58:59], v22 offset:4352
  s_waitcnt lgkmcnt(14)
  v_mfma_f32_32x32x16_bf16 v[176:191], v[60:63], v[212:215], v[176:191]
  ds_read_b64_tr_b16 v[60:61], v23 offset:256
  s_waitcnt lgkmcnt(14)
  ds_read_b64_tr_b16 v[62:63], v23 offset:4352
  s_waitcnt vmcnt(8)
  s_barrier
  v_add_u32 v20, 131072, v17
  v_xor_b32 v21, 64, v20
  v_xor_b32 v22, 128, v20
  v_xor_b32 v23, 192, v20
  s_waitcnt lgkmcnt(14)
  v_mfma_f32_32x32x16_bf16 v[64:79], v[32:35], v[216:219], v[64:79]
  ds_read_b64_tr_b16 v[32:33], v20 offset:0
  s_waitcnt lgkmcnt(14)
  ds_read_b64_tr_b16 v[34:35], v20 offset:4096
  s_waitcnt lgkmcnt(14)
  v_mfma_f32_32x32x16_bf16 v[80:95], v[36:39], v[216:219], v[80:95]
  ds_read_b64_tr_b16 v[36:37], v21 offset:0
  s_waitcnt lgkmcnt(14)
  ds_read_b64_tr_b16 v[38:39], v21 offset:4096
  s_waitcnt lgkmcnt(14)
  v_mfma_f32_32x32x16_bf16 v[96:111], v[40:43], v[216:219], v[96:111]
  ds_read_b64_tr_b16 v[40:41], v22 offset:0
  s_waitcnt lgkmcnt(14)
  ds_read_b64_tr_b16 v[42:43], v22 offset:4096
  s_waitcnt lgkmcnt(14)
  v_mfma_f32_32x32x16_bf16 v[112:127], v[44:47], v[216:219], v[112:127]
  ds_read_b64_tr_b16 v[44:45], v23 offset:0
  s_waitcnt lgkmcnt(14)
  ds_read_b64_tr_b16 v[46:47], v23 offset:4096
  s_waitcnt lgkmcnt(14)
  v_mfma_f32_32x32x16_bf16 v[128:143], v[48:51], v[216:219], v[128:143]
  ds_read_b64_tr_b16 v[48:49], v20 offset:256
  s_waitcnt lgkmcnt(14)
  ds_read_b64_tr_b16 v[50:51], v20 offset:4352
  s_waitcnt lgkmcnt(14)
  v_mfma_f32_32x32x16_bf16 v[144:159], v[52:55], v[216:219], v[144:159]
  ds_read_b64_tr_b16 v[52:53], v21 offset:256
  s_waitcnt lgkmcnt(14)
  ds_read_b64_tr_b16 v[54:55], v21 offset:4352
  s_waitcnt lgkmcnt(14)
  v_mfma_f32_32x32x16_bf16 v[160:175], v[56:59], v[216:219], v[160:175]
  ds_read_b64_tr_b16 v[56:57], v22 offset:256
  s_waitcnt lgkmcnt(14)
  ds_read_b64_tr_b16 v[58:59], v22 offset:4352
  s_waitcnt lgkmcnt(14)
  v_mfma_f32_32x32x16_bf16 v[176:191], v[60:63], v[216:219], v[176:191]
  ds_read_b64_tr_b16 v[60:61], v23 offset:256
  s_waitcnt lgkmcnt(14)
  ds_read_b64_tr_b16 v[62:63], v23 offset:4352
  s_waitcnt vmcnt(4)
  s_barrier
  v_add_u32 v20, 114688, v17
  v_xor_b32 v21, 64, v20
  v_xor_b32 v22, 128, v20
  v_xor_b32 v23, 192, v20
  s_waitcnt lgkmcnt(14)
  v_mfma_f32_32x32x16_bf16 v[64:79], v[32:35], v[220:223], v[64:79]
  ds_read_b64_tr_b16 v[32:33], v20 offset:0
  s_waitcnt lgkmcnt(14)
  ds_read_b64_tr_b16 v[34:35], v20 offset:4096
  s_waitcnt lgkmcnt(14)
  v_mfma_f32_32x32x16_bf16 v[80:95], v[36:39], v[220:223], v[80:95]
  ds_read_b64_tr_b16 v[36:37], v21 offset:0
  s_waitcnt lgkmcnt(14)
  ds_read_b64_tr_b16 v[38:39], v21 offset:4096
  s_waitcnt lgkmcnt(14)
  v_mfma_f32_32x32x16_bf16 v[96:111], v[40:43], v[220:223], v[96:111]
  ds_read_b64_tr_b16 v[40:41], v22 offset:0
  s_waitcnt lgkmcnt(14)
  ds_read_b64_tr_b16 v[42:43], v22 offset:4096
  s_waitcnt lgkmcnt(14)
  v_mfma_f32_32x32x16_bf16 v[112:127], v[44:47], v[220:223], v[112:127]
  ds_read_b64_tr_b16 v[44:45], v23 offset:0
  s_waitcnt lgkmcnt(14)
  ds_read_b64_tr_b16 v[46:47], v23 offset:4096
  s_waitcnt lgkmcnt(14)
  v_mfma_f32_32x32x16_bf16 v[128:143], v[48:51], v[220:223], v[128:143]
  ds_read_b64_tr_b16 v[48:49], v20 offset:256
  s_waitcnt lgkmcnt(14)
  ds_read_b64_tr_b16 v[50:51], v20 offset:4352
  s_waitcnt lgkmcnt(14)
  v_mfma_f32_32x32x16_bf16 v[144:159], v[52:55], v[220:223], v[144:159]
  ds_read_b64_tr_b16 v[52:53], v21 offset:256
  s_waitcnt lgkmcnt(14)
  ds_read_b64_tr_b16 v[54:55], v21 offset:4352
  s_waitcnt lgkmcnt(14)
  v_mfma_f32_32x32x16_bf16 v[160:175], v[56:59], v[220:223], v[160:175]
  ds_read_b64_tr_b16 v[56:57], v22 offset:256
  s_waitcnt lgkmcnt(14)
  ds_read_b64_tr_b16 v[58:59], v22 offset:4352
  s_waitcnt lgkmcnt(14)
  v_mfma_f32_32x32x16_bf16 v[176:191], v[60:63], v[220:223], v[176:191]
  ds_read_b64_tr_b16 v[60:61], v23 offset:256
  s_waitcnt lgkmcnt(14)
  ds_read_b64_tr_b16 v[62:63], v23 offset:4352
  s_waitcnt vmcnt(0)
  s_barrier
  v_add_u32 v20, 98304, v17
  v_xor_b32 v21, 64, v20
  v_xor_b32 v22, 128, v20
  v_xor_b32 v23, 192, v20
  s_waitcnt lgkmcnt(14)
  v_mfma_f32_32x32x16_bf16 v[64:79], v[32:35], v[224:227], v[64:79]
  ds_read_b64_tr_b16 v[32:33], v20 offset:0
  s_waitcnt lgkmcnt(14)
  ds_read_b64_tr_b16 v[34:35], v20 offset:4096
  s_waitcnt lgkmcnt(14)
  v_mfma_f32_32x32x16_bf16 v[80:95], v[36:39], v[224:227], v[80:95]
  ds_read_b64_tr_b16 v[36:37], v21 offset:0
  s_waitcnt lgkmcnt(14)
  ds_read_b64_tr_b16 v[38:39], v21 offset:4096
  s_waitcnt lgkmcnt(14)
  v_mfma_f32_32x32x16_bf16 v[96:111], v[40:43], v[224:227], v[96:111]
  ds_read_b64_tr_b16 v[40:41], v22 offset:0
  s_waitcnt lgkmcnt(14)
  ds_read_b64_tr_b16 v[42:43], v22 offset:4096
  s_waitcnt lgkmcnt(14)
  v_mfma_f32_32x32x16_bf16 v[112:127], v[44:47], v[224:227], v[112:127]
  ds_read_b64_tr_b16 v[44:45], v23 offset:0
  s_waitcnt lgkmcnt(14)
  ds_read_b64_tr_b16 v[46:47], v23 offset:4096
  s_waitcnt lgkmcnt(14)
  v_mfma_f32_32x32x16_bf16 v[128:143], v[48:51], v[224:227], v[128:143]
  ds_read_b64_tr_b16 v[48:49], v20 offset:256
  s_waitcnt lgkmcnt(14)
  ds_read_b64_tr_b16 v[50:51], v20 offset:4352
  s_waitcnt lgkmcnt(14)
  v_mfma_f32_32x32x16_bf16 v[144:159], v[52:55], v[224:227], v[144:159]
  ds_read_b64_tr_b16 v[52:53], v21 offset:256
  s_waitcnt lgkmcnt(14)
  ds_read_b64_tr_b16 v[54:55], v21 offset:4352
  s_waitcnt lgkmcnt(14)
  v_mfma_f32_32x32x16_bf16 v[160:175], v[56:59], v[224:227], v[160:175]
  ds_read_b64_tr_b16 v[56:57], v22 offset:256
  s_waitcnt lgkmcnt(14)
  ds_read_b64_tr_b16 v[58:59], v22 offset:4352
  s_waitcnt lgkmcnt(14)
  v_mfma_f32_32x32x16_bf16 v[176:191], v[60:63], v[224:227], v[176:191]
  ds_read_b64_tr_b16 v[60:61], v23 offset:256
  s_waitcnt lgkmcnt(14)
  ds_read_b64_tr_b16 v[62:63], v23 offset:4352
  s_barrier
  v_add_u32 v20, 81920, v17
  v_xor_b32 v21, 64, v20
  v_xor_b32 v22, 128, v20
  v_xor_b32 v23, 192, v20
  s_waitcnt lgkmcnt(14)
  v_mfma_f32_32x32x16_bf16 v[64:79], v[32:35], v[228:231], v[64:79]
  ds_read_b64_tr_b16 v[32:33], v20 offset:0
  s_waitcnt lgkmcnt(14)
  ds_read_b64_tr_b16 v[34:35], v20 offset:4096
  s_waitcnt lgkmcnt(14)
  v_mfma_f32_32x32x16_bf16 v[80:95], v[36:39], v[228:231], v[80:95]
  ds_read_b64_tr_b16 v[36:37], v21 offset:0
  s_waitcnt lgkmcnt(14)
  ds_read_b64_tr_b16 v[38:39], v21 offset:4096
  s_waitcnt lgkmcnt(14)
  v_mfma_f32_32x32x16_bf16 v[96:111], v[40:43], v[228:231], v[96:111]
  ds_read_b64_tr_b16 v[40:41], v22 offset:0
  s_waitcnt lgkmcnt(14)
  ds_read_b64_tr_b16 v[42:43], v22 offset:4096
  s_waitcnt lgkmcnt(14)
  v_mfma_f32_32x32x16_bf16 v[112:127], v[44:47], v[228:231], v[112:127]
  ds_read_b64_tr_b16 v[44:45], v23 offset:0
  s_waitcnt lgkmcnt(14)
  ds_read_b64_tr_b16 v[46:47], v23 offset:4096
  s_waitcnt lgkmcnt(14)
  v_mfma_f32_32x32x16_bf16 v[128:143], v[48:51], v[228:231], v[128:143]
  ds_read_b64_tr_b16 v[48:49], v20 offset:256
  s_waitcnt lgkmcnt(14)
  ds_read_b64_tr_b16 v[50:51], v20 offset:4352
  s_waitcnt lgkmcnt(14)
  v_mfma_f32_32x32x16_bf16 v[144:159], v[52:55], v[228:231], v[144:159]
  ds_read_b64_tr_b16 v[52:53], v21 offset:256
  s_waitcnt lgkmcnt(14)
  ds_read_b64_tr_b16 v[54:55], v21 offset:4352
  s_waitcnt lgkmcnt(14)
  v_mfma_f32_32x32x16_bf16 v[160:175], v[56:59], v[228:231], v[160:175]
  ds_read_b64_tr_b16 v[56:57], v22 offset:256
  s_waitcnt lgkmcnt(14)
  ds_read_b64_tr_b16 v[58:59], v22 offset:4352
  s_waitcnt lgkmcnt(14)
  v_mfma_f32_32x32x16_bf16 v[176:191], v[60:63], v[228:231], v[176:191]
  ds_read_b64_tr_b16 v[60:61], v23 offset:256
  s_waitcnt lgkmcnt(14)
  ds_read_b64_tr_b16 v[62:63], v23 offset:4352
  s_barrier
  v_add_u32 v20, 49152, v17
  v_xor_b32 v21, 64, v20
  v_xor_b32 v22, 128, v20
  v_xor_b32 v23, 192, v20
  s_waitcnt lgkmcnt(14)
  v_mfma_f32_32x32x16_bf16 v[64:79], v[32:35], v[232:235], v[64:79]
  ds_read_b64_tr_b16 v[32:33], v20 offset:0
  s_waitcnt lgkmcnt(14)
  ds_read_b64_tr_b16 v[34:35], v20 offset:4096
  s_waitcnt lgkmcnt(14)
  v_mfma_f32_32x32x16_bf16 v[80:95], v[36:39], v[232:235], v[80:95]
  ds_read_b64_tr_b16 v[36:37], v21 offset:0
  s_waitcnt lgkmcnt(14)
  ds_read_b64_tr_b16 v[38:39], v21 offset:4096
  s_waitcnt lgkmcnt(14)
  v_mfma_f32_32x32x16_bf16 v[96:111], v[40:43], v[232:235], v[96:111]
  ds_read_b64_tr_b16 v[40:41], v22 offset:0
  s_waitcnt lgkmcnt(14)
  ds_read_b64_tr_b16 v[42:43], v22 offset:4096
  s_waitcnt lgkmcnt(14)
  v_mfma_f32_32x32x16_bf16 v[112:127], v[44:47], v[232:235], v[112:127]
  ds_read_b64_tr_b16 v[44:45], v23 offset:0
  s_waitcnt lgkmcnt(14)
  ds_read_b64_tr_b16 v[46:47], v23 offset:4096
  s_waitcnt lgkmcnt(14)
  v_mfma_f32_32x32x16_bf16 v[128:143], v[48:51], v[232:235], v[128:143]
  ds_read_b64_tr_b16 v[48:49], v20 offset:256
  s_waitcnt lgkmcnt(14)
  ds_read_b64_tr_b16 v[50:51], v20 offset:4352
  s_waitcnt lgkmcnt(14)
  v_mfma_f32_32x32x16_bf16 v[144:159], v[52:55], v[232:235], v[144:159]
  ds_read_b64_tr_b16 v[52:53], v21 offset:256
  s_waitcnt lgkmcnt(14)
  ds_read_b64_tr_b16 v[54:55], v21 offset:4352
  s_waitcnt lgkmcnt(14)
  v_mfma_f32_32x32x16_bf16 v[160:175], v[56:59], v[232:235], v[160:175]
  ds_read_b64_tr_b16 v[56:57], v22 offset:256
  s_waitcnt lgkmcnt(14)
  ds_read_b64_tr_b16 v[58:59], v22 offset:4352
  s_waitcnt lgkmcnt(14)
  v_mfma_f32_32x32x16_bf16 v[176:191], v[60:63], v[232:235], v[176:191]
  ds_read_b64_tr_b16 v[60:61], v23 offset:256
  s_waitcnt lgkmcnt(14)
  ds_read_b64_tr_b16 v[62:63], v23 offset:4352
  s_barrier
  v_add_u32 v20, 32768, v17
  v_xor_b32 v21, 64, v20
  v_xor_b32 v22, 128, v20
  v_xor_b32 v23, 192, v20
  s_waitcnt lgkmcnt(14)
  v_mfma_f32_32x32x16_bf16 v[64:79], v[32:35], v[236:239], v[64:79]
  ds_read_b64_tr_b16 v[32:33], v20 offset:0
  s_waitcnt lgkmcnt(14)
  ds_read_b64_tr_b16 v[34:35], v20 offset:4096
  s_waitcnt lgkmcnt(14)
  v_mfma_f32_32x32x16_bf16 v[80:95], v[36:39], v[236:239], v[80:95]
  ds_read_b64_tr_b16 v[36:37], v21 offset:0
  s_waitcnt lgkmcnt(14)
  ds_read_b64_tr_b16 v[38:39], v21 offset:4096
  s_waitcnt lgkmcnt(14)
  v_mfma_f32_32x32x16_bf16 v[96:111], v[40:43], v[236:239], v[96:111]
  ds_read_b64_tr_b16 v[40:41], v22 offset:0
  s_waitcnt lgkmcnt(14)
  ds_read_b64_tr_b16 v[42:43], v22 offset:4096
  s_waitcnt lgkmcnt(14)
  v_mfma_f32_32x32x16_bf16 v[112:127], v[44:47], v[236:239], v[112:127]
  ds_read_b64_tr_b16 v[44:45], v23 offset:0
  s_waitcnt lgkmcnt(14)
  ds_read_b64_tr_b16 v[46:47], v23 offset:4096
  s_waitcnt lgkmcnt(14)
  v_mfma_f32_32x32x16_bf16 v[128:143], v[48:51], v[236:239], v[128:143]
  ds_read_b64_tr_b16 v[48:49], v20 offset:256
  s_waitcnt lgkmcnt(14)
  ds_read_b64_tr_b16 v[50:51], v20 offset:4352
  s_waitcnt lgkmcnt(14)
  v_mfma_f32_32x32x16_bf16 v[144:159], v[52:55], v[236:239], v[144:159]
  ds_read_b64_tr_b16 v[52:53], v21 offset:256
  s_waitcnt lgkmcnt(14)
  ds_read_b64_tr_b16 v[54:55], v21 offset:4352
  s_waitcnt lgkmcnt(14)
  v_mfma_f32_32x32x16_bf16 v[160:175], v[56:59], v[236:239], v[160:175]
  ds_read_b64_tr_b16 v[56:57], v22 offset:256
  s_waitcnt lgkmcnt(14)
  ds_read_b64_tr_b16 v[58:59], v22 offset:4352
  s_waitcnt lgkmcnt(14)
  v_mfma_f32_32x32x16_bf16 v[176:191], v[60:63], v[236:239], v[176:191]
  ds_read_b64_tr_b16 v[60:61], v23 offset:256
  s_waitcnt lgkmcnt(14)
  ds_read_b64_tr_b16 v[62:63], v23 offset:4352
  s_barrier
  v_add_u32 v20, 0, v17
  v_xor_b32 v21, 64, v20
  v_xor_b32 v22, 128, v20
  v_xor_b32 v23, 192, v20
  s_waitcnt lgkmcnt(14)
  v_mfma_f32_32x32x16_bf16 v[64:79], v[32:35], v[240:243], v[64:79]
  ds_read_b64_tr_b16 v[32:33], v20 offset:0
  s_waitcnt lgkmcnt(14)
  ds_read_b64_tr_b16 v[34:35], v20 offset:4096
  s_waitcnt lgkmcnt(14)
  v_mfma_f32_32x32x16_bf16 v[80:95], v[36:39], v[240:243], v[80:95]
  ds_read_b64_tr_b16 v[36:37], v21 offset:0
  s_waitcnt lgkmcnt(14)
  ds_read_b64_tr_b16 v[38:39], v21 offset:4096
  s_waitcnt lgkmcnt(14)
  v_mfma_f32_32x32x16_bf16 v[96:111], v[40:43], v[240:243], v[96:111]
  ds_read_b64_tr_b16 v[40:41], v22 offset:0
  s_waitcnt lgkmcnt(14)
  ds_read_b64_tr_b16 v[42:43], v22 offset:4096
  s_waitcnt lgkmcnt(14)
  v_mfma_f32_32x32x16_bf16 v[112:127], v[44:47], v[240:243], v[112:127]
  ds_read_b64_tr_b16 v[44:45], v23 offset:0
  s_waitcnt lgkmcnt(14)
  ds_read_b64_tr_b16 v[46:47], v23 offset:4096
  s_waitcnt lgkmcnt(14)
  v_mfma_f32_32x32x16_bf16 v[128:143], v[48:51], v[240:243], v[128:143]
  ds_read_b64_tr_b16 v[48:49], v20 offset:256
  s_waitcnt lgkmcnt(14)
  ds_read_b64_tr_b16 v[50:51], v20 offset:4352
  s_waitcnt lgkmcnt(14)
  v_mfma_f32_32x32x16_bf16 v[144:159], v[52:55], v[240:243], v[144:159]
  ds_read_b64_tr_b16 v[52:53], v21 offset:256
  s_waitcnt lgkmcnt(14)
  ds_read_b64_tr_b16 v[54:55], v21 offset:4352
  s_waitcnt lgkmcnt(14)
  v_mfma_f32_32x32x16_bf16 v[160:175], v[56:59], v[240:243], v[160:175]
  ds_read_b64_tr_b16 v[56:57], v22 offset:256
  s_waitcnt lgkmcnt(14)
  ds_read_b64_tr_b16 v[58:59], v22 offset:4352
  s_waitcnt lgkmcnt(14)
  v_mfma_f32_32x32x16_bf16 v[176:191], v[60:63], v[240:243], v[176:191]
  ds_read_b64_tr_b16 v[60:61], v23 offset:256
  s_waitcnt lgkmcnt(14)
  ds_read_b64_tr_b16 v[62:63], v23 offset:4352
  s_barrier
  v_add_u32 v20, 147456, v17
  v_xor_b32 v21, 64, v20
  v_xor_b32 v22, 128, v20
  v_xor_b32 v23, 192, v20
  s_waitcnt lgkmcnt(14)
  v_mfma_f32_32x32x16_bf16 v[64:79], v[32:35], v[244:247], v[64:79]
  ds_read_b64_tr_b16 v[32:33], v20 offset:0
  s_waitcnt lgkmcnt(14)
  ds_read_b64_tr_b16 v[34:35], v20 offset:4096
  s_waitcnt lgkmcnt(14)
  v_mfma_f32_32x32x16_bf16 v[80:95], v[36:39], v[244:247], v[80:95]
  ds_read_b64_tr_b16 v[36:37], v21 offset:0
  s_waitcnt lgkmcnt(14)
  ds_read_b64_tr_b16 v[38:39], v21 offset:4096
  s_waitcnt lgkmcnt(14)
  v_mfma_f32_32x32x16_bf16 v[96:111], v[40:43], v[244:247], v[96:111]
  ds_read_b64_tr_b16 v[40:41], v22 offset:0
  s_waitcnt lgkmcnt(14)
  ds_read_b64_tr_b16 v[42:43], v22 offset:4096
  s_waitcnt lgkmcnt(14)
  v_mfma_f32_32x32x16_bf16 v[112:127], v[44:47], v[244:247], v[112:127]
  ds_read_b64_tr_b16 v[44:45], v23 offset:0
  s_waitcnt lgkmcnt(14)
  ds_read_b64_tr_b16 v[46:47], v23 offset:4096
  s_waitcnt lgkmcnt(14)
  v_mfma_f32_32x32x16_bf16 v[128:143], v[48:51], v[244:247], v[128:143]
  ds_read_b64_tr_b16 v[48:49], v20 offset:256
  s_waitcnt lgkmcnt(14)
  ds_read_b64_tr_b16 v[50:51], v20 offset:4352
  s_waitcnt lgkmcnt(14)
  v_mfma_f32_32x32x16_bf16 v[144:159], v[52:55], v[244:247], v[144:159]
  ds_read_b64_tr_b16 v[52:53], v21 offset:256
  s_waitcnt lgkmcnt(14)
  ds_read_b64_tr_b16 v[54:55], v21 offset:4352
  s_waitcnt lgkmcnt(14)
  v_mfma_f32_32x32x16_bf16 v[160:175], v[56:59], v[244:247], v[160:175]
  ds_read_b64_tr_b16 v[56:57], v22 offset:256
  s_waitcnt lgkmcnt(14)
  ds_read_b64_tr_b16 v[58:59], v22 offset:4352
  s_waitcnt lgkmcnt(14)
  v_mfma_f32_32x32x16_bf16 v[176:191], v[60:63], v[244:247], v[176:191]
  ds_read_b64_tr_b16 v[60:61], v23 offset:256
  s_waitcnt lgkmcnt(14)
  ds_read_b64_tr_b16 v[62:63], v23 offset:4352
  s_barrier
  v_add_u32 v20, 131072, v17
  v_xor_b32 v21, 64, v20
  v_xor_b32 v22, 128, v20
  v_xor_b32 v23, 192, v20
  s_waitcnt lgkmcnt(14)
  v_mfma_f32_32x32x16_bf16 v[64:79], v[32:35], v[248:251], v[64:79]
  ds_read_b64_tr_b16 v[32:33], v20 offset:0
  s_waitcnt lgkmcnt(14)
  ds_read_b64_tr_b16 v[34:35], v20 offset:4096
  s_waitcnt lgkmcnt(14)
  v_mfma_f32_32x32x16_bf16 v[80:95], v[36:39], v[248:251], v[80:95]
  ds_read_b64_tr_b16 v[36:37], v21 offset:0
  s_waitcnt lgkmcnt(14)
  ds_read_b64_tr_b16 v[38:39], v21 offset:4096
  s_waitcnt lgkmcnt(14)
  v_mfma_f32_32x32x16_bf16 v[96:111], v[40:43], v[248:251], v[96:111]
  ds_read_b64_tr_b16 v[40:41], v22 offset:0
  s_waitcnt lgkmcnt(14)
  ds_read_b64_tr_b16 v[42:43], v22 offset:4096
  s_waitcnt lgkmcnt(14)
  v_mfma_f32_32x32x16_bf16 v[112:127], v[44:47], v[248:251], v[112:127]
  ds_read_b64_tr_b16 v[44:45], v23 offset:0
  s_waitcnt lgkmcnt(14)
  ds_read_b64_tr_b16 v[46:47], v23 offset:4096
  s_waitcnt lgkmcnt(14)
  v_mfma_f32_32x32x16_bf16 v[128:143], v[48:51], v[248:251], v[128:143]
  ds_read_b64_tr_b16 v[48:49], v20 offset:256
  s_waitcnt lgkmcnt(14)
  ds_read_b64_tr_b16 v[50:51], v20 offset:4352
  s_waitcnt lgkmcnt(14)
  v_mfma_f32_32x32x16_bf16 v[144:159], v[52:55], v[248:251], v[144:159]
  ds_read_b64_tr_b16 v[52:53], v21 offset:256
  s_waitcnt lgkmcnt(14)
  ds_read_b64_tr_b16 v[54:55], v21 offset:4352
  s_waitcnt lgkmcnt(14)
  v_mfma_f32_32x32x16_bf16 v[160:175], v[56:59], v[248:251], v[160:175]
  ds_read_b64_tr_b16 v[56:57], v22 offset:256
  s_waitcnt lgkmcnt(14)
  ds_read_b64_tr_b16 v[58:59], v22 offset:4352
  s_waitcnt lgkmcnt(14)
  v_mfma_f32_32x32x16_bf16 v[176:191], v[60:63], v[248:251], v[176:191]
  ds_read_b64_tr_b16 v[60:61], v23 offset:256
  s_waitcnt lgkmcnt(14)
  ds_read_b64_tr_b16 v[62:63], v23 offset:4352
  s_barrier
  v_add_u32 v20, 114688, v17
  v_xor_b32 v21, 64, v20
  v_xor_b32 v22, 128, v20
  v_xor_b32 v23, 192, v20
  s_waitcnt lgkmcnt(14)
  v_mfma_f32_32x32x16_bf16 v[64:79], v[32:35], v[252:255], v[64:79]
  ds_read_b64_tr_b16 v[32:33], v20 offset:0
  s_waitcnt lgkmcnt(14)
  ds_read_b64_tr_b16 v[34:35], v20 offset:4096
  s_waitcnt lgkmcnt(14)
  v_mfma_f32_32x32x16_bf16 v[80:95], v[36:39], v[252:255], v[80:95]
  ds_read_b64_tr_b16 v[36:37], v21 offset:0
  s_waitcnt lgkmcnt(14)
  ds_read_b64_tr_b16 v[38:39], v21 offset:4096
  s_waitcnt lgkmcnt(14)
  v_mfma_f32_32x32x16_bf16 v[96:111], v[40:43], v[252:255], v[96:111]
  ds_read_b64_tr_b16 v[40:41], v22 offset:0
  s_waitcnt lgkmcnt(14)
  ds_read_b64_tr_b16 v[42:43], v22 offset:4096
  s_waitcnt lgkmcnt(14)
  v_mfma_f32_32x32x16_bf16 v[112:127], v[44:47], v[252:255], v[112:127]
  ds_read_b64_tr_b16 v[44:45], v23 offset:0
  s_waitcnt lgkmcnt(14)
  ds_read_b64_tr_b16 v[46:47], v23 offset:4096
  s_waitcnt lgkmcnt(14)
  v_mfma_f32_32x32x16_bf16 v[128:143], v[48:51], v[252:255], v[128:143]
  ds_read_b64_tr_b16 v[48:49], v20 offset:256
  s_waitcnt lgkmcnt(14)
  ds_read_b64_tr_b16 v[50:51], v20 offset:4352
  s_waitcnt lgkmcnt(14)
  v_mfma_f32_32x32x16_bf16 v[144:159], v[52:55], v[252:255], v[144:159]
  ds_read_b64_tr_b16 v[52:53], v21 offset:256
  s_waitcnt lgkmcnt(14)
  ds_read_b64_tr_b16 v[54:55], v21 offset:4352
  s_waitcnt lgkmcnt(14)
  v_mfma_f32_32x32x16_bf16 v[160:175], v[56:59], v[252:255], v[160:175]
  ds_read_b64_tr_b16 v[56:57], v22 offset:256
  s_waitcnt lgkmcnt(14)
  ds_read_b64_tr_b16 v[58:59], v22 offset:4352
  s_waitcnt lgkmcnt(14)
  v_mfma_f32_32x32x16_bf16 v[176:191], v[60:63], v[252:255], v[176:191]
  ds_read_b64_tr_b16 v[60:61], v23 offset:256
  s_waitcnt lgkmcnt(14)
  ds_read_b64_tr_b16 v[62:63], v23 offset:4352
  s_barrier
  v_add_u32 v28, s39, v18
  s_cmp_eq_u32 s46, 0
  s_cselect_b32 s43, 49152, 0
  s_lshl_b32 s44, s47, 13
  s_add_u32 s43, s43, s44
  v_add_u32 v29, s43, v18
  s_waitcnt lgkmcnt(14)
  ds_read_b128 v[192:195], v28 offset:16384
  s_waitcnt lgkmcnt(14)
  ds_read_b128 v[196:199], v28 offset:17408
  s_waitcnt lgkmcnt(14)
  ds_read_b128 v[200:203], v28 offset:18432
  s_waitcnt lgkmcnt(14)
  ds_read_b128 v[204:207], v28 offset:19456
  s_waitcnt lgkmcnt(14)
  ds_read_b128 v[208:211], v28 offset:20480
  s_waitcnt lgkmcnt(14)
  ds_read_b128 v[212:215], v28 offset:21504
  s_waitcnt lgkmcnt(14)
  ds_read_b128 v[216:219], v28 offset:22528
  s_waitcnt lgkmcnt(14)
  ds_read_b128 v[220:223], v28 offset:23552
  s_waitcnt lgkmcnt(14)
  ds_read_b128 v[224:227], v29 offset:16384
  s_waitcnt lgkmcnt(14)
  ds_read_b128 v[228:231], v29 offset:17408
  s_waitcnt lgkmcnt(14)
  ds_read_b128 v[232:235], v29 offset:18432
  s_waitcnt lgkmcnt(14)
  ds_read_b128 v[236:239], v29 offset:19456
  s_waitcnt lgkmcnt(14)
  ds_read_b128 v[240:243], v29 offset:20480
  s_waitcnt lgkmcnt(14)
  ds_read_b128 v[244:247], v29 offset:21504
  s_waitcnt lgkmcnt(14)
  ds_read_b128 v[248:251], v29 offset:22528
  s_waitcnt lgkmcnt(14)
  ds_read_b128 v[252:255], v29 offset:23552
  v_add_u32 v20, 98304, v17
  v_xor_b32 v21, 64, v20
  v_xor_b32 v22, 128, v20
  v_xor_b32 v23, 192, v20
  v_mfma_f32_32x32x16_bf16 v[64:79], v[32:35], v[192:195], v[64:79]
  s_waitcnt lgkmcnt(14)
  ds_read_b64_tr_b16 v[32:33], v20 offset:0
  s_waitcnt lgkmcnt(14)
  ds_read_b64_tr_b16 v[34:35], v20 offset:4096
  v_mfma_f32_32x32x16_bf16 v[80:95], v[36:39], v[192:195], v[80:95]
  s_waitcnt lgkmcnt(14)
  ds_read_b64_tr_b16 v[36:37], v21 offset:0
  s_waitcnt lgkmcnt(14)
  ds_read_b64_tr_b16 v[38:39], v21 offset:4096
  v_mfma_f32_32x32x16_bf16 v[96:111], v[40:43], v[192:195], v[96:111]
  s_waitcnt lgkmcnt(14)
  ds_read_b64_tr_b16 v[40:41], v22 offset:0
  s_waitcnt lgkmcnt(14)
  ds_read_b64_tr_b16 v[42:43], v22 offset:4096
  v_mfma_f32_32x32x16_bf16 v[112:127], v[44:47], v[192:195], v[112:127]
  s_waitcnt lgkmcnt(14)
  ds_read_b64_tr_b16 v[44:45], v23 offset:0
  s_waitcnt lgkmcnt(14)
  ds_read_b64_tr_b16 v[46:47], v23 offset:4096
  v_mfma_f32_32x32x16_bf16 v[128:143], v[48:51], v[192:195], v[128:143]
  s_waitcnt lgkmcnt(14)
  ds_read_b64_tr_b16 v[48:49], v20 offset:256
  s_waitcnt lgkmcnt(14)
  ds_read_b64_tr_b16 v[50:51], v20 offset:4352
  v_mfma_f32_32x32x16_bf16 v[144:159], v[52:55], v[192:195], v[144:159]
  s_waitcnt lgkmcnt(14)
  ds_read_b64_tr_b16 v[52:53], v21 offset:256
  s_waitcnt lgkmcnt(14)
  ds_read_b64_tr_b16 v[54:55], v21 offset:4352
  v_mfma_f32_32x32x16_bf16 v[160:175], v[56:59], v[192:195], v[160:175]
  s_waitcnt lgkmcnt(14)
  ds_read_b64_tr_b16 v[56:57], v22 offset:256
  s_waitcnt lgkmcnt(14)
  ds_read_b64_tr_b16 v[58:59], v22 offset:4352
  v_mfma_f32_32x32x16_bf16 v[176:191], v[60:63], v[192:195], v[176:191]
  s_waitcnt lgkmcnt(14)
  ds_read_b64_tr_b16 v[60:61], v23 offset:256
  s_waitcnt lgkmcnt(14)
  ds_read_b64_tr_b16 v[62:63], v23 offset:4352
  s_barrier
  v_add_u32 v20, 81920, v17
  v_xor_b32 v21, 64, v20
  v_xor_b32 v22, 128, v20
  v_xor_b32 v23, 192, v20
  s_waitcnt lgkmcnt(14)
  v_mfma_f32_32x32x16_bf16 v[64:79], v[32:35], v[196:199], v[64:79]
  ds_read_b64_tr_b16 v[32:33], v20 offset:0
  s_waitcnt lgkmcnt(14)
  ds_read_b64_tr_b16 v[34:35], v20 offset:4096
  s_waitcnt lgkmcnt(14)
  v_mfma_f32_32x32x16_bf16 v[80:95], v[36:39], v[196:199], v[80:95]
  ds_read_b64_tr_b16 v[36:37], v21 offset:0
  s_waitcnt lgkmcnt(14)
  ds_read_b64_tr_b16 v[38:39], v21 offset:4096
  s_waitcnt lgkmcnt(14)
  v_mfma_f32_32x32x16_bf16 v[96:111], v[40:43], v[196:199], v[96:111]
  ds_read_b64_tr_b16 v[40:41], v22 offset:0
  s_waitcnt lgkmcnt(14)
  ds_read_b64_tr_b16 v[42:43], v22 offset:4096
  s_waitcnt lgkmcnt(14)
  v_mfma_f32_32x32x16_bf16 v[112:127], v[44:47], v[196:199], v[112:127]
  ds_read_b64_tr_b16 v[44:45], v23 offset:0
  s_waitcnt lgkmcnt(14)
  ds_read_b64_tr_b16 v[46:47], v23 offset:4096
  s_waitcnt lgkmcnt(14)
  v_mfma_f32_32x32x16_bf16 v[128:143], v[48:51], v[196:199], v[128:143]
  ds_read_b64_tr_b16 v[48:49], v20 offset:256
  s_waitcnt lgkmcnt(14)
  ds_read_b64_tr_b16 v[50:51], v20 offset:4352
  s_waitcnt lgkmcnt(14)
  v_mfma_f32_32x32x16_bf16 v[144:159], v[52:55], v[196:199], v[144:159]
  ds_read_b64_tr_b16 v[52:53], v21 offset:256
  s_waitcnt lgkmcnt(14)
  ds_read_b64_tr_b16 v[54:55], v21 offset:4352
  s_waitcnt lgkmcnt(14)
  v_mfma_f32_32x32x16_bf16 v[160:175], v[56:59], v[196:199], v[160:175]
  ds_read_b64_tr_b16 v[56:57], v22 offset:256
  s_waitcnt lgkmcnt(14)
  ds_read_b64_tr_b16 v[58:59], v22 offset:4352
  s_waitcnt lgkmcnt(14)
  v_mfma_f32_32x32x16_bf16 v[176:191], v[60:63], v[196:199], v[176:191]
  ds_read_b64_tr_b16 v[60:61], v23 offset:256
  s_waitcnt lgkmcnt(14)
  ds_read_b64_tr_b16 v[62:63], v23 offset:4352
  s_barrier
  v_add_u32 v20, 49152, v17
  v_xor_b32 v21, 64, v20
  v_xor_b32 v22, 128, v20
  v_xor_b32 v23, 192, v20
  s_waitcnt lgkmcnt(14)
  v_mfma_f32_32x32x16_bf16 v[64:79], v[32:35], v[200:203], v[64:79]
  ds_read_b64_tr_b16 v[32:33], v20 offset:0
  s_waitcnt lgkmcnt(14)
  ds_read_b64_tr_b16 v[34:35], v20 offset:4096
  s_waitcnt lgkmcnt(14)
  v_mfma_f32_32x32x16_bf16 v[80:95], v[36:39], v[200:203], v[80:95]
  ds_read_b64_tr_b16 v[36:37], v21 offset:0
  s_waitcnt lgkmcnt(14)
  ds_read_b64_tr_b16 v[38:39], v21 offset:4096
  s_waitcnt lgkmcnt(14)
  v_mfma_f32_32x32x16_bf16 v[96:111], v[40:43], v[200:203], v[96:111]
  ds_read_b64_tr_b16 v[40:41], v22 offset:0
  s_waitcnt lgkmcnt(14)
  ds_read_b64_tr_b16 v[42:43], v22 offset:4096
  s_waitcnt lgkmcnt(14)
  v_mfma_f32_32x32x16_bf16 v[112:127], v[44:47], v[200:203], v[112:127]
  ds_read_b64_tr_b16 v[44:45], v23 offset:0
  s_waitcnt lgkmcnt(14)
  ds_read_b64_tr_b16 v[46:47], v23 offset:4096
  s_waitcnt lgkmcnt(14)
  v_mfma_f32_32x32x16_bf16 v[128:143], v[48:51], v[200:203], v[128:143]
  ds_read_b64_tr_b16 v[48:49], v20 offset:256
  s_waitcnt lgkmcnt(14)
  ds_read_b64_tr_b16 v[50:51], v20 offset:4352
  s_waitcnt lgkmcnt(14)
  v_mfma_f32_32x32x16_bf16 v[144:159], v[52:55], v[200:203], v[144:159]
  ds_read_b64_tr_b16 v[52:53], v21 offset:256
  s_waitcnt lgkmcnt(14)
  ds_read_b64_tr_b16 v[54:55], v21 offset:4352
  s_waitcnt lgkmcnt(14)
  v_mfma_f32_32x32x16_bf16 v[160:175], v[56:59], v[200:203], v[160:175]
  ds_read_b64_tr_b16 v[56:57], v22 offset:256
  s_waitcnt lgkmcnt(14)
  ds_read_b64_tr_b16 v[58:59], v22 offset:4352
  s_waitcnt lgkmcnt(14)
  v_mfma_f32_32x32x16_bf16 v[176:191], v[60:63], v[200:203], v[176:191]
  ds_read_b64_tr_b16 v[60:61], v23 offset:256
  s_waitcnt lgkmcnt(14)
  ds_read_b64_tr_b16 v[62:63], v23 offset:4352
  s_barrier
  v_add_u32 v20, 32768, v17
  v_xor_b32 v21, 64, v20
  v_xor_b32 v22, 128, v20
  v_xor_b32 v23, 192, v20
  s_waitcnt lgkmcnt(14)
  v_mfma_f32_32x32x16_bf16 v[64:79], v[32:35], v[204:207], v[64:79]
  ds_read_b64_tr_b16 v[32:33], v20 offset:0
  s_waitcnt lgkmcnt(14)
  ds_read_b64_tr_b16 v[34:35], v20 offset:4096
  s_waitcnt lgkmcnt(14)
  v_mfma_f32_32x32x16_bf16 v[80:95], v[36:39], v[204:207], v[80:95]
  ds_read_b64_tr_b16 v[36:37], v21 offset:0
  s_waitcnt lgkmcnt(14)
  ds_read_b64_tr_b16 v[38:39], v21 offset:4096
  s_waitcnt lgkmcnt(14)
  v_mfma_f32_32x32x16_bf16 v[96:111], v[40:43], v[204:207], v[96:111]
  ds_read_b64_tr_b16 v[40:41], v22 offset:0
  s_waitcnt lgkmcnt(14)
  ds_read_b64_tr_b16 v[42:43], v22 offset:4096
  s_waitcnt lgkmcnt(14)
  v_mfma_f32_32x32x16_bf16 v[112:127], v[44:47], v[204:207], v[112:127]
  ds_read_b64_tr_b16 v[44:45], v23 offset:0
  s_waitcnt lgkmcnt(14)
  ds_read_b64_tr_b16 v[46:47], v23 offset:4096
  s_waitcnt lgkmcnt(14)
  v_mfma_f32_32x32x16_bf16 v[128:143], v[48:51], v[204:207], v[128:143]
  ds_read_b64_tr_b16 v[48:49], v20 offset:256
  s_waitcnt lgkmcnt(14)
  ds_read_b64_tr_b16 v[50:51], v20 offset:4352
  s_waitcnt lgkmcnt(14)
  v_mfma_f32_32x32x16_bf16 v[144:159], v[52:55], v[204:207], v[144:159]
  ds_read_b64_tr_b16 v[52:53], v21 offset:256
  s_waitcnt lgkmcnt(14)
  ds_read_b64_tr_b16 v[54:55], v21 offset:4352
  s_waitcnt lgkmcnt(14)
  v_mfma_f32_32x32x16_bf16 v[160:175], v[56:59], v[204:207], v[160:175]
  ds_read_b64_tr_b16 v[56:57], v22 offset:256
  s_waitcnt lgkmcnt(14)
  ds_read_b64_tr_b16 v[58:59], v22 offset:4352
  s_waitcnt lgkmcnt(14)
  v_mfma_f32_32x32x16_bf16 v[176:191], v[60:63], v[204:207], v[176:191]
  ds_read_b64_tr_b16 v[60:61], v23 offset:256
  s_waitcnt lgkmcnt(14)
  ds_read_b64_tr_b16 v[62:63], v23 offset:4352
  s_barrier
  v_add_u32 v20, 0, v17
  v_xor_b32 v21, 64, v20
  v_xor_b32 v22, 128, v20
  v_xor_b32 v23, 192, v20
  s_waitcnt lgkmcnt(14)
  v_mfma_f32_32x32x16_bf16 v[64:79], v[32:35], v[208:211], v[64:79]
  ds_read_b64_tr_b16 v[32:33], v20 offset:0
  s_waitcnt lgkmcnt(14)
  ds_read_b64_tr_b16 v[34:35], v20 offset:4096
  s_waitcnt lgkmcnt(14)
  v_mfma_f32_32x32x16_bf16 v[80:95], v[36:39], v[208:211], v[80:95]
  ds_read_b64_tr_b16 v[36:37], v21 offset:0
  s_waitcnt lgkmcnt(14)
  ds_read_b64_tr_b16 v[38:39], v21 offset:4096
  s_waitcnt lgkmcnt(14)
  v_mfma_f32_32x32x16_bf16 v[96:111], v[40:43], v[208:211], v[96:111]
  ds_read_b64_tr_b16 v[40:41], v22 offset:0
  s_waitcnt lgkmcnt(14)
  ds_read_b64_tr_b16 v[42:43], v22 offset:4096
  s_waitcnt lgkmcnt(14)
  v_mfma_f32_32x32x16_bf16 v[112:127], v[44:47], v[208:211], v[112:127]
  ds_read_b64_tr_b16 v[44:45], v23 offset:0
  s_waitcnt lgkmcnt(14)
  ds_read_b64_tr_b16 v[46:47], v23 offset:4096
  s_waitcnt lgkmcnt(14)
  v_mfma_f32_32x32x16_bf16 v[128:143], v[48:51], v[208:211], v[128:143]
  ds_read_b64_tr_b16 v[48:49], v20 offset:256
  s_waitcnt lgkmcnt(14)
  ds_read_b64_tr_b16 v[50:51], v20 offset:4352
  s_waitcnt lgkmcnt(14)
  v_mfma_f32_32x32x16_bf16 v[144:159], v[52:55], v[208:211], v[144:159]
  ds_read_b64_tr_b16 v[52:53], v21 offset:256
  s_waitcnt lgkmcnt(14)
  ds_read_b64_tr_b16 v[54:55], v21 offset:4352
  s_waitcnt lgkmcnt(14)
  v_mfma_f32_32x32x16_bf16 v[160:175], v[56:59], v[208:211], v[160:175]
  ds_read_b64_tr_b16 v[56:57], v22 offset:256
  s_waitcnt lgkmcnt(14)
  ds_read_b64_tr_b16 v[58:59], v22 offset:4352
  s_waitcnt lgkmcnt(14)
  v_mfma_f32_32x32x16_bf16 v[176:191], v[60:63], v[208:211], v[176:191]
  ds_read_b64_tr_b16 v[60:61], v23 offset:256
  s_waitcnt lgkmcnt(14)
  ds_read_b64_tr_b16 v[62:63], v23 offset:4352
  s_barrier
  v_add_u32 v20, 147456, v17
  v_xor_b32 v21, 64, v20
  v_xor_b32 v22, 128, v20
  v_xor_b32 v23, 192, v20
  s_waitcnt lgkmcnt(14)
  v_mfma_f32_32x32x16_bf16 v[64:79], v[32:35], v[212:215], v[64:79]
  ds_read_b64_tr_b16 v[32:33], v20 offset:0
  s_waitcnt lgkmcnt(14)
  ds_read_b64_tr_b16 v[34:35], v20 offset:4096
  s_waitcnt lgkmcnt(14)
  v_mfma_f32_32x32x16_bf16 v[80:95], v[36:39], v[212:215], v[80:95]
  ds_read_b64_tr_b16 v[36:37], v21 offset:0
  s_waitcnt lgkmcnt(14)
  ds_read_b64_tr_b16 v[38:39], v21 offset:4096
  s_waitcnt lgkmcnt(14)
  v_mfma_f32_32x32x16_bf16 v[96:111], v[40:43], v[212:215], v[96:111]
  ds_read_b64_tr_b16 v[40:41], v22 offset:0
  s_waitcnt lgkmcnt(14)
  ds_read_b64_tr_b16 v[42:43], v22 offset:4096
  s_waitcnt lgkmcnt(14)
  v_mfma_f32_32x32x16_bf16 v[112:127], v[44:47], v[212:215], v[112:127]
  ds_read_b64_tr_b16 v[44:45], v23 offset:0
  s_waitcnt lgkmcnt(14)
  ds_read_b64_tr_b16 v[46:47], v23 offset:4096
  s_waitcnt lgkmcnt(14)
  v_mfma_f32_32x32x16_bf16 v[128:143], v[48:51], v[212:215], v[128:143]
  ds_read_b64_tr_b16 v[48:49], v20 offset:256
  s_waitcnt lgkmcnt(14)
  ds_read_b64_tr_b16 v[50:51], v20 offset:4352
  s_waitcnt lgkmcnt(14)
  v_mfma_f32_32x32x16_bf16 v[144:159], v[52:55], v[212:215], v[144:159]
  ds_read_b64_tr_b16 v[52:53], v21 offset:256
  s_waitcnt lgkmcnt(14)
  ds_read_b64_tr_b16 v[54:55], v21 offset:4352
  s_waitcnt lgkmcnt(14)
  v_mfma_f32_32x32x16_bf16 v[160:175], v[56:59], v[212:215], v[160:175]
  ds_read_b64_tr_b16 v[56:57], v22 offset:256
  s_waitcnt lgkmcnt(14)
  ds_read_b64_tr_b16 v[58:59], v22 offset:4352
  s_waitcnt lgkmcnt(14)
  v_mfma_f32_32x32x16_bf16 v[176:191], v[60:63], v[212:215], v[176:191]
  ds_read_b64_tr_b16 v[60:61], v23 offset:256
  s_waitcnt lgkmcnt(14)
  ds_read_b64_tr_b16 v[62:63], v23 offset:4352
  s_barrier
  v_add_u32 v20, 131072, v17
  v_xor_b32 v21, 64, v20
  v_xor_b32 v22, 128, v20
  v_xor_b32 v23, 192, v20
  s_waitcnt lgkmcnt(14)
  v_mfma_f32_32x32x16_bf16 v[64:79], v[32:35], v[216:219], v[64:79]
  ds_read_b64_tr_b16 v[32:33], v20 offset:0
  s_waitcnt lgkmcnt(14)
  ds_read_b64_tr_b16 v[34:35], v20 offset:4096
  s_waitcnt lgkmcnt(14)
  v_mfma_f32_32x32x16_bf16 v[80:95], v[36:39], v[216:219], v[80:95]
  ds_read_b64_tr_b16 v[36:37], v21 offset:0
  s_waitcnt lgkmcnt(14)
  ds_read_b64_tr_b16 v[38:39], v21 offset:4096
  s_waitcnt lgkmcnt(14)
  v_mfma_f32_32x32x16_bf16 v[96:111], v[40:43], v[216:219], v[96:111]
  ds_read_b64_tr_b16 v[40:41], v22 offset:0
  s_waitcnt lgkmcnt(14)
  ds_read_b64_tr_b16 v[42:43], v22 offset:4096
  s_waitcnt lgkmcnt(14)
  v_mfma_f32_32x32x16_bf16 v[112:127], v[44:47], v[216:219], v[112:127]
  ds_read_b64_tr_b16 v[44:45], v23 offset:0
  s_waitcnt lgkmcnt(14)
  ds_read_b64_tr_b16 v[46:47], v23 offset:4096
  s_waitcnt lgkmcnt(14)
  v_mfma_f32_32x32x16_bf16 v[128:143], v[48:51], v[216:219], v[128:143]
  ds_read_b64_tr_b16 v[48:49], v20 offset:256
  s_waitcnt lgkmcnt(14)
  ds_read_b64_tr_b16 v[50:51], v20 offset:4352
  s_waitcnt lgkmcnt(14)
  v_mfma_f32_32x32x16_bf16 v[144:159], v[52:55], v[216:219], v[144:159]
  ds_read_b64_tr_b16 v[52:53], v21 offset:256
  s_waitcnt lgkmcnt(14)
  ds_read_b64_tr_b16 v[54:55], v21 offset:4352
  s_waitcnt lgkmcnt(14)
  v_mfma_f32_32x32x16_bf16 v[160:175], v[56:59], v[216:219], v[160:175]
  ds_read_b64_tr_b16 v[56:57], v22 offset:256
  s_waitcnt lgkmcnt(14)
  ds_read_b64_tr_b16 v[58:59], v22 offset:4352
  s_waitcnt lgkmcnt(14)
  v_mfma_f32_32x32x16_bf16 v[176:191], v[60:63], v[216:219], v[176:191]
  ds_read_b64_tr_b16 v[60:61], v23 offset:256
  s_waitcnt lgkmcnt(14)
  ds_read_b64_tr_b16 v[62:63], v23 offset:4352
  s_barrier
  v_add_u32 v20, 114688, v17
  v_xor_b32 v21, 64, v20
  v_xor_b32 v22, 128, v20
  v_xor_b32 v23, 192, v20
  s_waitcnt lgkmcnt(14)
  v_mfma_f32_32x32x16_bf16 v[64:79], v[32:35], v[220:223], v[64:79]
  ds_read_b64_tr_b16 v[32:33], v20 offset:0
  s_waitcnt lgkmcnt(14)
  ds_read_b64_tr_b16 v[34:35], v20 offset:4096
  s_waitcnt lgkmcnt(14)
  v_mfma_f32_32x32x16_bf16 v[80:95], v[36:39], v[220:223], v[80:95]
  ds_read_b64_tr_b16 v[36:37], v21 offset:0
  s_waitcnt lgkmcnt(14)
  ds_read_b64_tr_b16 v[38:39], v21 offset:4096
  s_waitcnt lgkmcnt(14)
  v_mfma_f32_32x32x16_bf16 v[96:111], v[40:43], v[220:223], v[96:111]
  ds_read_b64_tr_b16 v[40:41], v22 offset:0
  s_waitcnt lgkmcnt(14)
  ds_read_b64_tr_b16 v[42:43], v22 offset:4096
  s_waitcnt lgkmcnt(14)
  v_mfma_f32_32x32x16_bf16 v[112:127], v[44:47], v[220:223], v[112:127]
  ds_read_b64_tr_b16 v[44:45], v23 offset:0
  s_waitcnt lgkmcnt(14)
  ds_read_b64_tr_b16 v[46:47], v23 offset:4096
  s_waitcnt lgkmcnt(14)
  v_mfma_f32_32x32x16_bf16 v[128:143], v[48:51], v[220:223], v[128:143]
  ds_read_b64_tr_b16 v[48:49], v20 offset:256
  s_waitcnt lgkmcnt(14)
  ds_read_b64_tr_b16 v[50:51], v20 offset:4352
  s_waitcnt lgkmcnt(14)
  v_mfma_f32_32x32x16_bf16 v[144:159], v[52:55], v[220:223], v[144:159]
  ds_read_b64_tr_b16 v[52:53], v21 offset:256
  s_waitcnt lgkmcnt(14)
  ds_read_b64_tr_b16 v[54:55], v21 offset:4352
  s_waitcnt lgkmcnt(14)
  v_mfma_f32_32x32x16_bf16 v[160:175], v[56:59], v[220:223], v[160:175]
  ds_read_b64_tr_b16 v[56:57], v22 offset:256
  s_waitcnt lgkmcnt(14)
  ds_read_b64_tr_b16 v[58:59], v22 offset:4352
  s_waitcnt lgkmcnt(14)
  v_mfma_f32_32x32x16_bf16 v[176:191], v[60:63], v[220:223], v[176:191]
  ds_read_b64_tr_b16 v[60:61], v23 offset:256
  s_waitcnt lgkmcnt(14)
  ds_read_b64_tr_b16 v[62:63], v23 offset:4352
  s_barrier
  v_add_u32 v20, 65536, v17
  v_xor_b32 v21, 64, v20
  v_xor_b32 v22, 128, v20
  v_xor_b32 v23, 192, v20
  s_waitcnt lgkmcnt(14)
  v_mfma_f32_32x32x16_bf16 v[64:79], v[32:35], v[224:227], v[64:79]
  ds_read_b64_tr_b16 v[32:33], v20 offset:0
  s_waitcnt lgkmcnt(14)
  ds_read_b64_tr_b16 v[34:35], v20 offset:4096
  s_waitcnt lgkmcnt(14)
  v_mfma_f32_32x32x16_bf16 v[80:95], v[36:39], v[224:227], v[80:95]
  ds_read_b64_tr_b16 v[36:37], v21 offset:0
  s_waitcnt lgkmcnt(14)
  ds_read_b64_tr_b16 v[38:39], v21 offset:4096
  s_waitcnt lgkmcnt(14)
  v_mfma_f32_32x32x16_bf16 v[96:111], v[40:43], v[224:227], v[96:111]
  ds_read_b64_tr_b16 v[40:41], v22 offset:0
  s_waitcnt lgkmcnt(14)
  ds_read_b64_tr_b16 v[42:43], v22 offset:4096
  s_waitcnt lgkmcnt(14)
  v_mfma_f32_32x32x16_bf16 v[112:127], v[44:47], v[224:227], v[112:127]
  ds_read_b64_tr_b16 v[44:45], v23 offset:0
  s_waitcnt lgkmcnt(14)
  ds_read_b64_tr_b16 v[46:47], v23 offset:4096
  s_waitcnt lgkmcnt(14)
  v_mfma_f32_32x32x16_bf16 v[128:143], v[48:51], v[224:227], v[128:143]
  ds_read_b64_tr_b16 v[48:49], v20 offset:256
  s_waitcnt lgkmcnt(14)
  ds_read_b64_tr_b16 v[50:51], v20 offset:4352
  s_waitcnt lgkmcnt(14)
  v_mfma_f32_32x32x16_bf16 v[144:159], v[52:55], v[224:227], v[144:159]
  ds_read_b64_tr_b16 v[52:53], v21 offset:256
  s_waitcnt lgkmcnt(14)
  ds_read_b64_tr_b16 v[54:55], v21 offset:4352
  s_waitcnt lgkmcnt(14)
  v_mfma_f32_32x32x16_bf16 v[160:175], v[56:59], v[224:227], v[160:175]
  ds_read_b64_tr_b16 v[56:57], v22 offset:256
  s_waitcnt lgkmcnt(14)
  ds_read_b64_tr_b16 v[58:59], v22 offset:4352
  s_waitcnt lgkmcnt(14)
  v_mfma_f32_32x32x16_bf16 v[176:191], v[60:63], v[224:227], v[176:191]
  ds_read_b64_tr_b16 v[60:61], v23 offset:256
  s_waitcnt lgkmcnt(14)
  ds_read_b64_tr_b16 v[62:63], v23 offset:4352
  v_add_u32 v20, 16384, v17
  v_xor_b32 v21, 64, v20
  v_xor_b32 v22, 128, v20
  v_xor_b32 v23, 192, v20
  s_waitcnt lgkmcnt(14)
  v_mfma_f32_32x32x16_bf16 v[64:79], v[32:35], v[228:231], v[64:79]
  ds_read_b64_tr_b16 v[32:33], v20 offset:0
  s_waitcnt lgkmcnt(14)
  ds_read_b64_tr_b16 v[34:35], v20 offset:4096
  s_waitcnt lgkmcnt(14)
  v_mfma_f32_32x32x16_bf16 v[80:95], v[36:39], v[228:231], v[80:95]
  ds_read_b64_tr_b16 v[36:37], v21 offset:0
  s_waitcnt lgkmcnt(14)
  ds_read_b64_tr_b16 v[38:39], v21 offset:4096
  s_waitcnt lgkmcnt(14)
  v_mfma_f32_32x32x16_bf16 v[96:111], v[40:43], v[228:231], v[96:111]
  ds_read_b64_tr_b16 v[40:41], v22 offset:0
  s_waitcnt lgkmcnt(14)
  ds_read_b64_tr_b16 v[42:43], v22 offset:4096
  s_waitcnt lgkmcnt(14)
  v_mfma_f32_32x32x16_bf16 v[112:127], v[44:47], v[228:231], v[112:127]
  ds_read_b64_tr_b16 v[44:45], v23 offset:0
  s_waitcnt lgkmcnt(14)
  ds_read_b64_tr_b16 v[46:47], v23 offset:4096
  s_waitcnt lgkmcnt(14)
  v_mfma_f32_32x32x16_bf16 v[128:143], v[48:51], v[228:231], v[128:143]
  ds_read_b64_tr_b16 v[48:49], v20 offset:256
  s_waitcnt lgkmcnt(14)
  ds_read_b64_tr_b16 v[50:51], v20 offset:4352
  s_waitcnt lgkmcnt(14)
  v_mfma_f32_32x32x16_bf16 v[144:159], v[52:55], v[228:231], v[144:159]
  ds_read_b64_tr_b16 v[52:53], v21 offset:256
  s_waitcnt lgkmcnt(14)
  ds_read_b64_tr_b16 v[54:55], v21 offset:4352
  s_waitcnt lgkmcnt(14)
  v_mfma_f32_32x32x16_bf16 v[160:175], v[56:59], v[228:231], v[160:175]
  ds_read_b64_tr_b16 v[56:57], v22 offset:256
  s_waitcnt lgkmcnt(14)
  ds_read_b64_tr_b16 v[58:59], v22 offset:4352
  s_waitcnt lgkmcnt(14)
  v_mfma_f32_32x32x16_bf16 v[176:191], v[60:63], v[228:231], v[176:191]
  ds_read_b64_tr_b16 v[60:61], v23 offset:256
  s_waitcnt lgkmcnt(14)
  ds_read_b64_tr_b16 v[62:63], v23 offset:4352
  v_add_u32 v20, 98304, v17
  v_xor_b32 v21, 64, v20
  v_xor_b32 v22, 128, v20
  v_xor_b32 v23, 192, v20
  s_waitcnt lgkmcnt(14)
  v_mfma_f32_32x32x16_bf16 v[64:79], v[32:35], v[232:235], v[64:79]
  ds_read_b64_tr_b16 v[32:33], v20 offset:0
  s_waitcnt lgkmcnt(14)
  ds_read_b64_tr_b16 v[34:35], v20 offset:4096
  s_waitcnt lgkmcnt(14)
  v_mfma_f32_32x32x16_bf16 v[80:95], v[36:39], v[232:235], v[80:95]
  ds_read_b64_tr_b16 v[36:37], v21 offset:0
  s_waitcnt lgkmcnt(14)
  ds_read_b64_tr_b16 v[38:39], v21 offset:4096
  s_waitcnt lgkmcnt(14)
  v_mfma_f32_32x32x16_bf16 v[96:111], v[40:43], v[232:235], v[96:111]
  ds_read_b64_tr_b16 v[40:41], v22 offset:0
  s_waitcnt lgkmcnt(14)
  ds_read_b64_tr_b16 v[42:43], v22 offset:4096
  s_waitcnt lgkmcnt(14)
  v_mfma_f32_32x32x16_bf16 v[112:127], v[44:47], v[232:235], v[112:127]
  ds_read_b64_tr_b16 v[44:45], v23 offset:0
  s_waitcnt lgkmcnt(14)
  ds_read_b64_tr_b16 v[46:47], v23 offset:4096
  s_waitcnt lgkmcnt(14)
  v_mfma_f32_32x32x16_bf16 v[128:143], v[48:51], v[232:235], v[128:143]
  ds_read_b64_tr_b16 v[48:49], v20 offset:256
  s_waitcnt lgkmcnt(14)
  ds_read_b64_tr_b16 v[50:51], v20 offset:4352
  s_waitcnt lgkmcnt(14)
  v_mfma_f32_32x32x16_bf16 v[144:159], v[52:55], v[232:235], v[144:159]
  ds_read_b64_tr_b16 v[52:53], v21 offset:256
  s_waitcnt lgkmcnt(14)
  ds_read_b64_tr_b16 v[54:55], v21 offset:4352
  s_waitcnt lgkmcnt(14)
  v_mfma_f32_32x32x16_bf16 v[160:175], v[56:59], v[232:235], v[160:175]
  ds_read_b64_tr_b16 v[56:57], v22 offset:256
  s_waitcnt lgkmcnt(14)
  ds_read_b64_tr_b16 v[58:59], v22 offset:4352
  s_waitcnt lgkmcnt(14)
  v_mfma_f32_32x32x16_bf16 v[176:191], v[60:63], v[232:235], v[176:191]
  ds_read_b64_tr_b16 v[60:61], v23 offset:256
  s_waitcnt lgkmcnt(14)
  ds_read_b64_tr_b16 v[62:63], v23 offset:4352
  v_add_u32 v20, 81920, v17
  v_xor_b32 v21, 64, v20
  v_xor_b32 v22, 128, v20
  v_xor_b32 v23, 192, v20
  s_waitcnt lgkmcnt(14)
  v_mfma_f32_32x32x16_bf16 v[64:79], v[32:35], v[236:239], v[64:79]
  ds_read_b64_tr_b16 v[32:33], v20 offset:0
  s_waitcnt lgkmcnt(14)
  ds_read_b64_tr_b16 v[34:35], v20 offset:4096
  s_waitcnt lgkmcnt(14)
  v_mfma_f32_32x32x16_bf16 v[80:95], v[36:39], v[236:239], v[80:95]
  ds_read_b64_tr_b16 v[36:37], v21 offset:0
  s_waitcnt lgkmcnt(14)
  ds_read_b64_tr_b16 v[38:39], v21 offset:4096
  s_waitcnt lgkmcnt(14)
  v_mfma_f32_32x32x16_bf16 v[96:111], v[40:43], v[236:239], v[96:111]
  ds_read_b64_tr_b16 v[40:41], v22 offset:0
  s_waitcnt lgkmcnt(14)
  ds_read_b64_tr_b16 v[42:43], v22 offset:4096
  s_waitcnt lgkmcnt(14)
  v_mfma_f32_32x32x16_bf16 v[112:127], v[44:47], v[236:239], v[112:127]
  ds_read_b64_tr_b16 v[44:45], v23 offset:0
  s_waitcnt lgkmcnt(14)
  ds_read_b64_tr_b16 v[46:47], v23 offset:4096
  s_waitcnt lgkmcnt(14)
  v_mfma_f32_32x32x16_bf16 v[128:143], v[48:51], v[236:239], v[128:143]
  ds_read_b64_tr_b16 v[48:49], v20 offset:256
  s_waitcnt lgkmcnt(14)
  ds_read_b64_tr_b16 v[50:51], v20 offset:4352
  s_waitcnt lgkmcnt(14)
  v_mfma_f32_32x32x16_bf16 v[144:159], v[52:55], v[236:239], v[144:159]
  ds_read_b64_tr_b16 v[52:53], v21 offset:256
  s_waitcnt lgkmcnt(14)
  ds_read_b64_tr_b16 v[54:55], v21 offset:4352
  s_waitcnt lgkmcnt(14)
  v_mfma_f32_32x32x16_bf16 v[160:175], v[56:59], v[236:239], v[160:175]
  ds_read_b64_tr_b16 v[56:57], v22 offset:256
  s_waitcnt lgkmcnt(14)
  ds_read_b64_tr_b16 v[58:59], v22 offset:4352
  s_waitcnt lgkmcnt(14)
  v_mfma_f32_32x32x16_bf16 v[176:191], v[60:63], v[236:239], v[176:191]
  ds_read_b64_tr_b16 v[60:61], v23 offset:256
  s_waitcnt lgkmcnt(14)
  ds_read_b64_tr_b16 v[62:63], v23 offset:4352
  v_add_u32 v20, 49152, v17
  v_xor_b32 v21, 64, v20
  v_xor_b32 v22, 128, v20
  v_xor_b32 v23, 192, v20
  s_waitcnt lgkmcnt(14)
  v_mfma_f32_32x32x16_bf16 v[64:79], v[32:35], v[240:243], v[64:79]
  ds_read_b64_tr_b16 v[32:33], v20 offset:0
  s_waitcnt lgkmcnt(14)
  ds_read_b64_tr_b16 v[34:35], v20 offset:4096
  s_waitcnt lgkmcnt(14)
  v_mfma_f32_32x32x16_bf16 v[80:95], v[36:39], v[240:243], v[80:95]
  ds_read_b64_tr_b16 v[36:37], v21 offset:0
  s_waitcnt lgkmcnt(14)
  ds_read_b64_tr_b16 v[38:39], v21 offset:4096
  s_waitcnt lgkmcnt(14)
  v_mfma_f32_32x32x16_bf16 v[96:111], v[40:43], v[240:243], v[96:111]
  ds_read_b64_tr_b16 v[40:41], v22 offset:0
  s_waitcnt lgkmcnt(14)
  ds_read_b64_tr_b16 v[42:43], v22 offset:4096
  s_waitcnt lgkmcnt(14)
  v_mfma_f32_32x32x16_bf16 v[112:127], v[44:47], v[240:243], v[112:127]
  ds_read_b64_tr_b16 v[44:45], v23 offset:0
  s_waitcnt lgkmcnt(14)
  ds_read_b64_tr_b16 v[46:47], v23 offset:4096
  s_waitcnt lgkmcnt(14)
  v_mfma_f32_32x32x16_bf16 v[128:143], v[48:51], v[240:243], v[128:143]
  ds_read_b64_tr_b16 v[48:49], v20 offset:256
  s_waitcnt lgkmcnt(14)
  ds_read_b64_tr_b16 v[50:51], v20 offset:4352
  s_waitcnt lgkmcnt(14)
  v_mfma_f32_32x32x16_bf16 v[144:159], v[52:55], v[240:243], v[144:159]
  ds_read_b64_tr_b16 v[52:53], v21 offset:256
  s_waitcnt lgkmcnt(14)
  ds_read_b64_tr_b16 v[54:55], v21 offset:4352
  s_waitcnt lgkmcnt(14)
  v_mfma_f32_32x32x16_bf16 v[160:175], v[56:59], v[240:243], v[160:175]
  ds_read_b64_tr_b16 v[56:57], v22 offset:256
  s_waitcnt lgkmcnt(14)
  ds_read_b64_tr_b16 v[58:59], v22 offset:4352
  s_waitcnt lgkmcnt(14)
  v_mfma_f32_32x32x16_bf16 v[176:191], v[60:63], v[240:243], v[176:191]
  ds_read_b64_tr_b16 v[60:61], v23 offset:256
  s_waitcnt lgkmcnt(14)
  ds_read_b64_tr_b16 v[62:63], v23 offset:4352
  v_add_u32 v20, 32768, v17
  v_xor_b32 v21, 64, v20
  v_xor_b32 v22, 128, v20
  v_xor_b32 v23, 192, v20
  s_waitcnt lgkmcnt(14)
  v_mfma_f32_32x32x16_bf16 v[64:79], v[32:35], v[244:247], v[64:79]
  ds_read_b64_tr_b16 v[32:33], v20 offset:0
  s_waitcnt lgkmcnt(14)
  ds_read_b64_tr_b16 v[34:35], v20 offset:4096
  s_waitcnt lgkmcnt(14)
  v_mfma_f32_32x32x16_bf16 v[80:95], v[36:39], v[244:247], v[80:95]
  ds_read_b64_tr_b16 v[36:37], v21 offset:0
  s_waitcnt lgkmcnt(14)
  ds_read_b64_tr_b16 v[38:39], v21 offset:4096
  s_waitcnt lgkmcnt(14)
  v_mfma_f32_32x32x16_bf16 v[96:111], v[40:43], v[244:247], v[96:111]
  ds_read_b64_tr_b16 v[40:41], v22 offset:0
  s_waitcnt lgkmcnt(14)
  ds_read_b64_tr_b16 v[42:43], v22 offset:4096
  s_waitcnt lgkmcnt(14)
  v_mfma_f32_32x32x16_bf16 v[112:127], v[44:47], v[244:247], v[112:127]
  ds_read_b64_tr_b16 v[44:45], v23 offset:0
  s_waitcnt lgkmcnt(14)
  ds_read_b64_tr_b16 v[46:47], v23 offset:4096
  s_waitcnt lgkmcnt(14)
  v_mfma_f32_32x32x16_bf16 v[128:143], v[48:51], v[244:247], v[128:143]
  ds_read_b64_tr_b16 v[48:49], v20 offset:256
  s_waitcnt lgkmcnt(14)
  ds_read_b64_tr_b16 v[50:51], v20 offset:4352
  s_waitcnt lgkmcnt(14)
  v_mfma_f32_32x32x16_bf16 v[144:159], v[52:55], v[244:247], v[144:159]
  ds_read_b64_tr_b16 v[52:53], v21 offset:256
  s_waitcnt lgkmcnt(14)
  ds_read_b64_tr_b16 v[54:55], v21 offset:4352
  s_waitcnt lgkmcnt(14)
  v_mfma_f32_32x32x16_bf16 v[160:175], v[56:59], v[244:247], v[160:175]
  ds_read_b64_tr_b16 v[56:57], v22 offset:256
  s_waitcnt lgkmcnt(14)
  ds_read_b64_tr_b16 v[58:59], v22 offset:4352
  s_waitcnt lgkmcnt(14)
  v_mfma_f32_32x32x16_bf16 v[176:191], v[60:63], v[244:247], v[176:191]
  ds_read_b64_tr_b16 v[60:61], v23 offset:256
  s_waitcnt lgkmcnt(14)
  ds_read_b64_tr_b16 v[62:63], v23 offset:4352
  v_add_u32 v20, 0, v17
  v_xor_b32 v21, 64, v20
  v_xor_b32 v22, 128, v20
  v_xor_b32 v23, 192, v20
  s_waitcnt lgkmcnt(14)
  v_mfma_f32_32x32x16_bf16 v[64:79], v[32:35], v[248:251], v[64:79]
  ds_read_b64_tr_b16 v[32:33], v20 offset:0
  s_waitcnt lgkmcnt(14)
  ds_read_b64_tr_b16 v[34:35], v20 offset:4096
  s_waitcnt lgkmcnt(14)
  v_mfma_f32_32x32x16_bf16 v[80:95], v[36:39], v[248:251], v[80:95]
  ds_read_b64_tr_b16 v[36:37], v21 offset:0
  s_waitcnt lgkmcnt(14)
  ds_read_b64_tr_b16 v[38:39], v21 offset:4096
  s_waitcnt lgkmcnt(14)
  v_mfma_f32_32x32x16_bf16 v[96:111], v[40:43], v[248:251], v[96:111]
  ds_read_b64_tr_b16 v[40:41], v22 offset:0
  s_waitcnt lgkmcnt(14)
  ds_read_b64_tr_b16 v[42:43], v22 offset:4096
  s_waitcnt lgkmcnt(14)
  v_mfma_f32_32x32x16_bf16 v[112:127], v[44:47], v[248:251], v[112:127]
  ds_read_b64_tr_b16 v[44:45], v23 offset:0
  s_waitcnt lgkmcnt(14)
  ds_read_b64_tr_b16 v[46:47], v23 offset:4096
  s_waitcnt lgkmcnt(14)
  v_mfma_f32_32x32x16_bf16 v[128:143], v[48:51], v[248:251], v[128:143]
  ds_read_b64_tr_b16 v[48:49], v20 offset:256
  s_waitcnt lgkmcnt(14)
  ds_read_b64_tr_b16 v[50:51], v20 offset:4352
  s_waitcnt lgkmcnt(14)
  v_mfma_f32_32x32x16_bf16 v[144:159], v[52:55], v[248:251], v[144:159]
  ds_read_b64_tr_b16 v[52:53], v21 offset:256
  s_waitcnt lgkmcnt(14)
  ds_read_b64_tr_b16 v[54:55], v21 offset:4352
  s_waitcnt lgkmcnt(14)
  v_mfma_f32_32x32x16_bf16 v[160:175], v[56:59], v[248:251], v[160:175]
  ds_read_b64_tr_b16 v[56:57], v22 offset:256
  s_waitcnt lgkmcnt(14)
  ds_read_b64_tr_b16 v[58:59], v22 offset:4352
  s_waitcnt lgkmcnt(14)
  v_mfma_f32_32x32x16_bf16 v[176:191], v[60:63], v[248:251], v[176:191]
  ds_read_b64_tr_b16 v[60:61], v23 offset:256
  s_waitcnt lgkmcnt(14)
  ds_read_b64_tr_b16 v[62:63], v23 offset:4352
  s_waitcnt lgkmcnt(14)
  v_mfma_f32_32x32x16_bf16 v[64:79], v[32:35], v[252:255], v[64:79]
  s_waitcnt lgkmcnt(12)
  v_mfma_f32_32x32x16_bf16 v[80:95], v[36:39], v[252:255], v[80:95]
  s_waitcnt lgkmcnt(10)
  v_mfma_f32_32x32x16_bf16 v[96:111], v[40:43], v[252:255], v[96:111]
  s_waitcnt lgkmcnt(8)
  v_mfma_f32_32x32x16_bf16 v[112:127], v[44:47], v[252:255], v[112:127]
  s_waitcnt lgkmcnt(6)
  v_mfma_f32_32x32x16_bf16 v[128:143], v[48:51], v[252:255], v[128:143]
  s_waitcnt lgkmcnt(4)
  v_mfma_f32_32x32x16_bf16 v[144:159], v[52:55], v[252:255], v[144:159]
  s_waitcnt lgkmcnt(2)
  v_mfma_f32_32x32x16_bf16 v[160:175], v[56:59], v[252:255], v[160:175]
  s_waitcnt lgkmcnt(0)
  v_mfma_f32_32x32x16_bf16 v[176:191], v[60:63], v[252:255], v[176:191]
  s_nop 7
  s_nop 7
  s_lshl_b32 s43, s45, 14
  v_cvt_pk_bf16_f32 v32, v64, v65
  v_cvt_pk_bf16_f32 v33, v66, v67
  v_cvt_pk_bf16_f32 v34, v68, v69
  v_cvt_pk_bf16_f32 v35, v70, v71
  buffer_store_dwordx4 v[32:35], v18, s[28:31], s43 offen sc1
  v_cvt_pk_bf16_f32 v36, v72, v73
  v_cvt_pk_bf16_f32 v37, v74, v75
  v_cvt_pk_bf16_f32 v38, v76, v77
  v_cvt_pk_bf16_f32 v39, v78, v79
  buffer_store_dwordx4 v[36:39], v18, s[28:31], s43 offen offset:1024 sc1
  v_cvt_pk_bf16_f32 v40, v80, v81
  v_cvt_pk_bf16_f32 v41, v82, v83
  v_cvt_pk_bf16_f32 v42, v84, v85
  v_cvt_pk_bf16_f32 v43, v86, v87
  buffer_store_dwordx4 v[40:43], v18, s[28:31], s43 offen offset:2048 sc1
  v_cvt_pk_bf16_f32 v44, v88, v89
  v_cvt_pk_bf16_f32 v45, v90, v91
  v_cvt_pk_bf16_f32 v46, v92, v93
  v_cvt_pk_bf16_f32 v47, v94, v95
  buffer_store_dwordx4 v[44:47], v18, s[28:31], s43 offen offset:3072 sc1
  v_cvt_pk_bf16_f32 v48, v96, v97
  v_cvt_pk_bf16_f32 v49, v98, v99
  v_cvt_pk_bf16_f32 v50, v100, v101
  v_cvt_pk_bf16_f32 v51, v102, v103
  s_add_u32 s43, s43, 4096
  buffer_store_dwordx4 v[48:51], v18, s[28:31], s43 offen sc1
  v_cvt_pk_bf16_f32 v52, v104, v105
  v_cvt_pk_bf16_f32 v53, v106, v107
  v_cvt_pk_bf16_f32 v54, v108, v109
  v_cvt_pk_bf16_f32 v55, v110, v111
  buffer_store_dwordx4 v[52:55], v18, s[28:31], s43 offen offset:1024 sc1
  v_cvt_pk_bf16_f32 v56, v112, v113
  v_cvt_pk_bf16_f32 v57, v114, v115
  v_cvt_pk_bf16_f32 v58, v116, v117
  v_cvt_pk_bf16_f32 v59, v118, v119
  buffer_store_dwordx4 v[56:59], v18, s[28:31], s43 offen offset:2048 sc1
  v_cvt_pk_bf16_f32 v60, v120, v121
  v_cvt_pk_bf16_f32 v61, v122, v123
  v_cvt_pk_bf16_f32 v62, v124, v125
  v_cvt_pk_bf16_f32 v63, v126, v127
  buffer_store_dwordx4 v[60:63], v18, s[28:31], s43 offen offset:3072 sc1
  v_cvt_pk_bf16_f32 v32, v128, v129
  v_cvt_pk_bf16_f32 v33, v130, v131
  v_cvt_pk_bf16_f32 v34, v132, v133
  v_cvt_pk_bf16_f32 v35, v134, v135
  s_add_u32 s43, s43, 4096
  buffer_store_dwordx4 v[32:35], v18, s[28:31], s43 offen sc1
  v_cvt_pk_bf16_f32 v36, v136, v137
  v_cvt_pk_bf16_f32 v37, v138, v139
  v_cvt_pk_bf16_f32 v38, v140, v141
  v_cvt_pk_bf16_f32 v39, v142, v143
  buffer_store_dwordx4 v[36:39], v18, s[28:31], s43 offen offset:1024 sc1
  v_cvt_pk_bf16_f32 v40, v144, v145
  v_cvt_pk_bf16_f32 v41, v146, v147
  v_cvt_pk_bf16_f32 v42, v148, v149
  v_cvt_pk_bf16_f32 v43, v150, v151
  buffer_store_dwordx4 v[40:43], v18, s[28:31], s43 offen offset:2048 sc1
  v_cvt_pk_bf16_f32 v44, v152, v153
  v_cvt_pk_bf16_f32 v45, v154, v155
  v_cvt_pk_bf16_f32 v46, v156, v157
  v_cvt_pk_bf16_f32 v47, v158, v159
  buffer_store_dwordx4 v[44:47], v18, s[28:31], s43 offen offset:3072 sc1
  v_cvt_pk_bf16_f32 v48, v160, v161
  v_cvt_pk_bf16_f32 v49, v162, v163
  v_cvt_pk_bf16_f32 v50, v164, v165
  v_cvt_pk_bf16_f32 v51, v166, v167
  s_add_u32 s43, s43, 4096
  buffer_store_dwordx4 v[48:51], v18, s[28:31], s43 offen sc1
  v_cvt_pk_bf16_f32 v52, v168, v169
  v_cvt_pk_bf16_f32 v53, v170, v171
  v_cvt_pk_bf16_f32 v54, v172, v173
  v_cvt_pk_bf16_f32 v55, v174, v175
  buffer_store_dwordx4 v[52:55], v18, s[28:31], s43 offen offset:1024 sc1
  v_cvt_pk_bf16_f32 v56, v176, v177
  v_cvt_pk_bf16_f32 v57, v178, v179
  v_cvt_pk_bf16_f32 v58, v180, v181
  v_cvt_pk_bf16_f32 v59, v182, v183
  buffer_store_dwordx4 v[56:59], v18, s[28:31], s43 offen offset:2048 sc1
  v_cvt_pk_bf16_f32 v60, v184, v185
  v_cvt_pk_bf16_f32 v61, v186, v187
  v_cvt_pk_bf16_f32 v62, v188, v189
  v_cvt_pk_bf16_f32 v63, v190, v191
  buffer_store_dwordx4 v[60:63], v18, s[28:31], s43 offen offset:3072 sc1
  s_branch L_final
L_rare_27:
  s_waitcnt lgkmcnt(0)
  v_mfma_f32_32x32x16_bf16 v[96:111], v[136:139], v[56:59], v[96:111]
  ds_read_b128 v[136:139], v242 offset:16384
  v_mfma_f32_32x32x16_bf16 v[112:127], v[140:143], v[56:59], v[112:127]
  ds_read_b128 v[140:143], v243 offset:16384
  v_mfma_f32_32x32x16_bf16 v[64:79], v[144:147], v[60:63], v[64:79]
  ds_read_b128 v[144:147], v244 offset:16384
  v_mfma_f32_32x32x16_bf16 v[80:95], v[148:151], v[60:63], v[80:95]
  ds_read_b128 v[148:151], v245 offset:16384
  v_mfma_f32_32x32x16_bf16 v[96:111], v[152:155], v[60:63], v[96:111]
  ds_read_b128 v[152:155], v246 offset:16384
  v_mfma_f32_32x32x16_bf16 v[112:127], v[156:159], v[60:63], v[112:127]
  ds_read_b128 v[156:159], v247 offset:16384
  v_mov_b32 v37, v36
  s_nop 1
  v_permlane32_swap_b32 v36, v37
  s_nop 1
  v_max3_f32 v36, v36, v37, 0
  v_sub_f32 v37, 0, v36
  v_exp_f32 v37, v37
  v_sub_f32 v224, v40, v36
  v_sub_f32 v160, v160, v36
  v_sub_f32 v225, v41, v36
  v_sub_f32 v161, v161, v36
  v_sub_f32 v226, v42, v36
  v_sub_f32 v162, v162, v36
  v_sub_f32 v227, v43, v36
  v_sub_f32 v163, v163, v36
  v_sub_f32 v228, v44, v36
  v_sub_f32 v164, v164, v36
  v_sub_f32 v229, v45, v36
  v_sub_f32 v165, v165, v36
  v_sub_f32 v230, v46, v36
  v_sub_f32 v166, v166, v36
  v_sub_f32 v231, v47, v36
  v_sub_f32 v167, v167, v36
  v_sub_f32 v232, v48, v36
  v_sub_f32 v168, v168, v36
  v_sub_f32 v233, v49, v36
  v_sub_f32 v169, v169, v36
  v_sub_f32 v234, v50, v36
  v_sub_f32 v170, v170, v36
  v_sub_f32 v235, v51, v36
  v_sub_f32 v171, v171, v36
  v_sub_f32 v236, v52, v36
  v_sub_f32 v172, v172, v36
  v_sub_f32 v237, v53, v36
  v_sub_f32 v173, v173, v36
  v_sub_f32 v238, v54, v36
  v_sub_f32 v174, v174, v36
  v_sub_f32 v239, v55, v36
  v_sub_f32 v175, v175, v36
  v_exp_f32 v224, v224
  v_exp_f32 v225, v225
  v_exp_f32 v226, v226
  v_exp_f32 v227, v227
  v_exp_f32 v228, v228
  v_exp_f32 v229, v229
  v_exp_f32 v230, v230
  v_exp_f32 v231, v231
  v_exp_f32 v232, v232
  v_exp_f32 v233, v233
  v_exp_f32 v234, v234
  v_exp_f32 v235, v235
  v_exp_f32 v236, v236
  v_exp_f32 v237, v237
  v_exp_f32 v238, v238
  v_exp_f32 v239, v239
  v_mul_f32 v252, v252, v37
  v_mul_f32 v64, v64, v37
  v_mul_f32 v65, v65, v37
  v_mul_f32 v66, v66, v37
  v_mul_f32 v67, v67, v37
  v_mul_f32 v68, v68, v37
  v_mul_f32 v69, v69, v37
  v_mul_f32 v70, v70, v37
  v_mul_f32 v71, v71, v37
  v_mul_f32 v72, v72, v37
  v_mul_f32 v73, v73, v37
  v_mul_f32 v74, v74, v37
  v_mul_f32 v75, v75, v37
  v_mul_f32 v76, v76, v37
  v_mul_f32 v77, v77, v37
  v_mul_f32 v78, v78, v37
  v_mul_f32 v79, v79, v37
  v_mul_f32 v80, v80, v37
  v_mul_f32 v81, v81, v37
  v_mul_f32 v82, v82, v37
  v_mul_f32 v83, v83, v37
  v_mul_f32 v84, v84, v37
  v_mul_f32 v85, v85, v37
  v_mul_f32 v86, v86, v37
  v_mul_f32 v87, v87, v37
  v_mul_f32 v88, v88, v37
  v_mul_f32 v89, v89, v37
  v_mul_f32 v90, v90, v37
  v_mul_f32 v91, v91, v37
  v_mul_f32 v92, v92, v37
  v_mul_f32 v93, v93, v37
  v_mul_f32 v94, v94, v37
  v_mul_f32 v95, v95, v37
  v_mul_f32 v96, v96, v37
  v_mul_f32 v97, v97, v37
  v_mul_f32 v98, v98, v37
  v_mul_f32 v99, v99, v37
  v_mul_f32 v100, v100, v37
  v_mul_f32 v101, v101, v37
  v_mul_f32 v102, v102, v37
  v_mul_f32 v103, v103, v37
  v_mul_f32 v104, v104, v37
  v_mul_f32 v105, v105, v37
  v_mul_f32 v106, v106, v37
  v_mul_f32 v107, v107, v37
  v_mul_f32 v108, v108, v37
  v_mul_f32 v109, v109, v37
  v_mul_f32 v110, v110, v37
  v_mul_f32 v111, v111, v37
  v_mul_f32 v112, v112, v37
  v_mul_f32 v113, v113, v37
  v_mul_f32 v114, v114, v37
  v_mul_f32 v115, v115, v37
  v_mul_f32 v116, v116, v37
  v_mul_f32 v117, v117, v37
  v_mul_f32 v118, v118, v37
  v_mul_f32 v119, v119, v37
  v_mul_f32 v120, v120, v37
  v_mul_f32 v121, v121, v37
  v_mul_f32 v122, v122, v37
  v_mul_f32 v123, v123, v37
  v_mul_f32 v124, v124, v37
  v_mul_f32 v125, v125, v37
  v_mul_f32 v126, v126, v37
  v_mul_f32 v127, v127, v37
  s_waitcnt lgkmcnt(0)
  s_branch L_back_28
L_rare_29:
  s_waitcnt lgkmcnt(0)
  v_mfma_f32_32x32x16_bf16 v[96:111], v[136:139], v[56:59], v[96:111]
  ds_read_b128 v[136:139], v242 offset:32768
  v_mfma_f32_32x32x16_bf16 v[112:127], v[140:143], v[56:59], v[112:127]
  ds_read_b128 v[140:143], v243 offset:32768
  v_mfma_f32_32x32x16_bf16 v[64:79], v[144:147], v[60:63], v[64:79]
  ds_read_b128 v[144:147], v244 offset:32768
  v_mfma_f32_32x32x16_bf16 v[80:95], v[148:151], v[60:63], v[80:95]
  ds_read_b128 v[148:151], v245 offset:32768
  v_mfma_f32_32x32x16_bf16 v[96:111], v[152:155], v[60:63], v[96:111]
  ds_read_b128 v[152:155], v246 offset:32768
  v_mfma_f32_32x32x16_bf16 v[112:127], v[156:159], v[60:63], v[112:127]
  ds_read_b128 v[156:159], v247 offset:32768
  v_mov_b32 v37, v36
  s_nop 1
  v_permlane32_swap_b32 v36, v37
  s_nop 1
  v_max3_f32 v36, v36, v37, 0
  v_sub_f32 v37, 0, v36
  v_exp_f32 v37, v37
  v_sub_f32 v224, v40, v36
  v_sub_f32 v160, v160, v36
  v_sub_f32 v225, v41, v36
  v_sub_f32 v161, v161, v36
  v_sub_f32 v226, v42, v36
  v_sub_f32 v162, v162, v36
  v_sub_f32 v227, v43, v36
  v_sub_f32 v163, v163, v36
  v_sub_f32 v228, v44, v36
  v_sub_f32 v164, v164, v36
  v_sub_f32 v229, v45, v36
  v_sub_f32 v165, v165, v36
  v_sub_f32 v230, v46, v36
  v_sub_f32 v166, v166, v36
  v_sub_f32 v231, v47, v36
  v_sub_f32 v167, v167, v36
  v_sub_f32 v232, v48, v36
  v_sub_f32 v168, v168, v36
  v_sub_f32 v233, v49, v36
  v_sub_f32 v169, v169, v36
  v_sub_f32 v234, v50, v36
  v_sub_f32 v170, v170, v36
  v_sub_f32 v235, v51, v36
  v_sub_f32 v171, v171, v36
  v_sub_f32 v236, v52, v36
  v_sub_f32 v172, v172, v36
  v_sub_f32 v237, v53, v36
  v_sub_f32 v173, v173, v36
  v_sub_f32 v238, v54, v36
  v_sub_f32 v174, v174, v36
  v_sub_f32 v239, v55, v36
  v_sub_f32 v175, v175, v36
  v_exp_f32 v224, v224
  v_exp_f32 v225, v225
  v_exp_f32 v226, v226
  v_exp_f32 v227, v227
  v_exp_f32 v228, v228
  v_exp_f32 v229, v229
  v_exp_f32 v230, v230
  v_exp_f32 v231, v231
  v_exp_f32 v232, v232
  v_exp_f32 v233, v233
  v_exp_f32 v234, v234
  v_exp_f32 v235, v235
  v_exp_f32 v236, v236
  v_exp_f32 v237, v237
  v_exp_f32 v238, v238
  v_exp_f32 v239, v239
  v_mul_f32 v252, v252, v37
  v_mul_f32 v64, v64, v37
  v_mul_f32 v65, v65, v37
  v_mul_f32 v66, v66, v37
  v_mul_f32 v67, v67, v37
  v_mul_f32 v68, v68, v37
  v_mul_f32 v69, v69, v37
  v_mul_f32 v70, v70, v37
  v_mul_f32 v71, v71, v37
  v_mul_f32 v72, v72, v37
  v_mul_f32 v73, v73, v37
  v_mul_f32 v74, v74, v37
  v_mul_f32 v75, v75, v37
  v_mul_f32 v76, v76, v37
  v_mul_f32 v77, v77, v37
  v_mul_f32 v78, v78, v37
  v_mul_f32 v79, v79, v37
  v_mul_f32 v80, v80, v37
  v_mul_f32 v81, v81, v37
  v_mul_f32 v82, v82, v37
  v_mul_f32 v83, v83, v37
  v_mul_f32 v84, v84, v37
  v_mul_f32 v85, v85, v37
  v_mul_f32 v86, v86, v37
  v_mul_f32 v87, v87, v37
  v_mul_f32 v88, v88, v37
  v_mul_f32 v89, v89, v37
  v_mul_f32 v90, v90, v37
  v_mul_f32 v91, v91, v37
  v_mul_f32 v92, v92, v37
  v_mul_f32 v93, v93, v37
  v_mul_f32 v94, v94, v37
  v_mul_f32 v95, v95, v37
  v_mul_f32 v96, v96, v37
  v_mul_f32 v97, v97, v37
  v_mul_f32 v98, v98, v37
  v_mul_f32 v99, v99, v37
  v_mul_f32 v100, v100, v37
  v_mul_f32 v101, v101, v37
  v_mul_f32 v102, v102, v37
  v_mul_f32 v103, v103, v37
  v_mul_f32 v104, v104, v37
  v_mul_f32 v105, v105, v37
  v_mul_f32 v106, v106, v37
  v_mul_f32 v107, v107, v37
  v_mul_f32 v108, v108, v37
  v_mul_f32 v109, v109, v37
  v_mul_f32 v110, v110, v37
  v_mul_f32 v111, v111, v37
  v_mul_f32 v112, v112, v37
  v_mul_f32 v113, v113, v37
  v_mul_f32 v114, v114, v37
  v_mul_f32 v115, v115, v37
  v_mul_f32 v116, v116, v37
  v_mul_f32 v117, v117, v37
  v_mul_f32 v118, v118, v37
  v_mul_f32 v119, v119, v37
  v_mul_f32 v120, v120, v37
  v_mul_f32 v121, v121, v37
  v_mul_f32 v122, v122, v37
  v_mul_f32 v123, v123, v37
  v_mul_f32 v124, v124, v37
  v_mul_f32 v125, v125, v37
  v_mul_f32 v126, v126, v37
  v_mul_f32 v127, v127, v37
  s_waitcnt lgkmcnt(0)
  s_branch L_back_30
L_rare_31:
  s_waitcnt lgkmcnt(0)
  v_mfma_f32_32x32x16_bf16 v[96:111], v[136:139], v[56:59], v[96:111]
  ds_read_b128 v[136:139], v242 offset:0
  v_mfma_f32_32x32x16_bf16 v[112:127], v[140:143], v[56:59], v[112:127]
  ds_read_b128 v[140:143], v243 offset:0
  v_mfma_f32_32x32x16_bf16 v[64:79], v[144:147], v[60:63], v[64:79]
  ds_read_b128 v[144:147], v244 offset:0
  v_mfma_f32_32x32x16_bf16 v[80:95], v[148:151], v[60:63], v[80:95]
  ds_read_b128 v[148:151], v245 offset:0
  v_mfma_f32_32x32x16_bf16 v[96:111], v[152:155], v[60:63], v[96:111]
  ds_read_b128 v[152:155], v246 offset:0
  v_mfma_f32_32x32x16_bf16 v[112:127], v[156:159], v[60:63], v[112:127]
  ds_read_b128 v[156:159], v247 offset:0
  v_mov_b32 v37, v36
  s_nop 1
  v_permlane32_swap_b32 v36, v37
  s_nop 1
  v_max3_f32 v36, v36, v37, 0
  v_sub_f32 v37, 0, v36
  v_exp_f32 v37, v37
  v_sub_f32 v224, v40, v36
  v_sub_f32 v160, v160, v36
  v_sub_f32 v225, v41, v36
  v_sub_f32 v161, v161, v36
  v_sub_f32 v226, v42, v36
  v_sub_f32 v162, v162, v36
  v_sub_f32 v227, v43, v36
  v_sub_f32 v163, v163, v36
  v_sub_f32 v228, v44, v36
  v_sub_f32 v164, v164, v36
  v_sub_f32 v229, v45, v36
  v_sub_f32 v165, v165, v36
  v_sub_f32 v230, v46, v36
  v_sub_f32 v166, v166, v36
  v_sub_f32 v231, v47, v36
  v_sub_f32 v167, v167, v36
  v_sub_f32 v232, v48, v36
  v_sub_f32 v168, v168, v36
  v_sub_f32 v233, v49, v36
  v_sub_f32 v169, v169, v36
  v_sub_f32 v234, v50, v36
  v_sub_f32 v170, v170, v36
  v_sub_f32 v235, v51, v36
  v_sub_f32 v171, v171, v36
  v_sub_f32 v236, v52, v36
  v_sub_f32 v172, v172, v36
  v_sub_f32 v237, v53, v36
  v_sub_f32 v173, v173, v36
  v_sub_f32 v238, v54, v36
  v_sub_f32 v174, v174, v36
  v_sub_f32 v239, v55, v36
  v_sub_f32 v175, v175, v36
  v_exp_f32 v224, v224
  v_exp_f32 v225, v225
  v_exp_f32 v226, v226
  v_exp_f32 v227, v227
  v_exp_f32 v228, v228
  v_exp_f32 v229, v229
  v_exp_f32 v230, v230
  v_exp_f32 v231, v231
  v_exp_f32 v232, v232
  v_exp_f32 v233, v233
  v_exp_f32 v234, v234
  v_exp_f32 v235, v235
  v_exp_f32 v236, v236
  v_exp_f32 v237, v237
  v_exp_f32 v238, v238
  v_exp_f32 v239, v239
  v_mul_f32 v252, v252, v37
  v_mul_f32 v64, v64, v37
  v_mul_f32 v65, v65, v37
  v_mul_f32 v66, v66, v37
  v_mul_f32 v67, v67, v37
  v_mul_f32 v68, v68, v37
  v_mul_f32 v69, v69, v37
  v_mul_f32 v70, v70, v37
  v_mul_f32 v71, v71, v37
  v_mul_f32 v72, v72, v37
  v_mul_f32 v73, v73, v37
  v_mul_f32 v74, v74, v37
  v_mul_f32 v75, v75, v37
  v_mul_f32 v76, v76, v37
  v_mul_f32 v77, v77, v37
  v_mul_f32 v78, v78, v37
  v_mul_f32 v79, v79, v37
  v_mul_f32 v80, v80, v37
  v_mul_f32 v81, v81, v37
  v_mul_f32 v82, v82, v37
  v_mul_f32 v83, v83, v37
  v_mul_f32 v84, v84, v37
  v_mul_f32 v85, v85, v37
  v_mul_f32 v86, v86, v37
  v_mul_f32 v87, v87, v37
  v_mul_f32 v88, v88, v37
  v_mul_f32 v89, v89, v37
  v_mul_f32 v90, v90, v37
  v_mul_f32 v91, v91, v37
  v_mul_f32 v92, v92, v37
  v_mul_f32 v93, v93, v37
  v_mul_f32 v94, v94, v37
  v_mul_f32 v95, v95, v37
  v_mul_f32 v96, v96, v37
  v_mul_f32 v97, v97, v37
  v_mul_f32 v98, v98, v37
  v_mul_f32 v99, v99, v37
  v_mul_f32 v100, v100, v37
  v_mul_f32 v101, v101, v37
  v_mul_f32 v102, v102, v37
  v_mul_f32 v103, v103, v37
  v_mul_f32 v104, v104, v37
  v_mul_f32 v105, v105, v37
  v_mul_f32 v106, v106, v37
  v_mul_f32 v107, v107, v37
  v_mul_f32 v108, v108, v37
  v_mul_f32 v109, v109, v37
  v_mul_f32 v110, v110, v37
  v_mul_f32 v111, v111, v37
  v_mul_f32 v112, v112, v37
  v_mul_f32 v113, v113, v37
  v_mul_f32 v114, v114, v37
  v_mul_f32 v115, v115, v37
  v_mul_f32 v116, v116, v37
  v_mul_f32 v117, v117, v37
  v_mul_f32 v118, v118, v37
  v_mul_f32 v119, v119, v37
  v_mul_f32 v120, v120, v37
  v_mul_f32 v121, v121, v37
  v_mul_f32 v122, v122, v37
  v_mul_f32 v123, v123, v37
  v_mul_f32 v124, v124, v37
  v_mul_f32 v125, v125, v37
  v_mul_f32 v126, v126, v37
  v_mul_f32 v127, v127, v37
  s_waitcnt lgkmcnt(0)
  s_branch L_back_32
L_rare_34:
  s_waitcnt lgkmcnt(0)
  v_mfma_f32_32x32x16_bf16 v[96:111], v[136:139], v[56:59], v[96:111]
  ds_read_b64_tr_b16 v[136:137], v250 offset:24576
  ds_read_b64_tr_b16 v[138:139], v250 offset:26624
  v_mfma_f32_32x32x16_bf16 v[112:127], v[140:143], v[56:59], v[112:127]
  ds_read_b64_tr_b16 v[140:141], v251 offset:24576
  ds_read_b64_tr_b16 v[142:143], v251 offset:26624
  v_mfma_f32_32x32x16_bf16 v[64:79], v[144:147], v[60:63], v[64:79]
  ds_read_b64_tr_b16 v[144:145], v248 offset:28672
  ds_read_b64_tr_b16 v[146:147], v248 offset:30720
  v_mfma_f32_32x32x16_bf16 v[80:95], v[148:151], v[60:63], v[80:95]
  ds_read_b64_tr_b16 v[148:149], v249 offset:28672
  ds_read_b64_tr_b16 v[150:151], v249 offset:30720
  v_mfma_f32_32x32x16_bf16 v[96:111], v[152:155], v[60:63], v[96:111]
  ds_read_b64_tr_b16 v[152:153], v250 offset:28672
  ds_read_b64_tr_b16 v[154:155], v250 offset:30720
  v_mfma_f32_32x32x16_bf16 v[112:127], v[156:159], v[60:63], v[112:127]
  ds_read_b64_tr_b16 v[156:157], v251 offset:28672
  ds_read_b64_tr_b16 v[158:159], v251 offset:30720
  v_mov_b32 v37, v36
  s_nop 1
  v_permlane32_swap_b32 v36, v37
  s_nop 1
  v_max3_f32 v36, v36, v37, 0
  v_sub_f32 v37, 0, v36
  v_exp_f32 v37, v37
  v_sub_f32 v224, v40, v36
  v_sub_f32 v160, v160, v36
  v_sub_f32 v225, v41, v36
  v_sub_f32 v161, v161, v36
  v_sub_f32 v226, v42, v36
  v_sub_f32 v162, v162, v36
  v_sub_f32 v227, v43, v36
  v_sub_f32 v163, v163, v36
  v_sub_f32 v228, v44, v36
  v_sub_f32 v164, v164, v36
  v_sub_f32 v229, v45, v36
  v_sub_f32 v165, v165, v36
  v_sub_f32 v230, v46, v36
  v_sub_f32 v166, v166, v36
  v_sub_f32 v231, v47, v36
  v_sub_f32 v167, v167, v36
  v_sub_f32 v232, v48, v36
  v_sub_f32 v168, v168, v36
  v_sub_f32 v233, v49, v36
  v_sub_f32 v169, v169, v36
  v_sub_f32 v234, v50, v36
  v_sub_f32 v170, v170, v36
  v_sub_f32 v235, v51, v36
  v_sub_f32 v171, v171, v36
  v_sub_f32 v236, v52, v36
  v_sub_f32 v172, v172, v36
  v_sub_f32 v237, v53, v36
  v_sub_f32 v173, v173, v36
  v_sub_f32 v238, v54, v36
  v_sub_f32 v174, v174, v36
  v_sub_f32 v239, v55, v36
  v_sub_f32 v175, v175, v36
  v_exp_f32 v224, v224
  v_exp_f32 v225, v225
  v_exp_f32 v226, v226
  v_exp_f32 v227, v227
  v_exp_f32 v228, v228
  v_exp_f32 v229, v229
  v_exp_f32 v230, v230
  v_exp_f32 v231, v231
  v_exp_f32 v232, v232
  v_exp_f32 v233, v233
  v_exp_f32 v234, v234
  v_exp_f32 v235, v235
  v_exp_f32 v236, v236
  v_exp_f32 v237, v237
  v_exp_f32 v238, v238
  v_exp_f32 v239, v239
  v_mul_f32 v252, v252, v37
  v_mul_f32 v64, v64, v37
  v_mul_f32 v65, v65, v37
  v_mul_f32 v66, v66, v37
  v_mul_f32 v67, v67, v37
  v_mul_f32 v68, v68, v37
  v_mul_f32 v69, v69, v37
  v_mul_f32 v70, v70, v37
  v_mul_f32 v71, v71, v37
  v_mul_f32 v72, v72, v37
  v_mul_f32 v73, v73, v37
  v_mul_f32 v74, v74, v37
  v_mul_f32 v75, v75, v37
  v_mul_f32 v76, v76, v37
  v_mul_f32 v77, v77, v37
  v_mul_f32 v78, v78, v37
  v_mul_f32 v79, v79, v37
  v_mul_f32 v80, v80, v37
  v_mul_f32 v81, v81, v37
  v_mul_f32 v82, v82, v37
  v_mul_f32 v83, v83, v37
  v_mul_f32 v84, v84, v37
  v_mul_f32 v85, v85, v37
  v_mul_f32 v86, v86, v37
  v_mul_f32 v87, v87, v37
  v_mul_f32 v88, v88, v37
  v_mul_f32 v89, v89, v37
  v_mul_f32 v90, v90, v37
  v_mul_f32 v91, v91, v37
  v_mul_f32 v92, v92, v37
  v_mul_f32 v93, v93, v37
  v_mul_f32 v94, v94, v37
  v_mul_f32 v95, v95, v37
  v_mul_f32 v96, v96, v37
  v_mul_f32 v97, v97, v37
  v_mul_f32 v98, v98, v37
  v_mul_f32 v99, v99, v37
  v_mul_f32 v100, v100, v37
  v_mul_f32 v101, v101, v37
  v_mul_f32 v102, v102, v37
  v_mul_f32 v103, v103, v37
  v_mul_f32 v104, v104, v37
  v_mul_f32 v105, v105, v37
  v_mul_f32 v106, v106, v37
  v_mul_f32 v107, v107, v37
  v_mul_f32 v108, v108, v37
  v_mul_f32 v109, v109, v37
  v_mul_f32 v110, v110, v37
  v_mul_f32 v111, v111, v37
  v_mul_f32 v112, v112, v37
  v_mul_f32 v113, v113, v37
  v_mul_f32 v114, v114, v37
  v_mul_f32 v115, v115, v37
  v_mul_f32 v116, v116, v37
  v_mul_f32 v117, v117, v37
  v_mul_f32 v118, v118, v37
  v_mul_f32 v119, v119, v37
  v_mul_f32 v120, v120, v37
  v_mul_f32 v121, v121, v37
  v_mul_f32 v122, v122, v37
  v_mul_f32 v123, v123, v37
  v_mul_f32 v124, v124, v37
  v_mul_f32 v125, v125, v37
  v_mul_f32 v126, v126, v37
  v_mul_f32 v127, v127, v37
  s_waitcnt lgkmcnt(0)
  s_branch L_back_35
L_A:
  s_cmp_ge_u32 s3, 4
  s_cbranch_scc1 L_AG1
L_AG0:
  s_lshl_b32 s43, s6, 3
  s_add_u32 s43, s43, s4
  s_lshl_b32 s43, s43, 19
  s_bitcmp1_b32 s3, 0
  s_cselect_b32 s60, s76, s74
  s_cselect_b32 s61, s77, s75
  s_add_u32 s60, s60, s43
  s_addc_u32 s61, s61, 0
  s_and_b32 s61, s61, 0xffff
  s_mov_b32 s62, 0x80000
  s_mov_b32 s63, 0x20000
  v_lshlrev_b32 v29, 3, v18
  s_add_u32 s43, s42, 24576
  s_and_b32 s43, s43, 0x1ffff
  s_add_u32 s43, s43, s37
  buffer_load_dword v12, v29, s[60:63], s43 offen
  s_add_u32 s43, s42, 40960
  s_and_b32 s43, s43, 0x1ffff
  s_add_u32 s43, s43, s37
  buffer_load_dword v12, v29, s[60:63], s43 offen
  v_lshrrev_b32 v2, 5, v1
  v_and_b32 v3, 31, v1
  s_and_b32 s44, s3, 1
  s_lshl_b32 s44, s44, 3
  v_or_b32 v28, s44, v2
  v_xor_b32 v28, v28, v3
  v_lshlrev_b32 v29, 10, v2
  s_lshl_b32 s44, s49, 2
  v_xor_b32 v20, 0, v28
  v_add_u32 v20, s44, v20
  v_and_b32 v20, 63, v20
  v_lshl_add_u32 v20, v20, 4, v29
  v_xor_b32 v21, 2, v28
  v_add_u32 v21, s44, v21
  v_and_b32 v21, 63, v21
  v_lshl_add_u32 v21, v21, 4, v29
  v_add_u32 v21, 1024, v21
  v_xor_b32 v22, 4, v28
  v_add_u32 v22, s44, v22
  v_and_b32 v22, 63, v22
  v_lshl_add_u32 v22, v22, 4, v29
  v_add_u32 v22, 2048, v22
  v_xor_b32 v23, 6, v28
  v_add_u32 v23, s44, v23
  v_and_b32 v23, 63, v23
  v_lshl_add_u32 v23, v23, 4, v29
  v_add_u32 v23, 3072, v23
  s_lshl_b32 s43, s3, 12
  s_add_u32 m0, s43, 0
  s_lshl_b32 s43, s3, 13
  buffer_load_dwordx4 v20, s[20:23], s43 offen lds
  buffer_load_dwordx4 v21, s[20:23], s43 offen offset:1024 lds
  buffer_load_dwordx4 v22, s[20:23], s43 offen offset:2048 lds
  buffer_load_dwordx4 v23, s[20:23], s43 offen offset:3072 lds
  v_lshrrev_b32 v2, 5, v1
  v_and_b32 v3, 31, v1
  v_add_u32 v29, 0, v2
  v_lshlrev_b32 v29, 2, v29
  v_xor_b32 v29, v29, v3
  v_lshlrev_b32 v29, 4, v29
  v_lshl_add_u32 v29, v2, 13, v29
  v_add_u32 v8, 0, v29
  v_add_u32 v29, 2, v2
  v_lshlrev_b32 v29, 2, v29
  v_xor_b32 v29, v29, v3
  v_lshlrev_b32 v29, 4, v29
  v_lshl_add_u32 v29, v2, 13, v29
  v_add_u32 v9, 15360, v29
  v_add_u32 v29, 0, v2
  v_lshlrev_b32 v29, 2, v29
  v_xor_b32 v29, v29, v3
  v_lshlrev_b32 v29, 4, v29
  v_lshl_add_u32 v29, v2, 13, v29
  v_add_u32 v10, 30720, v29
  v_add_u32 v29, 2, v2
  v_lshlrev_b32 v29, 2, v29
  v_xor_b32 v29, v29, v3
  v_lshlrev_b32 v29, 4, v29
  v_lshl_add_u32 v29, v2, 13, v29
  v_add_u32 v11, 46080, v29
  s_add_u32 s43, s48, 0
  s_add_u32 m0, s33, 147456
  s_and_b32 s43, s43, 0x3fffff
  buffer_load_dwordx4 v8, s[12:15], s43 offen lds
  buffer_load_dwordx4 v9, s[12:15], s43 offen offset:1024 lds
  buffer_load_dwordx4 v10, s[12:15], s43 offen offset:2048 lds
  buffer_load_dwordx4 v11, s[12:15], s43 offen offset:3072 lds
  s_add_u32 s43, s48, 262144
  s_add_u32 m0, s33, 114688
  s_and_b32 s43, s43, 0x3fffff
  buffer_load_dwordx4 v8, s[12:15], s43 offen lds
  buffer_load_dwordx4 v9, s[12:15], s43 offen offset:1024 lds
  buffer_load_dwordx4 v10, s[12:15], s43 offen offset:2048 lds
  buffer_load_dwordx4 v11, s[12:15], s43 offen offset:3072 lds
  s_load_dwordx2 s[58:59], s[0:1], 80
  v_mov_b32 v2, 0
  s_mov_b64 exec, 1
  s_sub_u32 s43, s10, 4
  buffer_load_dword v12, v2, s[8:11], 0 offen
  buffer_load_dword v12, v2, s[8:11], s43 offen
  s_lshl_b32 s43, s45, 17
  buffer_load_dword v12, v2, s[24:27], s43 offen
  buffer_load_dword v12, v2, s[28:31], 0 offen sc1
  s_lshl_b32 s43, s6, 17
  v_mov_b32 v3, s43
  s_waitcnt lgkmcnt(0)
  global_load_dword v12, v3, s[58:59]
  s_mov_b64 exec, -1
  v_lshrrev_b32 v2, 4, v1
  v_and_b32 v3, 15, v1
  v_lshlrev_b32 v19, 2, v2
  s_bitcmp1_b32 s3, 0
  s_cselect_b64 vcc, -1, 0
  v_add_u32 v29, 0, v2
  v_cndmask_b32 v29, v29, v19, vcc
  v_xor_b32 v29, v29, v3
  v_lshlrev_b32 v29, 4, v29
  v_lshl_add_u32 v4, v2, 8, v29
  v_add_u32 v29, 4, v2
  v_cndmask_b32 v29, v29, v19, vcc
  v_xor_b32 v29, v29, v3
  v_lshlrev_b32 v29, 4, v29
  v_lshl_add_u32 v5, v2, 8, v29
  v_add_u32 v29, 8, v2
  v_cndmask_b32 v29, v29, v19, vcc
  v_xor_b32 v29, v29, v3
  v_lshlrev_b32 v29, 4, v29
  v_lshl_add_u32 v6, v2, 8, v29
  v_add_u32 v29, 12, v2
  v_cndmask_b32 v29, v29, v19, vcc
  v_xor_b32 v29, v29, v3
  v_lshlrev_b32 v29, 4, v29
  v_lshl_add_u32 v7, v2, 8, v29
  v_and_b32 v2, 31, v1
  v_lshrrev_b32 v3, 5, v1
  v_and_b32 v19, 15, v1
  v_xor_b32 v19, v19, v3
  v_lshlrev_b32 v19, 4, v19
  v_lshl_add_u32 v13, v2, 8, v19
  v_lshl_add_u32 v19, v2, 9, v19
  s_lshl_b32 s43, s47, 14
  v_add_u32 v16, s43, v19
  v_bfe_u32 v32, v1, 4, 1
  v_bfe_u32 v33, v1, 2, 2
  v_and_b32 v34, 1, v1
  v_bfe_u32 v35, v1, 1, 1
  v_lshlrev_b32 v36, 1, v34
  v_or_b32 v36, v36, v35
  v_lshl_add_u32 v36, v32, 2, v36
  v_lshlrev_b32 v36, 3, v36
  v_lshl_add_u32 v36, v33, 6, v36
  v_lshlrev_b32 v37, 2, v3
  v_add_u32 v37, v37, v33
  v_lshl_add_u32 v14, v37, 8, v36
  v_lshlrev_b32 v37, 3, v3
  v_add_u32 v37, v37, v33
  v_lshl_add_u32 v38, v37, 9, v36
  s_lshl_b32 s43, s46, 8
  v_add_u32 v15, s43, v38
  v_lshlrev_b32 v36, 2, v34
  v_lshl_add_u32 v36, v32, 1, v36
  v_add_u32 v36, v36, v35
  v_lshlrev_b32 v36, 3, v36
  v_lshl_add_u32 v36, v33, 6, v36
  v_lshl_add_u32 v38, v37, 10, v36
  s_lshl_b32 s43, s46, 9
  v_add_u32 v17, s43, v38
  s_waitcnt vmcnt(9) lgkmcnt(0)
  s_barrier
  v_xor_b32 v2, 32, v16
  v_xor_b32 v3, 64, v16
  v_xor_b32 v24, 96, v16
  v_xor_b32 v25, 128, v16
  v_xor_b32 v26, 160, v16
  v_xor_b32 v27, 192, v16
  v_xor_b32 v28, 224, v16
  ds_read_b128 v[128:131], v16 offset:0
  ds_read_b128 v[132:135], v2 offset:0
  ds_read_b128 v[136:139], v3 offset:0
  ds_read_b128 v[140:143], v24 offset:0
  ds_read_b128 v[144:147], v25 offset:0
  ds_read_b128 v[148:151], v26 offset:0
  ds_read_b128 v[152:155], v27 offset:0
  ds_read_b128 v[156:159], v28 offset:0
  ds_read_b128 v[160:163], v16 offset:256
  ds_read_b128 v[164:167], v2 offset:256
  ds_read_b128 v[168:171], v3 offset:256
  ds_read_b128 v[172:175], v24 offset:256
  ds_read_b128 v[176:179], v25 offset:256
  ds_read_b128 v[180:183], v26 offset:256
  ds_read_b128 v[184:187], v27 offset:256
  s_waitcnt lgkmcnt(14)
  ds_read_b128 v[188:191], v28 offset:256
  s_add_u32 s43, s48, 524288
  s_add_u32 m0, s33, 32768
  s_and_b32 s43, s43, 0x3fffff
  buffer_load_dwordx4 v8, s[12:15], s43 offen lds
  buffer_load_dwordx4 v9, s[12:15], s43 offen offset:1024 lds
  buffer_load_dwordx4 v10, s[12:15], s43 offen offset:2048 lds
  buffer_load_dwordx4 v11, s[12:15], s43 offen offset:3072 lds
  v_xor_b32 v20, 0x200, v20
  v_xor_b32 v21, 0x200, v21
  v_xor_b32 v22, 0x200, v22
  v_xor_b32 v23, 0x200, v23
  s_lshl_b32 s43, s3, 12
  s_add_u32 m0, s43, 49152
  s_lshl_b32 s43, s3, 13
  buffer_load_dwordx4 v20, s[20:23], s43 offen lds
  buffer_load_dwordx4 v21, s[20:23], s43 offen offset:1024 lds
  buffer_load_dwordx4 v22, s[20:23], s43 offen offset:2048 lds
  buffer_load_dwordx4 v23, s[20:23], s43 offen offset:3072 lds
  v_add_u32 v20, 147456, v15
  v_xor_b32 v21, 64, v20
  v_xor_b32 v22, 128, v20
  v_xor_b32 v23, 192, v20
  s_waitcnt lgkmcnt(14)
  ds_read_b64_tr_b16 v[32:33], v20 offset:0
  s_waitcnt lgkmcnt(14)
  ds_read_b64_tr_b16 v[34:35], v20 offset:2048
  s_waitcnt lgkmcnt(14)
  ds_read_b64_tr_b16 v[36:37], v21 offset:0
  s_waitcnt lgkmcnt(14)
  ds_read_b64_tr_b16 v[38:39], v21 offset:2048
  s_waitcnt lgkmcnt(14)
  ds_read_b64_tr_b16 v[40:41], v22 offset:0
  s_waitcnt lgkmcnt(14)
  ds_read_b64_tr_b16 v[42:43], v22 offset:2048
  s_waitcnt lgkmcnt(14)
  ds_read_b64_tr_b16 v[44:45], v23 offset:0
  s_waitcnt lgkmcnt(14)
  ds_read_b64_tr_b16 v[46:47], v23 offset:2048
  s_waitcnt lgkmcnt(14)
  ds_read_b64_tr_b16 v[48:49], v20 offset:8192
  s_waitcnt lgkmcnt(14)
  ds_read_b64_tr_b16 v[50:51], v20 offset:10240
  s_waitcnt lgkmcnt(14)
  ds_read_b64_tr_b16 v[52:53], v21 offset:8192
  s_waitcnt lgkmcnt(14)
  ds_read_b64_tr_b16 v[54:55], v21 offset:10240
  s_waitcnt lgkmcnt(14)
  ds_read_b64_tr_b16 v[56:57], v22 offset:8192
  s_waitcnt lgkmcnt(14)
  ds_read_b64_tr_b16 v[58:59], v22 offset:10240
  s_waitcnt lgkmcnt(14)
  ds_read_b64_tr_b16 v[60:61], v23 offset:8192
  s_waitcnt lgkmcnt(14)
  ds_read_b64_tr_b16 v[62:63], v23 offset:10240
  s_waitcnt vmcnt(13) lgkmcnt(0)
  s_barrier
  s_lshl_b32 s40, s46, 12
  s_lshl_b32 s38, s47, 13
  s_add_u32 s38, s38, s40
  s_add_u32 s51, s38, 98304
  s_add_u32 s40, s40, s42
  s_add_u32 s40, s40, 122880
  v_add_u32 v20, 114688, v15
  v_xor_b32 v21, 64, v20
  v_xor_b32 v22, 128, v20
  v_xor_b32 v23, 192, v20
  v_mfma_f32_32x32x16_bf16 v[64:79], v[32:35], v[128:131], 0
  ds_read_b64_tr_b16 v[32:33], v20 offset:0
  ds_read_b64_tr_b16 v[34:35], v20 offset:2048
  s_add_u32 s43, s48, 786432
  s_add_u32 m0, s33, 0
  s_and_b32 s43, s43, 0x3fffff
  buffer_load_dwordx4 v8, s[12:15], s43 offen lds
  v_mfma_f32_32x32x16_bf16 v[80:95], v[36:39], v[128:131], 0
  ds_read_b64_tr_b16 v[36:37], v21 offset:0
  ds_read_b64_tr_b16 v[38:39], v21 offset:2048
  buffer_load_dwordx4 v9, s[12:15], s43 offen offset:1024 lds
  v_mfma_f32_32x32x16_bf16 v[96:111], v[40:43], v[128:131], 0
  ds_read_b64_tr_b16 v[40:41], v22 offset:0
  ds_read_b64_tr_b16 v[42:43], v22 offset:2048
  buffer_load_dwordx4 v10, s[12:15], s43 offen offset:2048 lds
  v_mfma_f32_32x32x16_bf16 v[112:127], v[44:47], v[128:131], 0
  ds_read_b64_tr_b16 v[44:45], v23 offset:0
  ds_read_b64_tr_b16 v[46:47], v23 offset:2048
  buffer_load_dwordx4 v11, s[12:15], s43 offen offset:3072 lds
  v_mfma_f32_32x32x16_bf16 v[64:79], v[48:51], v[132:135], v[64:79]
  ds_read_b64_tr_b16 v[48:49], v20 offset:8192
  ds_read_b64_tr_b16 v[50:51], v20 offset:10240
  v_mfma_f32_32x32x16_bf16 v[80:95], v[52:55], v[132:135], v[80:95]
  ds_read_b64_tr_b16 v[52:53], v21 offset:8192
  ds_read_b64_tr_b16 v[54:55], v21 offset:10240
  v_mfma_f32_32x32x16_bf16 v[96:111], v[56:59], v[132:135], v[96:111]
  ds_read_b64_tr_b16 v[56:57], v22 offset:8192
  ds_read_b64_tr_b16 v[58:59], v22 offset:10240
  v_mfma_f32_32x32x16_bf16 v[112:127], v[60:63], v[132:135], v[112:127]
  ds_read_b64_tr_b16 v[60:61], v23 offset:8192
  s_waitcnt lgkmcnt(14)
  ds_read_b64_tr_b16 v[62:63], v23 offset:10240
  s_waitcnt vmcnt(8)
  s_barrier
  v_add_u32 v20, 32768, v15
  v_xor_b32 v21, 64, v20
  v_xor_b32 v22, 128, v20
  v_xor_b32 v23, 192, v20
  s_waitcnt lgkmcnt(14)
  v_mfma_f32_32x32x16_bf16 v[64:79], v[32:35], v[136:139], v[64:79]
  ds_read_b64_tr_b16 v[32:33], v20 offset:0
  s_waitcnt lgkmcnt(14)
  ds_read_b64_tr_b16 v[34:35], v20 offset:2048
  s_add_u32 s43, s48, 1048576
  s_add_u32 m0, s33, 147456
  s_and_b32 s43, s43, 0x3fffff
  buffer_load_dwordx4 v8, s[12:15], s43 offen lds
  s_waitcnt lgkmcnt(14)
  v_mfma_f32_32x32x16_bf16 v[80:95], v[36:39], v[136:139], v[80:95]
  ds_read_b64_tr_b16 v[36:37], v21 offset:0
  s_waitcnt lgkmcnt(14)
  ds_read_b64_tr_b16 v[38:39], v21 offset:2048
  buffer_load_dwordx4 v9, s[12:15], s43 offen offset:1024 lds
  s_waitcnt lgkmcnt(14)
  v_mfma_f32_32x32x16_bf16 v[96:111], v[40:43], v[136:139], v[96:111]
  ds_read_b64_tr_b16 v[40:41], v22 offset:0
  s_waitcnt lgkmcnt(14)
  ds_read_b64_tr_b16 v[42:43], v22 offset:2048
  buffer_load_dwordx4 v10, s[12:15], s43 offen offset:2048 lds
  s_waitcnt lgkmcnt(14)
  v_mfma_f32_32x32x16_bf16 v[112:127], v[44:47], v[136:139], v[112:127]
  ds_read_b64_tr_b16 v[44:45], v23 offset:0
  s_waitcnt lgkmcnt(14)
  ds_read_b64_tr_b16 v[46:47], v23 offset:2048
  buffer_load_dwordx4 v11, s[12:15], s43 offen offset:3072 lds
  s_waitcnt lgkmcnt(14)
  v_mfma_f32_32x32x16_bf16 v[64:79], v[48:51], v[140:143], v[64:79]
  ds_read_b64_tr_b16 v[48:49], v20 offset:8192
  s_waitcnt lgkmcnt(14)
  ds_read_b64_tr_b16 v[50:51], v20 offset:10240
  s_waitcnt lgkmcnt(14)
  v_mfma_f32_32x32x16_bf16 v[80:95], v[52:55], v[140:143], v[80:95]
  ds_read_b64_tr_b16 v[52:53], v21 offset:8192
  s_waitcnt lgkmcnt(14)
  ds_read_b64_tr_b16 v[54:55], v21 offset:10240
  s_waitcnt lgkmcnt(14)
  v_mfma_f32_32x32x16_bf16 v[96:111], v[56:59], v[140:143], v[96:111]
  ds_read_b64_tr_b16 v[56:57], v22 offset:8192
  s_waitcnt lgkmcnt(14)
  ds_read_b64_tr_b16 v[58:59], v22 offset:10240
  s_waitcnt lgkmcnt(14)
  v_mfma_f32_32x32x16_bf16 v[112:127], v[60:63], v[140:143], v[112:127]
  ds_read_b64_tr_b16 v[60:61], v23 offset:8192
  s_waitcnt lgkmcnt(14)
  ds_read_b64_tr_b16 v[62:63], v23 offset:10240
  s_waitcnt vmcnt(4)
  s_barrier
  v_add_u32 v20, 0, v15
  v_xor_b32 v21, 64, v20
  v_xor_b32 v22, 128, v20
  v_xor_b32 v23, 192, v20
  s_waitcnt lgkmcnt(14)
  v_mfma_f32_32x32x16_bf16 v[64:79], v[32:35], v[144:147], v[64:79]
  ds_read_b64_tr_b16 v[32:33], v20 offset:0
  s_waitcnt lgkmcnt(14)
  ds_read_b64_tr_b16 v[34:35], v20 offset:2048
  s_add_u32 s43, s48, 1310720
  s_add_u32 m0, s33, 114688
  s_and_b32 s43, s43, 0x3fffff
  buffer_load_dwordx4 v8, s[12:15], s43 offen lds
  s_waitcnt lgkmcnt(14)
  v_mfma_f32_32x32x16_bf16 v[80:95], v[36:39], v[144:147], v[80:95]
  ds_read_b64_tr_b16 v[36:37], v21 offset:0
  s_waitcnt lgkmcnt(14)
  ds_read_b64_tr_b16 v[38:39], v21 offset:2048
  buffer_load_dwordx4 v9, s[12:15], s43 offen offset:1024 lds
  s_waitcnt lgkmcnt(14)
  v_mfma_f32_32x32x16_bf16 v[96:111], v[40:43], v[144:147], v[96:111]
  ds_read_b64_tr_b16 v[40:41], v22 offset:0
  s_waitcnt lgkmcnt(14)
  ds_read_b64_tr_b16 v[42:43], v22 offset:2048
  buffer_load_dwordx4 v10, s[12:15], s43 offen offset:2048 lds
  s_waitcnt lgkmcnt(14)
  v_mfma_f32_32x32x16_bf16 v[112:127], v[44:47], v[144:147], v[112:127]
  ds_read_b64_tr_b16 v[44:45], v23 offset:0
  s_waitcnt lgkmcnt(14)
  ds_read_b64_tr_b16 v[46:47], v23 offset:2048
  buffer_load_dwordx4 v11, s[12:15], s43 offen offset:3072 lds
  s_waitcnt lgkmcnt(14)
  v_mfma_f32_32x32x16_bf16 v[64:79], v[48:51], v[148:151], v[64:79]
  ds_read_b64_tr_b16 v[48:49], v20 offset:8192
  s_waitcnt lgkmcnt(14)
  ds_read_b64_tr_b16 v[50:51], v20 offset:10240
  s_waitcnt lgkmcnt(14)
  v_mfma_f32_32x32x16_bf16 v[80:95], v[52:55], v[148:151], v[80:95]
  ds_read_b64_tr_b16 v[52:53], v21 offset:8192
  s_waitcnt lgkmcnt(14)
  ds_read_b64_tr_b16 v[54:55], v21 offset:10240
  s_waitcnt lgkmcnt(14)
  v_mfma_f32_32x32x16_bf16 v[96:111], v[56:59], v[148:151], v[96:111]
  ds_read_b64_tr_b16 v[56:57], v22 offset:8192
  s_waitcnt lgkmcnt(14)
  ds_read_b64_tr_b16 v[58:59], v22 offset:10240
  s_waitcnt lgkmcnt(14)
  v_mfma_f32_32x32x16_bf16 v[112:127], v[60:63], v[148:151], v[112:127]
  ds_read_b64_tr_b16 v[60:61], v23 offset:8192
  s_waitcnt lgkmcnt(14)
  ds_read_b64_tr_b16 v[62:63], v23 offset:10240
  s_waitcnt vmcnt(4)
  s_barrier
  v_xor_b32 v2, 32, v16
  v_xor_b32 v3, 64, v16
  v_xor_b32 v24, 96, v16
  v_xor_b32 v25, 128, v16
  v_xor_b32 v26, 160, v16
  v_xor_b32 v27, 192, v16
  v_xor_b32 v28, 224, v16
  s_waitcnt lgkmcnt(14)
  ds_read_b128 v[192:195], v16 offset:49152
  s_waitcnt lgkmcnt(14)
  ds_read_b128 v[196:199], v2 offset:49152
  s_waitcnt lgkmcnt(14)
  ds_read_b128 v[200:203], v3 offset:49152
  s_waitcnt lgkmcnt(14)
  ds_read_b128 v[204:207], v24 offset:49152
  s_waitcnt lgkmcnt(14)
  ds_read_b128 v[208:211], v25 offset:49152
  s_waitcnt lgkmcnt(14)
  ds_read_b128 v[212:215], v26 offset:49152
  s_waitcnt lgkmcnt(14)
  ds_read_b128 v[216:219], v27 offset:49152
  s_waitcnt lgkmcnt(14)
  ds_read_b128 v[220:223], v28 offset:49152
  s_waitcnt lgkmcnt(14)
  ds_read_b128 v[224:227], v16 offset:49408
  s_waitcnt lgkmcnt(14)
  ds_read_b128 v[228:231], v2 offset:49408
  s_waitcnt lgkmcnt(14)
  ds_read_b128 v[232:235], v3 offset:49408
  s_waitcnt lgkmcnt(14)
  ds_read_b128 v[236:239], v24 offset:49408
  s_waitcnt lgkmcnt(14)
  ds_read_b128 v[240:243], v25 offset:49408
  s_waitcnt lgkmcnt(14)
  ds_read_b128 v[244:247], v26 offset:49408
  s_waitcnt lgkmcnt(14)
  ds_read_b128 v[248:251], v27 offset:49408
  s_waitcnt lgkmcnt(14)
  ds_read_b128 v[252:255], v28 offset:49408
  v_add_u32 v20, 147456, v15
  v_xor_b32 v21, 64, v20
  v_xor_b32 v22, 128, v20
  v_xor_b32 v23, 192, v20
  v_mfma_f32_32x32x16_bf16 v[64:79], v[32:35], v[152:155], v[64:79]
  s_waitcnt lgkmcnt(14)
  ds_read_b64_tr_b16 v[32:33], v20 offset:0
  s_waitcnt lgkmcnt(14)
  ds_read_b64_tr_b16 v[34:35], v20 offset:2048
  s_add_u32 s43, s48, 1572864
  s_add_u32 m0, s33, 32768
  s_and_b32 s43, s43, 0x3fffff
  buffer_load_dwordx4 v8, s[12:15], s43 offen lds
  v_mfma_f32_32x32x16_bf16 v[80:95], v[36:39], v[152:155], v[80:95]
  s_waitcnt lgkmcnt(14)
  ds_read_b64_tr_b16 v[36:37], v21 offset:0
  s_waitcnt lgkmcnt(14)
  ds_read_b64_tr_b16 v[38:39], v21 offset:2048
  buffer_load_dwordx4 v9, s[12:15], s43 offen offset:1024 lds
  v_mfma_f32_32x32x16_bf16 v[96:111], v[40:43], v[152:155], v[96:111]
  s_waitcnt lgkmcnt(14)
  ds_read_b64_tr_b16 v[40:41], v22 offset:0
  s_waitcnt lgkmcnt(14)
  ds_read_b64_tr_b16 v[42:43], v22 offset:2048
  buffer_load_dwordx4 v10, s[12:15], s43 offen offset:2048 lds
  v_mfma_f32_32x32x16_bf16 v[112:127], v[44:47], v[152:155], v[112:127]
  s_waitcnt lgkmcnt(14)
  ds_read_b64_tr_b16 v[44:45], v23 offset:0
  s_waitcnt lgkmcnt(14)
  ds_read_b64_tr_b16 v[46:47], v23 offset:2048
  buffer_load_dwordx4 v11, s[12:15], s43 offen offset:3072 lds
  v_mfma_f32_32x32x16_bf16 v[64:79], v[48:51], v[156:159], v[64:79]
  s_waitcnt lgkmcnt(14)
  ds_read_b64_tr_b16 v[48:49], v20 offset:8192
  s_waitcnt lgkmcnt(14)
  ds_read_b64_tr_b16 v[50:51], v20 offset:10240
  v_mfma_f32_32x32x16_bf16 v[80:95], v[52:55], v[156:159], v[80:95]
  s_waitcnt lgkmcnt(14)
  ds_read_b64_tr_b16 v[52:53], v21 offset:8192
  s_waitcnt lgkmcnt(14)
  ds_read_b64_tr_b16 v[54:55], v21 offset:10240
  v_mfma_f32_32x32x16_bf16 v[96:111], v[56:59], v[156:159], v[96:111]
  s_waitcnt lgkmcnt(14)
  ds_read_b64_tr_b16 v[56:57], v22 offset:8192
  s_waitcnt lgkmcnt(14)
  ds_read_b64_tr_b16 v[58:59], v22 offset:10240
  v_mfma_f32_32x32x16_bf16 v[112:127], v[60:63], v[156:159], v[112:127]
  s_waitcnt lgkmcnt(14)
  ds_read_b64_tr_b16 v[60:61], v23 offset:8192
  s_waitcnt lgkmcnt(14)
  ds_read_b64_tr_b16 v[62:63], v23 offset:10240
  s_waitcnt vmcnt(4)
  s_barrier
  v_add_u32 v20, 114688, v15
  v_xor_b32 v21, 64, v20
  v_xor_b32 v22, 128, v20
  v_xor_b32 v23, 192, v20
  s_waitcnt lgkmcnt(14)
  v_mfma_f32_32x32x16_bf16 v[64:79], v[32:35], v[160:163], v[64:79]
  ds_read_b64_tr_b16 v[32:33], v20 offset:0
  s_waitcnt lgkmcnt(14)
  ds_read_b64_tr_b16 v[34:35], v20 offset:2048
  s_add_u32 s43, s48, 1835008
  s_add_u32 m0, s33, 49152
  s_and_b32 s43, s43, 0x3fffff
  buffer_load_dwordx4 v8, s[12:15], s43 offen lds
  s_waitcnt lgkmcnt(14)
  v_mfma_f32_32x32x16_bf16 v[80:95], v[36:39], v[160:163], v[80:95]
  ds_read_b64_tr_b16 v[36:37], v21 offset:0
  s_waitcnt lgkmcnt(14)
  ds_read_b64_tr_b16 v[38:39], v21 offset:2048
  buffer_load_dwordx4 v9, s[12:15], s43 offen offset:1024 lds
  s_waitcnt lgkmcnt(14)
  v_mfma_f32_32x32x16_bf16 v[96:111], v[40:43], v[160:163], v[96:111]
  ds_read_b64_tr_b16 v[40:41], v22 offset:0
  s_waitcnt lgkmcnt(14)
  ds_read_b64_tr_b16 v[42:43], v22 offset:2048
  buffer_load_dwordx4 v10, s[12:15], s43 offen offset:2048 lds
  s_waitcnt lgkmcnt(14)
  v_mfma_f32_32x32x16_bf16 v[112:127], v[44:47], v[160:163], v[112:127]
  ds_read_b64_tr_b16 v[44:45], v23 offset:0
  s_waitcnt lgkmcnt(14)
  ds_read_b64_tr_b16 v[46:47], v23 offset:2048
  buffer_load_dwordx4 v11, s[12:15], s43 offen offset:3072 lds
  s_waitcnt lgkmcnt(14)
  v_mfma_f32_32x32x16_bf16 v[64:79], v[48:51], v[164:167], v[64:79]
  ds_read_b64_tr_b16 v[48:49], v20 offset:8192
  s_waitcnt lgkmcnt(14)
  ds_read_b64_tr_b16 v[50:51], v20 offset:10240
  s_add_u32 s43, s48, 2097152
  s_add_u32 m0, s33, 0
  s_and_b32 s43, s43, 0x3fffff
  buffer_load_dwordx4 v8, s[12:15], s43 offen lds
  s_waitcnt lgkmcnt(14)
  v_mfma_f32_32x32x16_bf16 v[80:95], v[52:55], v[164:167], v[80:95]
  ds_read_b64_tr_b16 v[52:53], v21 offset:8192
  s_waitcnt lgkmcnt(14)
  ds_read_b64_tr_b16 v[54:55], v21 offset:10240
  buffer_load_dwordx4 v9, s[12:15], s43 offen offset:1024 lds
  s_waitcnt lgkmcnt(14)
  v_mfma_f32_32x32x16_bf16 v[96:111], v[56:59], v[164:167], v[96:111]
  ds_read_b64_tr_b16 v[56:57], v22 offset:8192
  s_waitcnt lgkmcnt(14)
  ds_read_b64_tr_b16 v[58:59], v22 offset:10240
  buffer_load_dwordx4 v10, s[12:15], s43 offen offset:2048 lds
  s_waitcnt lgkmcnt(14)
  v_mfma_f32_32x32x16_bf16 v[112:127], v[60:63], v[164:167], v[112:127]
  ds_read_b64_tr_b16 v[60:61], v23 offset:8192
  s_waitcnt lgkmcnt(14)
  ds_read_b64_tr_b16 v[62:63], v23 offset:10240
  buffer_load_dwordx4 v11, s[12:15], s43 offen offset:3072 lds
  s_waitcnt vmcnt(8)
  s_barrier
  v_add_u32 v20, 32768, v15
  v_xor_b32 v21, 64, v20
  v_xor_b32 v22, 128, v20
  v_xor_b32 v23, 192, v20
  s_waitcnt lgkmcnt(14)
  v_mfma_f32_32x32x16_bf16 v[64:79], v[32:35], v[168:171], v[64:79]
  ds_read_b64_tr_b16 v[32:33], v20 offset:0
  s_waitcnt lgkmcnt(14)
  ds_read_b64_tr_b16 v[34:35], v20 offset:2048
  s_add_u32 s43, s48, 2359296
  s_add_u32 m0, s33, 147456
  s_and_b32 s43, s43, 0x3fffff
  buffer_load_dwordx4 v8, s[12:15], s43 offen lds
  s_waitcnt lgkmcnt(14)
  v_mfma_f32_32x32x16_bf16 v[80:95], v[36:39], v[168:171], v[80:95]
  ds_read_b64_tr_b16 v[36:37], v21 offset:0
  s_waitcnt lgkmcnt(14)
  ds_read_b64_tr_b16 v[38:39], v21 offset:2048
  buffer_load_dwordx4 v9, s[12:15], s43 offen offset:1024 lds
  s_waitcnt lgkmcnt(14)
  v_mfma_f32_32x32x16_bf16 v[96:111], v[40:43], v[168:171], v[96:111]
  ds_read_b64_tr_b16 v[40:41], v22 offset:0
  s_waitcnt lgkmcnt(14)
  ds_read_b64_tr_b16 v[42:43], v22 offset:2048
  buffer_load_dwordx4 v10, s[12:15], s43 offen offset:2048 lds
  s_waitcnt lgkmcnt(14)
  v_mfma_f32_32x32x16_bf16 v[112:127], v[44:47], v[168:171], v[112:127]
  ds_read_b64_tr_b16 v[44:45], v23 offset:0
  s_waitcnt lgkmcnt(14)
  ds_read_b64_tr_b16 v[46:47], v23 offset:2048
  buffer_load_dwordx4 v11, s[12:15], s43 offen offset:3072 lds
  s_waitcnt lgkmcnt(14)
  v_mfma_f32_32x32x16_bf16 v[64:79], v[48:51], v[172:175], v[64:79]
  ds_read_b64_tr_b16 v[48:49], v20 offset:8192
  s_waitcnt lgkmcnt(14)
  ds_read_b64_tr_b16 v[50:51], v20 offset:10240
  s_waitcnt lgkmcnt(14)
  v_mfma_f32_32x32x16_bf16 v[80:95], v[52:55], v[172:175], v[80:95]
  ds_read_b64_tr_b16 v[52:53], v21 offset:8192
  s_waitcnt lgkmcnt(14)
  ds_read_b64_tr_b16 v[54:55], v21 offset:10240
  s_waitcnt lgkmcnt(14)
  v_mfma_f32_32x32x16_bf16 v[96:111], v[56:59], v[172:175], v[96:111]
  ds_read_b64_tr_b16 v[56:57], v22 offset:8192
  s_waitcnt lgkmcnt(14)
  ds_read_b64_tr_b16 v[58:59], v22 offset:10240
  s_waitcnt lgkmcnt(14)
  v_mfma_f32_32x32x16_bf16 v[112:127], v[60:63], v[172:175], v[112:127]
  ds_read_b64_tr_b16 v[60:61], v23 offset:8192
  s_waitcnt lgkmcnt(14)
  ds_read_b64_tr_b16 v[62:63], v23 offset:10240
  s_waitcnt vmcnt(8)
  s_barrier
  v_add_u32 v20, 49152, v15
  v_xor_b32 v21, 64, v20
  v_xor_b32 v22, 128, v20
  v_xor_b32 v23, 192, v20
  s_waitcnt lgkmcnt(14)
  v_mfma_f32_32x32x16_bf16 v[64:79], v[32:35], v[176:179], v[64:79]
  ds_read_b64_tr_b16 v[32:33], v20 offset:0
  s_waitcnt lgkmcnt(14)
  ds_read_b64_tr_b16 v[34:35], v20 offset:2048
  s_add_u32 s43, s48, 2621440
  s_add_u32 m0, s33, 114688
  s_and_b32 s43, s43, 0x3fffff
  buffer_load_dwordx4 v8, s[12:15], s43 offen lds
  s_waitcnt lgkmcnt(14)
  v_mfma_f32_32x32x16_bf16 v[80:95], v[36:39], v[176:179], v[80:95]
  ds_read_b64_tr_b16 v[36:37], v21 offset:0
  s_waitcnt lgkmcnt(14)
  ds_read_b64_tr_b16 v[38:39], v21 offset:2048
  buffer_load_dwordx4 v9, s[12:15], s43 offen offset:1024 lds
  s_waitcnt lgkmcnt(14)
  v_mfma_f32_32x32x16_bf16 v[96:111], v[40:43], v[176:179], v[96:111]
  ds_read_b64_tr_b16 v[40:41], v22 offset:0
  s_waitcnt lgkmcnt(14)
  ds_read_b64_tr_b16 v[42:43], v22 offset:2048
  buffer_load_dwordx4 v10, s[12:15], s43 offen offset:2048 lds
  s_waitcnt lgkmcnt(14)
  v_mfma_f32_32x32x16_bf16 v[112:127], v[44:47], v[176:179], v[112:127]
  ds_read_b64_tr_b16 v[44:45], v23 offset:0
  s_waitcnt lgkmcnt(14)
  ds_read_b64_tr_b16 v[46:47], v23 offset:2048
  buffer_load_dwordx4 v11, s[12:15], s43 offen offset:3072 lds
  s_waitcnt lgkmcnt(14)
  v_mfma_f32_32x32x16_bf16 v[64:79], v[48:51], v[180:183], v[64:79]
  ds_read_b64_tr_b16 v[48:49], v20 offset:8192
  s_waitcnt lgkmcnt(14)
  ds_read_b64_tr_b16 v[50:51], v20 offset:10240
  s_waitcnt lgkmcnt(14)
  v_mfma_f32_32x32x16_bf16 v[80:95], v[52:55], v[180:183], v[80:95]
  ds_read_b64_tr_b16 v[52:53], v21 offset:8192
  s_waitcnt lgkmcnt(14)
  ds_read_b64_tr_b16 v[54:55], v21 offset:10240
  s_waitcnt lgkmcnt(14)
  v_mfma_f32_32x32x16_bf16 v[96:111], v[56:59], v[180:183], v[96:111]
  ds_read_b64_tr_b16 v[56:57], v22 offset:8192
  s_waitcnt lgkmcnt(14)
  ds_read_b64_tr_b16 v[58:59], v22 offset:10240
  s_waitcnt lgkmcnt(14)
  v_mfma_f32_32x32x16_bf16 v[112:127], v[60:63], v[180:183], v[112:127]
  ds_read_b64_tr_b16 v[60:61], v23 offset:8192
  s_waitcnt lgkmcnt(14)
  ds_read_b64_tr_b16 v[62:63], v23 offset:10240
  s_waitcnt vmcnt(8)
  s_barrier
  v_add_u32 v20, 0, v15
  v_xor_b32 v21, 64, v20
  v_xor_b32 v22, 128, v20
  v_xor_b32 v23, 192, v20
  s_waitcnt lgkmcnt(14)
  v_mfma_f32_32x32x16_bf16 v[64:79], v[32:35], v[184:187], v[64:79]
  ds_read_b64_tr_b16 v[32:33], v20 offset:0
  s_waitcnt lgkmcnt(14)
  ds_read_b64_tr_b16 v[34:35], v20 offset:2048
  s_add_u32 s43, s48, 2883584
  s_add_u32 m0, s33, 32768
  s_and_b32 s43, s43, 0x3fffff
  buffer_load_dwordx4 v8, s[12:15], s43 offen lds
  s_waitcnt lgkmcnt(14)
  v_mfma_f32_32x32x16_bf16 v[80:95], v[36:39], v[184:187], v[80:95]
  ds_read_b64_tr_b16 v[36:37], v21 offset:0
  s_waitcnt lgkmcnt(14)
  ds_read_b64_tr_b16 v[38:39], v21 offset:2048
  buffer_load_dwordx4 v9, s[12:15], s43 offen offset:1024 lds
  s_waitcnt lgkmcnt(14)
  v_mfma_f32_32x32x16_bf16 v[96:111], v[40:43], v[184:187], v[96:111]
  ds_read_b64_tr_b16 v[40:41], v22 offset:0
  s_waitcnt lgkmcnt(14)
  ds_read_b64_tr_b16 v[42:43], v22 offset:2048
  buffer_load_dwordx4 v10, s[12:15], s43 offen offset:2048 lds
  s_waitcnt lgkmcnt(14)
  v_mfma_f32_32x32x16_bf16 v[112:127], v[44:47], v[184:187], v[112:127]
  ds_read_b64_tr_b16 v[44:45], v23 offset:0
  s_waitcnt lgkmcnt(14)
  ds_read_b64_tr_b16 v[46:47], v23 offset:2048
  buffer_load_dwordx4 v11, s[12:15], s43 offen offset:3072 lds
  s_waitcnt lgkmcnt(14)
  v_mfma_f32_32x32x16_bf16 v[64:79], v[48:51], v[188:191], v[64:79]
  ds_read_b64_tr_b16 v[48:49], v20 offset:8192
  s_waitcnt lgkmcnt(14)
  ds_read_b64_tr_b16 v[50:51], v20 offset:10240
  s_waitcnt lgkmcnt(14)
  v_mfma_f32_32x32x16_bf16 v[80:95], v[52:55], v[188:191], v[80:95]
  ds_read_b64_tr_b16 v[52:53], v21 offset:8192
  s_waitcnt lgkmcnt(14)
  ds_read_b64_tr_b16 v[54:55], v21 offset:10240
  s_waitcnt lgkmcnt(14)
  v_mfma_f32_32x32x16_bf16 v[96:111], v[56:59], v[188:191], v[96:111]
  ds_read_b64_tr_b16 v[56:57], v22 offset:8192
  s_waitcnt lgkmcnt(14)
  ds_read_b64_tr_b16 v[58:59], v22 offset:10240
  s_waitcnt lgkmcnt(14)
  v_mfma_f32_32x32x16_bf16 v[112:127], v[60:63], v[188:191], v[112:127]
  ds_read_b64_tr_b16 v[60:61], v23 offset:8192
  s_waitcnt lgkmcnt(14)
  ds_read_b64_tr_b16 v[62:63], v23 offset:10240
  s_waitcnt vmcnt(8)
  s_barrier
  v_add_u32 v20, 147456, v15
  v_xor_b32 v21, 64, v20
  v_xor_b32 v22, 128, v20
  v_xor_b32 v23, 192, v20
  s_waitcnt lgkmcnt(14)
  v_mfma_f32_32x32x16_bf16 v[64:79], v[32:35], v[192:195], v[64:79]
  ds_read_b64_tr_b16 v[32:33], v20 offset:0
  s_waitcnt lgkmcnt(14)
  ds_read_b64_tr_b16 v[34:35], v20 offset:2048
  s_add_u32 s43, s48, 3145728
  s_add_u32 m0, s33, 49152
  s_and_b32 s43, s43, 0x3fffff
  buffer_load_dwordx4 v8, s[12:15], s43 offen lds
  s_waitcnt lgkmcnt(14)
  v_mfma_f32_32x32x16_bf16 v[80:95], v[36:39], v[192:195], v[80:95]
  ds_read_b64_tr_b16 v[36:37], v21 offset:0
  s_waitcnt lgkmcnt(14)
  ds_read_b64_tr_b16 v[38:39], v21 offset:2048
  buffer_load_dwordx4 v9, s[12:15], s43 offen offset:1024 lds
  s_waitcnt lgkmcnt(14)
  v_mfma_f32_32x32x16_bf16 v[96:111], v[40:43], v[192:195], v[96:111]
  ds_read_b64_tr_b16 v[40:41], v22 offset:0
  s_waitcnt lgkmcnt(14)
  ds_read_b64_tr_b16 v[42:43], v22 offset:2048
  buffer_load_dwordx4 v10, s[12:15], s43 offen offset:2048 lds
  s_waitcnt lgkmcnt(14)
  v_mfma_f32_32x32x16_bf16 v[112:127], v[44:47], v[192:195], v[112:127]
  ds_read_b64_tr_b16 v[44:45], v23 offset:0
  s_waitcnt lgkmcnt(14)
  ds_read_b64_tr_b16 v[46:47], v23 offset:2048
  buffer_load_dwordx4 v11, s[12:15], s43 offen offset:3072 lds
  s_waitcnt lgkmcnt(14)
  v_mfma_f32_32x32x16_bf16 v[64:79], v[48:51], v[196:199], v[64:79]
  ds_read_b64_tr_b16 v[48:49], v20 offset:8192
  s_waitcnt lgkmcnt(14)
  ds_read_b64_tr_b16 v[50:51], v20 offset:10240
  s_waitcnt lgkmcnt(14)
  v_mfma_f32_32x32x16_bf16 v[80:95], v[52:55], v[196:199], v[80:95]
  ds_read_b64_tr_b16 v[52:53], v21 offset:8192
  s_waitcnt lgkmcnt(14)
  ds_read_b64_tr_b16 v[54:55], v21 offset:10240
  s_waitcnt lgkmcnt(14)
  v_mfma_f32_32x32x16_bf16 v[96:111], v[56:59], v[196:199], v[96:111]
  ds_read_b64_tr_b16 v[56:57], v22 offset:8192
  s_waitcnt lgkmcnt(14)
  ds_read_b64_tr_b16 v[58:59], v22 offset:10240
  s_waitcnt lgkmcnt(14)
  v_mfma_f32_32x32x16_bf16 v[112:127], v[60:63], v[196:199], v[112:127]
  ds_read_b64_tr_b16 v[60:61], v23 offset:8192
  s_waitcnt lgkmcnt(14)
  ds_read_b64_tr_b16 v[62:63], v23 offset:10240
  s_waitcnt vmcnt(8)
  s_barrier
  v_add_u32 v20, 114688, v15
  v_xor_b32 v21, 64, v20
  v_xor_b32 v22, 128, v20
  v_xor_b32 v23, 192, v20
  s_waitcnt lgkmcnt(14)
  v_mfma_f32_32x32x16_bf16 v[64:79], v[32:35], v[200:203], v[64:79]
  ds_read_b64_tr_b16 v[32:33], v20 offset:0
  s_waitcnt lgkmcnt(14)
  ds_read_b64_tr_b16 v[34:35], v20 offset:2048
  s_add_u32 s43, s48, 3407872
  s_add_u32 m0, s33, 0
  s_and_b32 s43, s43, 0x3fffff
  buffer_load_dwordx4 v8, s[12:15], s43 offen lds
  s_waitcnt lgkmcnt(14)
  v_mfma_f32_32x32x16_bf16 v[80:95], v[36:39], v[200:203], v[80:95]
  ds_read_b64_tr_b16 v[36:37], v21 offset:0
  s_waitcnt lgkmcnt(14)
  ds_read_b64_tr_b16 v[38:39], v21 offset:2048
  buffer_load_dwordx4 v9, s[12:15], s43 offen offset:1024 lds
  s_waitcnt lgkmcnt(14)
  v_mfma_f32_32x32x16_bf16 v[96:111], v[40:43], v[200:203], v[96:111]
  ds_read_b64_tr_b16 v[40:41], v22 offset:0
  s_waitcnt lgkmcnt(14)
  ds_read_b64_tr_b16 v[42:43], v22 offset:2048
  buffer_load_dwordx4 v10, s[12:15], s43 offen offset:2048 lds
  s_waitcnt lgkmcnt(14)
  v_mfma_f32_32x32x16_bf16 v[112:127], v[44:47], v[200:203], v[112:127]
  ds_read_b64_tr_b16 v[44:45], v23 offset:0
  s_waitcnt lgkmcnt(14)
  ds_read_b64_tr_b16 v[46:47], v23 offset:2048
  buffer_load_dwordx4 v11, s[12:15], s43 offen offset:3072 lds
  s_waitcnt lgkmcnt(14)
  v_mfma_f32_32x32x16_bf16 v[64:79], v[48:51], v[204:207], v[64:79]
  ds_read_b64_tr_b16 v[48:49], v20 offset:8192
  s_waitcnt lgkmcnt(14)
  ds_read_b64_tr_b16 v[50:51], v20 offset:10240
  s_waitcnt lgkmcnt(14)
  v_mfma_f32_32x32x16_bf16 v[80:95], v[52:55], v[204:207], v[80:95]
  ds_read_b64_tr_b16 v[52:53], v21 offset:8192
  s_waitcnt lgkmcnt(14)
  ds_read_b64_tr_b16 v[54:55], v21 offset:10240
  s_waitcnt lgkmcnt(14)
  v_mfma_f32_32x32x16_bf16 v[96:111], v[56:59], v[204:207], v[96:111]
  ds_read_b64_tr_b16 v[56:57], v22 offset:8192
  s_waitcnt lgkmcnt(14)
  ds_read_b64_tr_b16 v[58:59], v22 offset:10240
  s_waitcnt lgkmcnt(14)
  v_mfma_f32_32x32x16_bf16 v[112:127], v[60:63], v[204:207], v[112:127]
  ds_read_b64_tr_b16 v[60:61], v23 offset:8192
  s_waitcnt lgkmcnt(14)
  ds_read_b64_tr_b16 v[62:63], v23 offset:10240
  s_waitcnt vmcnt(8)
  s_barrier
  v_add_u32 v20, 32768, v15
  v_xor_b32 v21, 64, v20
  v_xor_b32 v22, 128, v20
  v_xor_b32 v23, 192, v20
  s_waitcnt lgkmcnt(14)
  v_mfma_f32_32x32x16_bf16 v[64:79], v[32:35], v[208:211], v[64:79]
  ds_read_b64_tr_b16 v[32:33], v20 offset:0
  s_waitcnt lgkmcnt(14)
  ds_read_b64_tr_b16 v[34:35], v20 offset:2048
  s_add_u32 s43, s48, 3670016
  s_add_u32 m0, s33, 147456
  s_and_b32 s43, s43, 0x3fffff
  buffer_load_dwordx4 v8, s[12:15], s43 offen lds
  s_waitcnt lgkmcnt(14)
  v_mfma_f32_32x32x16_bf16 v[80:95], v[36:39], v[208:211], v[80:95]
  ds_read_b64_tr_b16 v[36:37], v21 offset:0
  s_waitcnt lgkmcnt(14)
  ds_read_b64_tr_b16 v[38:39], v21 offset:2048
  buffer_load_dwordx4 v9, s[12:15], s43 offen offset:1024 lds
  s_waitcnt lgkmcnt(14)
  v_mfma_f32_32x32x16_bf16 v[96:111], v[40:43], v[208:211], v[96:111]
  ds_read_b64_tr_b16 v[40:41], v22 offset:0
  s_waitcnt lgkmcnt(14)
  ds_read_b64_tr_b16 v[42:43], v22 offset:2048
  buffer_load_dwordx4 v10, s[12:15], s43 offen offset:2048 lds
  s_waitcnt lgkmcnt(14)
  v_mfma_f32_32x32x16_bf16 v[112:127], v[44:47], v[208:211], v[112:127]
  ds_read_b64_tr_b16 v[44:45], v23 offset:0
  s_waitcnt lgkmcnt(14)
  ds_read_b64_tr_b16 v[46:47], v23 offset:2048
  buffer_load_dwordx4 v11, s[12:15], s43 offen offset:3072 lds
  s_waitcnt lgkmcnt(14)
  v_mfma_f32_32x32x16_bf16 v[64:79], v[48:51], v[212:215], v[64:79]
  ds_read_b64_tr_b16 v[48:49], v20 offset:8192
  s_waitcnt lgkmcnt(14)
  ds_read_b64_tr_b16 v[50:51], v20 offset:10240
  s_waitcnt lgkmcnt(14)
  v_mfma_f32_32x32x16_bf16 v[80:95], v[52:55], v[212:215], v[80:95]
  ds_read_b64_tr_b16 v[52:53], v21 offset:8192
  s_waitcnt lgkmcnt(14)
  ds_read_b64_tr_b16 v[54:55], v21 offset:10240
  s_waitcnt lgkmcnt(14)
  v_mfma_f32_32x32x16_bf16 v[96:111], v[56:59], v[212:215], v[96:111]
  ds_read_b64_tr_b16 v[56:57], v22 offset:8192
  s_waitcnt lgkmcnt(14)
  ds_read_b64_tr_b16 v[58:59], v22 offset:10240
  s_waitcnt lgkmcnt(14)
  v_mfma_f32_32x32x16_bf16 v[112:127], v[60:63], v[212:215], v[112:127]
  ds_read_b64_tr_b16 v[60:61], v23 offset:8192
  s_waitcnt lgkmcnt(14)
  ds_read_b64_tr_b16 v[62:63], v23 offset:10240
  s_waitcnt vmcnt(8)
  s_barrier
  v_add_u32 v20, 49152, v15
  v_xor_b32 v21, 64, v20
  v_xor_b32 v22, 128, v20
  v_xor_b32 v23, 192, v20
  s_waitcnt lgkmcnt(14)
  v_mfma_f32_32x32x16_bf16 v[64:79], v[32:35], v[216:219], v[64:79]
  ds_read_b64_tr_b16 v[32:33], v20 offset:0
  s_waitcnt lgkmcnt(14)
  ds_read_b64_tr_b16 v[34:35], v20 offset:2048
  s_add_u32 s43, s48, 3932160
  s_add_u32 m0, s33, 114688
  s_and_b32 s43, s43, 0x3fffff
  buffer_load_dwordx4 v8, s[12:15], s43 offen lds
  s_waitcnt lgkmcnt(14)
  v_mfma_f32_32x32x16_bf16 v[80:95], v[36:39], v[216:219], v[80:95]
  ds_read_b64_tr_b16 v[36:37], v21 offset:0
  s_waitcnt lgkmcnt(14)
  ds_read_b64_tr_b16 v[38:39], v21 offset:2048
  buffer_load_dwordx4 v9, s[12:15], s43 offen offset:1024 lds
  s_waitcnt lgkmcnt(14)
  v_mfma_f32_32x32x16_bf16 v[96:111], v[40:43], v[216:219], v[96:111]
  ds_read_b64_tr_b16 v[40:41], v22 offset:0
  s_waitcnt lgkmcnt(14)
  ds_read_b64_tr_b16 v[42:43], v22 offset:2048
  buffer_load_dwordx4 v10, s[12:15], s43 offen offset:2048 lds
  s_waitcnt lgkmcnt(14)
  v_mfma_f32_32x32x16_bf16 v[112:127], v[44:47], v[216:219], v[112:127]
  ds_read_b64_tr_b16 v[44:45], v23 offset:0
  s_waitcnt lgkmcnt(14)
  ds_read_b64_tr_b16 v[46:47], v23 offset:2048
  buffer_load_dwordx4 v11, s[12:15], s43 offen offset:3072 lds
  s_waitcnt lgkmcnt(14)
  v_mfma_f32_32x32x16_bf16 v[64:79], v[48:51], v[220:223], v[64:79]
  ds_read_b64_tr_b16 v[48:49], v20 offset:8192
  s_waitcnt lgkmcnt(14)
  ds_read_b64_tr_b16 v[50:51], v20 offset:10240
  s_waitcnt lgkmcnt(14)
  v_mfma_f32_32x32x16_bf16 v[80:95], v[52:55], v[220:223], v[80:95]
  ds_read_b64_tr_b16 v[52:53], v21 offset:8192
  s_waitcnt lgkmcnt(14)
  ds_read_b64_tr_b16 v[54:55], v21 offset:10240
  s_waitcnt lgkmcnt(14)
  v_mfma_f32_32x32x16_bf16 v[96:111], v[56:59], v[220:223], v[96:111]
  ds_read_b64_tr_b16 v[56:57], v22 offset:8192
  s_waitcnt lgkmcnt(14)
  ds_read_b64_tr_b16 v[58:59], v22 offset:10240
  s_waitcnt lgkmcnt(14)
  v_mfma_f32_32x32x16_bf16 v[112:127], v[60:63], v[220:223], v[112:127]
  ds_read_b64_tr_b16 v[60:61], v23 offset:8192
  s_waitcnt lgkmcnt(14)
  ds_read_b64_tr_b16 v[62:63], v23 offset:10240
  s_waitcnt vmcnt(8)
  s_barrier
  v_add_u32 v20, 0, v15
  v_xor_b32 v21, 64, v20
  v_xor_b32 v22, 128, v20
  v_xor_b32 v23, 192, v20
  s_waitcnt lgkmcnt(14)
  v_mfma_f32_32x32x16_bf16 v[64:79], v[32:35], v[224:227], v[64:79]
  ds_read_b64_tr_b16 v[32:33], v20 offset:0
  s_waitcnt lgkmcnt(14)
  ds_read_b64_tr_b16 v[34:35], v20 offset:2048
  s_waitcnt lgkmcnt(14)
  v_mfma_f32_32x32x16_bf16 v[80:95], v[36:39], v[224:227], v[80:95]
  ds_read_b64_tr_b16 v[36:37], v21 offset:0
  s_waitcnt lgkmcnt(14)
  ds_read_b64_tr_b16 v[38:39], v21 offset:2048
  s_waitcnt lgkmcnt(14)
  v_mfma_f32_32x32x16_bf16 v[96:111], v[40:43], v[224:227], v[96:111]
  ds_read_b64_tr_b16 v[40:41], v22 offset:0
  s_waitcnt lgkmcnt(14)
  ds_read_b64_tr_b16 v[42:43], v22 offset:2048
  s_waitcnt lgkmcnt(14)
  v_mfma_f32_32x32x16_bf16 v[112:127], v[44:47], v[224:227], v[112:127]
  ds_read_b64_tr_b16 v[44:45], v23 offset:0
  s_waitcnt lgkmcnt(14)
  ds_read_b64_tr_b16 v[46:47], v23 offset:2048
  s_waitcnt lgkmcnt(14)
  v_mfma_f32_32x32x16_bf16 v[64:79], v[48:51], v[228:231], v[64:79]
  ds_read_b64_tr_b16 v[48:49], v20 offset:8192
  s_waitcnt lgkmcnt(14)
  ds_read_b64_tr_b16 v[50:51], v20 offset:10240
  s_waitcnt lgkmcnt(14)
  v_mfma_f32_32x32x16_bf16 v[80:95], v[52:55], v[228:231], v[80:95]
  ds_read_b64_tr_b16 v[52:53], v21 offset:8192
  s_waitcnt lgkmcnt(14)
  ds_read_b64_tr_b16 v[54:55], v21 offset:10240
  s_waitcnt lgkmcnt(14)
  v_mfma_f32_32x32x16_bf16 v[96:111], v[56:59], v[228:231], v[96:111]
  ds_read_b64_tr_b16 v[56:57], v22 offset:8192
  s_waitcnt lgkmcnt(14)
  ds_read_b64_tr_b16 v[58:59], v22 offset:10240
  s_waitcnt lgkmcnt(14)
  v_mfma_f32_32x32x16_bf16 v[112:127], v[60:63], v[228:231], v[112:127]
  ds_read_b64_tr_b16 v[60:61], v23 offset:8192
  s_waitcnt lgkmcnt(14)
  ds_read_b64_tr_b16 v[62:63], v23 offset:10240
  s_waitcnt vmcnt(4)
  s_barrier
  v_add_u32 v20, 147456, v15
  v_xor_b32 v21, 64, v20
  v_xor_b32 v22, 128, v20
  v_xor_b32 v23, 192, v20
  s_waitcnt lgkmcnt(14)
  v_mfma_f32_32x32x16_bf16 v[64:79], v[32:35], v[232:235], v[64:79]
  ds_read_b64_tr_b16 v[32:33], v20 offset:0
  s_waitcnt lgkmcnt(14)
  ds_read_b64_tr_b16 v[34:35], v20 offset:2048
  s_waitcnt lgkmcnt(14)
  v_mfma_f32_32x32x16_bf16 v[80:95], v[36:39], v[232:235], v[80:95]
  ds_read_b64_tr_b16 v[36:37], v21 offset:0
  s_waitcnt lgkmcnt(14)
  ds_read_b64_tr_b16 v[38:39], v21 offset:2048
  s_waitcnt lgkmcnt(14)
  v_mfma_f32_32x32x16_bf16 v[96:111], v[40:43], v[232:235], v[96:111]
  ds_read_b64_tr_b16 v[40:41], v22 offset:0
  s_waitcnt lgkmcnt(14)
  ds_read_b64_tr_b16 v[42:43], v22 offset:2048
  s_waitcnt lgkmcnt(14)
  v_mfma_f32_32x32x16_bf16 v[112:127], v[44:47], v[232:235], v[112:127]
  ds_read_b64_tr_b16 v[44:45], v23 offset:0
  s_waitcnt lgkmcnt(14)
  ds_read_b64_tr_b16 v[46:47], v23 offset:2048
  s_waitcnt lgkmcnt(14)
  v_mfma_f32_32x32x16_bf16 v[64:79], v[48:51], v[236:239], v[64:79]
  ds_read_b64_tr_b16 v[48:49], v20 offset:8192
  s_waitcnt lgkmcnt(14)
  ds_read_b64_tr_b16 v[50:51], v20 offset:10240
  s_waitcnt lgkmcnt(14)
  v_mfma_f32_32x32x16_bf16 v[80:95], v[52:55], v[236:239], v[80:95]
  ds_read_b64_tr_b16 v[52:53], v21 offset:8192
  s_waitcnt lgkmcnt(14)
  ds_read_b64_tr_b16 v[54:55], v21 offset:10240
  s_waitcnt lgkmcnt(14)
  v_mfma_f32_32x32x16_bf16 v[96:111], v[56:59], v[236:239], v[96:111]
  ds_read_b64_tr_b16 v[56:57], v22 offset:8192
  s_waitcnt lgkmcnt(14)
  ds_read_b64_tr_b16 v[58:59], v22 offset:10240
  s_waitcnt lgkmcnt(14)
  v_mfma_f32_32x32x16_bf16 v[112:127], v[60:63], v[236:239], v[112:127]
  ds_read_b64_tr_b16 v[60:61], v23 offset:8192
  s_waitcnt lgkmcnt(14)
  ds_read_b64_tr_b16 v[62:63], v23 offset:10240
  s_waitcnt vmcnt(0)
  s_barrier
  v_add_u32 v20, 114688, v15
  v_xor_b32 v21, 64, v20
  v_xor_b32 v22, 128, v20
  v_xor_b32 v23, 192, v20
  s_waitcnt lgkmcnt(14)
  v_mfma_f32_32x32x16_bf16 v[64:79], v[32:35], v[240:243], v[64:79]
  ds_read_b64_tr_b16 v[32:33], v20 offset:0
  s_waitcnt lgkmcnt(14)
  ds_read_b64_tr_b16 v[34:35], v20 offset:2048
  s_waitcnt lgkmcnt(14)
  v_mfma_f32_32x32x16_bf16 v[80:95], v[36:39], v[240:243], v[80:95]
  ds_read_b64_tr_b16 v[36:37], v21 offset:0
  s_waitcnt lgkmcnt(14)
  ds_read_b64_tr_b16 v[38:39], v21 offset:2048
  s_waitcnt lgkmcnt(14)
  v_mfma_f32_32x32x16_bf16 v[96:111], v[40:43], v[240:243], v[96:111]
  ds_read_b64_tr_b16 v[40:41], v22 offset:0
  s_waitcnt lgkmcnt(14)
  ds_read_b64_tr_b16 v[42:43], v22 offset:2048
  s_waitcnt lgkmcnt(14)
  v_mfma_f32_32x32x16_bf16 v[112:127], v[44:47], v[240:243], v[112:127]
  ds_read_b64_tr_b16 v[44:45], v23 offset:0
  s_waitcnt lgkmcnt(14)
  ds_read_b64_tr_b16 v[46:47], v23 offset:2048
  s_waitcnt lgkmcnt(14)
  v_mfma_f32_32x32x16_bf16 v[64:79], v[48:51], v[244:247], v[64:79]
  ds_read_b64_tr_b16 v[48:49], v20 offset:8192
  s_waitcnt lgkmcnt(14)
  ds_read_b64_tr_b16 v[50:51], v20 offset:10240
  s_waitcnt lgkmcnt(14)
  v_mfma_f32_32x32x16_bf16 v[80:95], v[52:55], v[244:247], v[80:95]
  ds_read_b64_tr_b16 v[52:53], v21 offset:8192
  s_waitcnt lgkmcnt(14)
  ds_read_b64_tr_b16 v[54:55], v21 offset:10240
  s_waitcnt lgkmcnt(14)
  v_mfma_f32_32x32x16_bf16 v[96:111], v[56:59], v[244:247], v[96:111]
  ds_read_b64_tr_b16 v[56:57], v22 offset:8192
  s_waitcnt lgkmcnt(14)
  ds_read_b64_tr_b16 v[58:59], v22 offset:10240
  s_waitcnt lgkmcnt(14)
  v_mfma_f32_32x32x16_bf16 v[112:127], v[60:63], v[244:247], v[112:127]
  ds_read_b64_tr_b16 v[60:61], v23 offset:8192
  s_waitcnt lgkmcnt(14)
  ds_read_b64_tr_b16 v[62:63], v23 offset:10240
  s_mov_b32 m0, s38
  s_cmp_eq_u32 s47, 0
  s_cselect_b64 exec, -1, 1
  s_and_b32 s36, s40, 0x1ffff
  buffer_load_dwordx4 v4, s[8:11], s36 offen nt lds
  buffer_load_dwordx4 v5, s[8:11], s36 offen offset:1024 nt lds
  buffer_load_dwordx4 v6, s[8:11], s36 offen offset:2048 nt lds
  buffer_load_dwordx4 v7, s[8:11], s36 offen offset:3072 nt lds
  s_mov_b64 exec, -1
  s_add_u32 s40, s40, 8192
  s_add_u32 s38, s38, 16384
  s_cmp_ge_u32 s38, s51
  s_cselect_b32 s43, 98304, 0
  s_sub_u32 s38, s38, s43
  s_mov_b32 m0, s38
  s_and_b32 s36, s40, 0x1ffff
  buffer_load_dwordx4 v4, s[8:11], s36 offen nt lds
  buffer_load_dwordx4 v5, s[8:11], s36 offen offset:1024 nt lds
  buffer_load_dwordx4 v6, s[8:11], s36 offen offset:2048 nt lds
  buffer_load_dwordx4 v7, s[8:11], s36 offen offset:3072 nt lds
  s_add_u32 s40, s40, 8192
  s_add_u32 s38, s38, 16384
  s_cmp_ge_u32 s38, s51
  s_cselect_b32 s43, 98304, 0
  s_sub_u32 s38, s38, s43
  s_barrier
  s_waitcnt lgkmcnt(14)
  v_mfma_f32_32x32x16_bf16 v[64:79], v[32:35], v[248:251], v[64:79]
  s_waitcnt lgkmcnt(12)
  v_mfma_f32_32x32x16_bf16 v[80:95], v[36:39], v[248:251], v[80:95]
  s_waitcnt lgkmcnt(10)
  v_mfma_f32_32x32x16_bf16 v[96:111], v[40:43], v[248:251], v[96:111]
  s_waitcnt lgkmcnt(8)
  v_mfma_f32_32x32x16_bf16 v[112:127], v[44:47], v[248:251], v[112:127]
  s_waitcnt lgkmcnt(6)
  v_mfma_f32_32x32x16_bf16 v[64:79], v[48:51], v[252:255], v[64:79]
  s_waitcnt lgkmcnt(4)
  v_mfma_f32_32x32x16_bf16 v[80:95], v[52:55], v[252:255], v[80:95]
  s_waitcnt lgkmcnt(2)
  v_mfma_f32_32x32x16_bf16 v[96:111], v[56:59], v[252:255], v[96:111]
  s_waitcnt lgkmcnt(0)
  v_mfma_f32_32x32x16_bf16 v[112:127], v[60:63], v[252:255], v[112:127]
  s_waitcnt vmcnt(4)
  s_barrier
  s_nop 7
  v_mov_b32 v36, s41
  s_nop 6
  v_pk_mul_f32 v[64:65], v[64:65], v[36:37] op_sel_hi:[1,0]
  v_pk_mul_f32 v[66:67], v[66:67], v[36:37] op_sel_hi:[1,0]
  v_cvt_pk_bf16_f32 v192, v64, v65
  v_pk_mul_f32 v[68:69], v[68:69], v[36:37] op_sel_hi:[1,0]
  v_cvt_pk_bf16_f32 v193, v66, v67
  v_pk_mul_f32 v[70:71], v[70:71], v[36:37] op_sel_hi:[1,0]
  v_cvt_pk_bf16_f32 v194, v68, v69
  v_pk_mul_f32 v[72:73], v[72:73], v[36:37] op_sel_hi:[1,0]
  v_cvt_pk_bf16_f32 v195, v70, v71
  v_pk_mul_f32 v[74:75], v[74:75], v[36:37] op_sel_hi:[1,0]
  v_cvt_pk_bf16_f32 v196, v72, v73
  v_pk_mul_f32 v[76:77], v[76:77], v[36:37] op_sel_hi:[1,0]
  v_cvt_pk_bf16_f32 v197, v74, v75
  v_pk_mul_f32 v[78:79], v[78:79], v[36:37] op_sel_hi:[1,0]
  v_cvt_pk_bf16_f32 v198, v76, v77
  v_pk_mul_f32 v[80:81], v[80:81], v[36:37] op_sel_hi:[1,0]
  v_cvt_pk_bf16_f32 v199, v78, v79
  v_pk_mul_f32 v[82:83], v[82:83], v[36:37] op_sel_hi:[1,0]
  v_cvt_pk_bf16_f32 v200, v80, v81
  v_pk_mul_f32 v[84:85], v[84:85], v[36:37] op_sel_hi:[1,0]
  v_cvt_pk_bf16_f32 v201, v82, v83
  v_pk_mul_f32 v[86:87], v[86:87], v[36:37] op_sel_hi:[1,0]
  v_cvt_pk_bf16_f32 v202, v84, v85
  v_pk_mul_f32 v[88:89], v[88:89], v[36:37] op_sel_hi:[1,0]
  v_cvt_pk_bf16_f32 v203, v86, v87
  v_pk_mul_f32 v[90:91], v[90:91], v[36:37] op_sel_hi:[1,0]
  v_cvt_pk_bf16_f32 v204, v88, v89
  v_pk_mul_f32 v[92:93], v[92:93], v[36:37] op_sel_hi:[1,0]
  v_cvt_pk_bf16_f32 v205, v90, v91
  v_pk_mul_f32 v[94:95], v[94:95], v[36:37] op_sel_hi:[1,0]
  v_cvt_pk_bf16_f32 v206, v92, v93
  v_pk_mul_f32 v[96:97], v[96:97], v[36:37] op_sel_hi:[1,0]
  v_cvt_pk_bf16_f32 v207, v94, v95
  v_pk_mul_f32 v[98:99], v[98:99], v[36:37] op_sel_hi:[1,0]
  v_cvt_pk_bf16_f32 v208, v96, v97
  v_pk_mul_f32 v[100:101], v[100:101], v[36:37] op_sel_hi:[1,0]
  v_cvt_pk_bf16_f32 v209, v98, v99
  v_pk_mul_f32 v[102:103], v[102:103], v[36:37] op_sel_hi:[1,0]
  v_cvt_pk_bf16_f32 v210, v100, v101
  v_pk_mul_f32 v[104:105], v[104:105], v[36:37] op_sel_hi:[1,0]
  v_cvt_pk_bf16_f32 v211, v102, v103
  v_pk_mul_f32 v[106:107], v[106:107], v[36:37] op_sel_hi:[1,0]
  v_cvt_pk_bf16_f32 v212, v104, v105
  v_pk_mul_f32 v[108:109], v[108:109], v[36:37] op_sel_hi:[1,0]
  v_cvt_pk_bf16_f32 v213, v106, v107
  v_pk_mul_f32 v[110:111], v[110:111], v[36:37] op_sel_hi:[1,0]
  v_cvt_pk_bf16_f32 v214, v108, v109
  v_pk_mul_f32 v[112:113], v[112:113], v[36:37] op_sel_hi:[1,0]
  v_cvt_pk_bf16_f32 v215, v110, v111
  v_pk_mul_f32 v[114:115], v[114:115], v[36:37] op_sel_hi:[1,0]
  v_cvt_pk_bf16_f32 v216, v112, v113
  v_pk_mul_f32 v[116:117], v[116:117], v[36:37] op_sel_hi:[1,0]
  v_cvt_pk_bf16_f32 v217, v114, v115
  v_pk_mul_f32 v[118:119], v[118:119], v[36:37] op_sel_hi:[1,0]
  v_cvt_pk_bf16_f32 v218, v116, v117
  v_pk_mul_f32 v[120:121], v[120:121], v[36:37] op_sel_hi:[1,0]
  v_cvt_pk_bf16_f32 v219, v118, v119
  v_pk_mul_f32 v[122:123], v[122:123], v[36:37] op_sel_hi:[1,0]
  v_cvt_pk_bf16_f32 v220, v120, v121
  v_pk_mul_f32 v[124:125], v[124:125], v[36:37] op_sel_hi:[1,0]
  v_cvt_pk_bf16_f32 v221, v122, v123
  v_pk_mul_f32 v[126:127], v[126:127], v[36:37] op_sel_hi:[1,0]
  v_cvt_pk_bf16_f32 v222, v124, v125
  v_cvt_pk_bf16_f32 v223, v126, v127
  v_add_u32 v240, 0, v13
  v_add_u32 v248, 0, v14
  v_xor_b32 v241, 32, v240
  v_xor_b32 v242, 64, v240
  v_xor_b32 v243, 96, v240
  v_xor_b32 v244, 128, v240
  v_xor_b32 v245, 160, v240
  v_xor_b32 v246, 192, v240
  v_xor_b32 v247, 224, v240
  ds_read_b128 v[128:131], v240 offset:0
  ds_read_b128 v[132:135], v241 offset:0
  ds_read_b128 v[136:139], v242 offset:0
  ds_read_b128 v[140:143], v243 offset:0
  ds_read_b128 v[144:147], v244 offset:0
  ds_read_b128 v[148:151], v245 offset:0
  ds_read_b128 v[152:155], v246 offset:0
  ds_read_b128 v[156:159], v247 offset:0
  v_xor_b32 v249, 64, v248
  v_xor_b32 v250, 128, v248
  v_xor_b32 v251, 192, v248
  s_waitcnt lgkmcnt(7)
  v_mfma_f32_32x32x16_bf16 v[40:55], v[128:131], v[192:195], 0
  v_mov_b64 v[64:65], 0
  v_mov_b64 v[66:67], 0
  v_mov_b64 v[68:69], 0
  v_mov_b64 v[70:71], 0
  v_mov_b64 v[72:73], 0
  s_waitcnt lgkmcnt(6)
  v_mfma_f32_32x32x16_bf16 v[40:55], v[132:135], v[196:199], v[40:55]
  v_mov_b64 v[74:75], 0
  v_mov_b64 v[76:77], 0
  v_mov_b64 v[78:79], 0
  v_mov_b64 v[80:81], 0
  v_mov_b64 v[82:83], 0
  s_waitcnt lgkmcnt(5)
  v_mfma_f32_32x32x16_bf16 v[40:55], v[136:139], v[200:203], v[40:55]
  v_mov_b64 v[84:85], 0
  v_mov_b64 v[86:87], 0
  v_mov_b64 v[88:89], 0
  v_mov_b64 v[90:91], 0
  v_mov_b64 v[92:93], 0
  s_waitcnt lgkmcnt(4)
  v_mfma_f32_32x32x16_bf16 v[40:55], v[140:143], v[204:207], v[40:55]
  v_mov_b64 v[94:95], 0
  v_mov_b64 v[96:97], 0
  v_mov_b64 v[98:99], 0
  v_mov_b64 v[100:101], 0
  v_mov_b64 v[102:103], 0
  s_waitcnt lgkmcnt(3)
  v_mfma_f32_32x32x16_bf16 v[40:55], v[144:147], v[208:211], v[40:55]
  v_mov_b64 v[104:105], 0
  v_mov_b64 v[106:107], 0
  v_mov_b64 v[108:109], 0
  v_mov_b64 v[110:111], 0
  v_mov_b64 v[112:113], 0
  s_waitcnt lgkmcnt(2)
  v_mfma_f32_32x32x16_bf16 v[40:55], v[148:151], v[212:215], v[40:55]
  v_mov_b64 v[114:115], 0
  v_mov_b64 v[116:117], 0
  v_mov_b64 v[118:119], 0
  v_mov_b64 v[120:121], 0
  v_mov_b64 v[122:123], 0
  s_waitcnt lgkmcnt(1)
  v_mfma_f32_32x32x16_bf16 v[40:55], v[152:155], v[216:219], v[40:55]
  v_mov_b64 v[124:125], 0
  v_mov_b64 v[126:127], 0
  v_mov_b64 v[252:253], 0
  v_mov_b64 v[254:255], 0
  v_mov_b64 v[56:57], 0
  s_waitcnt lgkmcnt(0)
  v_mfma_f32_32x32x16_bf16 v[40:55], v[156:159], v[220:223], v[40:55]
  v_mov_b64 v[58:59], 0
  v_mov_b64 v[60:61], 0
  v_mov_b64 v[62:63], 0
  v_lshrrev_b32 v36, 2, v1
  v_lshrrev_b32 v37, 4, v1
  v_xor_b32 v36, v36, v37
  v_and_b32 v36, 1, v36
  v_and_b32 v37, 3, v1
  v_or_b32 v36, v36, v37
  v_cmp_eq_u32 vcc, 0, v36
  v_mov_b32 v37, 0x3f803f80
  s_nop 0
  v_cndmask_b32 v176, 0, v37, vcc
  v_cndmask_b32 v177, 0, v37, vcc
  v_cndmask_b32 v178, 0, v37, vcc
  v_cndmask_b32 v179, 0, v37, vcc
  s_nop 1
  v_max3_f32 v36, v40, v41, v42
  v_max3_f32 v37, v43, v44, v45
  v_max3_f32 v36, v36, v46, v47
  v_max3_f32 v37, v37, v48, v49
  v_max3_f32 v36, v36, v50, v51
  v_max3_f32 v37, v37, v52, v53
  v_max3_f32 v36, v36, v54, v55
  v_max_f32 v36, v36, v37
  v_mov_b32 v37, v36
  s_nop 1
  v_permlane32_swap_b32 v36, v37
  s_nop 1
  v_max_f32 v36, v36, v37
  v_sub_f32 v40, v40, v36
  v_sub_f32 v160, 0, v36
  v_sub_f32 v41, v41, v36
  v_sub_f32 v161, 0, v36
  v_sub_f32 v42, v42, v36
  v_sub_f32 v162, 0, v36
  v_sub_f32 v43, v43, v36
  v_sub_f32 v163, 0, v36
  v_sub_f32 v44, v44, v36
  v_sub_f32 v164, 0, v36
  v_sub_f32 v45, v45, v36
  v_sub_f32 v165, 0, v36
  v_sub_f32 v46, v46, v36
  v_sub_f32 v166, 0, v36
  v_sub_f32 v47, v47, v36
  v_sub_f32 v167, 0, v36
  v_sub_f32 v48, v48, v36
  v_sub_f32 v168, 0, v36
  v_sub_f32 v49, v49, v36
  v_sub_f32 v169, 0, v36
  v_sub_f32 v50, v50, v36
  v_sub_f32 v170, 0, v36
  v_sub_f32 v51, v51, v36
  v_sub_f32 v171, 0, v36
  v_sub_f32 v52, v52, v36
  v_sub_f32 v172, 0, v36
  v_sub_f32 v53, v53, v36
  v_sub_f32 v173, 0, v36
  v_sub_f32 v54, v54, v36
  v_sub_f32 v174, 0, v36
  v_sub_f32 v55, v55, v36
  v_sub_f32 v175, 0, v36
  s_waitcnt vmcnt(0) lgkmcnt(0)
  s_barrier
  s_mov_b32 s32, 0
L_attn_1:
  s_mov_b32 m0, s38
  s_and_b32 s36, s40, 0x1ffff
  buffer_load_dwordx4 v4, s[8:11], s36 offen nt lds
  buffer_load_dwordx4 v5, s[8:11], s36 offen offset:1024 nt lds
  buffer_load_dwordx4 v6, s[8:11], s36 offen offset:2048 nt lds
  buffer_load_dwordx4 v7, s[8:11], s36 offen offset:3072 nt lds
  s_add_u32 s40, s40, 8192
  s_add_u32 s38, s38, 16384
  s_cmp_ge_u32 s38, s51
  s_cselect_b32 s43, 98304, 0
  s_sub_u32 s38, s38, s43
  s_nop 7
  s_waitcnt lgkmcnt(14)
  v_mfma_f32_32x32x16_bf16 v[64:79], v[128:131], v[56:59], v[64:79]
  ds_read_b128 v[128:131], v240 offset:16384
  v_max3_f32 v36, v40, v41, v42
  v_max3_f32 v37, v43, v44, v45
  v_max3_f32 v36, v36, v46, v47
  v_max3_f32 v37, v37, v48, v49
  s_waitcnt lgkmcnt(13)
  v_mfma_f32_32x32x16_bf16 v[80:95], v[132:135], v[56:59], v[80:95]
  ds_read_b128 v[132:135], v241 offset:16384
  v_max3_f32 v36, v36, v50, v51
  v_max3_f32 v37, v37, v52, v53
  v_max3_f32 v36, v36, v54, v55
  v_max_f32 v36, v36, v37
  v_cmp_lt_f32 vcc, s53, v36
  s_cbranch_vccnz L_rare_2
  s_waitcnt lgkmcnt(12)
  v_mfma_f32_32x32x16_bf16 v[96:111], v[136:139], v[56:59], v[96:111]
  ds_read_b128 v[136:139], v242 offset:16384
  v_exp_f32 v224, v40
  v_exp_f32 v225, v41
  s_waitcnt lgkmcnt(11)
  v_mfma_f32_32x32x16_bf16 v[112:127], v[140:143], v[56:59], v[112:127]
  ds_read_b128 v[140:143], v243 offset:16384
  v_exp_f32 v226, v42
  v_exp_f32 v227, v43
  v_exp_f32 v228, v44
  s_waitcnt lgkmcnt(10)
  v_mfma_f32_32x32x16_bf16 v[64:79], v[144:147], v[60:63], v[64:79]
  ds_read_b128 v[144:147], v244 offset:16384
  v_exp_f32 v229, v45
  v_exp_f32 v230, v46
  s_waitcnt lgkmcnt(9)
  v_mfma_f32_32x32x16_bf16 v[80:95], v[148:151], v[60:63], v[80:95]
  ds_read_b128 v[148:151], v245 offset:16384
  v_exp_f32 v231, v47
  v_exp_f32 v232, v48
  v_exp_f32 v233, v49
  s_waitcnt lgkmcnt(8)
  v_mfma_f32_32x32x16_bf16 v[96:111], v[152:155], v[60:63], v[96:111]
  ds_read_b128 v[152:155], v246 offset:16384
  v_exp_f32 v234, v50
  v_exp_f32 v235, v51
  s_waitcnt lgkmcnt(7)
  v_mfma_f32_32x32x16_bf16 v[112:127], v[156:159], v[60:63], v[112:127]
  ds_read_b128 v[156:159], v247 offset:16384
  v_exp_f32 v236, v52
  v_exp_f32 v237, v53
  v_exp_f32 v238, v54
  v_exp_f32 v239, v55
L_back_3:
  s_waitcnt lgkmcnt(7)
  v_mfma_f32_32x32x16_bf16 v[40:55], v[128:131], v[192:195], v[160:175]
  ds_read_b64_tr_b16 v[128:129], v248 offset:24576
  ds_read_b64_tr_b16 v[130:131], v248 offset:26624
  v_cvt_pk_bf16_f32 v56, v224, v225
  v_cvt_pk_bf16_f32 v57, v226, v227
  v_cvt_pk_bf16_f32 v58, v228, v229
  s_waitcnt lgkmcnt(8)
  v_mfma_f32_32x32x16_bf16 v[40:55], v[132:135], v[196:199], v[40:55]
  ds_read_b64_tr_b16 v[132:133], v249 offset:24576
  ds_read_b64_tr_b16 v[134:135], v249 offset:26624
  v_cvt_pk_bf16_f32 v59, v230, v231
  v_cvt_pk_bf16_f32 v60, v232, v233
  v_cvt_pk_bf16_f32 v61, v234, v235
  s_waitcnt lgkmcnt(9)
  v_mfma_f32_32x32x16_bf16 v[40:55], v[136:139], v[200:203], v[40:55]
  ds_read_b64_tr_b16 v[136:137], v250 offset:24576
  ds_read_b64_tr_b16 v[138:139], v250 offset:26624
  v_cvt_pk_bf16_f32 v62, v236, v237
  v_cvt_pk_bf16_f32 v63, v238, v239
  s_waitcnt lgkmcnt(10)
  v_mfma_f32_32x32x16_bf16 v[40:55], v[140:143], v[204:207], v[40:55]
  ds_read_b64_tr_b16 v[140:141], v251 offset:24576
  ds_read_b64_tr_b16 v[142:143], v251 offset:26624
  s_waitcnt lgkmcnt(11)
  v_mfma_f32_32x32x16_bf16 v[40:55], v[144:147], v[208:211], v[40:55]
  ds_read_b64_tr_b16 v[144:145], v248 offset:28672
  ds_read_b64_tr_b16 v[146:147], v248 offset:30720
  v_mfma_f32_16x16x32_bf16 v[252:255], v[176:179], v[56:59], v[252:255]
  s_waitcnt lgkmcnt(12)
  v_mfma_f32_32x32x16_bf16 v[40:55], v[148:151], v[212:215], v[40:55]
  ds_read_b64_tr_b16 v[148:149], v249 offset:28672
  ds_read_b64_tr_b16 v[150:151], v249 offset:30720
  s_waitcnt lgkmcnt(13)
  v_mfma_f32_32x32x16_bf16 v[40:55], v[152:155], v[216:219], v[40:55]
  ds_read_b64_tr_b16 v[152:153], v250 offset:28672
  ds_read_b64_tr_b16 v[154:155], v250 offset:30720
  v_mfma_f32_16x16x32_bf16 v[252:255], v[176:179], v[60:63], v[252:255]
  s_waitcnt lgkmcnt(14)
  v_mfma_f32_32x32x16_bf16 v[40:55], v[156:159], v[220:223], v[40:55]
  ds_read_b64_tr_b16 v[156:157], v251 offset:28672
  s_waitcnt lgkmcnt(14)
  ds_read_b64_tr_b16 v[158:159], v251 offset:30720
  s_waitcnt vmcnt(0)
  s_barrier
  s_mov_b32 m0, s38
  s_and_b32 s36, s40, 0x1ffff
  buffer_load_dwordx4 v4, s[8:11], s36 offen nt lds
  buffer_load_dwordx4 v5, s[8:11], s36 offen offset:1024 nt lds
  buffer_load_dwordx4 v6, s[8:11], s36 offen offset:2048 nt lds
  buffer_load_dwordx4 v7, s[8:11], s36 offen offset:3072 nt lds
  s_add_u32 s40, s40, 8192
  s_add_u32 s38, s38, 16384
  s_cmp_ge_u32 s38, s51
  s_cselect_b32 s43, 98304, 0
  s_sub_u32 s38, s38, s43
  s_nop 7
  s_waitcnt lgkmcnt(14)
  v_mfma_f32_32x32x16_bf16 v[64:79], v[128:131], v[56:59], v[64:79]
  ds_read_b128 v[128:131], v240 offset:32768
  v_max3_f32 v36, v40, v41, v42
  v_max3_f32 v37, v43, v44, v45
  v_max3_f32 v36, v36, v46, v47
  v_max3_f32 v37, v37, v48, v49
  s_waitcnt lgkmcnt(13)
  v_mfma_f32_32x32x16_bf16 v[80:95], v[132:135], v[56:59], v[80:95]
  ds_read_b128 v[132:135], v241 offset:32768
  v_max3_f32 v36, v36, v50, v51
  v_max3_f32 v37, v37, v52, v53
  v_max3_f32 v36, v36, v54, v55
  v_max_f32 v36, v36, v37
  v_cmp_lt_f32 vcc, s53, v36
  s_cbranch_vccnz L_rare_4
  s_waitcnt lgkmcnt(12)
  v_mfma_f32_32x32x16_bf16 v[96:111], v[136:139], v[56:59], v[96:111]
  ds_read_b128 v[136:139], v242 offset:32768
  v_exp_f32 v224, v40
  v_exp_f32 v225, v41
  s_waitcnt lgkmcnt(11)
  v_mfma_f32_32x32x16_bf16 v[112:127], v[140:143], v[56:59], v[112:127]
  ds_read_b128 v[140:143], v243 offset:32768
  v_exp_f32 v226, v42
  v_exp_f32 v227, v43
  v_exp_f32 v228, v44
  s_waitcnt lgkmcnt(10)
  v_mfma_f32_32x32x16_bf16 v[64:79], v[144:147], v[60:63], v[64:79]
  ds_read_b128 v[144:147], v244 offset:32768
  v_exp_f32 v229, v45
  v_exp_f32 v230, v46
  s_waitcnt lgkmcnt(9)
  v_mfma_f32_32x32x16_bf16 v[80:95], v[148:151], v[60:63], v[80:95]
  ds_read_b128 v[148:151], v245 offset:32768
  v_exp_f32 v231, v47
  v_exp_f32 v232, v48
  v_exp_f32 v233, v49
  s_waitcnt lgkmcnt(8)
  v_mfma_f32_32x32x16_bf16 v[96:111], v[152:155], v[60:63], v[96:111]
  ds_read_b128 v[152:155], v246 offset:32768
  v_exp_f32 v234, v50
  v_exp_f32 v235, v51
  s_waitcnt lgkmcnt(7)
  v_mfma_f32_32x32x16_bf16 v[112:127], v[156:159], v[60:63], v[112:127]
  ds_read_b128 v[156:159], v247 offset:32768
  v_exp_f32 v236, v52
  v_exp_f32 v237, v53
  v_exp_f32 v238, v54
  v_exp_f32 v239, v55
L_back_5:
  s_waitcnt lgkmcnt(7)
  v_mfma_f32_32x32x16_bf16 v[40:55], v[128:131], v[192:195], v[160:175]
  ds_read_b64_tr_b16 v[128:129], v248 offset:40960
  ds_read_b64_tr_b16 v[130:131], v248 offset:43008
  v_cvt_pk_bf16_f32 v56, v224, v225
  v_cvt_pk_bf16_f32 v57, v226, v227
  v_cvt_pk_bf16_f32 v58, v228, v229
  s_waitcnt lgkmcnt(8)
  v_mfma_f32_32x32x16_bf16 v[40:55], v[132:135], v[196:199], v[40:55]
  ds_read_b64_tr_b16 v[132:133], v249 offset:40960
  ds_read_b64_tr_b16 v[134:135], v249 offset:43008
  v_cvt_pk_bf16_f32 v59, v230, v231
  v_cvt_pk_bf16_f32 v60, v232, v233
  v_cvt_pk_bf16_f32 v61, v234, v235
  s_waitcnt lgkmcnt(9)
  v_mfma_f32_32x32x16_bf16 v[40:55], v[136:139], v[200:203], v[40:55]
  ds_read_b64_tr_b16 v[136:137], v250 offset:40960
  ds_read_b64_tr_b16 v[138:139], v250 offset:43008
  v_cvt_pk_bf16_f32 v62, v236, v237
  v_cvt_pk_bf16_f32 v63, v238, v239
  s_waitcnt lgkmcnt(10)
  v_mfma_f32_32x32x16_bf16 v[40:55], v[140:143], v[204:207], v[40:55]
  ds_read_b64_tr_b16 v[140:141], v251 offset:40960
  ds_read_b64_tr_b16 v[142:143], v251 offset:43008
  s_waitcnt lgkmcnt(11)
  v_mfma_f32_32x32x16_bf16 v[40:55], v[144:147], v[208:211], v[40:55]
  ds_read_b64_tr_b16 v[144:145], v248 offset:45056
  ds_read_b64_tr_b16 v[146:147], v248 offset:47104
  v_mfma_f32_16x16x32_bf16 v[252:255], v[176:179], v[56:59], v[252:255]
  s_waitcnt lgkmcnt(12)
  v_mfma_f32_32x32x16_bf16 v[40:55], v[148:151], v[212:215], v[40:55]
  ds_read_b64_tr_b16 v[148:149], v249 offset:45056
  ds_read_b64_tr_b16 v[150:151], v249 offset:47104
  s_waitcnt lgkmcnt(13)
  v_mfma_f32_32x32x16_bf16 v[40:55], v[152:155], v[216:219], v[40:55]
  ds_read_b64_tr_b16 v[152:153], v250 offset:45056
  ds_read_b64_tr_b16 v[154:155], v250 offset:47104
  v_mfma_f32_16x16x32_bf16 v[252:255], v[176:179], v[60:63], v[252:255]
  s_waitcnt lgkmcnt(14)
  v_mfma_f32_32x32x16_bf16 v[40:55], v[156:159], v[220:223], v[40:55]
  ds_read_b64_tr_b16 v[156:157], v251 offset:45056
  s_waitcnt lgkmcnt(14)
  ds_read_b64_tr_b16 v[158:159], v251 offset:47104
  v_xor_b32 v240, 0xc000, v240
  v_xor_b32 v241, 0xc000, v241
  v_xor_b32 v242, 0xc000, v242
  v_xor_b32 v243, 0xc000, v243
  v_xor_b32 v244, 0xc000, v244
  v_xor_b32 v245, 0xc000, v245
  v_xor_b32 v246, 0xc000, v246
  v_xor_b32 v247, 0xc000, v247
  v_xor_b32 v248, 0xc000, v248
  v_xor_b32 v249, 0xc000, v249
  v_xor_b32 v250, 0xc000, v250
  v_xor_b32 v251, 0xc000, v251
  s_waitcnt vmcnt(0)
  s_barrier
  s_mov_b32 m0, s38
  s_and_b32 s36, s40, 0x1ffff
  buffer_load_dwordx4 v4, s[8:11], s36 offen nt lds
  buffer_load_dwordx4 v5, s[8:11], s36 offen offset:1024 nt lds
  buffer_load_dwordx4 v6, s[8:11], s36 offen offset:2048 nt lds
  buffer_load_dwordx4 v7, s[8:11], s36 offen offset:3072 nt lds
  s_add_u32 s40, s40, 8192
  s_add_u32 s38, s38, 16384
  s_cmp_ge_u32 s38, s51
  s_cselect_b32 s43, 98304, 0
  s_sub_u32 s38, s38, s43
  s_nop 7
  s_waitcnt lgkmcnt(14)
  v_mfma_f32_32x32x16_bf16 v[64:79], v[128:131], v[56:59], v[64:79]
  ds_read_b128 v[128:131], v240 offset:0
  v_max3_f32 v36, v40, v41, v42
  v_max3_f32 v37, v43, v44, v45
  v_max3_f32 v36, v36, v46, v47
  v_max3_f32 v37, v37, v48, v49
  s_waitcnt lgkmcnt(13)
  v_mfma_f32_32x32x16_bf16 v[80:95], v[132:135], v[56:59], v[80:95]
  ds_read_b128 v[132:135], v241 offset:0
  v_max3_f32 v36, v36, v50, v51
  v_max3_f32 v37, v37, v52, v53
  v_max3_f32 v36, v36, v54, v55
  v_max_f32 v36, v36, v37
  v_cmp_lt_f32 vcc, s53, v36
  s_cbranch_vccnz L_rare_6
  s_waitcnt lgkmcnt(12)
  v_mfma_f32_32x32x16_bf16 v[96:111], v[136:139], v[56:59], v[96:111]
  ds_read_b128 v[136:139], v242 offset:0
  v_exp_f32 v224, v40
  v_exp_f32 v225, v41
  s_waitcnt lgkmcnt(11)
  v_mfma_f32_32x32x16_bf16 v[112:127], v[140:143], v[56:59], v[112:127]
  ds_read_b128 v[140:143], v243 offset:0
  v_exp_f32 v226, v42
  v_exp_f32 v227, v43
  v_exp_f32 v228, v44
  s_waitcnt lgkmcnt(10)
  v_mfma_f32_32x32x16_bf16 v[64:79], v[144:147], v[60:63], v[64:79]
  ds_read_b128 v[144:147], v244 offset:0
  v_exp_f32 v229, v45
  v_exp_f32 v230, v46
  s_waitcnt lgkmcnt(9)
  v_mfma_f32_32x32x16_bf16 v[80:95], v[148:151], v[60:63], v[80:95]
  ds_read_b128 v[148:151], v245 offset:0
  v_exp_f32 v231, v47
  v_exp_f32 v232, v48
  v_exp_f32 v233, v49
  s_waitcnt lgkmcnt(8)
  v_mfma_f32_32x32x16_bf16 v[96:111], v[152:155], v[60:63], v[96:111]
  ds_read_b128 v[152:155], v246 offset:0
  v_exp_f32 v234, v50
  v_exp_f32 v235, v51
  s_waitcnt lgkmcnt(7)
  v_mfma_f32_32x32x16_bf16 v[112:127], v[156:159], v[60:63], v[112:127]
  ds_read_b128 v[156:159], v247 offset:0
  v_exp_f32 v236, v52
  v_exp_f32 v237, v53
  v_exp_f32 v238, v54
  v_exp_f32 v239, v55
L_back_7:
  s_waitcnt lgkmcnt(7)
  v_mfma_f32_32x32x16_bf16 v[40:55], v[128:131], v[192:195], v[160:175]
  ds_read_b64_tr_b16 v[128:129], v248 offset:8192
  ds_read_b64_tr_b16 v[130:131], v248 offset:10240
  v_cvt_pk_bf16_f32 v56, v224, v225
  v_cvt_pk_bf16_f32 v57, v226, v227
  v_cvt_pk_bf16_f32 v58, v228, v229
  s_waitcnt lgkmcnt(8)
  v_mfma_f32_32x32x16_bf16 v[40:55], v[132:135], v[196:199], v[40:55]
  ds_read_b64_tr_b16 v[132:133], v249 offset:8192
  ds_read_b64_tr_b16 v[134:135], v249 offset:10240
  v_cvt_pk_bf16_f32 v59, v230, v231
  v_cvt_pk_bf16_f32 v60, v232, v233
  v_cvt_pk_bf16_f32 v61, v234, v235
  s_waitcnt lgkmcnt(9)
  v_mfma_f32_32x32x16_bf16 v[40:55], v[136:139], v[200:203], v[40:55]
  ds_read_b64_tr_b16 v[136:137], v250 offset:8192
  ds_read_b64_tr_b16 v[138:139], v250 offset:10240
  v_cvt_pk_bf16_f32 v62, v236, v237
  v_cvt_pk_bf16_f32 v63, v238, v239
  s_waitcnt lgkmcnt(10)
  v_mfma_f32_32x32x16_bf16 v[40:55], v[140:143], v[204:207], v[40:55]
  ds_read_b64_tr_b16 v[140:141], v251 offset:8192
  ds_read_b64_tr_b16 v[142:143], v251 offset:10240
  s_waitcnt lgkmcnt(11)
  v_mfma_f32_32x32x16_bf16 v[40:55], v[144:147], v[208:211], v[40:55]
  ds_read_b64_tr_b16 v[144:145], v248 offset:12288
  ds_read_b64_tr_b16 v[146:147], v248 offset:14336
  v_mfma_f32_16x16x32_bf16 v[252:255], v[176:179], v[56:59], v[252:255]
  s_waitcnt lgkmcnt(12)
  v_mfma_f32_32x32x16_bf16 v[40:55], v[148:151], v[212:215], v[40:55]
  ds_read_b64_tr_b16 v[148:149], v249 offset:12288
  ds_read_b64_tr_b16 v[150:151], v249 offset:14336
  s_waitcnt lgkmcnt(13)
  v_mfma_f32_32x32x16_bf16 v[40:55], v[152:155], v[216:219], v[40:55]
  ds_read_b64_tr_b16 v[152:153], v250 offset:12288
  ds_read_b64_tr_b16 v[154:155], v250 offset:14336
  v_mfma_f32_16x16x32_bf16 v[252:255], v[176:179], v[60:63], v[252:255]
  s_waitcnt lgkmcnt(14)
  v_mfma_f32_32x32x16_bf16 v[40:55], v[156:159], v[220:223], v[40:55]
  ds_read_b64_tr_b16 v[156:157], v251 offset:12288
  s_waitcnt lgkmcnt(14)
  ds_read_b64_tr_b16 v[158:159], v251 offset:14336
  s_waitcnt vmcnt(0)
  s_barrier
  s_add_u32 s32, s32, 1
  s_cmp_lt_u32 s32, 5
  s_cbranch_scc1 L_attn_1
  s_nop 7
  s_waitcnt lgkmcnt(14)
  v_mfma_f32_32x32x16_bf16 v[64:79], v[128:131], v[56:59], v[64:79]
  ds_read_b64_tr_b16 v[128:129], v248 offset:24576
  s_waitcnt lgkmcnt(14)
  ds_read_b64_tr_b16 v[130:131], v248 offset:26624
  v_max3_f32 v36, v40, v41, v42
  v_max3_f32 v37, v43, v44, v45
  v_max3_f32 v36, v36, v46, v47
  v_max3_f32 v37, v37, v48, v49
  s_waitcnt lgkmcnt(14)
  v_mfma_f32_32x32x16_bf16 v[80:95], v[132:135], v[56:59], v[80:95]
  ds_read_b64_tr_b16 v[132:133], v249 offset:24576
  s_waitcnt lgkmcnt(14)
  ds_read_b64_tr_b16 v[134:135], v249 offset:26624
  v_max3_f32 v36, v36, v50, v51
  v_max3_f32 v37, v37, v52, v53
  v_max3_f32 v36, v36, v54, v55
  v_max_f32 v36, v36, v37
  v_cmp_lt_f32 vcc, s53, v36
  s_cbranch_vccnz L_rare_8
  s_waitcnt lgkmcnt(14)
  v_mfma_f32_32x32x16_bf16 v[96:111], v[136:139], v[56:59], v[96:111]
  ds_read_b64_tr_b16 v[136:137], v250 offset:24576
  s_waitcnt lgkmcnt(14)
  ds_read_b64_tr_b16 v[138:139], v250 offset:26624
  v_exp_f32 v224, v40
  v_exp_f32 v225, v41
  s_waitcnt lgkmcnt(14)
  v_mfma_f32_32x32x16_bf16 v[112:127], v[140:143], v[56:59], v[112:127]
  ds_read_b64_tr_b16 v[140:141], v251 offset:24576
  s_waitcnt lgkmcnt(14)
  ds_read_b64_tr_b16 v[142:143], v251 offset:26624
  v_exp_f32 v226, v42
  v_exp_f32 v227, v43
  v_exp_f32 v228, v44
  s_waitcnt lgkmcnt(14)
  v_mfma_f32_32x32x16_bf16 v[64:79], v[144:147], v[60:63], v[64:79]
  ds_read_b64_tr_b16 v[144:145], v248 offset:28672
  s_waitcnt lgkmcnt(14)
  ds_read_b64_tr_b16 v[146:147], v248 offset:30720
  v_exp_f32 v229, v45
  v_exp_f32 v230, v46
  s_waitcnt lgkmcnt(14)
  v_mfma_f32_32x32x16_bf16 v[80:95], v[148:151], v[60:63], v[80:95]
  ds_read_b64_tr_b16 v[148:149], v249 offset:28672
  s_waitcnt lgkmcnt(14)
  ds_read_b64_tr_b16 v[150:151], v249 offset:30720
  v_exp_f32 v231, v47
  v_exp_f32 v232, v48
  v_exp_f32 v233, v49
  s_waitcnt lgkmcnt(14)
  v_mfma_f32_32x32x16_bf16 v[96:111], v[152:155], v[60:63], v[96:111]
  ds_read_b64_tr_b16 v[152:153], v250 offset:28672
  s_waitcnt lgkmcnt(14)
  ds_read_b64_tr_b16 v[154:155], v250 offset:30720
  v_exp_f32 v234, v50
  v_exp_f32 v235, v51
  s_waitcnt lgkmcnt(14)
  v_mfma_f32_32x32x16_bf16 v[112:127], v[156:159], v[60:63], v[112:127]
  ds_read_b64_tr_b16 v[156:157], v251 offset:28672
  s_waitcnt lgkmcnt(14)
  ds_read_b64_tr_b16 v[158:159], v251 offset:30720
  v_exp_f32 v236, v52
  v_exp_f32 v237, v53
  v_exp_f32 v238, v54
  v_exp_f32 v239, v55
L_back_9:
  v_cvt_pk_bf16_f32 v56, v224, v225
  v_cvt_pk_bf16_f32 v57, v226, v227
  v_cvt_pk_bf16_f32 v58, v228, v229
  v_cvt_pk_bf16_f32 v59, v230, v231
  v_cvt_pk_bf16_f32 v60, v232, v233
  v_cvt_pk_bf16_f32 v61, v234, v235
  v_cvt_pk_bf16_f32 v62, v236, v237
  v_cvt_pk_bf16_f32 v63, v238, v239
  s_nop 1
  v_mfma_f32_16x16x32_bf16 v[252:255], v[176:179], v[56:59], v[252:255]
  v_mfma_f32_16x16x32_bf16 v[252:255], v[176:179], v[60:63], v[252:255]
  s_waitcnt lgkmcnt(14)
  v_mfma_f32_32x32x16_bf16 v[64:79], v[128:131], v[56:59], v[64:79]
  s_waitcnt lgkmcnt(12)
  v_mfma_f32_32x32x16_bf16 v[80:95], v[132:135], v[56:59], v[80:95]
  s_waitcnt lgkmcnt(10)
  v_mfma_f32_32x32x16_bf16 v[96:111], v[136:139], v[56:59], v[96:111]
  s_waitcnt lgkmcnt(8)
  v_mfma_f32_32x32x16_bf16 v[112:127], v[140:143], v[56:59], v[112:127]
  s_waitcnt lgkmcnt(6)
  v_mfma_f32_32x32x16_bf16 v[64:79], v[144:147], v[60:63], v[64:79]
  s_waitcnt lgkmcnt(4)
  v_mfma_f32_32x32x16_bf16 v[80:95], v[148:151], v[60:63], v[80:95]
  s_waitcnt lgkmcnt(2)
  v_mfma_f32_32x32x16_bf16 v[96:111], v[152:155], v[60:63], v[96:111]
  s_waitcnt lgkmcnt(0)
  v_mfma_f32_32x32x16_bf16 v[112:127], v[156:159], v[60:63], v[112:127]
  s_nop 7
  v_rcp_f32 v36, v252
  s_nop 7
  v_pk_mul_f32 v[64:65], v[64:65], v[36:37] op_sel_hi:[1,0]
  v_pk_mul_f32 v[66:67], v[66:67], v[36:37] op_sel_hi:[1,0]
  v_cvt_pk_bf16_f32 v192, v64, v65
  v_pk_mul_f32 v[68:69], v[68:69], v[36:37] op_sel_hi:[1,0]
  v_cvt_pk_bf16_f32 v193, v66, v67
  v_pk_mul_f32 v[70:71], v[70:71], v[36:37] op_sel_hi:[1,0]
  v_cvt_pk_bf16_f32 v194, v68, v69
  v_pk_mul_f32 v[72:73], v[72:73], v[36:37] op_sel_hi:[1,0]
  v_cvt_pk_bf16_f32 v195, v70, v71
  v_pk_mul_f32 v[74:75], v[74:75], v[36:37] op_sel_hi:[1,0]
  v_cvt_pk_bf16_f32 v196, v72, v73
  v_pk_mul_f32 v[76:77], v[76:77], v[36:37] op_sel_hi:[1,0]
  v_cvt_pk_bf16_f32 v197, v74, v75
  v_pk_mul_f32 v[78:79], v[78:79], v[36:37] op_sel_hi:[1,0]
  v_cvt_pk_bf16_f32 v198, v76, v77
  v_pk_mul_f32 v[80:81], v[80:81], v[36:37] op_sel_hi:[1,0]
  v_cvt_pk_bf16_f32 v199, v78, v79
  v_pk_mul_f32 v[82:83], v[82:83], v[36:37] op_sel_hi:[1,0]
  v_cvt_pk_bf16_f32 v200, v80, v81
  v_pk_mul_f32 v[84:85], v[84:85], v[36:37] op_sel_hi:[1,0]
  v_cvt_pk_bf16_f32 v201, v82, v83
  v_pk_mul_f32 v[86:87], v[86:87], v[36:37] op_sel_hi:[1,0]
  v_cvt_pk_bf16_f32 v202, v84, v85
  v_pk_mul_f32 v[88:89], v[88:89], v[36:37] op_sel_hi:[1,0]
  v_cvt_pk_bf16_f32 v203, v86, v87
  v_pk_mul_f32 v[90:91], v[90:91], v[36:37] op_sel_hi:[1,0]
  v_cvt_pk_bf16_f32 v204, v88, v89
  v_pk_mul_f32 v[92:93], v[92:93], v[36:37] op_sel_hi:[1,0]
  v_cvt_pk_bf16_f32 v205, v90, v91
  v_pk_mul_f32 v[94:95], v[94:95], v[36:37] op_sel_hi:[1,0]
  v_cvt_pk_bf16_f32 v206, v92, v93
  v_pk_mul_f32 v[96:97], v[96:97], v[36:37] op_sel_hi:[1,0]
  v_cvt_pk_bf16_f32 v207, v94, v95
  v_pk_mul_f32 v[98:99], v[98:99], v[36:37] op_sel_hi:[1,0]
  v_cvt_pk_bf16_f32 v208, v96, v97
  v_pk_mul_f32 v[100:101], v[100:101], v[36:37] op_sel_hi:[1,0]
  v_cvt_pk_bf16_f32 v209, v98, v99
  v_pk_mul_f32 v[102:103], v[102:103], v[36:37] op_sel_hi:[1,0]
  v_cvt_pk_bf16_f32 v210, v100, v101
  v_pk_mul_f32 v[104:105], v[104:105], v[36:37] op_sel_hi:[1,0]
  v_cvt_pk_bf16_f32 v211, v102, v103
  v_pk_mul_f32 v[106:107], v[106:107], v[36:37] op_sel_hi:[1,0]
  v_cvt_pk_bf16_f32 v212, v104, v105
  v_pk_mul_f32 v[108:109], v[108:109], v[36:37] op_sel_hi:[1,0]
  v_cvt_pk_bf16_f32 v213, v106, v107
  v_pk_mul_f32 v[110:111], v[110:111], v[36:37] op_sel_hi:[1,0]
  v_cvt_pk_bf16_f32 v214, v108, v109
  v_pk_mul_f32 v[112:113], v[112:113], v[36:37] op_sel_hi:[1,0]
  v_cvt_pk_bf16_f32 v215, v110, v111
  v_pk_mul_f32 v[114:115], v[114:115], v[36:37] op_sel_hi:[1,0]
  v_cvt_pk_bf16_f32 v216, v112, v113
  v_pk_mul_f32 v[116:117], v[116:117], v[36:37] op_sel_hi:[1,0]
  v_cvt_pk_bf16_f32 v217, v114, v115
  v_pk_mul_f32 v[118:119], v[118:119], v[36:37] op_sel_hi:[1,0]
  v_cvt_pk_bf16_f32 v218, v116, v117
  v_pk_mul_f32 v[120:121], v[120:121], v[36:37] op_sel_hi:[1,0]
  v_cvt_pk_bf16_f32 v219, v118, v119
  v_pk_mul_f32 v[122:123], v[122:123], v[36:37] op_sel_hi:[1,0]
  v_cvt_pk_bf16_f32 v220, v120, v121
  v_pk_mul_f32 v[124:125], v[124:125], v[36:37] op_sel_hi:[1,0]
  v_cvt_pk_bf16_f32 v221, v122, v123
  v_pk_mul_f32 v[126:127], v[126:127], v[36:37] op_sel_hi:[1,0]
  v_cvt_pk_bf16_f32 v222, v124, v125
  v_cvt_pk_bf16_f32 v223, v126, v127
  v_add_u32 v20, 147456, v17
  v_xor_b32 v21, 64, v20
  v_xor_b32 v22, 128, v20
  v_xor_b32 v23, 192, v20
  ds_read_b64_tr_b16 v[32:33], v20 offset:0
  ds_read_b64_tr_b16 v[34:35], v20 offset:4096
  ds_read_b64_tr_b16 v[36:37], v21 offset:0
  ds_read_b64_tr_b16 v[38:39], v21 offset:4096
  ds_read_b64_tr_b16 v[40:41], v22 offset:0
  ds_read_b64_tr_b16 v[42:43], v22 offset:4096
  ds_read_b64_tr_b16 v[44:45], v23 offset:0
  ds_read_b64_tr_b16 v[46:47], v23 offset:4096
  ds_read_b64_tr_b16 v[48:49], v20 offset:256
  ds_read_b64_tr_b16 v[50:51], v20 offset:4352
  ds_read_b64_tr_b16 v[52:53], v21 offset:256
  ds_read_b64_tr_b16 v[54:55], v21 offset:4352
  ds_read_b64_tr_b16 v[56:57], v22 offset:256
  ds_read_b64_tr_b16 v[58:59], v22 offset:4352
  ds_read_b64_tr_b16 v[60:61], v23 offset:256
  s_waitcnt lgkmcnt(14)
  ds_read_b64_tr_b16 v[62:63], v23 offset:4352
  s_barrier
  s_cmp_eq_u32 s3, 1
  s_cbranch_scc0 L_cc_10
  s_lshr_b32 s43, s2, 3
  s_lshl_b32 s43, s43, 2
  v_mov_b32 v2, s43
  v_mov_b32 v3, 1
  s_mov_b64 exec, 1
  global_atomic_add v2, v3, s[70:71]
  s_mov_b64 exec, -1
L_cc_10:
  v_add_u32 v28, s39, v18
  s_waitcnt lgkmcnt(14)
  ds_write_b128 v28, v[192:195] offset:0
  s_waitcnt lgkmcnt(14)
  ds_write_b128 v28, v[196:199] offset:1024
  s_waitcnt lgkmcnt(14)
  ds_write_b128 v28, v[200:203] offset:2048
  s_waitcnt lgkmcnt(14)
  ds_write_b128 v28, v[204:207] offset:3072
  s_waitcnt lgkmcnt(14)
  ds_write_b128 v28, v[208:211] offset:4096
  s_waitcnt lgkmcnt(14)
  ds_write_b128 v28, v[212:215] offset:5120
  s_waitcnt lgkmcnt(14)
  ds_write_b128 v28, v[216:219] offset:6144
  s_waitcnt lgkmcnt(14)
  ds_write_b128 v28, v[220:223] offset:7168
  v_add_u32 v20, 131072, v17
  v_xor_b32 v21, 64, v20
  v_xor_b32 v22, 128, v20
  v_xor_b32 v23, 192, v20
  v_mfma_f32_32x32x16_bf16 v[64:79], v[32:35], v[192:195], 0
  s_waitcnt lgkmcnt(14)
  ds_read_b64_tr_b16 v[32:33], v20 offset:0
  s_waitcnt lgkmcnt(14)
  ds_read_b64_tr_b16 v[34:35], v20 offset:4096
  v_mfma_f32_32x32x16_bf16 v[80:95], v[36:39], v[192:195], 0
  s_waitcnt lgkmcnt(14)
  ds_read_b64_tr_b16 v[36:37], v21 offset:0
  s_waitcnt lgkmcnt(14)
  ds_read_b64_tr_b16 v[38:39], v21 offset:4096
  v_mfma_f32_32x32x16_bf16 v[96:111], v[40:43], v[192:195], 0
  s_waitcnt lgkmcnt(14)
  ds_read_b64_tr_b16 v[40:41], v22 offset:0
  s_waitcnt lgkmcnt(14)
  ds_read_b64_tr_b16 v[42:43], v22 offset:4096
  v_mfma_f32_32x32x16_bf16 v[112:127], v[44:47], v[192:195], 0
  s_waitcnt lgkmcnt(14)
  ds_read_b64_tr_b16 v[44:45], v23 offset:0
  s_waitcnt lgkmcnt(14)
  ds_read_b64_tr_b16 v[46:47], v23 offset:4096
  v_mfma_f32_32x32x16_bf16 v[128:143], v[48:51], v[192:195], 0
  s_waitcnt lgkmcnt(14)
  ds_read_b64_tr_b16 v[48:49], v20 offset:256
  s_waitcnt lgkmcnt(14)
  ds_read_b64_tr_b16 v[50:51], v20 offset:4352
  v_mfma_f32_32x32x16_bf16 v[144:159], v[52:55], v[192:195], 0
  s_waitcnt lgkmcnt(14)
  ds_read_b64_tr_b16 v[52:53], v21 offset:256
  s_waitcnt lgkmcnt(14)
  ds_read_b64_tr_b16 v[54:55], v21 offset:4352
  v_mfma_f32_32x32x16_bf16 v[160:175], v[56:59], v[192:195], 0
  s_waitcnt lgkmcnt(14)
  ds_read_b64_tr_b16 v[56:57], v22 offset:256
  s_waitcnt lgkmcnt(14)
  ds_read_b64_tr_b16 v[58:59], v22 offset:4352
  v_mfma_f32_32x32x16_bf16 v[176:191], v[60:63], v[192:195], 0
  s_waitcnt lgkmcnt(14)
  ds_read_b64_tr_b16 v[60:61], v23 offset:256
  s_waitcnt lgkmcnt(14)
  ds_read_b64_tr_b16 v[62:63], v23 offset:4352
  s_barrier
  v_add_u32 v28, s39, v18
  s_cmp_eq_u32 s46, 0
  s_cselect_b32 s43, 49152, 0
  s_lshl_b32 s44, s47, 13
  s_add_u32 s43, s43, s44
  v_add_u32 v29, s43, v18
  s_waitcnt lgkmcnt(14)
  ds_read_b128 v[224:227], v29 offset:0
  s_waitcnt lgkmcnt(14)
  ds_read_b128 v[228:231], v29 offset:1024
  s_waitcnt lgkmcnt(14)
  ds_read_b128 v[232:235], v29 offset:2048
  s_waitcnt lgkmcnt(14)
  ds_read_b128 v[236:239], v29 offset:3072
  s_waitcnt lgkmcnt(14)
  ds_read_b128 v[240:243], v29 offset:4096
  s_waitcnt lgkmcnt(14)
  ds_read_b128 v[244:247], v29 offset:5120
  s_waitcnt lgkmcnt(14)
  ds_read_b128 v[248:251], v29 offset:6144
  s_waitcnt lgkmcnt(14)
  ds_read_b128 v[252:255], v29 offset:7168
  v_add_u32 v20, 114688, v17
  v_xor_b32 v21, 64, v20
  v_xor_b32 v22, 128, v20
  v_xor_b32 v23, 192, v20
  v_mfma_f32_32x32x16_bf16 v[64:79], v[32:35], v[196:199], v[64:79]
  s_waitcnt lgkmcnt(14)
  ds_read_b64_tr_b16 v[32:33], v20 offset:0
  s_waitcnt lgkmcnt(14)
  ds_read_b64_tr_b16 v[34:35], v20 offset:4096
  v_mfma_f32_32x32x16_bf16 v[80:95], v[36:39], v[196:199], v[80:95]
  s_waitcnt lgkmcnt(14)
  ds_read_b64_tr_b16 v[36:37], v21 offset:0
  s_waitcnt lgkmcnt(14)
  ds_read_b64_tr_b16 v[38:39], v21 offset:4096
  v_mfma_f32_32x32x16_bf16 v[96:111], v[40:43], v[196:199], v[96:111]
  s_waitcnt lgkmcnt(14)
  ds_read_b64_tr_b16 v[40:41], v22 offset:0
  s_waitcnt lgkmcnt(14)
  ds_read_b64_tr_b16 v[42:43], v22 offset:4096
  v_mfma_f32_32x32x16_bf16 v[112:127], v[44:47], v[196:199], v[112:127]
  s_waitcnt lgkmcnt(14)
  ds_read_b64_tr_b16 v[44:45], v23 offset:0
  s_waitcnt lgkmcnt(14)
  ds_read_b64_tr_b16 v[46:47], v23 offset:4096
  v_mfma_f32_32x32x16_bf16 v[128:143], v[48:51], v[196:199], v[128:143]
  s_waitcnt lgkmcnt(14)
  ds_read_b64_tr_b16 v[48:49], v20 offset:256
  s_waitcnt lgkmcnt(14)
  ds_read_b64_tr_b16 v[50:51], v20 offset:4352
  v_mfma_f32_32x32x16_bf16 v[144:159], v[52:55], v[196:199], v[144:159]
  s_waitcnt lgkmcnt(14)
  ds_read_b64_tr_b16 v[52:53], v21 offset:256
  s_waitcnt lgkmcnt(14)
  ds_read_b64_tr_b16 v[54:55], v21 offset:4352
  v_mfma_f32_32x32x16_bf16 v[160:175], v[56:59], v[196:199], v[160:175]
  s_waitcnt lgkmcnt(14)
  ds_read_b64_tr_b16 v[56:57], v22 offset:256
  s_waitcnt lgkmcnt(14)
  ds_read_b64_tr_b16 v[58:59], v22 offset:4352
  v_mfma_f32_32x32x16_bf16 v[176:191], v[60:63], v[196:199], v[176:191]
  s_waitcnt lgkmcnt(14)
  ds_read_b64_tr_b16 v[60:61], v23 offset:256
  s_waitcnt lgkmcnt(14)
  ds_read_b64_tr_b16 v[62:63], v23 offset:4352
  s_barrier
  v_add_u32 v20, 98304, v17
  v_xor_b32 v21, 64, v20
  v_xor_b32 v22, 128, v20
  v_xor_b32 v23, 192, v20
  s_waitcnt lgkmcnt(14)
  v_mfma_f32_32x32x16_bf16 v[64:79], v[32:35], v[200:203], v[64:79]
  ds_read_b64_tr_b16 v[32:33], v20 offset:0
  s_waitcnt lgkmcnt(14)
  ds_read_b64_tr_b16 v[34:35], v20 offset:4096
  s_waitcnt lgkmcnt(14)
  v_mfma_f32_32x32x16_bf16 v[80:95], v[36:39], v[200:203], v[80:95]
  ds_read_b64_tr_b16 v[36:37], v21 offset:0
  s_waitcnt lgkmcnt(14)
  ds_read_b64_tr_b16 v[38:39], v21 offset:4096
  s_waitcnt lgkmcnt(14)
  v_mfma_f32_32x32x16_bf16 v[96:111], v[40:43], v[200:203], v[96:111]
  ds_read_b64_tr_b16 v[40:41], v22 offset:0
  s_waitcnt lgkmcnt(14)
  ds_read_b64_tr_b16 v[42:43], v22 offset:4096
  s_waitcnt lgkmcnt(14)
  v_mfma_f32_32x32x16_bf16 v[112:127], v[44:47], v[200:203], v[112:127]
  ds_read_b64_tr_b16 v[44:45], v23 offset:0
  s_waitcnt lgkmcnt(14)
  ds_read_b64_tr_b16 v[46:47], v23 offset:4096
  s_waitcnt lgkmcnt(14)
  v_mfma_f32_32x32x16_bf16 v[128:143], v[48:51], v[200:203], v[128:143]
  ds_read_b64_tr_b16 v[48:49], v20 offset:256
  s_waitcnt lgkmcnt(14)
  ds_read_b64_tr_b16 v[50:51], v20 offset:4352
  s_waitcnt lgkmcnt(14)
  v_mfma_f32_32x32x16_bf16 v[144:159], v[52:55], v[200:203], v[144:159]
  ds_read_b64_tr_b16 v[52:53], v21 offset:256
  s_waitcnt lgkmcnt(14)
  ds_read_b64_tr_b16 v[54:55], v21 offset:4352
  s_waitcnt lgkmcnt(14)
  v_mfma_f32_32x32x16_bf16 v[160:175], v[56:59], v[200:203], v[160:175]
  ds_read_b64_tr_b16 v[56:57], v22 offset:256
  s_waitcnt lgkmcnt(14)
  ds_read_b64_tr_b16 v[58:59], v22 offset:4352
  s_waitcnt lgkmcnt(14)
  v_mfma_f32_32x32x16_bf16 v[176:191], v[60:63], v[200:203], v[176:191]
  ds_read_b64_tr_b16 v[60:61], v23 offset:256
  s_waitcnt lgkmcnt(14)
  ds_read_b64_tr_b16 v[62:63], v23 offset:4352
  s_barrier
  v_add_u32 v20, 32768, v17
  v_xor_b32 v21, 64, v20
  v_xor_b32 v22, 128, v20
  v_xor_b32 v23, 192, v20
  s_waitcnt lgkmcnt(14)
  v_mfma_f32_32x32x16_bf16 v[64:79], v[32:35], v[204:207], v[64:79]
  ds_read_b64_tr_b16 v[32:33], v20 offset:0
  s_waitcnt lgkmcnt(14)
  ds_read_b64_tr_b16 v[34:35], v20 offset:4096
  s_waitcnt lgkmcnt(14)
  v_mfma_f32_32x32x16_bf16 v[80:95], v[36:39], v[204:207], v[80:95]
  ds_read_b64_tr_b16 v[36:37], v21 offset:0
  s_waitcnt lgkmcnt(14)
  ds_read_b64_tr_b16 v[38:39], v21 offset:4096
  s_waitcnt lgkmcnt(14)
  v_mfma_f32_32x32x16_bf16 v[96:111], v[40:43], v[204:207], v[96:111]
  ds_read_b64_tr_b16 v[40:41], v22 offset:0
  s_waitcnt lgkmcnt(14)
  ds_read_b64_tr_b16 v[42:43], v22 offset:4096
  s_waitcnt lgkmcnt(14)
  v_mfma_f32_32x32x16_bf16 v[112:127], v[44:47], v[204:207], v[112:127]
  ds_read_b64_tr_b16 v[44:45], v23 offset:0
  s_waitcnt lgkmcnt(14)
  ds_read_b64_tr_b16 v[46:47], v23 offset:4096
  s_waitcnt lgkmcnt(14)
  v_mfma_f32_32x32x16_bf16 v[128:143], v[48:51], v[204:207], v[128:143]
  ds_read_b64_tr_b16 v[48:49], v20 offset:256
  s_waitcnt lgkmcnt(14)
  ds_read_b64_tr_b16 v[50:51], v20 offset:4352
  s_waitcnt lgkmcnt(14)
  v_mfma_f32_32x32x16_bf16 v[144:159], v[52:55], v[204:207], v[144:159]
  ds_read_b64_tr_b16 v[52:53], v21 offset:256
  s_waitcnt lgkmcnt(14)
  ds_read_b64_tr_b16 v[54:55], v21 offset:4352
  s_waitcnt lgkmcnt(14)
  v_mfma_f32_32x32x16_bf16 v[160:175], v[56:59], v[204:207], v[160:175]
  ds_read_b64_tr_b16 v[56:57], v22 offset:256
  s_waitcnt lgkmcnt(14)
  ds_read_b64_tr_b16 v[58:59], v22 offset:4352
  s_waitcnt lgkmcnt(14)
  v_mfma_f32_32x32x16_bf16 v[176:191], v[60:63], v[204:207], v[176:191]
  ds_read_b64_tr_b16 v[60:61], v23 offset:256
  s_waitcnt lgkmcnt(14)
  ds_read_b64_tr_b16 v[62:63], v23 offset:4352
  s_barrier
  v_add_u32 v20, 81920, v17
  v_xor_b32 v21, 64, v20
  v_xor_b32 v22, 128, v20
  v_xor_b32 v23, 192, v20
  s_waitcnt lgkmcnt(14)
  v_mfma_f32_32x32x16_bf16 v[64:79], v[32:35], v[208:211], v[64:79]
  ds_read_b64_tr_b16 v[32:33], v20 offset:0
  s_waitcnt lgkmcnt(14)
  ds_read_b64_tr_b16 v[34:35], v20 offset:4096
  s_waitcnt lgkmcnt(14)
  v_mfma_f32_32x32x16_bf16 v[80:95], v[36:39], v[208:211], v[80:95]
  ds_read_b64_tr_b16 v[36:37], v21 offset:0
  s_waitcnt lgkmcnt(14)
  ds_read_b64_tr_b16 v[38:39], v21 offset:4096
  s_waitcnt lgkmcnt(14)
  v_mfma_f32_32x32x16_bf16 v[96:111], v[40:43], v[208:211], v[96:111]
  ds_read_b64_tr_b16 v[40:41], v22 offset:0
  s_waitcnt lgkmcnt(14)
  ds_read_b64_tr_b16 v[42:43], v22 offset:4096
  s_waitcnt lgkmcnt(14)
  v_mfma_f32_32x32x16_bf16 v[112:127], v[44:47], v[208:211], v[112:127]
  ds_read_b64_tr_b16 v[44:45], v23 offset:0
  s_waitcnt lgkmcnt(14)
  ds_read_b64_tr_b16 v[46:47], v23 offset:4096
  s_waitcnt lgkmcnt(14)
  v_mfma_f32_32x32x16_bf16 v[128:143], v[48:51], v[208:211], v[128:143]
  ds_read_b64_tr_b16 v[48:49], v20 offset:256
  s_waitcnt lgkmcnt(14)
  ds_read_b64_tr_b16 v[50:51], v20 offset:4352
  s_waitcnt lgkmcnt(14)
  v_mfma_f32_32x32x16_bf16 v[144:159], v[52:55], v[208:211], v[144:159]
  ds_read_b64_tr_b16 v[52:53], v21 offset:256
  s_waitcnt lgkmcnt(14)
  ds_read_b64_tr_b16 v[54:55], v21 offset:4352
  s_waitcnt lgkmcnt(14)
  v_mfma_f32_32x32x16_bf16 v[160:175], v[56:59], v[208:211], v[160:175]
  ds_read_b64_tr_b16 v[56:57], v22 offset:256
  s_waitcnt lgkmcnt(14)
  ds_read_b64_tr_b16 v[58:59], v22 offset:4352
  s_waitcnt lgkmcnt(14)
  v_mfma_f32_32x32x16_bf16 v[176:191], v[60:63], v[208:211], v[176:191]
  ds_read_b64_tr_b16 v[60:61], v23 offset:256
  s_waitcnt lgkmcnt(14)
  ds_read_b64_tr_b16 v[62:63], v23 offset:4352
  s_barrier
  v_add_u32 v20, 147456, v17
  v_xor_b32 v21, 64, v20
  v_xor_b32 v22, 128, v20
  v_xor_b32 v23, 192, v20
  s_waitcnt lgkmcnt(14)
  v_mfma_f32_32x32x16_bf16 v[64:79], v[32:35], v[212:215], v[64:79]
  ds_read_b64_tr_b16 v[32:33], v20 offset:0
  s_waitcnt lgkmcnt(14)
  ds_read_b64_tr_b16 v[34:35], v20 offset:4096
  s_waitcnt lgkmcnt(14)
  v_mfma_f32_32x32x16_bf16 v[80:95], v[36:39], v[212:215], v[80:95]
  ds_read_b64_tr_b16 v[36:37], v21 offset:0
  s_waitcnt lgkmcnt(14)
  ds_read_b64_tr_b16 v[38:39], v21 offset:4096
  s_waitcnt lgkmcnt(14)
  v_mfma_f32_32x32x16_bf16 v[96:111], v[40:43], v[212:215], v[96:111]
  ds_read_b64_tr_b16 v[40:41], v22 offset:0
  s_waitcnt lgkmcnt(14)
  ds_read_b64_tr_b16 v[42:43], v22 offset:4096
  s_waitcnt lgkmcnt(14)
  v_mfma_f32_32x32x16_bf16 v[112:127], v[44:47], v[212:215], v[112:127]
  ds_read_b64_tr_b16 v[44:45], v23 offset:0
  s_waitcnt lgkmcnt(14)
  ds_read_b64_tr_b16 v[46:47], v23 offset:4096
  s_waitcnt lgkmcnt(14)
  v_mfma_f32_32x32x16_bf16 v[128:143], v[48:51], v[212:215], v[128:143]
  ds_read_b64_tr_b16 v[48:49], v20 offset:256
  s_waitcnt lgkmcnt(14)
  ds_read_b64_tr_b16 v[50:51], v20 offset:4352
  s_waitcnt lgkmcnt(14)
  v_mfma_f32_32x32x16_bf16 v[144:159], v[52:55], v[212:215], v[144:159]
  ds_read_b64_tr_b16 v[52:53], v21 offset:256
  s_waitcnt lgkmcnt(14)
  ds_read_b64_tr_b16 v[54:55], v21 offset:4352
  s_waitcnt lgkmcnt(14)
  v_mfma_f32_32x32x16_bf16 v[160:175], v[56:59], v[212:215], v[160:175]
  ds_read_b64_tr_b16 v[56:57], v22 offset:256
  s_waitcnt lgkmcnt(14)
  ds_read_b64_tr_b16 v[58:59], v22 offset:4352
  s_waitcnt lgkmcnt(14)
  v_mfma_f32_32x32x16_bf16 v[176:191], v[60:63], v[212:215], v[176:191]
  ds_read_b64_tr_b16 v[60:61], v23 offset:256
  s_waitcnt lgkmcnt(14)
  ds_read_b64_tr_b16 v[62:63], v23 offset:4352
  s_barrier
  v_add_u32 v20, 131072, v17
  v_xor_b32 v21, 64, v20
  v_xor_b32 v22, 128, v20
  v_xor_b32 v23, 192, v20
  s_waitcnt lgkmcnt(14)
  v_mfma_f32_32x32x16_bf16 v[64:79], v[32:35], v[216:219], v[64:79]
  ds_read_b64_tr_b16 v[32:33], v20 offset:0
  s_waitcnt lgkmcnt(14)
  ds_read_b64_tr_b16 v[34:35], v20 offset:4096
  s_waitcnt lgkmcnt(14)
  v_mfma_f32_32x32x16_bf16 v[80:95], v[36:39], v[216:219], v[80:95]
  ds_read_b64_tr_b16 v[36:37], v21 offset:0
  s_waitcnt lgkmcnt(14)
  ds_read_b64_tr_b16 v[38:39], v21 offset:4096
  s_waitcnt lgkmcnt(14)
  v_mfma_f32_32x32x16_bf16 v[96:111], v[40:43], v[216:219], v[96:111]
  ds_read_b64_tr_b16 v[40:41], v22 offset:0
  s_waitcnt lgkmcnt(14)
  ds_read_b64_tr_b16 v[42:43], v22 offset:4096
  s_waitcnt lgkmcnt(14)
  v_mfma_f32_32x32x16_bf16 v[112:127], v[44:47], v[216:219], v[112:127]
  ds_read_b64_tr_b16 v[44:45], v23 offset:0
  s_waitcnt lgkmcnt(14)
  ds_read_b64_tr_b16 v[46:47], v23 offset:4096
  s_waitcnt lgkmcnt(14)
  v_mfma_f32_32x32x16_bf16 v[128:143], v[48:51], v[216:219], v[128:143]
  ds_read_b64_tr_b16 v[48:49], v20 offset:256
  s_waitcnt lgkmcnt(14)
  ds_read_b64_tr_b16 v[50:51], v20 offset:4352
  s_waitcnt lgkmcnt(14)
  v_mfma_f32_32x32x16_bf16 v[144:159], v[52:55], v[216:219], v[144:159]
  ds_read_b64_tr_b16 v[52:53], v21 offset:256
  s_waitcnt lgkmcnt(14)
  ds_read_b64_tr_b16 v[54:55], v21 offset:4352
  s_waitcnt lgkmcnt(14)
  v_mfma_f32_32x32x16_bf16 v[160:175], v[56:59], v[216:219], v[160:175]
  ds_read_b64_tr_b16 v[56:57], v22 offset:256
  s_waitcnt lgkmcnt(14)
  ds_read_b64_tr_b16 v[58:59], v22 offset:4352
  s_waitcnt lgkmcnt(14)
  v_mfma_f32_32x32x16_bf16 v[176:191], v[60:63], v[216:219], v[176:191]
  ds_read_b64_tr_b16 v[60:61], v23 offset:256
  s_waitcnt lgkmcnt(14)
  ds_read_b64_tr_b16 v[62:63], v23 offset:4352
  s_barrier
  v_add_u32 v20, 49152, v17
  v_xor_b32 v21, 64, v20
  v_xor_b32 v22, 128, v20
  v_xor_b32 v23, 192, v20
  s_waitcnt lgkmcnt(14)
  v_mfma_f32_32x32x16_bf16 v[64:79], v[32:35], v[220:223], v[64:79]
  ds_read_b64_tr_b16 v[32:33], v20 offset:0
  s_waitcnt lgkmcnt(14)
  ds_read_b64_tr_b16 v[34:35], v20 offset:4096
  s_waitcnt lgkmcnt(14)
  v_mfma_f32_32x32x16_bf16 v[80:95], v[36:39], v[220:223], v[80:95]
  ds_read_b64_tr_b16 v[36:37], v21 offset:0
  s_waitcnt lgkmcnt(14)
  ds_read_b64_tr_b16 v[38:39], v21 offset:4096
  s_waitcnt lgkmcnt(14)
  v_mfma_f32_32x32x16_bf16 v[96:111], v[40:43], v[220:223], v[96:111]
  ds_read_b64_tr_b16 v[40:41], v22 offset:0
  s_waitcnt lgkmcnt(14)
  ds_read_b64_tr_b16 v[42:43], v22 offset:4096
  s_waitcnt lgkmcnt(14)
  v_mfma_f32_32x32x16_bf16 v[112:127], v[44:47], v[220:223], v[112:127]
  ds_read_b64_tr_b16 v[44:45], v23 offset:0
  s_waitcnt lgkmcnt(14)
  ds_read_b64_tr_b16 v[46:47], v23 offset:4096
  s_waitcnt lgkmcnt(14)
  v_mfma_f32_32x32x16_bf16 v[128:143], v[48:51], v[220:223], v[128:143]
  ds_read_b64_tr_b16 v[48:49], v20 offset:256
  s_waitcnt lgkmcnt(14)
  ds_read_b64_tr_b16 v[50:51], v20 offset:4352
  s_waitcnt lgkmcnt(14)
  v_mfma_f32_32x32x16_bf16 v[144:159], v[52:55], v[220:223], v[144:159]
  ds_read_b64_tr_b16 v[52:53], v21 offset:256
  s_waitcnt lgkmcnt(14)
  ds_read_b64_tr_b16 v[54:55], v21 offset:4352
  s_waitcnt lgkmcnt(14)
  v_mfma_f32_32x32x16_bf16 v[160:175], v[56:59], v[220:223], v[160:175]
  ds_read_b64_tr_b16 v[56:57], v22 offset:256
  s_waitcnt lgkmcnt(14)
  ds_read_b64_tr_b16 v[58:59], v22 offset:4352
  s_waitcnt lgkmcnt(14)
  v_mfma_f32_32x32x16_bf16 v[176:191], v[60:63], v[220:223], v[176:191]
  ds_read_b64_tr_b16 v[60:61], v23 offset:256
  s_waitcnt lgkmcnt(14)
  ds_read_b64_tr_b16 v[62:63], v23 offset:4352
  s_barrier
  v_add_u32 v20, 0, v17
  v_xor_b32 v21, 64, v20
  v_xor_b32 v22, 128, v20
  v_xor_b32 v23, 192, v20
  s_waitcnt lgkmcnt(14)
  v_mfma_f32_32x32x16_bf16 v[64:79], v[32:35], v[224:227], v[64:79]
  ds_read_b64_tr_b16 v[32:33], v20 offset:0
  s_waitcnt lgkmcnt(14)
  ds_read_b64_tr_b16 v[34:35], v20 offset:4096
  s_waitcnt lgkmcnt(14)
  v_mfma_f32_32x32x16_bf16 v[80:95], v[36:39], v[224:227], v[80:95]
  ds_read_b64_tr_b16 v[36:37], v21 offset:0
  s_waitcnt lgkmcnt(14)
  ds_read_b64_tr_b16 v[38:39], v21 offset:4096
  s_waitcnt lgkmcnt(14)
  v_mfma_f32_32x32x16_bf16 v[96:111], v[40:43], v[224:227], v[96:111]
  ds_read_b64_tr_b16 v[40:41], v22 offset:0
  s_waitcnt lgkmcnt(14)
  ds_read_b64_tr_b16 v[42:43], v22 offset:4096
  s_waitcnt lgkmcnt(14)
  v_mfma_f32_32x32x16_bf16 v[112:127], v[44:47], v[224:227], v[112:127]
  ds_read_b64_tr_b16 v[44:45], v23 offset:0
  s_waitcnt lgkmcnt(14)
  ds_read_b64_tr_b16 v[46:47], v23 offset:4096
  s_waitcnt lgkmcnt(14)
  v_mfma_f32_32x32x16_bf16 v[128:143], v[48:51], v[224:227], v[128:143]
  ds_read_b64_tr_b16 v[48:49], v20 offset:256
  s_waitcnt lgkmcnt(14)
  ds_read_b64_tr_b16 v[50:51], v20 offset:4352
  s_waitcnt lgkmcnt(14)
  v_mfma_f32_32x32x16_bf16 v[144:159], v[52:55], v[224:227], v[144:159]
  ds_read_b64_tr_b16 v[52:53], v21 offset:256
  s_waitcnt lgkmcnt(14)
  ds_read_b64_tr_b16 v[54:55], v21 offset:4352
  s_waitcnt lgkmcnt(14)
  v_mfma_f32_32x32x16_bf16 v[160:175], v[56:59], v[224:227], v[160:175]
  ds_read_b64_tr_b16 v[56:57], v22 offset:256
  s_waitcnt lgkmcnt(14)
  ds_read_b64_tr_b16 v[58:59], v22 offset:4352
  s_waitcnt lgkmcnt(14)
  v_mfma_f32_32x32x16_bf16 v[176:191], v[60:63], v[224:227], v[176:191]
  ds_read_b64_tr_b16 v[60:61], v23 offset:256
  s_waitcnt lgkmcnt(14)
  ds_read_b64_tr_b16 v[62:63], v23 offset:4352
  s_barrier
  v_add_u32 v20, 114688, v17
  v_xor_b32 v21, 64, v20
  v_xor_b32 v22, 128, v20
  v_xor_b32 v23, 192, v20
  s_waitcnt lgkmcnt(14)
  v_mfma_f32_32x32x16_bf16 v[64:79], v[32:35], v[228:231], v[64:79]
  ds_read_b64_tr_b16 v[32:33], v20 offset:0
  s_waitcnt lgkmcnt(14)
  ds_read_b64_tr_b16 v[34:35], v20 offset:4096
  s_waitcnt lgkmcnt(14)
  v_mfma_f32_32x32x16_bf16 v[80:95], v[36:39], v[228:231], v[80:95]
  ds_read_b64_tr_b16 v[36:37], v21 offset:0
  s_waitcnt lgkmcnt(14)
  ds_read_b64_tr_b16 v[38:39], v21 offset:4096
  s_waitcnt lgkmcnt(14)
  v_mfma_f32_32x32x16_bf16 v[96:111], v[40:43], v[228:231], v[96:111]
  ds_read_b64_tr_b16 v[40:41], v22 offset:0
  s_waitcnt lgkmcnt(14)
  ds_read_b64_tr_b16 v[42:43], v22 offset:4096
  s_waitcnt lgkmcnt(14)
  v_mfma_f32_32x32x16_bf16 v[112:127], v[44:47], v[228:231], v[112:127]
  ds_read_b64_tr_b16 v[44:45], v23 offset:0
  s_waitcnt lgkmcnt(14)
  ds_read_b64_tr_b16 v[46:47], v23 offset:4096
  s_waitcnt lgkmcnt(14)
  v_mfma_f32_32x32x16_bf16 v[128:143], v[48:51], v[228:231], v[128:143]
  ds_read_b64_tr_b16 v[48:49], v20 offset:256
  s_waitcnt lgkmcnt(14)
  ds_read_b64_tr_b16 v[50:51], v20 offset:4352
  s_waitcnt lgkmcnt(14)
  v_mfma_f32_32x32x16_bf16 v[144:159], v[52:55], v[228:231], v[144:159]
  ds_read_b64_tr_b16 v[52:53], v21 offset:256
  s_waitcnt lgkmcnt(14)
  ds_read_b64_tr_b16 v[54:55], v21 offset:4352
  s_waitcnt lgkmcnt(14)
  v_mfma_f32_32x32x16_bf16 v[160:175], v[56:59], v[228:231], v[160:175]
  ds_read_b64_tr_b16 v[56:57], v22 offset:256
  s_waitcnt lgkmcnt(14)
  ds_read_b64_tr_b16 v[58:59], v22 offset:4352
  s_waitcnt lgkmcnt(14)
  v_mfma_f32_32x32x16_bf16 v[176:191], v[60:63], v[228:231], v[176:191]
  ds_read_b64_tr_b16 v[60:61], v23 offset:256
  s_waitcnt lgkmcnt(14)
  ds_read_b64_tr_b16 v[62:63], v23 offset:4352
  s_barrier
  v_add_u32 v20, 98304, v17
  v_xor_b32 v21, 64, v20
  v_xor_b32 v22, 128, v20
  v_xor_b32 v23, 192, v20
  s_waitcnt lgkmcnt(14)
  v_mfma_f32_32x32x16_bf16 v[64:79], v[32:35], v[232:235], v[64:79]
  ds_read_b64_tr_b16 v[32:33], v20 offset:0
  s_waitcnt lgkmcnt(14)
  ds_read_b64_tr_b16 v[34:35], v20 offset:4096
  s_waitcnt lgkmcnt(14)
  v_mfma_f32_32x32x16_bf16 v[80:95], v[36:39], v[232:235], v[80:95]
  ds_read_b64_tr_b16 v[36:37], v21 offset:0
  s_waitcnt lgkmcnt(14)
  ds_read_b64_tr_b16 v[38:39], v21 offset:4096
  s_waitcnt lgkmcnt(14)
  v_mfma_f32_32x32x16_bf16 v[96:111], v[40:43], v[232:235], v[96:111]
  ds_read_b64_tr_b16 v[40:41], v22 offset:0
  s_waitcnt lgkmcnt(14)
  ds_read_b64_tr_b16 v[42:43], v22 offset:4096
  s_waitcnt lgkmcnt(14)
  v_mfma_f32_32x32x16_bf16 v[112:127], v[44:47], v[232:235], v[112:127]
  ds_read_b64_tr_b16 v[44:45], v23 offset:0
  s_waitcnt lgkmcnt(14)
  ds_read_b64_tr_b16 v[46:47], v23 offset:4096
  s_waitcnt lgkmcnt(14)
  v_mfma_f32_32x32x16_bf16 v[128:143], v[48:51], v[232:235], v[128:143]
  ds_read_b64_tr_b16 v[48:49], v20 offset:256
  s_waitcnt lgkmcnt(14)
  ds_read_b64_tr_b16 v[50:51], v20 offset:4352
  s_waitcnt lgkmcnt(14)
  v_mfma_f32_32x32x16_bf16 v[144:159], v[52:55], v[232:235], v[144:159]
  ds_read_b64_tr_b16 v[52:53], v21 offset:256
  s_waitcnt lgkmcnt(14)
  ds_read_b64_tr_b16 v[54:55], v21 offset:4352
  s_waitcnt lgkmcnt(14)
  v_mfma_f32_32x32x16_bf16 v[160:175], v[56:59], v[232:235], v[160:175]
  ds_read_b64_tr_b16 v[56:57], v22 offset:256
  s_waitcnt lgkmcnt(14)
  ds_read_b64_tr_b16 v[58:59], v22 offset:4352
  s_waitcnt lgkmcnt(14)
  v_mfma_f32_32x32x16_bf16 v[176:191], v[60:63], v[232:235], v[176:191]
  ds_read_b64_tr_b16 v[60:61], v23 offset:256
  s_waitcnt lgkmcnt(14)
  ds_read_b64_tr_b16 v[62:63], v23 offset:4352
  s_barrier
  v_add_u32 v20, 32768, v17
  v_xor_b32 v21, 64, v20
  v_xor_b32 v22, 128, v20
  v_xor_b32 v23, 192, v20
  s_waitcnt lgkmcnt(14)
  v_mfma_f32_32x32x16_bf16 v[64:79], v[32:35], v[236:239], v[64:79]
  ds_read_b64_tr_b16 v[32:33], v20 offset:0
  s_waitcnt lgkmcnt(14)
  ds_read_b64_tr_b16 v[34:35], v20 offset:4096
  s_waitcnt lgkmcnt(14)
  v_mfma_f32_32x32x16_bf16 v[80:95], v[36:39], v[236:239], v[80:95]
  ds_read_b64_tr_b16 v[36:37], v21 offset:0
  s_waitcnt lgkmcnt(14)
  ds_read_b64_tr_b16 v[38:39], v21 offset:4096
  s_waitcnt lgkmcnt(14)
  v_mfma_f32_32x32x16_bf16 v[96:111], v[40:43], v[236:239], v[96:111]
  ds_read_b64_tr_b16 v[40:41], v22 offset:0
  s_waitcnt lgkmcnt(14)
  ds_read_b64_tr_b16 v[42:43], v22 offset:4096
  s_waitcnt lgkmcnt(14)
  v_mfma_f32_32x32x16_bf16 v[112:127], v[44:47], v[236:239], v[112:127]
  ds_read_b64_tr_b16 v[44:45], v23 offset:0
  s_waitcnt lgkmcnt(14)
  ds_read_b64_tr_b16 v[46:47], v23 offset:4096
  s_waitcnt lgkmcnt(14)
  v_mfma_f32_32x32x16_bf16 v[128:143], v[48:51], v[236:239], v[128:143]
  ds_read_b64_tr_b16 v[48:49], v20 offset:256
  s_waitcnt lgkmcnt(14)
  ds_read_b64_tr_b16 v[50:51], v20 offset:4352
  s_waitcnt lgkmcnt(14)
  v_mfma_f32_32x32x16_bf16 v[144:159], v[52:55], v[236:239], v[144:159]
  ds_read_b64_tr_b16 v[52:53], v21 offset:256
  s_waitcnt lgkmcnt(14)
  ds_read_b64_tr_b16 v[54:55], v21 offset:4352
  s_waitcnt lgkmcnt(14)
  v_mfma_f32_32x32x16_bf16 v[160:175], v[56:59], v[236:239], v[160:175]
  ds_read_b64_tr_b16 v[56:57], v22 offset:256
  s_waitcnt lgkmcnt(14)
  ds_read_b64_tr_b16 v[58:59], v22 offset:4352
  s_waitcnt lgkmcnt(14)
  v_mfma_f32_32x32x16_bf16 v[176:191], v[60:63], v[236:239], v[176:191]
  ds_read_b64_tr_b16 v[60:61], v23 offset:256
  s_waitcnt lgkmcnt(14)
  ds_read_b64_tr_b16 v[62:63], v23 offset:4352
  s_barrier
  v_add_u32 v20, 81920, v17
  v_xor_b32 v21, 64, v20
  v_xor_b32 v22, 128, v20
  v_xor_b32 v23, 192, v20
  s_waitcnt lgkmcnt(14)
  v_mfma_f32_32x32x16_bf16 v[64:79], v[32:35], v[240:243], v[64:79]
  ds_read_b64_tr_b16 v[32:33], v20 offset:0
  s_waitcnt lgkmcnt(14)
  ds_read_b64_tr_b16 v[34:35], v20 offset:4096
  s_waitcnt lgkmcnt(14)
  v_mfma_f32_32x32x16_bf16 v[80:95], v[36:39], v[240:243], v[80:95]
  ds_read_b64_tr_b16 v[36:37], v21 offset:0
  s_waitcnt lgkmcnt(14)
  ds_read_b64_tr_b16 v[38:39], v21 offset:4096
  s_waitcnt lgkmcnt(14)
  v_mfma_f32_32x32x16_bf16 v[96:111], v[40:43], v[240:243], v[96:111]
  ds_read_b64_tr_b16 v[40:41], v22 offset:0
  s_waitcnt lgkmcnt(14)
  ds_read_b64_tr_b16 v[42:43], v22 offset:4096
  s_waitcnt lgkmcnt(14)
  v_mfma_f32_32x32x16_bf16 v[112:127], v[44:47], v[240:243], v[112:127]
  ds_read_b64_tr_b16 v[44:45], v23 offset:0
  s_waitcnt lgkmcnt(14)
  ds_read_b64_tr_b16 v[46:47], v23 offset:4096
  s_waitcnt lgkmcnt(14)
  v_mfma_f32_32x32x16_bf16 v[128:143], v[48:51], v[240:243], v[128:143]
  ds_read_b64_tr_b16 v[48:49], v20 offset:256
  s_waitcnt lgkmcnt(14)
  ds_read_b64_tr_b16 v[50:51], v20 offset:4352
  s_waitcnt lgkmcnt(14)
  v_mfma_f32_32x32x16_bf16 v[144:159], v[52:55], v[240:243], v[144:159]
  ds_read_b64_tr_b16 v[52:53], v21 offset:256
  s_waitcnt lgkmcnt(14)
  ds_read_b64_tr_b16 v[54:55], v21 offset:4352
  s_waitcnt lgkmcnt(14)
  v_mfma_f32_32x32x16_bf16 v[160:175], v[56:59], v[240:243], v[160:175]
  ds_read_b64_tr_b16 v[56:57], v22 offset:256
  s_waitcnt lgkmcnt(14)
  ds_read_b64_tr_b16 v[58:59], v22 offset:4352
  s_waitcnt lgkmcnt(14)
  v_mfma_f32_32x32x16_bf16 v[176:191], v[60:63], v[240:243], v[176:191]
  ds_read_b64_tr_b16 v[60:61], v23 offset:256
  s_waitcnt lgkmcnt(14)
  ds_read_b64_tr_b16 v[62:63], v23 offset:4352
  s_barrier
  v_add_u32 v20, 147456, v17
  v_xor_b32 v21, 64, v20
  v_xor_b32 v22, 128, v20
  v_xor_b32 v23, 192, v20
  s_waitcnt lgkmcnt(14)
  v_mfma_f32_32x32x16_bf16 v[64:79], v[32:35], v[244:247], v[64:79]
  ds_read_b64_tr_b16 v[32:33], v20 offset:0
  s_waitcnt lgkmcnt(14)
  ds_read_b64_tr_b16 v[34:35], v20 offset:4096
  s_waitcnt lgkmcnt(14)
  v_mfma_f32_32x32x16_bf16 v[80:95], v[36:39], v[244:247], v[80:95]
  ds_read_b64_tr_b16 v[36:37], v21 offset:0
  s_waitcnt lgkmcnt(14)
  ds_read_b64_tr_b16 v[38:39], v21 offset:4096
  s_waitcnt lgkmcnt(14)
  v_mfma_f32_32x32x16_bf16 v[96:111], v[40:43], v[244:247], v[96:111]
  ds_read_b64_tr_b16 v[40:41], v22 offset:0
  s_waitcnt lgkmcnt(14)
  ds_read_b64_tr_b16 v[42:43], v22 offset:4096
  s_waitcnt lgkmcnt(14)
  v_mfma_f32_32x32x16_bf16 v[112:127], v[44:47], v[244:247], v[112:127]
  ds_read_b64_tr_b16 v[44:45], v23 offset:0
  s_waitcnt lgkmcnt(14)
  ds_read_b64_tr_b16 v[46:47], v23 offset:4096
  s_waitcnt lgkmcnt(14)
  v_mfma_f32_32x32x16_bf16 v[128:143], v[48:51], v[244:247], v[128:143]
  ds_read_b64_tr_b16 v[48:49], v20 offset:256
  s_waitcnt lgkmcnt(14)
  ds_read_b64_tr_b16 v[50:51], v20 offset:4352
  s_waitcnt lgkmcnt(14)
  v_mfma_f32_32x32x16_bf16 v[144:159], v[52:55], v[244:247], v[144:159]
  ds_read_b64_tr_b16 v[52:53], v21 offset:256
  s_waitcnt lgkmcnt(14)
  ds_read_b64_tr_b16 v[54:55], v21 offset:4352
  s_waitcnt lgkmcnt(14)
  v_mfma_f32_32x32x16_bf16 v[160:175], v[56:59], v[244:247], v[160:175]
  ds_read_b64_tr_b16 v[56:57], v22 offset:256
  s_waitcnt lgkmcnt(14)
  ds_read_b64_tr_b16 v[58:59], v22 offset:4352
  s_waitcnt lgkmcnt(14)
  v_mfma_f32_32x32x16_bf16 v[176:191], v[60:63], v[244:247], v[176:191]
  ds_read_b64_tr_b16 v[60:61], v23 offset:256
  s_waitcnt lgkmcnt(14)
  ds_read_b64_tr_b16 v[62:63], v23 offset:4352
  s_barrier
  v_add_u32 v20, 131072, v17
  v_xor_b32 v21, 64, v20
  v_xor_b32 v22, 128, v20
  v_xor_b32 v23, 192, v20
  s_waitcnt lgkmcnt(14)
  v_mfma_f32_32x32x16_bf16 v[64:79], v[32:35], v[248:251], v[64:79]
  ds_read_b64_tr_b16 v[32:33], v20 offset:0
  s_waitcnt lgkmcnt(14)
  ds_read_b64_tr_b16 v[34:35], v20 offset:4096
  s_waitcnt lgkmcnt(14)
  v_mfma_f32_32x32x16_bf16 v[80:95], v[36:39], v[248:251], v[80:95]
  ds_read_b64_tr_b16 v[36:37], v21 offset:0
  s_waitcnt lgkmcnt(14)
  ds_read_b64_tr_b16 v[38:39], v21 offset:4096
  s_waitcnt lgkmcnt(14)
  v_mfma_f32_32x32x16_bf16 v[96:111], v[40:43], v[248:251], v[96:111]
  ds_read_b64_tr_b16 v[40:41], v22 offset:0
  s_waitcnt lgkmcnt(14)
  ds_read_b64_tr_b16 v[42:43], v22 offset:4096
  s_waitcnt lgkmcnt(14)
  v_mfma_f32_32x32x16_bf16 v[112:127], v[44:47], v[248:251], v[112:127]
  ds_read_b64_tr_b16 v[44:45], v23 offset:0
  s_waitcnt lgkmcnt(14)
  ds_read_b64_tr_b16 v[46:47], v23 offset:4096
  s_waitcnt lgkmcnt(14)
  v_mfma_f32_32x32x16_bf16 v[128:143], v[48:51], v[248:251], v[128:143]
  ds_read_b64_tr_b16 v[48:49], v20 offset:256
  s_waitcnt lgkmcnt(14)
  ds_read_b64_tr_b16 v[50:51], v20 offset:4352
  s_waitcnt lgkmcnt(14)
  v_mfma_f32_32x32x16_bf16 v[144:159], v[52:55], v[248:251], v[144:159]
  ds_read_b64_tr_b16 v[52:53], v21 offset:256
  s_waitcnt lgkmcnt(14)
  ds_read_b64_tr_b16 v[54:55], v21 offset:4352
  s_waitcnt lgkmcnt(14)
  v_mfma_f32_32x32x16_bf16 v[160:175], v[56:59], v[248:251], v[160:175]
  ds_read_b64_tr_b16 v[56:57], v22 offset:256
  s_waitcnt lgkmcnt(14)
  ds_read_b64_tr_b16 v[58:59], v22 offset:4352
  s_waitcnt lgkmcnt(14)
  v_mfma_f32_32x32x16_bf16 v[176:191], v[60:63], v[248:251], v[176:191]
  ds_read_b64_tr_b16 v[60:61], v23 offset:256
  s_waitcnt lgkmcnt(14)
  ds_read_b64_tr_b16 v[62:63], v23 offset:4352
  s_barrier
  v_add_u32 v20, 49152, v17
  v_xor_b32 v21, 64, v20
  v_xor_b32 v22, 128, v20
  v_xor_b32 v23, 192, v20
  s_waitcnt lgkmcnt(14)
  v_mfma_f32_32x32x16_bf16 v[64:79], v[32:35], v[252:255], v[64:79]
  ds_read_b64_tr_b16 v[32:33], v20 offset:0
  s_waitcnt lgkmcnt(14)
  ds_read_b64_tr_b16 v[34:35], v20 offset:4096
  s_waitcnt lgkmcnt(14)
  v_mfma_f32_32x32x16_bf16 v[80:95], v[36:39], v[252:255], v[80:95]
  ds_read_b64_tr_b16 v[36:37], v21 offset:0
  s_waitcnt lgkmcnt(14)
  ds_read_b64_tr_b16 v[38:39], v21 offset:4096
  s_waitcnt lgkmcnt(14)
  v_mfma_f32_32x32x16_bf16 v[96:111], v[40:43], v[252:255], v[96:111]
  ds_read_b64_tr_b16 v[40:41], v22 offset:0
  s_waitcnt lgkmcnt(14)
  ds_read_b64_tr_b16 v[42:43], v22 offset:4096
  s_waitcnt lgkmcnt(14)
  v_mfma_f32_32x32x16_bf16 v[112:127], v[44:47], v[252:255], v[112:127]
  ds_read_b64_tr_b16 v[44:45], v23 offset:0
  s_waitcnt lgkmcnt(14)
  ds_read_b64_tr_b16 v[46:47], v23 offset:4096
  s_waitcnt lgkmcnt(14)
  v_mfma_f32_32x32x16_bf16 v[128:143], v[48:51], v[252:255], v[128:143]
  ds_read_b64_tr_b16 v[48:49], v20 offset:256
  s_waitcnt lgkmcnt(14)
  ds_read_b64_tr_b16 v[50:51], v20 offset:4352
  s_waitcnt lgkmcnt(14)
  v_mfma_f32_32x32x16_bf16 v[144:159], v[52:55], v[252:255], v[144:159]
  ds_read_b64_tr_b16 v[52:53], v21 offset:256
  s_waitcnt lgkmcnt(14)
  ds_read_b64_tr_b16 v[54:55], v21 offset:4352
  s_waitcnt lgkmcnt(14)
  v_mfma_f32_32x32x16_bf16 v[160:175], v[56:59], v[252:255], v[160:175]
  ds_read_b64_tr_b16 v[56:57], v22 offset:256
  s_waitcnt lgkmcnt(14)
  ds_read_b64_tr_b16 v[58:59], v22 offset:4352
  s_waitcnt lgkmcnt(14)
  v_mfma_f32_32x32x16_bf16 v[176:191], v[60:63], v[252:255], v[176:191]
  ds_read_b64_tr_b16 v[60:61], v23 offset:256
  s_waitcnt lgkmcnt(14)
  ds_read_b64_tr_b16 v[62:63], v23 offset:4352
  s_barrier
  v_add_u32 v28, s39, v18
  s_cmp_eq_u32 s46, 0
  s_cselect_b32 s43, 49152, 0
  s_lshl_b32 s44, s47, 13
  s_add_u32 s43, s43, s44
  v_add_u32 v29, s43, v18
  s_waitcnt lgkmcnt(14)
  ds_read_b128 v[192:195], v28 offset:16384
  s_waitcnt lgkmcnt(14)
  ds_read_b128 v[196:199], v28 offset:17408
  s_waitcnt lgkmcnt(14)
  ds_read_b128 v[200:203], v28 offset:18432
  s_waitcnt lgkmcnt(14)
  ds_read_b128 v[204:207], v28 offset:19456
  s_waitcnt lgkmcnt(14)
  ds_read_b128 v[208:211], v28 offset:20480
  s_waitcnt lgkmcnt(14)
  ds_read_b128 v[212:215], v28 offset:21504
  s_waitcnt lgkmcnt(14)
  ds_read_b128 v[216:219], v28 offset:22528
  s_waitcnt lgkmcnt(14)
  ds_read_b128 v[220:223], v28 offset:23552
  s_waitcnt lgkmcnt(14)
  ds_read_b128 v[224:227], v29 offset:16384
  s_waitcnt lgkmcnt(14)
  ds_read_b128 v[228:231], v29 offset:17408
  s_waitcnt lgkmcnt(14)
  ds_read_b128 v[232:235], v29 offset:18432
  s_waitcnt lgkmcnt(14)
  ds_read_b128 v[236:239], v29 offset:19456
  s_waitcnt lgkmcnt(14)
  ds_read_b128 v[240:243], v29 offset:20480
  s_waitcnt lgkmcnt(14)
  ds_read_b128 v[244:247], v29 offset:21504
  s_waitcnt lgkmcnt(14)
  ds_read_b128 v[248:251], v29 offset:22528
  s_waitcnt lgkmcnt(14)
  ds_read_b128 v[252:255], v29 offset:23552
  v_add_u32 v20, 0, v17
  v_xor_b32 v21, 64, v20
  v_xor_b32 v22, 128, v20
  v_xor_b32 v23, 192, v20
  v_mfma_f32_32x32x16_bf16 v[64:79], v[32:35], v[192:195], v[64:79]
  s_waitcnt lgkmcnt(14)
  ds_read_b64_tr_b16 v[32:33], v20 offset:0
  s_waitcnt lgkmcnt(14)
  ds_read_b64_tr_b16 v[34:35], v20 offset:4096
  v_mfma_f32_32x32x16_bf16 v[80:95], v[36:39], v[192:195], v[80:95]
  s_waitcnt lgkmcnt(14)
  ds_read_b64_tr_b16 v[36:37], v21 offset:0
  s_waitcnt lgkmcnt(14)
  ds_read_b64_tr_b16 v[38:39], v21 offset:4096
  v_mfma_f32_32x32x16_bf16 v[96:111], v[40:43], v[192:195], v[96:111]
  s_waitcnt lgkmcnt(14)
  ds_read_b64_tr_b16 v[40:41], v22 offset:0
  s_waitcnt lgkmcnt(14)
  ds_read_b64_tr_b16 v[42:43], v22 offset:4096
  v_mfma_f32_32x32x16_bf16 v[112:127], v[44:47], v[192:195], v[112:127]
  s_waitcnt lgkmcnt(14)
  ds_read_b64_tr_b16 v[44:45], v23 offset:0
  s_waitcnt lgkmcnt(14)
  ds_read_b64_tr_b16 v[46:47], v23 offset:4096
  v_mfma_f32_32x32x16_bf16 v[128:143], v[48:51], v[192:195], v[128:143]
  s_waitcnt lgkmcnt(14)
  ds_read_b64_tr_b16 v[48:49], v20 offset:256
  s_waitcnt lgkmcnt(14)
  ds_read_b64_tr_b16 v[50:51], v20 offset:4352
  v_mfma_f32_32x32x16_bf16 v[144:159], v[52:55], v[192:195], v[144:159]
  s_waitcnt lgkmcnt(14)
  ds_read_b64_tr_b16 v[52:53], v21 offset:256
  s_waitcnt lgkmcnt(14)
  ds_read_b64_tr_b16 v[54:55], v21 offset:4352
  v_mfma_f32_32x32x16_bf16 v[160:175], v[56:59], v[192:195], v[160:175]
  s_waitcnt lgkmcnt(14)
  ds_read_b64_tr_b16 v[56:57], v22 offset:256
  s_waitcnt lgkmcnt(14)
  ds_read_b64_tr_b16 v[58:59], v22 offset:4352
  v_mfma_f32_32x32x16_bf16 v[176:191], v[60:63], v[192:195], v[176:191]
  s_waitcnt lgkmcnt(14)
  ds_read_b64_tr_b16 v[60:61], v23 offset:256
  s_waitcnt lgkmcnt(14)
  ds_read_b64_tr_b16 v[62:63], v23 offset:4352
  s_barrier
  v_add_u32 v20, 114688, v17
  v_xor_b32 v21, 64, v20
  v_xor_b32 v22, 128, v20
  v_xor_b32 v23, 192, v20
  s_waitcnt lgkmcnt(14)
  v_mfma_f32_32x32x16_bf16 v[64:79], v[32:35], v[196:199], v[64:79]
  ds_read_b64_tr_b16 v[32:33], v20 offset:0
  s_waitcnt lgkmcnt(14)
  ds_read_b64_tr_b16 v[34:35], v20 offset:4096
  s_waitcnt lgkmcnt(14)
  v_mfma_f32_32x32x16_bf16 v[80:95], v[36:39], v[196:199], v[80:95]
  ds_read_b64_tr_b16 v[36:37], v21 offset:0
  s_waitcnt lgkmcnt(14)
  ds_read_b64_tr_b16 v[38:39], v21 offset:4096
  s_waitcnt lgkmcnt(14)
  v_mfma_f32_32x32x16_bf16 v[96:111], v[40:43], v[196:199], v[96:111]
  ds_read_b64_tr_b16 v[40:41], v22 offset:0
  s_waitcnt lgkmcnt(14)
  ds_read_b64_tr_b16 v[42:43], v22 offset:4096
  s_waitcnt lgkmcnt(14)
  v_mfma_f32_32x32x16_bf16 v[112:127], v[44:47], v[196:199], v[112:127]
  ds_read_b64_tr_b16 v[44:45], v23 offset:0
  s_waitcnt lgkmcnt(14)
  ds_read_b64_tr_b16 v[46:47], v23 offset:4096
  s_waitcnt lgkmcnt(14)
  v_mfma_f32_32x32x16_bf16 v[128:143], v[48:51], v[196:199], v[128:143]
  ds_read_b64_tr_b16 v[48:49], v20 offset:256
  s_waitcnt lgkmcnt(14)
  ds_read_b64_tr_b16 v[50:51], v20 offset:4352
  s_waitcnt lgkmcnt(14)
  v_mfma_f32_32x32x16_bf16 v[144:159], v[52:55], v[196:199], v[144:159]
  ds_read_b64_tr_b16 v[52:53], v21 offset:256
  s_waitcnt lgkmcnt(14)
  ds_read_b64_tr_b16 v[54:55], v21 offset:4352
  s_waitcnt lgkmcnt(14)
  v_mfma_f32_32x32x16_bf16 v[160:175], v[56:59], v[196:199], v[160:175]
  ds_read_b64_tr_b16 v[56:57], v22 offset:256
  s_waitcnt lgkmcnt(14)
  ds_read_b64_tr_b16 v[58:59], v22 offset:4352
  s_waitcnt lgkmcnt(14)
  v_mfma_f32_32x32x16_bf16 v[176:191], v[60:63], v[196:199], v[176:191]
  ds_read_b64_tr_b16 v[60:61], v23 offset:256
  s_waitcnt lgkmcnt(14)
  ds_read_b64_tr_b16 v[62:63], v23 offset:4352
  s_barrier
  v_add_u32 v20, 98304, v17
  v_xor_b32 v21, 64, v20
  v_xor_b32 v22, 128, v20
  v_xor_b32 v23, 192, v20
  s_waitcnt lgkmcnt(14)
  v_mfma_f32_32x32x16_bf16 v[64:79], v[32:35], v[200:203], v[64:79]
  ds_read_b64_tr_b16 v[32:33], v20 offset:0
  s_waitcnt lgkmcnt(14)
  ds_read_b64_tr_b16 v[34:35], v20 offset:4096
  s_waitcnt lgkmcnt(14)
  v_mfma_f32_32x32x16_bf16 v[80:95], v[36:39], v[200:203], v[80:95]
  ds_read_b64_tr_b16 v[36:37], v21 offset:0
  s_waitcnt lgkmcnt(14)
  ds_read_b64_tr_b16 v[38:39], v21 offset:4096
  s_waitcnt lgkmcnt(14)
  v_mfma_f32_32x32x16_bf16 v[96:111], v[40:43], v[200:203], v[96:111]
  ds_read_b64_tr_b16 v[40:41], v22 offset:0
  s_waitcnt lgkmcnt(14)
  ds_read_b64_tr_b16 v[42:43], v22 offset:4096
  s_waitcnt lgkmcnt(14)
  v_mfma_f32_32x32x16_bf16 v[112:127], v[44:47], v[200:203], v[112:127]
  ds_read_b64_tr_b16 v[44:45], v23 offset:0
  s_waitcnt lgkmcnt(14)
  ds_read_b64_tr_b16 v[46:47], v23 offset:4096
  s_waitcnt lgkmcnt(14)
  v_mfma_f32_32x32x16_bf16 v[128:143], v[48:51], v[200:203], v[128:143]
  ds_read_b64_tr_b16 v[48:49], v20 offset:256
  s_waitcnt lgkmcnt(14)
  ds_read_b64_tr_b16 v[50:51], v20 offset:4352
  s_waitcnt lgkmcnt(14)
  v_mfma_f32_32x32x16_bf16 v[144:159], v[52:55], v[200:203], v[144:159]
  ds_read_b64_tr_b16 v[52:53], v21 offset:256
  s_waitcnt lgkmcnt(14)
  ds_read_b64_tr_b16 v[54:55], v21 offset:4352
  s_waitcnt lgkmcnt(14)
  v_mfma_f32_32x32x16_bf16 v[160:175], v[56:59], v[200:203], v[160:175]
  ds_read_b64_tr_b16 v[56:57], v22 offset:256
  s_waitcnt lgkmcnt(14)
  ds_read_b64_tr_b16 v[58:59], v22 offset:4352
  s_waitcnt lgkmcnt(14)
  v_mfma_f32_32x32x16_bf16 v[176:191], v[60:63], v[200:203], v[176:191]
  ds_read_b64_tr_b16 v[60:61], v23 offset:256
  s_waitcnt lgkmcnt(14)
  ds_read_b64_tr_b16 v[62:63], v23 offset:4352
  s_barrier
  v_add_u32 v20, 32768, v17
  v_xor_b32 v21, 64, v20
  v_xor_b32 v22, 128, v20
  v_xor_b32 v23, 192, v20
  s_waitcnt lgkmcnt(14)
  v_mfma_f32_32x32x16_bf16 v[64:79], v[32:35], v[204:207], v[64:79]
  ds_read_b64_tr_b16 v[32:33], v20 offset:0
  s_waitcnt lgkmcnt(14)
  ds_read_b64_tr_b16 v[34:35], v20 offset:4096
  s_waitcnt lgkmcnt(14)
  v_mfma_f32_32x32x16_bf16 v[80:95], v[36:39], v[204:207], v[80:95]
  ds_read_b64_tr_b16 v[36:37], v21 offset:0
  s_waitcnt lgkmcnt(14)
  ds_read_b64_tr_b16 v[38:39], v21 offset:4096
  s_waitcnt lgkmcnt(14)
  v_mfma_f32_32x32x16_bf16 v[96:111], v[40:43], v[204:207], v[96:111]
  ds_read_b64_tr_b16 v[40:41], v22 offset:0
  s_waitcnt lgkmcnt(14)
  ds_read_b64_tr_b16 v[42:43], v22 offset:4096
  s_waitcnt lgkmcnt(14)
  v_mfma_f32_32x32x16_bf16 v[112:127], v[44:47], v[204:207], v[112:127]
  ds_read_b64_tr_b16 v[44:45], v23 offset:0
  s_waitcnt lgkmcnt(14)
  ds_read_b64_tr_b16 v[46:47], v23 offset:4096
  s_waitcnt lgkmcnt(14)
  v_mfma_f32_32x32x16_bf16 v[128:143], v[48:51], v[204:207], v[128:143]
  ds_read_b64_tr_b16 v[48:49], v20 offset:256
  s_waitcnt lgkmcnt(14)
  ds_read_b64_tr_b16 v[50:51], v20 offset:4352
  s_waitcnt lgkmcnt(14)
  v_mfma_f32_32x32x16_bf16 v[144:159], v[52:55], v[204:207], v[144:159]
  ds_read_b64_tr_b16 v[52:53], v21 offset:256
  s_waitcnt lgkmcnt(14)
  ds_read_b64_tr_b16 v[54:55], v21 offset:4352
  s_waitcnt lgkmcnt(14)
  v_mfma_f32_32x32x16_bf16 v[160:175], v[56:59], v[204:207], v[160:175]
  ds_read_b64_tr_b16 v[56:57], v22 offset:256
  s_waitcnt lgkmcnt(14)
  ds_read_b64_tr_b16 v[58:59], v22 offset:4352
  s_waitcnt lgkmcnt(14)
  v_mfma_f32_32x32x16_bf16 v[176:191], v[60:63], v[204:207], v[176:191]
  ds_read_b64_tr_b16 v[60:61], v23 offset:256
  s_waitcnt lgkmcnt(14)
  ds_read_b64_tr_b16 v[62:63], v23 offset:4352
  s_barrier
  v_add_u32 v20, 81920, v17
  v_xor_b32 v21, 64, v20
  v_xor_b32 v22, 128, v20
  v_xor_b32 v23, 192, v20
  s_waitcnt lgkmcnt(14)
  v_mfma_f32_32x32x16_bf16 v[64:79], v[32:35], v[208:211], v[64:79]
  ds_read_b64_tr_b16 v[32:33], v20 offset:0
  s_waitcnt lgkmcnt(14)
  ds_read_b64_tr_b16 v[34:35], v20 offset:4096
  s_waitcnt lgkmcnt(14)
  v_mfma_f32_32x32x16_bf16 v[80:95], v[36:39], v[208:211], v[80:95]
  ds_read_b64_tr_b16 v[36:37], v21 offset:0
  s_waitcnt lgkmcnt(14)
  ds_read_b64_tr_b16 v[38:39], v21 offset:4096
  s_waitcnt lgkmcnt(14)
  v_mfma_f32_32x32x16_bf16 v[96:111], v[40:43], v[208:211], v[96:111]
  ds_read_b64_tr_b16 v[40:41], v22 offset:0
  s_waitcnt lgkmcnt(14)
  ds_read_b64_tr_b16 v[42:43], v22 offset:4096
  s_waitcnt lgkmcnt(14)
  v_mfma_f32_32x32x16_bf16 v[112:127], v[44:47], v[208:211], v[112:127]
  ds_read_b64_tr_b16 v[44:45], v23 offset:0
  s_waitcnt lgkmcnt(14)
  ds_read_b64_tr_b16 v[46:47], v23 offset:4096
  s_waitcnt lgkmcnt(14)
  v_mfma_f32_32x32x16_bf16 v[128:143], v[48:51], v[208:211], v[128:143]
  ds_read_b64_tr_b16 v[48:49], v20 offset:256
  s_waitcnt lgkmcnt(14)
  ds_read_b64_tr_b16 v[50:51], v20 offset:4352
  s_waitcnt lgkmcnt(14)
  v_mfma_f32_32x32x16_bf16 v[144:159], v[52:55], v[208:211], v[144:159]
  ds_read_b64_tr_b16 v[52:53], v21 offset:256
  s_waitcnt lgkmcnt(14)
  ds_read_b64_tr_b16 v[54:55], v21 offset:4352
  s_waitcnt lgkmcnt(14)
  v_mfma_f32_32x32x16_bf16 v[160:175], v[56:59], v[208:211], v[160:175]
  ds_read_b64_tr_b16 v[56:57], v22 offset:256
  s_waitcnt lgkmcnt(14)
  ds_read_b64_tr_b16 v[58:59], v22 offset:4352
  s_waitcnt lgkmcnt(14)
  v_mfma_f32_32x32x16_bf16 v[176:191], v[60:63], v[208:211], v[176:191]
  ds_read_b64_tr_b16 v[60:61], v23 offset:256
  s_waitcnt lgkmcnt(14)
  ds_read_b64_tr_b16 v[62:63], v23 offset:4352
  s_barrier
  v_add_u32 v20, 147456, v17
  v_xor_b32 v21, 64, v20
  v_xor_b32 v22, 128, v20
  v_xor_b32 v23, 192, v20
  s_waitcnt lgkmcnt(14)
  v_mfma_f32_32x32x16_bf16 v[64:79], v[32:35], v[212:215], v[64:79]
  ds_read_b64_tr_b16 v[32:33], v20 offset:0
  s_waitcnt lgkmcnt(14)
  ds_read_b64_tr_b16 v[34:35], v20 offset:4096
  s_waitcnt lgkmcnt(14)
  v_mfma_f32_32x32x16_bf16 v[80:95], v[36:39], v[212:215], v[80:95]
  ds_read_b64_tr_b16 v[36:37], v21 offset:0
  s_waitcnt lgkmcnt(14)
  ds_read_b64_tr_b16 v[38:39], v21 offset:4096
  s_waitcnt lgkmcnt(14)
  v_mfma_f32_32x32x16_bf16 v[96:111], v[40:43], v[212:215], v[96:111]
  ds_read_b64_tr_b16 v[40:41], v22 offset:0
  s_waitcnt lgkmcnt(14)
  ds_read_b64_tr_b16 v[42:43], v22 offset:4096
  s_waitcnt lgkmcnt(14)
  v_mfma_f32_32x32x16_bf16 v[112:127], v[44:47], v[212:215], v[112:127]
  ds_read_b64_tr_b16 v[44:45], v23 offset:0
  s_waitcnt lgkmcnt(14)
  ds_read_b64_tr_b16 v[46:47], v23 offset:4096
  s_waitcnt lgkmcnt(14)
  v_mfma_f32_32x32x16_bf16 v[128:143], v[48:51], v[212:215], v[128:143]
  ds_read_b64_tr_b16 v[48:49], v20 offset:256
  s_waitcnt lgkmcnt(14)
  ds_read_b64_tr_b16 v[50:51], v20 offset:4352
  s_waitcnt lgkmcnt(14)
  v_mfma_f32_32x32x16_bf16 v[144:159], v[52:55], v[212:215], v[144:159]
  ds_read_b64_tr_b16 v[52:53], v21 offset:256
  s_waitcnt lgkmcnt(14)
  ds_read_b64_tr_b16 v[54:55], v21 offset:4352
  s_waitcnt lgkmcnt(14)
  v_mfma_f32_32x32x16_bf16 v[160:175], v[56:59], v[212:215], v[160:175]
  ds_read_b64_tr_b16 v[56:57], v22 offset:256
  s_waitcnt lgkmcnt(14)
  ds_read_b64_tr_b16 v[58:59], v22 offset:4352
  s_waitcnt lgkmcnt(14)
  v_mfma_f32_32x32x16_bf16 v[176:191], v[60:63], v[212:215], v[176:191]
  ds_read_b64_tr_b16 v[60:61], v23 offset:256
  s_waitcnt lgkmcnt(14)
  ds_read_b64_tr_b16 v[62:63], v23 offset:4352
  s_barrier
  v_add_u32 v20, 131072, v17
  v_xor_b32 v21, 64, v20
  v_xor_b32 v22, 128, v20
  v_xor_b32 v23, 192, v20
  s_waitcnt lgkmcnt(14)
  v_mfma_f32_32x32x16_bf16 v[64:79], v[32:35], v[216:219], v[64:79]
  ds_read_b64_tr_b16 v[32:33], v20 offset:0
  s_waitcnt lgkmcnt(14)
  ds_read_b64_tr_b16 v[34:35], v20 offset:4096
  s_waitcnt lgkmcnt(14)
  v_mfma_f32_32x32x16_bf16 v[80:95], v[36:39], v[216:219], v[80:95]
  ds_read_b64_tr_b16 v[36:37], v21 offset:0
  s_waitcnt lgkmcnt(14)
  ds_read_b64_tr_b16 v[38:39], v21 offset:4096
  s_waitcnt lgkmcnt(14)
  v_mfma_f32_32x32x16_bf16 v[96:111], v[40:43], v[216:219], v[96:111]
  ds_read_b64_tr_b16 v[40:41], v22 offset:0
  s_waitcnt lgkmcnt(14)
  ds_read_b64_tr_b16 v[42:43], v22 offset:4096
  s_waitcnt lgkmcnt(14)
  v_mfma_f32_32x32x16_bf16 v[112:127], v[44:47], v[216:219], v[112:127]
  ds_read_b64_tr_b16 v[44:45], v23 offset:0
  s_waitcnt lgkmcnt(14)
  ds_read_b64_tr_b16 v[46:47], v23 offset:4096
  s_waitcnt lgkmcnt(14)
  v_mfma_f32_32x32x16_bf16 v[128:143], v[48:51], v[216:219], v[128:143]
  ds_read_b64_tr_b16 v[48:49], v20 offset:256
  s_waitcnt lgkmcnt(14)
  ds_read_b64_tr_b16 v[50:51], v20 offset:4352
  s_waitcnt lgkmcnt(14)
  v_mfma_f32_32x32x16_bf16 v[144:159], v[52:55], v[216:219], v[144:159]
  ds_read_b64_tr_b16 v[52:53], v21 offset:256
  s_waitcnt lgkmcnt(14)
  ds_read_b64_tr_b16 v[54:55], v21 offset:4352
  s_waitcnt lgkmcnt(14)
  v_mfma_f32_32x32x16_bf16 v[160:175], v[56:59], v[216:219], v[160:175]
  ds_read_b64_tr_b16 v[56:57], v22 offset:256
  s_waitcnt lgkmcnt(14)
  ds_read_b64_tr_b16 v[58:59], v22 offset:4352
  s_waitcnt lgkmcnt(14)
  v_mfma_f32_32x32x16_bf16 v[176:191], v[60:63], v[216:219], v[176:191]
  ds_read_b64_tr_b16 v[60:61], v23 offset:256
  s_waitcnt lgkmcnt(14)
  ds_read_b64_tr_b16 v[62:63], v23 offset:4352
  s_barrier
  v_add_u32 v20, 65536, v17
  v_xor_b32 v21, 64, v20
  v_xor_b32 v22, 128, v20
  v_xor_b32 v23, 192, v20
  s_waitcnt lgkmcnt(14)
  v_mfma_f32_32x32x16_bf16 v[64:79], v[32:35], v[220:223], v[64:79]
  ds_read_b64_tr_b16 v[32:33], v20 offset:0
  s_waitcnt lgkmcnt(14)
  ds_read_b64_tr_b16 v[34:35], v20 offset:4096
  s_waitcnt lgkmcnt(14)
  v_mfma_f32_32x32x16_bf16 v[80:95], v[36:39], v[220:223], v[80:95]
  ds_read_b64_tr_b16 v[36:37], v21 offset:0
  s_waitcnt lgkmcnt(14)
  ds_read_b64_tr_b16 v[38:39], v21 offset:4096
  s_waitcnt lgkmcnt(14)
  v_mfma_f32_32x32x16_bf16 v[96:111], v[40:43], v[220:223], v[96:111]
  ds_read_b64_tr_b16 v[40:41], v22 offset:0
  s_waitcnt lgkmcnt(14)
  ds_read_b64_tr_b16 v[42:43], v22 offset:4096
  s_waitcnt lgkmcnt(14)
  v_mfma_f32_32x32x16_bf16 v[112:127], v[44:47], v[220:223], v[112:127]
  ds_read_b64_tr_b16 v[44:45], v23 offset:0
  s_waitcnt lgkmcnt(14)
  ds_read_b64_tr_b16 v[46:47], v23 offset:4096
  s_waitcnt lgkmcnt(14)
  v_mfma_f32_32x32x16_bf16 v[128:143], v[48:51], v[220:223], v[128:143]
  ds_read_b64_tr_b16 v[48:49], v20 offset:256
  s_waitcnt lgkmcnt(14)
  ds_read_b64_tr_b16 v[50:51], v20 offset:4352
  s_waitcnt lgkmcnt(14)
  v_mfma_f32_32x32x16_bf16 v[144:159], v[52:55], v[220:223], v[144:159]
  ds_read_b64_tr_b16 v[52:53], v21 offset:256
  s_waitcnt lgkmcnt(14)
  ds_read_b64_tr_b16 v[54:55], v21 offset:4352
  s_waitcnt lgkmcnt(14)
  v_mfma_f32_32x32x16_bf16 v[160:175], v[56:59], v[220:223], v[160:175]
  ds_read_b64_tr_b16 v[56:57], v22 offset:256
  s_waitcnt lgkmcnt(14)
  ds_read_b64_tr_b16 v[58:59], v22 offset:4352
  s_waitcnt lgkmcnt(14)
  v_mfma_f32_32x32x16_bf16 v[176:191], v[60:63], v[220:223], v[176:191]
  ds_read_b64_tr_b16 v[60:61], v23 offset:256
  s_waitcnt lgkmcnt(14)
  ds_read_b64_tr_b16 v[62:63], v23 offset:4352
  s_barrier
  v_add_u32 v20, 49152, v17
  v_xor_b32 v21, 64, v20
  v_xor_b32 v22, 128, v20
  v_xor_b32 v23, 192, v20
  s_waitcnt lgkmcnt(14)
  v_mfma_f32_32x32x16_bf16 v[64:79], v[32:35], v[224:227], v[64:79]
  ds_read_b64_tr_b16 v[32:33], v20 offset:0
  s_waitcnt lgkmcnt(14)
  ds_read_b64_tr_b16 v[34:35], v20 offset:4096
  s_waitcnt lgkmcnt(14)
  v_mfma_f32_32x32x16_bf16 v[80:95], v[36:39], v[224:227], v[80:95]
  ds_read_b64_tr_b16 v[36:37], v21 offset:0
  s_waitcnt lgkmcnt(14)
  ds_read_b64_tr_b16 v[38:39], v21 offset:4096
  s_waitcnt lgkmcnt(14)
  v_mfma_f32_32x32x16_bf16 v[96:111], v[40:43], v[224:227], v[96:111]
  ds_read_b64_tr_b16 v[40:41], v22 offset:0
  s_waitcnt lgkmcnt(14)
  ds_read_b64_tr_b16 v[42:43], v22 offset:4096
  s_waitcnt lgkmcnt(14)
  v_mfma_f32_32x32x16_bf16 v[112:127], v[44:47], v[224:227], v[112:127]
  ds_read_b64_tr_b16 v[44:45], v23 offset:0
  s_waitcnt lgkmcnt(14)
  ds_read_b64_tr_b16 v[46:47], v23 offset:4096
  s_waitcnt lgkmcnt(14)
  v_mfma_f32_32x32x16_bf16 v[128:143], v[48:51], v[224:227], v[128:143]
  ds_read_b64_tr_b16 v[48:49], v20 offset:256
  s_waitcnt lgkmcnt(14)
  ds_read_b64_tr_b16 v[50:51], v20 offset:4352
  s_waitcnt lgkmcnt(14)
  v_mfma_f32_32x32x16_bf16 v[144:159], v[52:55], v[224:227], v[144:159]
  ds_read_b64_tr_b16 v[52:53], v21 offset:256
  s_waitcnt lgkmcnt(14)
  ds_read_b64_tr_b16 v[54:55], v21 offset:4352
  s_waitcnt lgkmcnt(14)
  v_mfma_f32_32x32x16_bf16 v[160:175], v[56:59], v[224:227], v[160:175]
  ds_read_b64_tr_b16 v[56:57], v22 offset:256
  s_waitcnt lgkmcnt(14)
  ds_read_b64_tr_b16 v[58:59], v22 offset:4352
  s_waitcnt lgkmcnt(14)
  v_mfma_f32_32x32x16_bf16 v[176:191], v[60:63], v[224:227], v[176:191]
  ds_read_b64_tr_b16 v[60:61], v23 offset:256
  s_waitcnt lgkmcnt(14)
  ds_read_b64_tr_b16 v[62:63], v23 offset:4352
  v_add_u32 v20, 16384, v17
  v_xor_b32 v21, 64, v20
  v_xor_b32 v22, 128, v20
  v_xor_b32 v23, 192, v20
  s_waitcnt lgkmcnt(14)
  v_mfma_f32_32x32x16_bf16 v[64:79], v[32:35], v[228:231], v[64:79]
  ds_read_b64_tr_b16 v[32:33], v20 offset:0
  s_waitcnt lgkmcnt(14)
  ds_read_b64_tr_b16 v[34:35], v20 offset:4096
  s_waitcnt lgkmcnt(14)
  v_mfma_f32_32x32x16_bf16 v[80:95], v[36:39], v[228:231], v[80:95]
  ds_read_b64_tr_b16 v[36:37], v21 offset:0
  s_waitcnt lgkmcnt(14)
  ds_read_b64_tr_b16 v[38:39], v21 offset:4096
  s_waitcnt lgkmcnt(14)
  v_mfma_f32_32x32x16_bf16 v[96:111], v[40:43], v[228:231], v[96:111]
  ds_read_b64_tr_b16 v[40:41], v22 offset:0
  s_waitcnt lgkmcnt(14)
  ds_read_b64_tr_b16 v[42:43], v22 offset:4096
  s_waitcnt lgkmcnt(14)
  v_mfma_f32_32x32x16_bf16 v[112:127], v[44:47], v[228:231], v[112:127]
  ds_read_b64_tr_b16 v[44:45], v23 offset:0
  s_waitcnt lgkmcnt(14)
  ds_read_b64_tr_b16 v[46:47], v23 offset:4096
  s_waitcnt lgkmcnt(14)
  v_mfma_f32_32x32x16_bf16 v[128:143], v[48:51], v[228:231], v[128:143]
  ds_read_b64_tr_b16 v[48:49], v20 offset:256
  s_waitcnt lgkmcnt(14)
  ds_read_b64_tr_b16 v[50:51], v20 offset:4352
  s_waitcnt lgkmcnt(14)
  v_mfma_f32_32x32x16_bf16 v[144:159], v[52:55], v[228:231], v[144:159]
  ds_read_b64_tr_b16 v[52:53], v21 offset:256
  s_waitcnt lgkmcnt(14)
  ds_read_b64_tr_b16 v[54:55], v21 offset:4352
  s_waitcnt lgkmcnt(14)
  v_mfma_f32_32x32x16_bf16 v[160:175], v[56:59], v[228:231], v[160:175]
  ds_read_b64_tr_b16 v[56:57], v22 offset:256
  s_waitcnt lgkmcnt(14)
  ds_read_b64_tr_b16 v[58:59], v22 offset:4352
  s_waitcnt lgkmcnt(14)
  v_mfma_f32_32x32x16_bf16 v[176:191], v[60:63], v[228:231], v[176:191]
  ds_read_b64_tr_b16 v[60:61], v23 offset:256
  s_waitcnt lgkmcnt(14)
  ds_read_b64_tr_b16 v[62:63], v23 offset:4352
  v_add_u32 v20, 0, v17
  v_xor_b32 v21, 64, v20
  v_xor_b32 v22, 128, v20
  v_xor_b32 v23, 192, v20
  s_waitcnt lgkmcnt(14)
  v_mfma_f32_32x32x16_bf16 v[64:79], v[32:35], v[232:235], v[64:79]
  ds_read_b64_tr_b16 v[32:33], v20 offset:0
  s_waitcnt lgkmcnt(14)
  ds_read_b64_tr_b16 v[34:35], v20 offset:4096
  s_waitcnt lgkmcnt(14)
  v_mfma_f32_32x32x16_bf16 v[80:95], v[36:39], v[232:235], v[80:95]
  ds_read_b64_tr_b16 v[36:37], v21 offset:0
  s_waitcnt lgkmcnt(14)
  ds_read_b64_tr_b16 v[38:39], v21 offset:4096
  s_waitcnt lgkmcnt(14)
  v_mfma_f32_32x32x16_bf16 v[96:111], v[40:43], v[232:235], v[96:111]
  ds_read_b64_tr_b16 v[40:41], v22 offset:0
  s_waitcnt lgkmcnt(14)
  ds_read_b64_tr_b16 v[42:43], v22 offset:4096
  s_waitcnt lgkmcnt(14)
  v_mfma_f32_32x32x16_bf16 v[112:127], v[44:47], v[232:235], v[112:127]
  ds_read_b64_tr_b16 v[44:45], v23 offset:0
  s_waitcnt lgkmcnt(14)
  ds_read_b64_tr_b16 v[46:47], v23 offset:4096
  s_waitcnt lgkmcnt(14)
  v_mfma_f32_32x32x16_bf16 v[128:143], v[48:51], v[232:235], v[128:143]
  ds_read_b64_tr_b16 v[48:49], v20 offset:256
  s_waitcnt lgkmcnt(14)
  ds_read_b64_tr_b16 v[50:51], v20 offset:4352
  s_waitcnt lgkmcnt(14)
  v_mfma_f32_32x32x16_bf16 v[144:159], v[52:55], v[232:235], v[144:159]
  ds_read_b64_tr_b16 v[52:53], v21 offset:256
  s_waitcnt lgkmcnt(14)
  ds_read_b64_tr_b16 v[54:55], v21 offset:4352
  s_waitcnt lgkmcnt(14)
  v_mfma_f32_32x32x16_bf16 v[160:175], v[56:59], v[232:235], v[160:175]
  ds_read_b64_tr_b16 v[56:57], v22 offset:256
  s_waitcnt lgkmcnt(14)
  ds_read_b64_tr_b16 v[58:59], v22 offset:4352
  s_waitcnt lgkmcnt(14)
  v_mfma_f32_32x32x16_bf16 v[176:191], v[60:63], v[232:235], v[176:191]
  ds_read_b64_tr_b16 v[60:61], v23 offset:256
  s_waitcnt lgkmcnt(14)
  ds_read_b64_tr_b16 v[62:63], v23 offset:4352
  v_add_u32 v20, 114688, v17
  v_xor_b32 v21, 64, v20
  v_xor_b32 v22, 128, v20
  v_xor_b32 v23, 192, v20
  s_waitcnt lgkmcnt(14)
  v_mfma_f32_32x32x16_bf16 v[64:79], v[32:35], v[236:239], v[64:79]
  ds_read_b64_tr_b16 v[32:33], v20 offset:0
  s_waitcnt lgkmcnt(14)
  ds_read_b64_tr_b16 v[34:35], v20 offset:4096
  s_waitcnt lgkmcnt(14)
  v_mfma_f32_32x32x16_bf16 v[80:95], v[36:39], v[236:239], v[80:95]
  ds_read_b64_tr_b16 v[36:37], v21 offset:0
  s_waitcnt lgkmcnt(14)
  ds_read_b64_tr_b16 v[38:39], v21 offset:4096
  s_waitcnt lgkmcnt(14)
  v_mfma_f32_32x32x16_bf16 v[96:111], v[40:43], v[236:239], v[96:111]
  ds_read_b64_tr_b16 v[40:41], v22 offset:0
  s_waitcnt lgkmcnt(14)
  ds_read_b64_tr_b16 v[42:43], v22 offset:4096
  s_waitcnt lgkmcnt(14)
  v_mfma_f32_32x32x16_bf16 v[112:127], v[44:47], v[236:239], v[112:127]
  ds_read_b64_tr_b16 v[44:45], v23 offset:0
  s_waitcnt lgkmcnt(14)
  ds_read_b64_tr_b16 v[46:47], v23 offset:4096
  s_waitcnt lgkmcnt(14)
  v_mfma_f32_32x32x16_bf16 v[128:143], v[48:51], v[236:239], v[128:143]
  ds_read_b64_tr_b16 v[48:49], v20 offset:256
  s_waitcnt lgkmcnt(14)
  ds_read_b64_tr_b16 v[50:51], v20 offset:4352
  s_waitcnt lgkmcnt(14)
  v_mfma_f32_32x32x16_bf16 v[144:159], v[52:55], v[236:239], v[144:159]
  ds_read_b64_tr_b16 v[52:53], v21 offset:256
  s_waitcnt lgkmcnt(14)
  ds_read_b64_tr_b16 v[54:55], v21 offset:4352
  s_waitcnt lgkmcnt(14)
  v_mfma_f32_32x32x16_bf16 v[160:175], v[56:59], v[236:239], v[160:175]
  ds_read_b64_tr_b16 v[56:57], v22 offset:256
  s_waitcnt lgkmcnt(14)
  ds_read_b64_tr_b16 v[58:59], v22 offset:4352
  s_waitcnt lgkmcnt(14)
  v_mfma_f32_32x32x16_bf16 v[176:191], v[60:63], v[236:239], v[176:191]
  ds_read_b64_tr_b16 v[60:61], v23 offset:256
  s_waitcnt lgkmcnt(14)
  ds_read_b64_tr_b16 v[62:63], v23 offset:4352
  v_add_u32 v20, 98304, v17
  v_xor_b32 v21, 64, v20
  v_xor_b32 v22, 128, v20
  v_xor_b32 v23, 192, v20
  s_waitcnt lgkmcnt(14)
  v_mfma_f32_32x32x16_bf16 v[64:79], v[32:35], v[240:243], v[64:79]
  ds_read_b64_tr_b16 v[32:33], v20 offset:0
  s_waitcnt lgkmcnt(14)
  ds_read_b64_tr_b16 v[34:35], v20 offset:4096
  s_waitcnt lgkmcnt(14)
  v_mfma_f32_32x32x16_bf16 v[80:95], v[36:39], v[240:243], v[80:95]
  ds_read_b64_tr_b16 v[36:37], v21 offset:0
  s_waitcnt lgkmcnt(14)
  ds_read_b64_tr_b16 v[38:39], v21 offset:4096
  s_waitcnt lgkmcnt(14)
  v_mfma_f32_32x32x16_bf16 v[96:111], v[40:43], v[240:243], v[96:111]
  ds_read_b64_tr_b16 v[40:41], v22 offset:0
  s_waitcnt lgkmcnt(14)
  ds_read_b64_tr_b16 v[42:43], v22 offset:4096
  s_waitcnt lgkmcnt(14)
  v_mfma_f32_32x32x16_bf16 v[112:127], v[44:47], v[240:243], v[112:127]
  ds_read_b64_tr_b16 v[44:45], v23 offset:0
  s_waitcnt lgkmcnt(14)
  ds_read_b64_tr_b16 v[46:47], v23 offset:4096
  s_waitcnt lgkmcnt(14)
  v_mfma_f32_32x32x16_bf16 v[128:143], v[48:51], v[240:243], v[128:143]
  ds_read_b64_tr_b16 v[48:49], v20 offset:256
  s_waitcnt lgkmcnt(14)
  ds_read_b64_tr_b16 v[50:51], v20 offset:4352
  s_waitcnt lgkmcnt(14)
  v_mfma_f32_32x32x16_bf16 v[144:159], v[52:55], v[240:243], v[144:159]
  ds_read_b64_tr_b16 v[52:53], v21 offset:256
  s_waitcnt lgkmcnt(14)
  ds_read_b64_tr_b16 v[54:55], v21 offset:4352
  s_waitcnt lgkmcnt(14)
  v_mfma_f32_32x32x16_bf16 v[160:175], v[56:59], v[240:243], v[160:175]
  ds_read_b64_tr_b16 v[56:57], v22 offset:256
  s_waitcnt lgkmcnt(14)
  ds_read_b64_tr_b16 v[58:59], v22 offset:4352
  s_waitcnt lgkmcnt(14)
  v_mfma_f32_32x32x16_bf16 v[176:191], v[60:63], v[240:243], v[176:191]
  ds_read_b64_tr_b16 v[60:61], v23 offset:256
  s_waitcnt lgkmcnt(14)
  ds_read_b64_tr_b16 v[62:63], v23 offset:4352
  v_add_u32 v20, 32768, v17
  v_xor_b32 v21, 64, v20
  v_xor_b32 v22, 128, v20
  v_xor_b32 v23, 192, v20
  s_waitcnt lgkmcnt(14)
  v_mfma_f32_32x32x16_bf16 v[64:79], v[32:35], v[244:247], v[64:79]
  ds_read_b64_tr_b16 v[32:33], v20 offset:0
  s_waitcnt lgkmcnt(14)
  ds_read_b64_tr_b16 v[34:35], v20 offset:4096
  s_waitcnt lgkmcnt(14)
  v_mfma_f32_32x32x16_bf16 v[80:95], v[36:39], v[244:247], v[80:95]
  ds_read_b64_tr_b16 v[36:37], v21 offset:0
  s_waitcnt lgkmcnt(14)
  ds_read_b64_tr_b16 v[38:39], v21 offset:4096
  s_waitcnt lgkmcnt(14)
  v_mfma_f32_32x32x16_bf16 v[96:111], v[40:43], v[244:247], v[96:111]
  ds_read_b64_tr_b16 v[40:41], v22 offset:0
  s_waitcnt lgkmcnt(14)
  ds_read_b64_tr_b16 v[42:43], v22 offset:4096
  s_waitcnt lgkmcnt(14)
  v_mfma_f32_32x32x16_bf16 v[112:127], v[44:47], v[244:247], v[112:127]
  ds_read_b64_tr_b16 v[44:45], v23 offset:0
  s_waitcnt lgkmcnt(14)
  ds_read_b64_tr_b16 v[46:47], v23 offset:4096
  s_waitcnt lgkmcnt(14)
  v_mfma_f32_32x32x16_bf16 v[128:143], v[48:51], v[244:247], v[128:143]
  ds_read_b64_tr_b16 v[48:49], v20 offset:256
  s_waitcnt lgkmcnt(14)
  ds_read_b64_tr_b16 v[50:51], v20 offset:4352
  s_waitcnt lgkmcnt(14)
  v_mfma_f32_32x32x16_bf16 v[144:159], v[52:55], v[244:247], v[144:159]
  ds_read_b64_tr_b16 v[52:53], v21 offset:256
  s_waitcnt lgkmcnt(14)
  ds_read_b64_tr_b16 v[54:55], v21 offset:4352
  s_waitcnt lgkmcnt(14)
  v_mfma_f32_32x32x16_bf16 v[160:175], v[56:59], v[244:247], v[160:175]
  ds_read_b64_tr_b16 v[56:57], v22 offset:256
  s_waitcnt lgkmcnt(14)
  ds_read_b64_tr_b16 v[58:59], v22 offset:4352
  s_waitcnt lgkmcnt(14)
  v_mfma_f32_32x32x16_bf16 v[176:191], v[60:63], v[244:247], v[176:191]
  ds_read_b64_tr_b16 v[60:61], v23 offset:256
  s_waitcnt lgkmcnt(14)
  ds_read_b64_tr_b16 v[62:63], v23 offset:4352
  v_add_u32 v20, 81920, v17
  v_xor_b32 v21, 64, v20
  v_xor_b32 v22, 128, v20
  v_xor_b32 v23, 192, v20
  s_waitcnt lgkmcnt(14)
  v_mfma_f32_32x32x16_bf16 v[64:79], v[32:35], v[248:251], v[64:79]
  ds_read_b64_tr_b16 v[32:33], v20 offset:0
  s_waitcnt lgkmcnt(14)
  ds_read_b64_tr_b16 v[34:35], v20 offset:4096
  s_waitcnt lgkmcnt(14)
  v_mfma_f32_32x32x16_bf16 v[80:95], v[36:39], v[248:251], v[80:95]
  ds_read_b64_tr_b16 v[36:37], v21 offset:0
  s_waitcnt lgkmcnt(14)
  ds_read_b64_tr_b16 v[38:39], v21 offset:4096
  s_waitcnt lgkmcnt(14)
  v_mfma_f32_32x32x16_bf16 v[96:111], v[40:43], v[248:251], v[96:111]
  ds_read_b64_tr_b16 v[40:41], v22 offset:0
  s_waitcnt lgkmcnt(14)
  ds_read_b64_tr_b16 v[42:43], v22 offset:4096
  s_waitcnt lgkmcnt(14)
  v_mfma_f32_32x32x16_bf16 v[112:127], v[44:47], v[248:251], v[112:127]
  ds_read_b64_tr_b16 v[44:45], v23 offset:0
  s_waitcnt lgkmcnt(14)
  ds_read_b64_tr_b16 v[46:47], v23 offset:4096
  s_waitcnt lgkmcnt(14)
  v_mfma_f32_32x32x16_bf16 v[128:143], v[48:51], v[248:251], v[128:143]
  ds_read_b64_tr_b16 v[48:49], v20 offset:256
  s_waitcnt lgkmcnt(14)
  ds_read_b64_tr_b16 v[50:51], v20 offset:4352
  s_waitcnt lgkmcnt(14)
  v_mfma_f32_32x32x16_bf16 v[144:159], v[52:55], v[248:251], v[144:159]
  ds_read_b64_tr_b16 v[52:53], v21 offset:256
  s_waitcnt lgkmcnt(14)
  ds_read_b64_tr_b16 v[54:55], v21 offset:4352
  s_waitcnt lgkmcnt(14)
  v_mfma_f32_32x32x16_bf16 v[160:175], v[56:59], v[248:251], v[160:175]
  ds_read_b64_tr_b16 v[56:57], v22 offset:256
  s_waitcnt lgkmcnt(14)
  ds_read_b64_tr_b16 v[58:59], v22 offset:4352
  s_waitcnt lgkmcnt(14)
  v_mfma_f32_32x32x16_bf16 v[176:191], v[60:63], v[248:251], v[176:191]
  ds_read_b64_tr_b16 v[60:61], v23 offset:256
  s_waitcnt lgkmcnt(14)
  ds_read_b64_tr_b16 v[62:63], v23 offset:4352
  s_waitcnt lgkmcnt(14)
  v_mfma_f32_32x32x16_bf16 v[64:79], v[32:35], v[252:255], v[64:79]
  s_waitcnt lgkmcnt(12)
  v_mfma_f32_32x32x16_bf16 v[80:95], v[36:39], v[252:255], v[80:95]
  s_waitcnt lgkmcnt(10)
  v_mfma_f32_32x32x16_bf16 v[96:111], v[40:43], v[252:255], v[96:111]
  s_waitcnt lgkmcnt(8)
  v_mfma_f32_32x32x16_bf16 v[112:127], v[44:47], v[252:255], v[112:127]
  s_waitcnt lgkmcnt(6)
  v_mfma_f32_32x32x16_bf16 v[128:143], v[48:51], v[252:255], v[128:143]
  s_waitcnt lgkmcnt(4)
  v_mfma_f32_32x32x16_bf16 v[144:159], v[52:55], v[252:255], v[144:159]
  s_waitcnt lgkmcnt(2)
  v_mfma_f32_32x32x16_bf16 v[160:175], v[56:59], v[252:255], v[160:175]
  s_waitcnt lgkmcnt(0)
  v_mfma_f32_32x32x16_bf16 v[176:191], v[60:63], v[252:255], v[176:191]
  s_nop 7
  s_nop 7
  s_lshl_b32 s43, s45, 14
  v_cvt_pk_bf16_f32 v32, v64, v65
  v_cvt_pk_bf16_f32 v33, v66, v67
  v_cvt_pk_bf16_f32 v34, v68, v69
  v_cvt_pk_bf16_f32 v35, v70, v71
  buffer_store_dwordx4 v[32:35], v18, s[28:31], s43 offen sc1
  v_cvt_pk_bf16_f32 v36, v72, v73
  v_cvt_pk_bf16_f32 v37, v74, v75
  v_cvt_pk_bf16_f32 v38, v76, v77
  v_cvt_pk_bf16_f32 v39, v78, v79
  buffer_store_dwordx4 v[36:39], v18, s[28:31], s43 offen offset:1024 sc1
  v_cvt_pk_bf16_f32 v40, v80, v81
  v_cvt_pk_bf16_f32 v41, v82, v83
  v_cvt_pk_bf16_f32 v42, v84, v85
  v_cvt_pk_bf16_f32 v43, v86, v87
  buffer_store_dwordx4 v[40:43], v18, s[28:31], s43 offen offset:2048 sc1
  v_cvt_pk_bf16_f32 v44, v88, v89
  v_cvt_pk_bf16_f32 v45, v90, v91
  v_cvt_pk_bf16_f32 v46, v92, v93
  v_cvt_pk_bf16_f32 v47, v94, v95
  buffer_store_dwordx4 v[44:47], v18, s[28:31], s43 offen offset:3072 sc1
  v_cvt_pk_bf16_f32 v48, v96, v97
  v_cvt_pk_bf16_f32 v49, v98, v99
  v_cvt_pk_bf16_f32 v50, v100, v101
  v_cvt_pk_bf16_f32 v51, v102, v103
  s_add_u32 s43, s43, 4096
  buffer_store_dwordx4 v[48:51], v18, s[28:31], s43 offen sc1
  v_cvt_pk_bf16_f32 v52, v104, v105
  v_cvt_pk_bf16_f32 v53, v106, v107
  v_cvt_pk_bf16_f32 v54, v108, v109
  v_cvt_pk_bf16_f32 v55, v110, v111
  buffer_store_dwordx4 v[52:55], v18, s[28:31], s43 offen offset:1024 sc1
  v_cvt_pk_bf16_f32 v56, v112, v113
  v_cvt_pk_bf16_f32 v57, v114, v115
  v_cvt_pk_bf16_f32 v58, v116, v117
  v_cvt_pk_bf16_f32 v59, v118, v119
  buffer_store_dwordx4 v[56:59], v18, s[28:31], s43 offen offset:2048 sc1
  v_cvt_pk_bf16_f32 v60, v120, v121
  v_cvt_pk_bf16_f32 v61, v122, v123
  v_cvt_pk_bf16_f32 v62, v124, v125
  v_cvt_pk_bf16_f32 v63, v126, v127
  buffer_store_dwordx4 v[60:63], v18, s[28:31], s43 offen offset:3072 sc1
  v_cvt_pk_bf16_f32 v32, v128, v129
  v_cvt_pk_bf16_f32 v33, v130, v131
  v_cvt_pk_bf16_f32 v34, v132, v133
  v_cvt_pk_bf16_f32 v35, v134, v135
  s_add_u32 s43, s43, 4096
  buffer_store_dwordx4 v[32:35], v18, s[28:31], s43 offen sc1
  v_cvt_pk_bf16_f32 v36, v136, v137
  v_cvt_pk_bf16_f32 v37, v138, v139
  v_cvt_pk_bf16_f32 v38, v140, v141
  v_cvt_pk_bf16_f32 v39, v142, v143
  buffer_store_dwordx4 v[36:39], v18, s[28:31], s43 offen offset:1024 sc1
  v_cvt_pk_bf16_f32 v40, v144, v145
  v_cvt_pk_bf16_f32 v41, v146, v147
  v_cvt_pk_bf16_f32 v42, v148, v149
  v_cvt_pk_bf16_f32 v43, v150, v151
  buffer_store_dwordx4 v[40:43], v18, s[28:31], s43 offen offset:2048 sc1
  v_cvt_pk_bf16_f32 v44, v152, v153
  v_cvt_pk_bf16_f32 v45, v154, v155
  v_cvt_pk_bf16_f32 v46, v156, v157
  v_cvt_pk_bf16_f32 v47, v158, v159
  buffer_store_dwordx4 v[44:47], v18, s[28:31], s43 offen offset:3072 sc1
  v_cvt_pk_bf16_f32 v48, v160, v161
  v_cvt_pk_bf16_f32 v49, v162, v163
  v_cvt_pk_bf16_f32 v50, v164, v165
  v_cvt_pk_bf16_f32 v51, v166, v167
  s_add_u32 s43, s43, 4096
  buffer_store_dwordx4 v[48:51], v18, s[28:31], s43 offen sc1
  v_cvt_pk_bf16_f32 v52, v168, v169
  v_cvt_pk_bf16_f32 v53, v170, v171
  v_cvt_pk_bf16_f32 v54, v172, v173
  v_cvt_pk_bf16_f32 v55, v174, v175
  buffer_store_dwordx4 v[52:55], v18, s[28:31], s43 offen offset:1024 sc1
  v_cvt_pk_bf16_f32 v56, v176, v177
  v_cvt_pk_bf16_f32 v57, v178, v179
  v_cvt_pk_bf16_f32 v58, v180, v181
  v_cvt_pk_bf16_f32 v59, v182, v183
  buffer_store_dwordx4 v[56:59], v18, s[28:31], s43 offen offset:2048 sc1
  v_cvt_pk_bf16_f32 v60, v184, v185
  v_cvt_pk_bf16_f32 v61, v186, v187
  v_cvt_pk_bf16_f32 v62, v188, v189
  v_cvt_pk_bf16_f32 v63, v190, v191
  buffer_store_dwordx4 v[60:63], v18, s[28:31], s43 offen offset:3072 sc1
  s_branch L_final
L_rare_2:
  s_waitcnt lgkmcnt(0)
  v_mfma_f32_32x32x16_bf16 v[96:111], v[136:139], v[56:59], v[96:111]
  ds_read_b128 v[136:139], v242 offset:16384
  v_mfma_f32_32x32x16_bf16 v[112:127], v[140:143], v[56:59], v[112:127]
  ds_read_b128 v[140:143], v243 offset:16384
  v_mfma_f32_32x32x16_bf16 v[64:79], v[144:147], v[60:63], v[64:79]
  ds_read_b128 v[144:147], v244 offset:16384
  v_mfma_f32_32x32x16_bf16 v[80:95], v[148:151], v[60:63], v[80:95]
  ds_read_b128 v[148:151], v245 offset:16384
  v_mfma_f32_32x32x16_bf16 v[96:111], v[152:155], v[60:63], v[96:111]
  ds_read_b128 v[152:155], v246 offset:16384
  v_mfma_f32_32x32x16_bf16 v[112:127], v[156:159], v[60:63], v[112:127]
  ds_read_b128 v[156:159], v247 offset:16384
  v_mov_b32 v37, v36
  s_nop 1
  v_permlane32_swap_b32 v36, v37
  s_nop 1
  v_max3_f32 v36, v36, v37, 0
  v_sub_f32 v37, 0, v36
  v_exp_f32 v37, v37
  v_sub_f32 v224, v40, v36
  v_sub_f32 v160, v160, v36
  v_sub_f32 v225, v41, v36
  v_sub_f32 v161, v161, v36
  v_sub_f32 v226, v42, v36
  v_sub_f32 v162, v162, v36
  v_sub_f32 v227, v43, v36
  v_sub_f32 v163, v163, v36
  v_sub_f32 v228, v44, v36
  v_sub_f32 v164, v164, v36
  v_sub_f32 v229, v45, v36
  v_sub_f32 v165, v165, v36
  v_sub_f32 v230, v46, v36
  v_sub_f32 v166, v166, v36
  v_sub_f32 v231, v47, v36
  v_sub_f32 v167, v167, v36
  v_sub_f32 v232, v48, v36
  v_sub_f32 v168, v168, v36
  v_sub_f32 v233, v49, v36
  v_sub_f32 v169, v169, v36
  v_sub_f32 v234, v50, v36
  v_sub_f32 v170, v170, v36
  v_sub_f32 v235, v51, v36
  v_sub_f32 v171, v171, v36
  v_sub_f32 v236, v52, v36
  v_sub_f32 v172, v172, v36
  v_sub_f32 v237, v53, v36
  v_sub_f32 v173, v173, v36
  v_sub_f32 v238, v54, v36
  v_sub_f32 v174, v174, v36
  v_sub_f32 v239, v55, v36
  v_sub_f32 v175, v175, v36
  v_exp_f32 v224, v224
  v_exp_f32 v225, v225
  v_exp_f32 v226, v226
  v_exp_f32 v227, v227
  v_exp_f32 v228, v228
  v_exp_f32 v229, v229
  v_exp_f32 v230, v230
  v_exp_f32 v231, v231
  v_exp_f32 v232, v232
  v_exp_f32 v233, v233
  v_exp_f32 v234, v234
  v_exp_f32 v235, v235
  v_exp_f32 v236, v236
  v_exp_f32 v237, v237
  v_exp_f32 v238, v238
  v_exp_f32 v239, v239
  v_mul_f32 v252, v252, v37
  v_mul_f32 v64, v64, v37
  v_mul_f32 v65, v65, v37
  v_mul_f32 v66, v66, v37
  v_mul_f32 v67, v67, v37
  v_mul_f32 v68, v68, v37
  v_mul_f32 v69, v69, v37
  v_mul_f32 v70, v70, v37
  v_mul_f32 v71, v71, v37
  v_mul_f32 v72, v72, v37
  v_mul_f32 v73, v73, v37
  v_mul_f32 v74, v74, v37
  v_mul_f32 v75, v75, v37
  v_mul_f32 v76, v76, v37
  v_mul_f32 v77, v77, v37
  v_mul_f32 v78, v78, v37
  v_mul_f32 v79, v79, v37
  v_mul_f32 v80, v80, v37
  v_mul_f32 v81, v81, v37
  v_mul_f32 v82, v82, v37
  v_mul_f32 v83, v83, v37
  v_mul_f32 v84, v84, v37
  v_mul_f32 v85, v85, v37
  v_mul_f32 v86, v86, v37
  v_mul_f32 v87, v87, v37
  v_mul_f32 v88, v88, v37
  v_mul_f32 v89, v89, v37
  v_mul_f32 v90, v90, v37
  v_mul_f32 v91, v91, v37
  v_mul_f32 v92, v92, v37
  v_mul_f32 v93, v93, v37
  v_mul_f32 v94, v94, v37
  v_mul_f32 v95, v95, v37
  v_mul_f32 v96, v96, v37
  v_mul_f32 v97, v97, v37
  v_mul_f32 v98, v98, v37
  v_mul_f32 v99, v99, v37
  v_mul_f32 v100, v100, v37
  v_mul_f32 v101, v101, v37
  v_mul_f32 v102, v102, v37
  v_mul_f32 v103, v103, v37
  v_mul_f32 v104, v104, v37
  v_mul_f32 v105, v105, v37
  v_mul_f32 v106, v106, v37
  v_mul_f32 v107, v107, v37
  v_mul_f32 v108, v108, v37
  v_mul_f32 v109, v109, v37
  v_mul_f32 v110, v110, v37
  v_mul_f32 v111, v111, v37
  v_mul_f32 v112, v112, v37
  v_mul_f32 v113, v113, v37
  v_mul_f32 v114, v114, v37
  v_mul_f32 v115, v115, v37
  v_mul_f32 v116, v116, v37
  v_mul_f32 v117, v117, v37
  v_mul_f32 v118, v118, v37
  v_mul_f32 v119, v119, v37
  v_mul_f32 v120, v120, v37
  v_mul_f32 v121, v121, v37
  v_mul_f32 v122, v122, v37
  v_mul_f32 v123, v123, v37
  v_mul_f32 v124, v124, v37
  v_mul_f32 v125, v125, v37
  v_mul_f32 v126, v126, v37
  v_mul_f32 v127, v127, v37
  s_waitcnt lgkmcnt(0)
  s_branch L_back_3
L_rare_4:
  s_waitcnt lgkmcnt(0)
  v_mfma_f32_32x32x16_bf16 v[96:111], v[136:139], v[56:59], v[96:111]
  ds_read_b128 v[136:139], v242 offset:32768
  v_mfma_f32_32x32x16_bf16 v[112:127], v[140:143], v[56:59], v[112:127]
  ds_read_b128 v[140:143], v243 offset:32768
  v_mfma_f32_32x32x16_bf16 v[64:79], v[144:147], v[60:63], v[64:79]
  ds_read_b128 v[144:147], v244 offset:32768
  v_mfma_f32_32x32x16_bf16 v[80:95], v[148:151], v[60:63], v[80:95]
  ds_read_b128 v[148:151], v245 offset:32768
  v_mfma_f32_32x32x16_bf16 v[96:111], v[152:155], v[60:63], v[96:111]
  ds_read_b128 v[152:155], v246 offset:32768
  v_mfma_f32_32x32x16_bf16 v[112:127], v[156:159], v[60:63], v[112:127]
  ds_read_b128 v[156:159], v247 offset:32768
  v_mov_b32 v37, v36
  s_nop 1
  v_permlane32_swap_b32 v36, v37
  s_nop 1
  v_max3_f32 v36, v36, v37, 0
  v_sub_f32 v37, 0, v36
  v_exp_f32 v37, v37
  v_sub_f32 v224, v40, v36
  v_sub_f32 v160, v160, v36
  v_sub_f32 v225, v41, v36
  v_sub_f32 v161, v161, v36
  v_sub_f32 v226, v42, v36
  v_sub_f32 v162, v162, v36
  v_sub_f32 v227, v43, v36
  v_sub_f32 v163, v163, v36
  v_sub_f32 v228, v44, v36
  v_sub_f32 v164, v164, v36
  v_sub_f32 v229, v45, v36
  v_sub_f32 v165, v165, v36
  v_sub_f32 v230, v46, v36
  v_sub_f32 v166, v166, v36
  v_sub_f32 v231, v47, v36
  v_sub_f32 v167, v167, v36
  v_sub_f32 v232, v48, v36
  v_sub_f32 v168, v168, v36
  v_sub_f32 v233, v49, v36
  v_sub_f32 v169, v169, v36
  v_sub_f32 v234, v50, v36
  v_sub_f32 v170, v170, v36
  v_sub_f32 v235, v51, v36
  v_sub_f32 v171, v171, v36
  v_sub_f32 v236, v52, v36
  v_sub_f32 v172, v172, v36
  v_sub_f32 v237, v53, v36
  v_sub_f32 v173, v173, v36
  v_sub_f32 v238, v54, v36
  v_sub_f32 v174, v174, v36
  v_sub_f32 v239, v55, v36
  v_sub_f32 v175, v175, v36
  v_exp_f32 v224, v224
  v_exp_f32 v225, v225
  v_exp_f32 v226, v226
  v_exp_f32 v227, v227
  v_exp_f32 v228, v228
  v_exp_f32 v229, v229
  v_exp_f32 v230, v230
  v_exp_f32 v231, v231
  v_exp_f32 v232, v232
  v_exp_f32 v233, v233
  v_exp_f32 v234, v234
  v_exp_f32 v235, v235
  v_exp_f32 v236, v236
  v_exp_f32 v237, v237
  v_exp_f32 v238, v238
  v_exp_f32 v239, v239
  v_mul_f32 v252, v252, v37
  v_mul_f32 v64, v64, v37
  v_mul_f32 v65, v65, v37
  v_mul_f32 v66, v66, v37
  v_mul_f32 v67, v67, v37
  v_mul_f32 v68, v68, v37
  v_mul_f32 v69, v69, v37
  v_mul_f32 v70, v70, v37
  v_mul_f32 v71, v71, v37
  v_mul_f32 v72, v72, v37
  v_mul_f32 v73, v73, v37
  v_mul_f32 v74, v74, v37
  v_mul_f32 v75, v75, v37
  v_mul_f32 v76, v76, v37
  v_mul_f32 v77, v77, v37
  v_mul_f32 v78, v78, v37
  v_mul_f32 v79, v79, v37
  v_mul_f32 v80, v80, v37
  v_mul_f32 v81, v81, v37
  v_mul_f32 v82, v82, v37
  v_mul_f32 v83, v83, v37
  v_mul_f32 v84, v84, v37
  v_mul_f32 v85, v85, v37
  v_mul_f32 v86, v86, v37
  v_mul_f32 v87, v87, v37
  v_mul_f32 v88, v88, v37
  v_mul_f32 v89, v89, v37
  v_mul_f32 v90, v90, v37
  v_mul_f32 v91, v91, v37
  v_mul_f32 v92, v92, v37
  v_mul_f32 v93, v93, v37
  v_mul_f32 v94, v94, v37
  v_mul_f32 v95, v95, v37
  v_mul_f32 v96, v96, v37
  v_mul_f32 v97, v97, v37
  v_mul_f32 v98, v98, v37
  v_mul_f32 v99, v99, v37
  v_mul_f32 v100, v100, v37
  v_mul_f32 v101, v101, v37
  v_mul_f32 v102, v102, v37
  v_mul_f32 v103, v103, v37
  v_mul_f32 v104, v104, v37
  v_mul_f32 v105, v105, v37
  v_mul_f32 v106, v106, v37
  v_mul_f32 v107, v107, v37
  v_mul_f32 v108, v108, v37
  v_mul_f32 v109, v109, v37
  v_mul_f32 v110, v110, v37
  v_mul_f32 v111, v111, v37
  v_mul_f32 v112, v112, v37
  v_mul_f32 v113, v113, v37
  v_mul_f32 v114, v114, v37
  v_mul_f32 v115, v115, v37
  v_mul_f32 v116, v116, v37
  v_mul_f32 v117, v117, v37
  v_mul_f32 v118, v118, v37
  v_mul_f32 v119, v119, v37
  v_mul_f32 v120, v120, v37
  v_mul_f32 v121, v121, v37
  v_mul_f32 v122, v122, v37
  v_mul_f32 v123, v123, v37
  v_mul_f32 v124, v124, v37
  v_mul_f32 v125, v125, v37
  v_mul_f32 v126, v126, v37
  v_mul_f32 v127, v127, v37
  s_waitcnt lgkmcnt(0)
  s_branch L_back_5
L_rare_6:
  s_waitcnt lgkmcnt(0)
  v_mfma_f32_32x32x16_bf16 v[96:111], v[136:139], v[56:59], v[96:111]
  ds_read_b128 v[136:139], v242 offset:0
  v_mfma_f32_32x32x16_bf16 v[112:127], v[140:143], v[56:59], v[112:127]
  ds_read_b128 v[140:143], v243 offset:0
  v_mfma_f32_32x32x16_bf16 v[64:79], v[144:147], v[60:63], v[64:79]
  ds_read_b128 v[144:147], v244 offset:0
  v_mfma_f32_32x32x16_bf16 v[80:95], v[148:151], v[60:63], v[80:95]
  ds_read_b128 v[148:151], v245 offset:0
  v_mfma_f32_32x32x16_bf16 v[96:111], v[152:155], v[60:63], v[96:111]
  ds_read_b128 v[152:155], v246 offset:0
  v_mfma_f32_32x32x16_bf16 v[112:127], v[156:159], v[60:63], v[112:127]
  ds_read_b128 v[156:159], v247 offset:0
  v_mov_b32 v37, v36
  s_nop 1
  v_permlane32_swap_b32 v36, v37
  s_nop 1
  v_max3_f32 v36, v36, v37, 0
  v_sub_f32 v37, 0, v36
  v_exp_f32 v37, v37
  v_sub_f32 v224, v40, v36
  v_sub_f32 v160, v160, v36
  v_sub_f32 v225, v41, v36
  v_sub_f32 v161, v161, v36
  v_sub_f32 v226, v42, v36
  v_sub_f32 v162, v162, v36
  v_sub_f32 v227, v43, v36
  v_sub_f32 v163, v163, v36
  v_sub_f32 v228, v44, v36
  v_sub_f32 v164, v164, v36
  v_sub_f32 v229, v45, v36
  v_sub_f32 v165, v165, v36
  v_sub_f32 v230, v46, v36
  v_sub_f32 v166, v166, v36
  v_sub_f32 v231, v47, v36
  v_sub_f32 v167, v167, v36
  v_sub_f32 v232, v48, v36
  v_sub_f32 v168, v168, v36
  v_sub_f32 v233, v49, v36
  v_sub_f32 v169, v169, v36
  v_sub_f32 v234, v50, v36
  v_sub_f32 v170, v170, v36
  v_sub_f32 v235, v51, v36
  v_sub_f32 v171, v171, v36
  v_sub_f32 v236, v52, v36
  v_sub_f32 v172, v172, v36
  v_sub_f32 v237, v53, v36
  v_sub_f32 v173, v173, v36
  v_sub_f32 v238, v54, v36
  v_sub_f32 v174, v174, v36
  v_sub_f32 v239, v55, v36
  v_sub_f32 v175, v175, v36
  v_exp_f32 v224, v224
  v_exp_f32 v225, v225
  v_exp_f32 v226, v226
  v_exp_f32 v227, v227
  v_exp_f32 v228, v228
  v_exp_f32 v229, v229
  v_exp_f32 v230, v230
  v_exp_f32 v231, v231
  v_exp_f32 v232, v232
  v_exp_f32 v233, v233
  v_exp_f32 v234, v234
  v_exp_f32 v235, v235
  v_exp_f32 v236, v236
  v_exp_f32 v237, v237
  v_exp_f32 v238, v238
  v_exp_f32 v239, v239
  v_mul_f32 v252, v252, v37
  v_mul_f32 v64, v64, v37
  v_mul_f32 v65, v65, v37
  v_mul_f32 v66, v66, v37
  v_mul_f32 v67, v67, v37
  v_mul_f32 v68, v68, v37
  v_mul_f32 v69, v69, v37
  v_mul_f32 v70, v70, v37
  v_mul_f32 v71, v71, v37
  v_mul_f32 v72, v72, v37
  v_mul_f32 v73, v73, v37
  v_mul_f32 v74, v74, v37
  v_mul_f32 v75, v75, v37
  v_mul_f32 v76, v76, v37
  v_mul_f32 v77, v77, v37
  v_mul_f32 v78, v78, v37
  v_mul_f32 v79, v79, v37
  v_mul_f32 v80, v80, v37
  v_mul_f32 v81, v81, v37
  v_mul_f32 v82, v82, v37
  v_mul_f32 v83, v83, v37
  v_mul_f32 v84, v84, v37
  v_mul_f32 v85, v85, v37
  v_mul_f32 v86, v86, v37
  v_mul_f32 v87, v87, v37
  v_mul_f32 v88, v88, v37
  v_mul_f32 v89, v89, v37
  v_mul_f32 v90, v90, v37
  v_mul_f32 v91, v91, v37
  v_mul_f32 v92, v92, v37
  v_mul_f32 v93, v93, v37
  v_mul_f32 v94, v94, v37
  v_mul_f32 v95, v95, v37
  v_mul_f32 v96, v96, v37
  v_mul_f32 v97, v97, v37
  v_mul_f32 v98, v98, v37
  v_mul_f32 v99, v99, v37
  v_mul_f32 v100, v100, v37
  v_mul_f32 v101, v101, v37
  v_mul_f32 v102, v102, v37
  v_mul_f32 v103, v103, v37
  v_mul_f32 v104, v104, v37
  v_mul_f32 v105, v105, v37
  v_mul_f32 v106, v106, v37
  v_mul_f32 v107, v107, v37
  v_mul_f32 v108, v108, v37
  v_mul_f32 v109, v109, v37
  v_mul_f32 v110, v110, v37
  v_mul_f32 v111, v111, v37
  v_mul_f32 v112, v112, v37
  v_mul_f32 v113, v113, v37
  v_mul_f32 v114, v114, v37
  v_mul_f32 v115, v115, v37
  v_mul_f32 v116, v116, v37
  v_mul_f32 v117, v117, v37
  v_mul_f32 v118, v118, v37
  v_mul_f32 v119, v119, v37
  v_mul_f32 v120, v120, v37
  v_mul_f32 v121, v121, v37
  v_mul_f32 v122, v122, v37
  v_mul_f32 v123, v123, v37
  v_mul_f32 v124, v124, v37
  v_mul_f32 v125, v125, v37
  v_mul_f32 v126, v126, v37
  v_mul_f32 v127, v127, v37
  s_waitcnt lgkmcnt(0)
  s_branch L_back_7
L_rare_8:
  s_waitcnt lgkmcnt(0)
  v_mfma_f32_32x32x16_bf16 v[96:111], v[136:139], v[56:59], v[96:111]
  ds_read_b64_tr_b16 v[136:137], v250 offset:24576
  ds_read_b64_tr_b16 v[138:139], v250 offset:26624
  v_mfma_f32_32x32x16_bf16 v[112:127], v[140:143], v[56:59], v[112:127]
  ds_read_b64_tr_b16 v[140:141], v251 offset:24576
  ds_read_b64_tr_b16 v[142:143], v251 offset:26624
  v_mfma_f32_32x32x16_bf16 v[64:79], v[144:147], v[60:63], v[64:79]
  ds_read_b64_tr_b16 v[144:145], v248 offset:28672
  ds_read_b64_tr_b16 v[146:147], v248 offset:30720
  v_mfma_f32_32x32x16_bf16 v[80:95], v[148:151], v[60:63], v[80:95]
  ds_read_b64_tr_b16 v[148:149], v249 offset:28672
  ds_read_b64_tr_b16 v[150:151], v249 offset:30720
  v_mfma_f32_32x32x16_bf16 v[96:111], v[152:155], v[60:63], v[96:111]
  ds_read_b64_tr_b16 v[152:153], v250 offset:28672
  ds_read_b64_tr_b16 v[154:155], v250 offset:30720
  v_mfma_f32_32x32x16_bf16 v[112:127], v[156:159], v[60:63], v[112:127]
  ds_read_b64_tr_b16 v[156:157], v251 offset:28672
  ds_read_b64_tr_b16 v[158:159], v251 offset:30720
  v_mov_b32 v37, v36
  s_nop 1
  v_permlane32_swap_b32 v36, v37
  s_nop 1
  v_max3_f32 v36, v36, v37, 0
  v_sub_f32 v37, 0, v36
  v_exp_f32 v37, v37
  v_sub_f32 v224, v40, v36
  v_sub_f32 v160, v160, v36
  v_sub_f32 v225, v41, v36
  v_sub_f32 v161, v161, v36
  v_sub_f32 v226, v42, v36
  v_sub_f32 v162, v162, v36
  v_sub_f32 v227, v43, v36
  v_sub_f32 v163, v163, v36
  v_sub_f32 v228, v44, v36
  v_sub_f32 v164, v164, v36
  v_sub_f32 v229, v45, v36
  v_sub_f32 v165, v165, v36
  v_sub_f32 v230, v46, v36
  v_sub_f32 v166, v166, v36
  v_sub_f32 v231, v47, v36
  v_sub_f32 v167, v167, v36
  v_sub_f32 v232, v48, v36
  v_sub_f32 v168, v168, v36
  v_sub_f32 v233, v49, v36
  v_sub_f32 v169, v169, v36
  v_sub_f32 v234, v50, v36
  v_sub_f32 v170, v170, v36
  v_sub_f32 v235, v51, v36
  v_sub_f32 v171, v171, v36
  v_sub_f32 v236, v52, v36
  v_sub_f32 v172, v172, v36
  v_sub_f32 v237, v53, v36
  v_sub_f32 v173, v173, v36
  v_sub_f32 v238, v54, v36
  v_sub_f32 v174, v174, v36
  v_sub_f32 v239, v55, v36
  v_sub_f32 v175, v175, v36
  v_exp_f32 v224, v224
  v_exp_f32 v225, v225
  v_exp_f32 v226, v226
  v_exp_f32 v227, v227
  v_exp_f32 v228, v228
  v_exp_f32 v229, v229
  v_exp_f32 v230, v230
  v_exp_f32 v231, v231
  v_exp_f32 v232, v232
  v_exp_f32 v233, v233
  v_exp_f32 v234, v234
  v_exp_f32 v235, v235
  v_exp_f32 v236, v236
  v_exp_f32 v237, v237
  v_exp_f32 v238, v238
  v_exp_f32 v239, v239
  v_mul_f32 v252, v252, v37
  v_mul_f32 v64, v64, v37
  v_mul_f32 v65, v65, v37
  v_mul_f32 v66, v66, v37
  v_mul_f32 v67, v67, v37
  v_mul_f32 v68, v68, v37
  v_mul_f32 v69, v69, v37
  v_mul_f32 v70, v70, v37
  v_mul_f32 v71, v71, v37
  v_mul_f32 v72, v72, v37
  v_mul_f32 v73, v73, v37
  v_mul_f32 v74, v74, v37
  v_mul_f32 v75, v75, v37
  v_mul_f32 v76, v76, v37
  v_mul_f32 v77, v77, v37
  v_mul_f32 v78, v78, v37
  v_mul_f32 v79, v79, v37
  v_mul_f32 v80, v80, v37
  v_mul_f32 v81, v81, v37
  v_mul_f32 v82, v82, v37
  v_mul_f32 v83, v83, v37
  v_mul_f32 v84, v84, v37
  v_mul_f32 v85, v85, v37
  v_mul_f32 v86, v86, v37
  v_mul_f32 v87, v87, v37
  v_mul_f32 v88, v88, v37
  v_mul_f32 v89, v89, v37
  v_mul_f32 v90, v90, v37
  v_mul_f32 v91, v91, v37
  v_mul_f32 v92, v92, v37
  v_mul_f32 v93, v93, v37
  v_mul_f32 v94, v94, v37
  v_mul_f32 v95, v95, v37
  v_mul_f32 v96, v96, v37
  v_mul_f32 v97, v97, v37
  v_mul_f32 v98, v98, v37
  v_mul_f32 v99, v99, v37
  v_mul_f32 v100, v100, v37
  v_mul_f32 v101, v101, v37
  v_mul_f32 v102, v102, v37
  v_mul_f32 v103, v103, v37
  v_mul_f32 v104, v104, v37
  v_mul_f32 v105, v105, v37
  v_mul_f32 v106, v106, v37
  v_mul_f32 v107, v107, v37
  v_mul_f32 v108, v108, v37
  v_mul_f32 v109, v109, v37
  v_mul_f32 v110, v110, v37
  v_mul_f32 v111, v111, v37
  v_mul_f32 v112, v112, v37
  v_mul_f32 v113, v113, v37
  v_mul_f32 v114, v114, v37
  v_mul_f32 v115, v115, v37
  v_mul_f32 v116, v116, v37
  v_mul_f32 v117, v117, v37
  v_mul_f32 v118, v118, v37
  v_mul_f32 v119, v119, v37
  v_mul_f32 v120, v120, v37
  v_mul_f32 v121, v121, v37
  v_mul_f32 v122, v122, v37
  v_mul_f32 v123, v123, v37
  v_mul_f32 v124, v124, v37
  v_mul_f32 v125, v125, v37
  v_mul_f32 v126, v126, v37
  v_mul_f32 v127, v127, v37
  s_waitcnt lgkmcnt(0)
  s_branch L_back_9
L_AG1:
  s_lshl_b32 s43, s6, 3
  s_add_u32 s43, s43, s4
  s_lshl_b32 s43, s43, 19
  s_bitcmp1_b32 s3, 0
  s_cselect_b32 s60, s76, s74
  s_cselect_b32 s61, s77, s75
  s_add_u32 s60, s60, s43
  s_addc_u32 s61, s61, 0
  s_and_b32 s61, s61, 0xffff
  s_mov_b32 s62, 0x80000
  s_mov_b32 s63, 0x20000
  v_lshlrev_b32 v29, 3, v18
  s_add_u32 s43, s42, 32768
  s_and_b32 s43, s43, 0x1ffff
  s_add_u32 s43, s43, s37
  buffer_load_dword v12, v29, s[60:63], s43 offen
  s_add_u32 s43, s42, 49152
  s_and_b32 s43, s43, 0x1ffff
  s_add_u32 s43, s43, s37
  buffer_load_dword v12, v29, s[60:63], s43 offen
  v_lshrrev_b32 v2, 5, v1
  v_and_b32 v3, 31, v1
  s_and_b32 s44, s3, 1
  s_lshl_b32 s44, s44, 3
  v_or_b32 v28, s44, v2
  v_xor_b32 v28, v28, v3
  v_lshlrev_b32 v29, 10, v2
  s_lshl_b32 s44, s49, 2
  v_xor_b32 v20, 0, v28
  v_add_u32 v20, s44, v20
  v_and_b32 v20, 63, v20
  v_lshl_add_u32 v20, v20, 4, v29
  v_xor_b32 v21, 2, v28
  v_add_u32 v21, s44, v21
  v_and_b32 v21, 63, v21
  v_lshl_add_u32 v21, v21, 4, v29
  v_add_u32 v21, 1024, v21
  v_xor_b32 v22, 4, v28
  v_add_u32 v22, s44, v22
  v_and_b32 v22, 63, v22
  v_lshl_add_u32 v22, v22, 4, v29
  v_add_u32 v22, 2048, v22
  v_xor_b32 v23, 6, v28
  v_add_u32 v23, s44, v23
  v_and_b32 v23, 63, v23
  v_lshl_add_u32 v23, v23, 4, v29
  v_add_u32 v23, 3072, v23
  s_lshl_b32 s43, s3, 12
  s_add_u32 m0, s43, 0
  s_lshl_b32 s43, s3, 13
  buffer_load_dwordx4 v20, s[20:23], s43 offen lds
  buffer_load_dwordx4 v21, s[20:23], s43 offen offset:1024 lds
  buffer_load_dwordx4 v22, s[20:23], s43 offen offset:2048 lds
  buffer_load_dwordx4 v23, s[20:23], s43 offen offset:3072 lds
  v_lshrrev_b32 v2, 5, v1
  v_and_b32 v3, 31, v1
  v_add_u32 v29, 0, v2
  v_lshlrev_b32 v29, 2, v29
  v_xor_b32 v29, v29, v3
  v_lshlrev_b32 v29, 4, v29
  v_lshl_add_u32 v29, v2, 13, v29
  v_add_u32 v8, 0, v29
  v_add_u32 v29, 2, v2
  v_lshlrev_b32 v29, 2, v29
  v_xor_b32 v29, v29, v3
  v_lshlrev_b32 v29, 4, v29
  v_lshl_add_u32 v29, v2, 13, v29
  v_add_u32 v9, 15360, v29
  v_add_u32 v29, 0, v2
  v_lshlrev_b32 v29, 2, v29
  v_xor_b32 v29, v29, v3
  v_lshlrev_b32 v29, 4, v29
  v_lshl_add_u32 v29, v2, 13, v29
  v_add_u32 v10, 30720, v29
  v_add_u32 v29, 2, v2
  v_lshlrev_b32 v29, 2, v29
  v_xor_b32 v29, v29, v3
  v_lshlrev_b32 v29, 4, v29
  v_lshl_add_u32 v29, v2, 13, v29
  v_add_u32 v11, 46080, v29
  s_add_u32 s43, s48, 512
  s_add_u32 m0, s33, 131072
  s_and_b32 s43, s43, 0x3fffff
  buffer_load_dwordx4 v8, s[12:15], s43 offen lds
  buffer_load_dwordx4 v9, s[12:15], s43 offen offset:1024 lds
  buffer_load_dwordx4 v10, s[12:15], s43 offen offset:2048 lds
  buffer_load_dwordx4 v11, s[12:15], s43 offen offset:3072 lds
  s_add_u32 s43, s48, 262656
  s_add_u32 m0, s33, 98304
  s_and_b32 s43, s43, 0x3fffff
  buffer_load_dwordx4 v8, s[12:15], s43 offen lds
  buffer_load_dwordx4 v9, s[12:15], s43 offen offset:1024 lds
  buffer_load_dwordx4 v10, s[12:15], s43 offen offset:2048 lds
  buffer_load_dwordx4 v11, s[12:15], s43 offen offset:3072 lds
  v_lshrrev_b32 v2, 4, v1
  v_and_b32 v3, 15, v1
  v_lshlrev_b32 v19, 2, v2
  s_bitcmp1_b32 s3, 0
  s_cselect_b64 vcc, -1, 0
  v_add_u32 v29, 0, v2
  v_cndmask_b32 v29, v29, v19, vcc
  v_xor_b32 v29, v29, v3
  v_lshlrev_b32 v29, 4, v29
  v_lshl_add_u32 v4, v2, 8, v29
  v_add_u32 v29, 4, v2
  v_cndmask_b32 v29, v29, v19, vcc
  v_xor_b32 v29, v29, v3
  v_lshlrev_b32 v29, 4, v29
  v_lshl_add_u32 v5, v2, 8, v29
  v_add_u32 v29, 8, v2
  v_cndmask_b32 v29, v29, v19, vcc
  v_xor_b32 v29, v29, v3
  v_lshlrev_b32 v29, 4, v29
  v_lshl_add_u32 v6, v2, 8, v29
  v_add_u32 v29, 12, v2
  v_cndmask_b32 v29, v29, v19, vcc
  v_xor_b32 v29, v29, v3
  v_lshlrev_b32 v29, 4, v29
  v_lshl_add_u32 v7, v2, 8, v29
  v_and_b32 v2, 31, v1
  v_lshrrev_b32 v3, 5, v1
  v_and_b32 v19, 15, v1
  v_xor_b32 v19, v19, v3
  v_lshlrev_b32 v19, 4, v19
  v_lshl_add_u32 v13, v2, 8, v19
  v_lshl_add_u32 v19, v2, 9, v19
  s_lshl_b32 s43, s47, 14
  v_add_u32 v16, s43, v19
  v_bfe_u32 v32, v1, 4, 1
  v_bfe_u32 v33, v1, 2, 2
  v_and_b32 v34, 1, v1
  v_bfe_u32 v35, v1, 1, 1
  v_lshlrev_b32 v36, 1, v34
  v_or_b32 v36, v36, v35
  v_lshl_add_u32 v36, v32, 2, v36
  v_lshlrev_b32 v36, 3, v36
  v_lshl_add_u32 v36, v33, 6, v36
  v_lshlrev_b32 v37, 2, v3
  v_add_u32 v37, v37, v33
  v_lshl_add_u32 v14, v37, 8, v36
  v_lshlrev_b32 v37, 3, v3
  v_add_u32 v37, v37, v33
  v_lshl_add_u32 v38, v37, 9, v36
  s_lshl_b32 s43, s46, 8
  v_add_u32 v15, s43, v38
  v_lshlrev_b32 v36, 2, v34
  v_lshl_add_u32 v36, v32, 1, v36
  v_add_u32 v36, v36, v35
  v_lshlrev_b32 v36, 3, v36
  v_lshl_add_u32 v36, v33, 6, v36
  v_lshl_add_u32 v38, v37, 10, v36
  s_lshl_b32 s43, s46, 9
  v_add_u32 v17, s43, v38
  s_waitcnt vmcnt(4) lgkmcnt(0)
  s_barrier
  v_xor_b32 v2, 32, v16
  v_xor_b32 v3, 64, v16
  v_xor_b32 v24, 96, v16
  v_xor_b32 v25, 128, v16
  v_xor_b32 v26, 160, v16
  v_xor_b32 v27, 192, v16
  v_xor_b32 v28, 224, v16
  ds_read_b128 v[128:131], v16 offset:0
  ds_read_b128 v[132:135], v2 offset:0
  ds_read_b128 v[136:139], v3 offset:0
  ds_read_b128 v[140:143], v24 offset:0
  ds_read_b128 v[144:147], v25 offset:0
  ds_read_b128 v[148:151], v26 offset:0
  ds_read_b128 v[152:155], v27 offset:0
  ds_read_b128 v[156:159], v28 offset:0
  ds_read_b128 v[160:163], v16 offset:256
  ds_read_b128 v[164:167], v2 offset:256
  ds_read_b128 v[168:171], v3 offset:256
  ds_read_b128 v[172:175], v24 offset:256
  ds_read_b128 v[176:179], v25 offset:256
  ds_read_b128 v[180:183], v26 offset:256
  ds_read_b128 v[184:187], v27 offset:256
  s_waitcnt lgkmcnt(14)
  ds_read_b128 v[188:191], v28 offset:256
  s_add_u32 s43, s48, 524800
  s_add_u32 m0, s33, 81920
  s_and_b32 s43, s43, 0x3fffff
  buffer_load_dwordx4 v8, s[12:15], s43 offen lds
  buffer_load_dwordx4 v9, s[12:15], s43 offen offset:1024 lds
  buffer_load_dwordx4 v10, s[12:15], s43 offen offset:2048 lds
  buffer_load_dwordx4 v11, s[12:15], s43 offen offset:3072 lds
  v_xor_b32 v20, 0x200, v20
  v_xor_b32 v21, 0x200, v21
  v_xor_b32 v22, 0x200, v22
  v_xor_b32 v23, 0x200, v23
  s_lshl_b32 s43, s3, 12
  s_add_u32 m0, s43, 49152
  s_lshl_b32 s43, s3, 13
  buffer_load_dwordx4 v20, s[20:23], s43 offen lds
  buffer_load_dwordx4 v21, s[20:23], s43 offen offset:1024 lds
  buffer_load_dwordx4 v22, s[20:23], s43 offen offset:2048 lds
  buffer_load_dwordx4 v23, s[20:23], s43 offen offset:3072 lds
  v_add_u32 v20, 131072, v15
  v_xor_b32 v21, 64, v20
  v_xor_b32 v22, 128, v20
  v_xor_b32 v23, 192, v20
  s_waitcnt lgkmcnt(14)
  ds_read_b64_tr_b16 v[32:33], v20 offset:0
  s_waitcnt lgkmcnt(14)
  ds_read_b64_tr_b16 v[34:35], v20 offset:2048
  s_waitcnt lgkmcnt(14)
  ds_read_b64_tr_b16 v[36:37], v21 offset:0
  s_waitcnt lgkmcnt(14)
  ds_read_b64_tr_b16 v[38:39], v21 offset:2048
  s_waitcnt lgkmcnt(14)
  ds_read_b64_tr_b16 v[40:41], v22 offset:0
  s_waitcnt lgkmcnt(14)
  ds_read_b64_tr_b16 v[42:43], v22 offset:2048
  s_waitcnt lgkmcnt(14)
  ds_read_b64_tr_b16 v[44:45], v23 offset:0
  s_waitcnt lgkmcnt(14)
  ds_read_b64_tr_b16 v[46:47], v23 offset:2048
  s_waitcnt lgkmcnt(14)
  ds_read_b64_tr_b16 v[48:49], v20 offset:8192
  s_waitcnt lgkmcnt(14)
  ds_read_b64_tr_b16 v[50:51], v20 offset:10240
  s_waitcnt lgkmcnt(14)
  ds_read_b64_tr_b16 v[52:53], v21 offset:8192
  s_waitcnt lgkmcnt(14)
  ds_read_b64_tr_b16 v[54:55], v21 offset:10240
  s_waitcnt lgkmcnt(14)
  ds_read_b64_tr_b16 v[56:57], v22 offset:8192
  s_waitcnt lgkmcnt(14)
  ds_read_b64_tr_b16 v[58:59], v22 offset:10240
  s_waitcnt lgkmcnt(14)
  ds_read_b64_tr_b16 v[60:61], v23 offset:8192
  s_waitcnt lgkmcnt(14)
  ds_read_b64_tr_b16 v[62:63], v23 offset:10240
  s_waitcnt vmcnt(8) lgkmcnt(0)
  s_barrier
  s_lshl_b32 s40, s46, 12
  s_lshl_b32 s38, s47, 13
  s_add_u32 s38, s38, s40
  s_add_u32 s51, s38, 98304
  s_add_u32 s40, s40, s42
  s_add_u32 s40, s40, 122880
  v_add_u32 v20, 98304, v15
  v_xor_b32 v21, 64, v20
  v_xor_b32 v22, 128, v20
  v_xor_b32 v23, 192, v20
  v_mfma_f32_32x32x16_bf16 v[64:79], v[32:35], v[128:131], 0
  ds_read_b64_tr_b16 v[32:33], v20 offset:0
  ds_read_b64_tr_b16 v[34:35], v20 offset:2048
  s_add_u32 s43, s48, 786944
  s_add_u32 m0, s33, 16384
  s_and_b32 s43, s43, 0x3fffff
  buffer_load_dwordx4 v8, s[12:15], s43 offen lds
  v_mfma_f32_32x32x16_bf16 v[80:95], v[36:39], v[128:131], 0
  ds_read_b64_tr_b16 v[36:37], v21 offset:0
  ds_read_b64_tr_b16 v[38:39], v21 offset:2048
  buffer_load_dwordx4 v9, s[12:15], s43 offen offset:1024 lds
  v_mfma_f32_32x32x16_bf16 v[96:111], v[40:43], v[128:131], 0
  ds_read_b64_tr_b16 v[40:41], v22 offset:0
  ds_read_b64_tr_b16 v[42:43], v22 offset:2048
  buffer_load_dwordx4 v10, s[12:15], s43 offen offset:2048 lds
  v_mfma_f32_32x32x16_bf16 v[112:127], v[44:47], v[128:131], 0
  ds_read_b64_tr_b16 v[44:45], v23 offset:0
  ds_read_b64_tr_b16 v[46:47], v23 offset:2048
  buffer_load_dwordx4 v11, s[12:15], s43 offen offset:3072 lds
  v_mfma_f32_32x32x16_bf16 v[64:79], v[48:51], v[132:135], v[64:79]
  ds_read_b64_tr_b16 v[48:49], v20 offset:8192
  ds_read_b64_tr_b16 v[50:51], v20 offset:10240
  v_mfma_f32_32x32x16_bf16 v[80:95], v[52:55], v[132:135], v[80:95]
  ds_read_b64_tr_b16 v[52:53], v21 offset:8192
  ds_read_b64_tr_b16 v[54:55], v21 offset:10240
  v_mfma_f32_32x32x16_bf16 v[96:111], v[56:59], v[132:135], v[96:111]
  ds_read_b64_tr_b16 v[56:57], v22 offset:8192
  ds_read_b64_tr_b16 v[58:59], v22 offset:10240
  v_mfma_f32_32x32x16_bf16 v[112:127], v[60:63], v[132:135], v[112:127]
  ds_read_b64_tr_b16 v[60:61], v23 offset:8192
  s_waitcnt lgkmcnt(14)
  ds_read_b64_tr_b16 v[62:63], v23 offset:10240
  s_waitcnt vmcnt(8)
  s_barrier
  v_add_u32 v20, 81920, v15
  v_xor_b32 v21, 64, v20
  v_xor_b32 v22, 128, v20
  v_xor_b32 v23, 192, v20
  s_waitcnt lgkmcnt(14)
  v_mfma_f32_32x32x16_bf16 v[64:79], v[32:35], v[136:139], v[64:79]
  ds_read_b64_tr_b16 v[32:33], v20 offset:0
  s_waitcnt lgkmcnt(14)
  ds_read_b64_tr_b16 v[34:35], v20 offset:2048
  s_add_u32 s43, s48, 1049088
  s_add_u32 m0, s33, 131072
  s_and_b32 s43, s43, 0x3fffff
  buffer_load_dwordx4 v8, s[12:15], s43 offen lds
  s_waitcnt lgkmcnt(14)
  v_mfma_f32_32x32x16_bf16 v[80:95], v[36:39], v[136:139], v[80:95]
  ds_read_b64_tr_b16 v[36:37], v21 offset:0
  s_waitcnt lgkmcnt(14)
  ds_read_b64_tr_b16 v[38:39], v21 offset:2048
  buffer_load_dwordx4 v9, s[12:15], s43 offen offset:1024 lds
  s_waitcnt lgkmcnt(14)
  v_mfma_f32_32x32x16_bf16 v[96:111], v[40:43], v[136:139], v[96:111]
  ds_read_b64_tr_b16 v[40:41], v22 offset:0
  s_waitcnt lgkmcnt(14)
  ds_read_b64_tr_b16 v[42:43], v22 offset:2048
  buffer_load_dwordx4 v10, s[12:15], s43 offen offset:2048 lds
  s_waitcnt lgkmcnt(14)
  v_mfma_f32_32x32x16_bf16 v[112:127], v[44:47], v[136:139], v[112:127]
  ds_read_b64_tr_b16 v[44:45], v23 offset:0
  s_waitcnt lgkmcnt(14)
  ds_read_b64_tr_b16 v[46:47], v23 offset:2048
  buffer_load_dwordx4 v11, s[12:15], s43 offen offset:3072 lds
  s_waitcnt lgkmcnt(14)
  v_mfma_f32_32x32x16_bf16 v[64:79], v[48:51], v[140:143], v[64:79]
  ds_read_b64_tr_b16 v[48:49], v20 offset:8192
  s_waitcnt lgkmcnt(14)
  ds_read_b64_tr_b16 v[50:51], v20 offset:10240
  s_waitcnt lgkmcnt(14)
  v_mfma_f32_32x32x16_bf16 v[80:95], v[52:55], v[140:143], v[80:95]
  ds_read_b64_tr_b16 v[52:53], v21 offset:8192
  s_waitcnt lgkmcnt(14)
  ds_read_b64_tr_b16 v[54:55], v21 offset:10240
  s_waitcnt lgkmcnt(14)
  v_mfma_f32_32x32x16_bf16 v[96:111], v[56:59], v[140:143], v[96:111]
  ds_read_b64_tr_b16 v[56:57], v22 offset:8192
  s_waitcnt lgkmcnt(14)
  ds_read_b64_tr_b16 v[58:59], v22 offset:10240
  s_waitcnt lgkmcnt(14)
  v_mfma_f32_32x32x16_bf16 v[112:127], v[60:63], v[140:143], v[112:127]
  ds_read_b64_tr_b16 v[60:61], v23 offset:8192
  s_waitcnt lgkmcnt(14)
  ds_read_b64_tr_b16 v[62:63], v23 offset:10240
  s_waitcnt vmcnt(4)
  s_barrier
  v_add_u32 v20, 16384, v15
  v_xor_b32 v21, 64, v20
  v_xor_b32 v22, 128, v20
  v_xor_b32 v23, 192, v20
  s_waitcnt lgkmcnt(14)
  v_mfma_f32_32x32x16_bf16 v[64:79], v[32:35], v[144:147], v[64:79]
  ds_read_b64_tr_b16 v[32:33], v20 offset:0
  s_waitcnt lgkmcnt(14)
  ds_read_b64_tr_b16 v[34:35], v20 offset:2048
  s_add_u32 s43, s48, 1311232
  s_add_u32 m0, s33, 98304
  s_and_b32 s43, s43, 0x3fffff
  buffer_load_dwordx4 v8, s[12:15], s43 offen lds
  s_waitcnt lgkmcnt(14)
  v_mfma_f32_32x32x16_bf16 v[80:95], v[36:39], v[144:147], v[80:95]
  ds_read_b64_tr_b16 v[36:37], v21 offset:0
  s_waitcnt lgkmcnt(14)
  ds_read_b64_tr_b16 v[38:39], v21 offset:2048
  buffer_load_dwordx4 v9, s[12:15], s43 offen offset:1024 lds
  s_waitcnt lgkmcnt(14)
  v_mfma_f32_32x32x16_bf16 v[96:111], v[40:43], v[144:147], v[96:111]
  ds_read_b64_tr_b16 v[40:41], v22 offset:0
  s_waitcnt lgkmcnt(14)
  ds_read_b64_tr_b16 v[42:43], v22 offset:2048
  buffer_load_dwordx4 v10, s[12:15], s43 offen offset:2048 lds
  s_waitcnt lgkmcnt(14)
  v_mfma_f32_32x32x16_bf16 v[112:127], v[44:47], v[144:147], v[112:127]
  ds_read_b64_tr_b16 v[44:45], v23 offset:0
  s_waitcnt lgkmcnt(14)
  ds_read_b64_tr_b16 v[46:47], v23 offset:2048
  buffer_load_dwordx4 v11, s[12:15], s43 offen offset:3072 lds
  s_waitcnt lgkmcnt(14)
  v_mfma_f32_32x32x16_bf16 v[64:79], v[48:51], v[148:151], v[64:79]
  ds_read_b64_tr_b16 v[48:49], v20 offset:8192
  s_waitcnt lgkmcnt(14)
  ds_read_b64_tr_b16 v[50:51], v20 offset:10240
  s_waitcnt lgkmcnt(14)
  v_mfma_f32_32x32x16_bf16 v[80:95], v[52:55], v[148:151], v[80:95]
  ds_read_b64_tr_b16 v[52:53], v21 offset:8192
  s_waitcnt lgkmcnt(14)
  ds_read_b64_tr_b16 v[54:55], v21 offset:10240
  s_waitcnt lgkmcnt(14)
  v_mfma_f32_32x32x16_bf16 v[96:111], v[56:59], v[148:151], v[96:111]
  ds_read_b64_tr_b16 v[56:57], v22 offset:8192
  s_waitcnt lgkmcnt(14)
  ds_read_b64_tr_b16 v[58:59], v22 offset:10240
  s_waitcnt lgkmcnt(14)
  v_mfma_f32_32x32x16_bf16 v[112:127], v[60:63], v[148:151], v[112:127]
  ds_read_b64_tr_b16 v[60:61], v23 offset:8192
  s_waitcnt lgkmcnt(14)
  ds_read_b64_tr_b16 v[62:63], v23 offset:10240
  s_waitcnt vmcnt(4)
  s_barrier
  v_xor_b32 v2, 32, v16
  v_xor_b32 v3, 64, v16
  v_xor_b32 v24, 96, v16
  v_xor_b32 v25, 128, v16
  v_xor_b32 v26, 160, v16
  v_xor_b32 v27, 192, v16
  v_xor_b32 v28, 224, v16
  s_waitcnt lgkmcnt(14)
  ds_read_b128 v[192:195], v16 offset:49152
  s_waitcnt lgkmcnt(14)
  ds_read_b128 v[196:199], v2 offset:49152
  s_waitcnt lgkmcnt(14)
  ds_read_b128 v[200:203], v3 offset:49152
  s_waitcnt lgkmcnt(14)
  ds_read_b128 v[204:207], v24 offset:49152
  s_waitcnt lgkmcnt(14)
  ds_read_b128 v[208:211], v25 offset:49152
  s_waitcnt lgkmcnt(14)
  ds_read_b128 v[212:215], v26 offset:49152
  s_waitcnt lgkmcnt(14)
  ds_read_b128 v[216:219], v27 offset:49152
  s_waitcnt lgkmcnt(14)
  ds_read_b128 v[220:223], v28 offset:49152
  s_waitcnt lgkmcnt(14)
  ds_read_b128 v[224:227], v16 offset:49408
  s_waitcnt lgkmcnt(14)
  ds_read_b128 v[228:231], v2 offset:49408
  s_waitcnt lgkmcnt(14)
  ds_read_b128 v[232:235], v3 offset:49408
  s_waitcnt lgkmcnt(14)
  ds_read_b128 v[236:239], v24 offset:49408
  s_waitcnt lgkmcnt(14)
  ds_read_b128 v[240:243], v25 offset:49408
  s_waitcnt lgkmcnt(14)
  ds_read_b128 v[244:247], v26 offset:49408
  s_waitcnt lgkmcnt(14)
  ds_read_b128 v[248:251], v27 offset:49408
  s_waitcnt lgkmcnt(14)
  ds_read_b128 v[252:255], v28 offset:49408
  v_add_u32 v20, 131072, v15
  v_xor_b32 v21, 64, v20
  v_xor_b32 v22, 128, v20
  v_xor_b32 v23, 192, v20
  v_mfma_f32_32x32x16_bf16 v[64:79], v[32:35], v[152:155], v[64:79]
  s_waitcnt lgkmcnt(14)
  ds_read_b64_tr_b16 v[32:33], v20 offset:0
  s_waitcnt lgkmcnt(14)
  ds_read_b64_tr_b16 v[34:35], v20 offset:2048
  s_add_u32 s43, s48, 1573376
  s_add_u32 m0, s33, 81920
  s_and_b32 s43, s43, 0x3fffff
  buffer_load_dwordx4 v8, s[12:15], s43 offen lds
  v_mfma_f32_32x32x16_bf16 v[80:95], v[36:39], v[152:155], v[80:95]
  s_waitcnt lgkmcnt(14)
  ds_read_b64_tr_b16 v[36:37], v21 offset:0
  s_waitcnt lgkmcnt(14)
  ds_read_b64_tr_b16 v[38:39], v21 offset:2048
  buffer_load_dwordx4 v9, s[12:15], s43 offen offset:1024 lds
  v_mfma_f32_32x32x16_bf16 v[96:111], v[40:43], v[152:155], v[96:111]
  s_waitcnt lgkmcnt(14)
  ds_read_b64_tr_b16 v[40:41], v22 offset:0
  s_waitcnt lgkmcnt(14)
  ds_read_b64_tr_b16 v[42:43], v22 offset:2048
  buffer_load_dwordx4 v10, s[12:15], s43 offen offset:2048 lds
  v_mfma_f32_32x32x16_bf16 v[112:127], v[44:47], v[152:155], v[112:127]
  s_waitcnt lgkmcnt(14)
  ds_read_b64_tr_b16 v[44:45], v23 offset:0
  s_waitcnt lgkmcnt(14)
  ds_read_b64_tr_b16 v[46:47], v23 offset:2048
  buffer_load_dwordx4 v11, s[12:15], s43 offen offset:3072 lds
  v_mfma_f32_32x32x16_bf16 v[64:79], v[48:51], v[156:159], v[64:79]
  s_waitcnt lgkmcnt(14)
  ds_read_b64_tr_b16 v[48:49], v20 offset:8192
  s_waitcnt lgkmcnt(14)
  ds_read_b64_tr_b16 v[50:51], v20 offset:10240
  v_mfma_f32_32x32x16_bf16 v[80:95], v[52:55], v[156:159], v[80:95]
  s_waitcnt lgkmcnt(14)
  ds_read_b64_tr_b16 v[52:53], v21 offset:8192
  s_waitcnt lgkmcnt(14)
  ds_read_b64_tr_b16 v[54:55], v21 offset:10240
  v_mfma_f32_32x32x16_bf16 v[96:111], v[56:59], v[156:159], v[96:111]
  s_waitcnt lgkmcnt(14)
  ds_read_b64_tr_b16 v[56:57], v22 offset:8192
  s_waitcnt lgkmcnt(14)
  ds_read_b64_tr_b16 v[58:59], v22 offset:10240
  v_mfma_f32_32x32x16_bf16 v[112:127], v[60:63], v[156:159], v[112:127]
  s_waitcnt lgkmcnt(14)
  ds_read_b64_tr_b16 v[60:61], v23 offset:8192
  s_waitcnt lgkmcnt(14)
  ds_read_b64_tr_b16 v[62:63], v23 offset:10240
  s_waitcnt vmcnt(4)
  s_barrier
  v_add_u32 v20, 98304, v15
  v_xor_b32 v21, 64, v20
  v_xor_b32 v22, 128, v20
  v_xor_b32 v23, 192, v20
  s_waitcnt lgkmcnt(14)
  v_mfma_f32_32x32x16_bf16 v[64:79], v[32:35], v[160:163], v[64:79]
  ds_read_b64_tr_b16 v[32:33], v20 offset:0
  s_waitcnt lgkmcnt(14)
  ds_read_b64_tr_b16 v[34:35], v20 offset:2048
  s_add_u32 s43, s48, 1835520
  s_add_u32 m0, s33, 65536
  s_and_b32 s43, s43, 0x3fffff
  buffer_load_dwordx4 v8, s[12:15], s43 offen lds
  s_waitcnt lgkmcnt(14)
  v_mfma_f32_32x32x16_bf16 v[80:95], v[36:39], v[160:163], v[80:95]
  ds_read_b64_tr_b16 v[36:37], v21 offset:0
  s_waitcnt lgkmcnt(14)
  ds_read_b64_tr_b16 v[38:39], v21 offset:2048
  buffer_load_dwordx4 v9, s[12:15], s43 offen offset:1024 lds
  s_waitcnt lgkmcnt(14)
  v_mfma_f32_32x32x16_bf16 v[96:111], v[40:43], v[160:163], v[96:111]
  ds_read_b64_tr_b16 v[40:41], v22 offset:0
  s_waitcnt lgkmcnt(14)
  ds_read_b64_tr_b16 v[42:43], v22 offset:2048
  buffer_load_dwordx4 v10, s[12:15], s43 offen offset:2048 lds
  s_waitcnt lgkmcnt(14)
  v_mfma_f32_32x32x16_bf16 v[112:127], v[44:47], v[160:163], v[112:127]
  ds_read_b64_tr_b16 v[44:45], v23 offset:0
  s_waitcnt lgkmcnt(14)
  ds_read_b64_tr_b16 v[46:47], v23 offset:2048
  buffer_load_dwordx4 v11, s[12:15], s43 offen offset:3072 lds
  s_waitcnt lgkmcnt(14)
  v_mfma_f32_32x32x16_bf16 v[64:79], v[48:51], v[164:167], v[64:79]
  ds_read_b64_tr_b16 v[48:49], v20 offset:8192
  s_waitcnt lgkmcnt(14)
  ds_read_b64_tr_b16 v[50:51], v20 offset:10240
  s_add_u32 s43, s48, 2097664
  s_add_u32 m0, s33, 16384
  s_and_b32 s43, s43, 0x3fffff
  buffer_load_dwordx4 v8, s[12:15], s43 offen lds
  s_waitcnt lgkmcnt(14)
  v_mfma_f32_32x32x16_bf16 v[80:95], v[52:55], v[164:167], v[80:95]
  ds_read_b64_tr_b16 v[52:53], v21 offset:8192
  s_waitcnt lgkmcnt(14)
  ds_read_b64_tr_b16 v[54:55], v21 offset:10240
  buffer_load_dwordx4 v9, s[12:15], s43 offen offset:1024 lds
  s_waitcnt lgkmcnt(14)
  v_mfma_f32_32x32x16_bf16 v[96:111], v[56:59], v[164:167], v[96:111]
  ds_read_b64_tr_b16 v[56:57], v22 offset:8192
  s_waitcnt lgkmcnt(14)
  ds_read_b64_tr_b16 v[58:59], v22 offset:10240
  buffer_load_dwordx4 v10, s[12:15], s43 offen offset:2048 lds
  s_waitcnt lgkmcnt(14)
  v_mfma_f32_32x32x16_bf16 v[112:127], v[60:63], v[164:167], v[112:127]
  ds_read_b64_tr_b16 v[60:61], v23 offset:8192
  s_waitcnt lgkmcnt(14)
  ds_read_b64_tr_b16 v[62:63], v23 offset:10240
  buffer_load_dwordx4 v11, s[12:15], s43 offen offset:3072 lds
  s_waitcnt vmcnt(8)
  s_barrier
  v_add_u32 v20, 81920, v15
  v_xor_b32 v21, 64, v20
  v_xor_b32 v22, 128, v20
  v_xor_b32 v23, 192, v20
  s_waitcnt lgkmcnt(14)
  v_mfma_f32_32x32x16_bf16 v[64:79], v[32:35], v[168:171], v[64:79]
  ds_read_b64_tr_b16 v[32:33], v20 offset:0
  s_waitcnt lgkmcnt(14)
  ds_read_b64_tr_b16 v[34:35], v20 offset:2048
  s_add_u32 s43, s48, 2359808
  s_add_u32 m0, s33, 131072
  s_and_b32 s43, s43, 0x3fffff
  buffer_load_dwordx4 v8, s[12:15], s43 offen lds
  s_waitcnt lgkmcnt(14)
  v_mfma_f32_32x32x16_bf16 v[80:95], v[36:39], v[168:171], v[80:95]
  ds_read_b64_tr_b16 v[36:37], v21 offset:0
  s_waitcnt lgkmcnt(14)
  ds_read_b64_tr_b16 v[38:39], v21 offset:2048
  buffer_load_dwordx4 v9, s[12:15], s43 offen offset:1024 lds
  s_waitcnt lgkmcnt(14)
  v_mfma_f32_32x32x16_bf16 v[96:111], v[40:43], v[168:171], v[96:111]
  ds_read_b64_tr_b16 v[40:41], v22 offset:0
  s_waitcnt lgkmcnt(14)
  ds_read_b64_tr_b16 v[42:43], v22 offset:2048
  buffer_load_dwordx4 v10, s[12:15], s43 offen offset:2048 lds
  s_waitcnt lgkmcnt(14)
  v_mfma_f32_32x32x16_bf16 v[112:127], v[44:47], v[168:171], v[112:127]
  ds_read_b64_tr_b16 v[44:45], v23 offset:0
  s_waitcnt lgkmcnt(14)
  ds_read_b64_tr_b16 v[46:47], v23 offset:2048
  buffer_load_dwordx4 v11, s[12:15], s43 offen offset:3072 lds
  s_waitcnt lgkmcnt(14)
  v_mfma_f32_32x32x16_bf16 v[64:79], v[48:51], v[172:175], v[64:79]
  ds_read_b64_tr_b16 v[48:49], v20 offset:8192
  s_waitcnt lgkmcnt(14)
  ds_read_b64_tr_b16 v[50:51], v20 offset:10240
  s_waitcnt lgkmcnt(14)
  v_mfma_f32_32x32x16_bf16 v[80:95], v[52:55], v[172:175], v[80:95]
  ds_read_b64_tr_b16 v[52:53], v21 offset:8192
  s_waitcnt lgkmcnt(14)
  ds_read_b64_tr_b16 v[54:55], v21 offset:10240
  s_waitcnt lgkmcnt(14)
  v_mfma_f32_32x32x16_bf16 v[96:111], v[56:59], v[172:175], v[96:111]
  ds_read_b64_tr_b16 v[56:57], v22 offset:8192
  s_waitcnt lgkmcnt(14)
  ds_read_b64_tr_b16 v[58:59], v22 offset:10240
  s_waitcnt lgkmcnt(14)
  v_mfma_f32_32x32x16_bf16 v[112:127], v[60:63], v[172:175], v[112:127]
  ds_read_b64_tr_b16 v[60:61], v23 offset:8192
  s_waitcnt lgkmcnt(14)
  ds_read_b64_tr_b16 v[62:63], v23 offset:10240
  s_waitcnt vmcnt(8)
  s_barrier
  v_add_u32 v20, 65536, v15
  v_xor_b32 v21, 64, v20
  v_xor_b32 v22, 128, v20
  v_xor_b32 v23, 192, v20
  s_waitcnt lgkmcnt(14)
  v_mfma_f32_32x32x16_bf16 v[64:79], v[32:35], v[176:179], v[64:79]
  ds_read_b64_tr_b16 v[32:33], v20 offset:0
  s_waitcnt lgkmcnt(14)
  ds_read_b64_tr_b16 v[34:35], v20 offset:2048
  s_add_u32 s43, s48, 2621952
  s_add_u32 m0, s33, 98304
  s_and_b32 s43, s43, 0x3fffff
  buffer_load_dwordx4 v8, s[12:15], s43 offen lds
  s_waitcnt lgkmcnt(14)
  v_mfma_f32_32x32x16_bf16 v[80:95], v[36:39], v[176:179], v[80:95]
  ds_read_b64_tr_b16 v[36:37], v21 offset:0
  s_waitcnt lgkmcnt(14)
  ds_read_b64_tr_b16 v[38:39], v21 offset:2048
  buffer_load_dwordx4 v9, s[12:15], s43 offen offset:1024 lds
  s_waitcnt lgkmcnt(14)
  v_mfma_f32_32x32x16_bf16 v[96:111], v[40:43], v[176:179], v[96:111]
  ds_read_b64_tr_b16 v[40:41], v22 offset:0
  s_waitcnt lgkmcnt(14)
  ds_read_b64_tr_b16 v[42:43], v22 offset:2048
  buffer_load_dwordx4 v10, s[12:15], s43 offen offset:2048 lds
  s_waitcnt lgkmcnt(14)
  v_mfma_f32_32x32x16_bf16 v[112:127], v[44:47], v[176:179], v[112:127]
  ds_read_b64_tr_b16 v[44:45], v23 offset:0
  s_waitcnt lgkmcnt(14)
  ds_read_b64_tr_b16 v[46:47], v23 offset:2048
  buffer_load_dwordx4 v11, s[12:15], s43 offen offset:3072 lds
  s_waitcnt lgkmcnt(14)
  v_mfma_f32_32x32x16_bf16 v[64:79], v[48:51], v[180:183], v[64:79]
  ds_read_b64_tr_b16 v[48:49], v20 offset:8192
  s_waitcnt lgkmcnt(14)
  ds_read_b64_tr_b16 v[50:51], v20 offset:10240
  s_waitcnt lgkmcnt(14)
  v_mfma_f32_32x32x16_bf16 v[80:95], v[52:55], v[180:183], v[80:95]
  ds_read_b64_tr_b16 v[52:53], v21 offset:8192
  s_waitcnt lgkmcnt(14)
  ds_read_b64_tr_b16 v[54:55], v21 offset:10240
  s_waitcnt lgkmcnt(14)
  v_mfma_f32_32x32x16_bf16 v[96:111], v[56:59], v[180:183], v[96:111]
  ds_read_b64_tr_b16 v[56:57], v22 offset:8192
  s_waitcnt lgkmcnt(14)
  ds_read_b64_tr_b16 v[58:59], v22 offset:10240
  s_waitcnt lgkmcnt(14)
  v_mfma_f32_32x32x16_bf16 v[112:127], v[60:63], v[180:183], v[112:127]
  ds_read_b64_tr_b16 v[60:61], v23 offset:8192
  s_waitcnt lgkmcnt(14)
  ds_read_b64_tr_b16 v[62:63], v23 offset:10240
  s_waitcnt vmcnt(8)
  s_barrier
  v_add_u32 v20, 16384, v15
  v_xor_b32 v21, 64, v20
  v_xor_b32 v22, 128, v20
  v_xor_b32 v23, 192, v20
  s_waitcnt lgkmcnt(14)
  v_mfma_f32_32x32x16_bf16 v[64:79], v[32:35], v[184:187], v[64:79]
  ds_read_b64_tr_b16 v[32:33], v20 offset:0
  s_waitcnt lgkmcnt(14)
  ds_read_b64_tr_b16 v[34:35], v20 offset:2048
  s_add_u32 s43, s48, 2884096
  s_add_u32 m0, s33, 81920
  s_and_b32 s43, s43, 0x3fffff
  buffer_load_dwordx4 v8, s[12:15], s43 offen lds
  s_waitcnt lgkmcnt(14)
  v_mfma_f32_32x32x16_bf16 v[80:95], v[36:39], v[184:187], v[80:95]
  ds_read_b64_tr_b16 v[36:37], v21 offset:0
  s_waitcnt lgkmcnt(14)
  ds_read_b64_tr_b16 v[38:39], v21 offset:2048
  buffer_load_dwordx4 v9, s[12:15], s43 offen offset:1024 lds
  s_waitcnt lgkmcnt(14)
  v_mfma_f32_32x32x16_bf16 v[96:111], v[40:43], v[184:187], v[96:111]
  ds_read_b64_tr_b16 v[40:41], v22 offset:0
  s_waitcnt lgkmcnt(14)
  ds_read_b64_tr_b16 v[42:43], v22 offset:2048
  buffer_load_dwordx4 v10, s[12:15], s43 offen offset:2048 lds
  s_waitcnt lgkmcnt(14)
  v_mfma_f32_32x32x16_bf16 v[112:127], v[44:47], v[184:187], v[112:127]
  ds_read_b64_tr_b16 v[44:45], v23 offset:0
  s_waitcnt lgkmcnt(14)
  ds_read_b64_tr_b16 v[46:47], v23 offset:2048
  buffer_load_dwordx4 v11, s[12:15], s43 offen offset:3072 lds
  s_waitcnt lgkmcnt(14)
  v_mfma_f32_32x32x16_bf16 v[64:79], v[48:51], v[188:191], v[64:79]
  ds_read_b64_tr_b16 v[48:49], v20 offset:8192
  s_waitcnt lgkmcnt(14)
  ds_read_b64_tr_b16 v[50:51], v20 offset:10240
  s_waitcnt lgkmcnt(14)
  v_mfma_f32_32x32x16_bf16 v[80:95], v[52:55], v[188:191], v[80:95]
  ds_read_b64_tr_b16 v[52:53], v21 offset:8192
  s_waitcnt lgkmcnt(14)
  ds_read_b64_tr_b16 v[54:55], v21 offset:10240
  s_waitcnt lgkmcnt(14)
  v_mfma_f32_32x32x16_bf16 v[96:111], v[56:59], v[188:191], v[96:111]
  ds_read_b64_tr_b16 v[56:57], v22 offset:8192
  s_waitcnt lgkmcnt(14)
  ds_read_b64_tr_b16 v[58:59], v22 offset:10240
  s_waitcnt lgkmcnt(14)
  v_mfma_f32_32x32x16_bf16 v[112:127], v[60:63], v[188:191], v[112:127]
  ds_read_b64_tr_b16 v[60:61], v23 offset:8192
  s_waitcnt lgkmcnt(14)
  ds_read_b64_tr_b16 v[62:63], v23 offset:10240
  s_waitcnt vmcnt(8)
  s_barrier
  v_add_u32 v20, 131072, v15
  v_xor_b32 v21, 64, v20
  v_xor_b32 v22, 128, v20
  v_xor_b32 v23, 192, v20
  s_waitcnt lgkmcnt(14)
  v_mfma_f32_32x32x16_bf16 v[64:79], v[32:35], v[192:195], v[64:79]
  ds_read_b64_tr_b16 v[32:33], v20 offset:0
  s_waitcnt lgkmcnt(14)
  ds_read_b64_tr_b16 v[34:35], v20 offset:2048
  s_add_u32 s43, s48, 3146240
  s_add_u32 m0, s33, 65536
  s_and_b32 s43, s43, 0x3fffff
  buffer_load_dwordx4 v8, s[12:15], s43 offen lds
  s_waitcnt lgkmcnt(14)
  v_mfma_f32_32x32x16_bf16 v[80:95], v[36:39], v[192:195], v[80:95]
  ds_read_b64_tr_b16 v[36:37], v21 offset:0
  s_waitcnt lgkmcnt(14)
  ds_read_b64_tr_b16 v[38:39], v21 offset:2048
  buffer_load_dwordx4 v9, s[12:15], s43 offen offset:1024 lds
  s_waitcnt lgkmcnt(14)
  v_mfma_f32_32x32x16_bf16 v[96:111], v[40:43], v[192:195], v[96:111]
  ds_read_b64_tr_b16 v[40:41], v22 offset:0
  s_waitcnt lgkmcnt(14)
  ds_read_b64_tr_b16 v[42:43], v22 offset:2048
  buffer_load_dwordx4 v10, s[12:15], s43 offen offset:2048 lds
  s_waitcnt lgkmcnt(14)
  v_mfma_f32_32x32x16_bf16 v[112:127], v[44:47], v[192:195], v[112:127]
  ds_read_b64_tr_b16 v[44:45], v23 offset:0
  s_waitcnt lgkmcnt(14)
  ds_read_b64_tr_b16 v[46:47], v23 offset:2048
  buffer_load_dwordx4 v11, s[12:15], s43 offen offset:3072 lds
  s_waitcnt lgkmcnt(14)
  v_mfma_f32_32x32x16_bf16 v[64:79], v[48:51], v[196:199], v[64:79]
  ds_read_b64_tr_b16 v[48:49], v20 offset:8192
  s_waitcnt lgkmcnt(14)
  ds_read_b64_tr_b16 v[50:51], v20 offset:10240
  s_waitcnt lgkmcnt(14)
  v_mfma_f32_32x32x16_bf16 v[80:95], v[52:55], v[196:199], v[80:95]
  ds_read_b64_tr_b16 v[52:53], v21 offset:8192
  s_waitcnt lgkmcnt(14)
  ds_read_b64_tr_b16 v[54:55], v21 offset:10240
  s_waitcnt lgkmcnt(14)
  v_mfma_f32_32x32x16_bf16 v[96:111], v[56:59], v[196:199], v[96:111]
  ds_read_b64_tr_b16 v[56:57], v22 offset:8192
  s_waitcnt lgkmcnt(14)
  ds_read_b64_tr_b16 v[58:59], v22 offset:10240
  s_waitcnt lgkmcnt(14)
  v_mfma_f32_32x32x16_bf16 v[112:127], v[60:63], v[196:199], v[112:127]
  ds_read_b64_tr_b16 v[60:61], v23 offset:8192
  s_waitcnt lgkmcnt(14)
  ds_read_b64_tr_b16 v[62:63], v23 offset:10240
  s_waitcnt vmcnt(8)
  s_barrier
  v_add_u32 v20, 98304, v15
  v_xor_b32 v21, 64, v20
  v_xor_b32 v22, 128, v20
  v_xor_b32 v23, 192, v20
  s_waitcnt lgkmcnt(14)
  v_mfma_f32_32x32x16_bf16 v[64:79], v[32:35], v[200:203], v[64:79]
  ds_read_b64_tr_b16 v[32:33], v20 offset:0
  s_waitcnt lgkmcnt(14)
  ds_read_b64_tr_b16 v[34:35], v20 offset:2048
  s_add_u32 s43, s48, 3408384
  s_add_u32 m0, s33, 16384
  s_and_b32 s43, s43, 0x3fffff
  buffer_load_dwordx4 v8, s[12:15], s43 offen lds
  s_waitcnt lgkmcnt(14)
  v_mfma_f32_32x32x16_bf16 v[80:95], v[36:39], v[200:203], v[80:95]
  ds_read_b64_tr_b16 v[36:37], v21 offset:0
  s_waitcnt lgkmcnt(14)
  ds_read_b64_tr_b16 v[38:39], v21 offset:2048
  buffer_load_dwordx4 v9, s[12:15], s43 offen offset:1024 lds
  s_waitcnt lgkmcnt(14)
  v_mfma_f32_32x32x16_bf16 v[96:111], v[40:43], v[200:203], v[96:111]
  ds_read_b64_tr_b16 v[40:41], v22 offset:0
  s_waitcnt lgkmcnt(14)
  ds_read_b64_tr_b16 v[42:43], v22 offset:2048
  buffer_load_dwordx4 v10, s[12:15], s43 offen offset:2048 lds
  s_waitcnt lgkmcnt(14)
  v_mfma_f32_32x32x16_bf16 v[112:127], v[44:47], v[200:203], v[112:127]
  ds_read_b64_tr_b16 v[44:45], v23 offset:0
  s_waitcnt lgkmcnt(14)
  ds_read_b64_tr_b16 v[46:47], v23 offset:2048
  buffer_load_dwordx4 v11, s[12:15], s43 offen offset:3072 lds
  s_waitcnt lgkmcnt(14)
  v_mfma_f32_32x32x16_bf16 v[64:79], v[48:51], v[204:207], v[64:79]
  ds_read_b64_tr_b16 v[48:49], v20 offset:8192
  s_waitcnt lgkmcnt(14)
  ds_read_b64_tr_b16 v[50:51], v20 offset:10240
  s_waitcnt lgkmcnt(14)
  v_mfma_f32_32x32x16_bf16 v[80:95], v[52:55], v[204:207], v[80:95]
  ds_read_b64_tr_b16 v[52:53], v21 offset:8192
  s_waitcnt lgkmcnt(14)
  ds_read_b64_tr_b16 v[54:55], v21 offset:10240
  s_waitcnt lgkmcnt(14)
  v_mfma_f32_32x32x16_bf16 v[96:111], v[56:59], v[204:207], v[96:111]
  ds_read_b64_tr_b16 v[56:57], v22 offset:8192
  s_waitcnt lgkmcnt(14)
  ds_read_b64_tr_b16 v[58:59], v22 offset:10240
  s_waitcnt lgkmcnt(14)
  v_mfma_f32_32x32x16_bf16 v[112:127], v[60:63], v[204:207], v[112:127]
  ds_read_b64_tr_b16 v[60:61], v23 offset:8192
  s_waitcnt lgkmcnt(14)
  ds_read_b64_tr_b16 v[62:63], v23 offset:10240
  s_waitcnt vmcnt(8)
  s_barrier
  v_add_u32 v20, 81920, v15
  v_xor_b32 v21, 64, v20
  v_xor_b32 v22, 128, v20
  v_xor_b32 v23, 192, v20
  s_waitcnt lgkmcnt(14)
  v_mfma_f32_32x32x16_bf16 v[64:79], v[32:35], v[208:211], v[64:79]
  ds_read_b64_tr_b16 v[32:33], v20 offset:0
  s_waitcnt lgkmcnt(14)
  ds_read_b64_tr_b16 v[34:35], v20 offset:2048
  s_add_u32 s43, s48, 3670528
  s_add_u32 m0, s33, 131072
  s_and_b32 s43, s43, 0x3fffff
  buffer_load_dwordx4 v8, s[12:15], s43 offen lds
  s_waitcnt lgkmcnt(14)
  v_mfma_f32_32x32x16_bf16 v[80:95], v[36:39], v[208:211], v[80:95]
  ds_read_b64_tr_b16 v[36:37], v21 offset:0
  s_waitcnt lgkmcnt(14)
  ds_read_b64_tr_b16 v[38:39], v21 offset:2048
  buffer_load_dwordx4 v9, s[12:15], s43 offen offset:1024 lds
  s_waitcnt lgkmcnt(14)
  v_mfma_f32_32x32x16_bf16 v[96:111], v[40:43], v[208:211], v[96:111]
  ds_read_b64_tr_b16 v[40:41], v22 offset:0
  s_waitcnt lgkmcnt(14)
  ds_read_b64_tr_b16 v[42:43], v22 offset:2048
  buffer_load_dwordx4 v10, s[12:15], s43 offen offset:2048 lds
  s_waitcnt lgkmcnt(14)
  v_mfma_f32_32x32x16_bf16 v[112:127], v[44:47], v[208:211], v[112:127]
  ds_read_b64_tr_b16 v[44:45], v23 offset:0
  s_waitcnt lgkmcnt(14)
  ds_read_b64_tr_b16 v[46:47], v23 offset:2048
  buffer_load_dwordx4 v11, s[12:15], s43 offen offset:3072 lds
  s_waitcnt lgkmcnt(14)
  v_mfma_f32_32x32x16_bf16 v[64:79], v[48:51], v[212:215], v[64:79]
  ds_read_b64_tr_b16 v[48:49], v20 offset:8192
  s_waitcnt lgkmcnt(14)
  ds_read_b64_tr_b16 v[50:51], v20 offset:10240
  s_waitcnt lgkmcnt(14)
  v_mfma_f32_32x32x16_bf16 v[80:95], v[52:55], v[212:215], v[80:95]
  ds_read_b64_tr_b16 v[52:53], v21 offset:8192
  s_waitcnt lgkmcnt(14)
  ds_read_b64_tr_b16 v[54:55], v21 offset:10240
  s_waitcnt lgkmcnt(14)
  v_mfma_f32_32x32x16_bf16 v[96:111], v[56:59], v[212:215], v[96:111]
  ds_read_b64_tr_b16 v[56:57], v22 offset:8192
  s_waitcnt lgkmcnt(14)
  ds_read_b64_tr_b16 v[58:59], v22 offset:10240
  s_waitcnt lgkmcnt(14)
  v_mfma_f32_32x32x16_bf16 v[112:127], v[60:63], v[212:215], v[112:127]
  ds_read_b64_tr_b16 v[60:61], v23 offset:8192
  s_waitcnt lgkmcnt(14)
  ds_read_b64_tr_b16 v[62:63], v23 offset:10240
  s_waitcnt vmcnt(8)
  s_barrier
  v_add_u32 v20, 65536, v15
  v_xor_b32 v21, 64, v20
  v_xor_b32 v22, 128, v20
  v_xor_b32 v23, 192, v20
  s_waitcnt lgkmcnt(14)
  v_mfma_f32_32x32x16_bf16 v[64:79], v[32:35], v[216:219], v[64:79]
  ds_read_b64_tr_b16 v[32:33], v20 offset:0
  s_waitcnt lgkmcnt(14)
  ds_read_b64_tr_b16 v[34:35], v20 offset:2048
  s_add_u32 s43, s48, 3932672
  s_add_u32 m0, s33, 98304
  s_and_b32 s43, s43, 0x3fffff
  buffer_load_dwordx4 v8, s[12:15], s43 offen lds
  s_waitcnt lgkmcnt(14)
  v_mfma_f32_32x32x16_bf16 v[80:95], v[36:39], v[216:219], v[80:95]
  ds_read_b64_tr_b16 v[36:37], v21 offset:0
  s_waitcnt lgkmcnt(14)
  ds_read_b64_tr_b16 v[38:39], v21 offset:2048
  buffer_load_dwordx4 v9, s[12:15], s43 offen offset:1024 lds
  s_waitcnt lgkmcnt(14)
  v_mfma_f32_32x32x16_bf16 v[96:111], v[40:43], v[216:219], v[96:111]
  ds_read_b64_tr_b16 v[40:41], v22 offset:0
  s_waitcnt lgkmcnt(14)
  ds_read_b64_tr_b16 v[42:43], v22 offset:2048
  buffer_load_dwordx4 v10, s[12:15], s43 offen offset:2048 lds
  s_waitcnt lgkmcnt(14)
  v_mfma_f32_32x32x16_bf16 v[112:127], v[44:47], v[216:219], v[112:127]
  ds_read_b64_tr_b16 v[44:45], v23 offset:0
  s_waitcnt lgkmcnt(14)
  ds_read_b64_tr_b16 v[46:47], v23 offset:2048
  buffer_load_dwordx4 v11, s[12:15], s43 offen offset:3072 lds
  s_waitcnt lgkmcnt(14)
  v_mfma_f32_32x32x16_bf16 v[64:79], v[48:51], v[220:223], v[64:79]
  ds_read_b64_tr_b16 v[48:49], v20 offset:8192
  s_waitcnt lgkmcnt(14)
  ds_read_b64_tr_b16 v[50:51], v20 offset:10240
  s_waitcnt lgkmcnt(14)
  v_mfma_f32_32x32x16_bf16 v[80:95], v[52:55], v[220:223], v[80:95]
  ds_read_b64_tr_b16 v[52:53], v21 offset:8192
  s_waitcnt lgkmcnt(14)
  ds_read_b64_tr_b16 v[54:55], v21 offset:10240
  s_waitcnt lgkmcnt(14)
  v_mfma_f32_32x32x16_bf16 v[96:111], v[56:59], v[220:223], v[96:111]
  ds_read_b64_tr_b16 v[56:57], v22 offset:8192
  s_waitcnt lgkmcnt(14)
  ds_read_b64_tr_b16 v[58:59], v22 offset:10240
  s_waitcnt lgkmcnt(14)
  v_mfma_f32_32x32x16_bf16 v[112:127], v[60:63], v[220:223], v[112:127]
  ds_read_b64_tr_b16 v[60:61], v23 offset:8192
  s_waitcnt lgkmcnt(14)
  ds_read_b64_tr_b16 v[62:63], v23 offset:10240
  s_waitcnt vmcnt(8)
  s_barrier
  v_add_u32 v20, 16384, v15
  v_xor_b32 v21, 64, v20
  v_xor_b32 v22, 128, v20
  v_xor_b32 v23, 192, v20
  s_waitcnt lgkmcnt(14)
  v_mfma_f32_32x32x16_bf16 v[64:79], v[32:35], v[224:227], v[64:79]
  ds_read_b64_tr_b16 v[32:33], v20 offset:0
  s_waitcnt lgkmcnt(14)
  ds_read_b64_tr_b16 v[34:35], v20 offset:2048
  s_waitcnt lgkmcnt(14)
  v_mfma_f32_32x32x16_bf16 v[80:95], v[36:39], v[224:227], v[80:95]
  ds_read_b64_tr_b16 v[36:37], v21 offset:0
  s_waitcnt lgkmcnt(14)
  ds_read_b64_tr_b16 v[38:39], v21 offset:2048
  s_waitcnt lgkmcnt(14)
  v_mfma_f32_32x32x16_bf16 v[96:111], v[40:43], v[224:227], v[96:111]
  ds_read_b64_tr_b16 v[40:41], v22 offset:0
  s_waitcnt lgkmcnt(14)
  ds_read_b64_tr_b16 v[42:43], v22 offset:2048
  s_waitcnt lgkmcnt(14)
  v_mfma_f32_32x32x16_bf16 v[112:127], v[44:47], v[224:227], v[112:127]
  ds_read_b64_tr_b16 v[44:45], v23 offset:0
  s_waitcnt lgkmcnt(14)
  ds_read_b64_tr_b16 v[46:47], v23 offset:2048
  s_waitcnt lgkmcnt(14)
  v_mfma_f32_32x32x16_bf16 v[64:79], v[48:51], v[228:231], v[64:79]
  ds_read_b64_tr_b16 v[48:49], v20 offset:8192
  s_waitcnt lgkmcnt(14)
  ds_read_b64_tr_b16 v[50:51], v20 offset:10240
  s_waitcnt lgkmcnt(14)
  v_mfma_f32_32x32x16_bf16 v[80:95], v[52:55], v[228:231], v[80:95]
  ds_read_b64_tr_b16 v[52:53], v21 offset:8192
  s_waitcnt lgkmcnt(14)
  ds_read_b64_tr_b16 v[54:55], v21 offset:10240
  s_waitcnt lgkmcnt(14)
  v_mfma_f32_32x32x16_bf16 v[96:111], v[56:59], v[228:231], v[96:111]
  ds_read_b64_tr_b16 v[56:57], v22 offset:8192
  s_waitcnt lgkmcnt(14)
  ds_read_b64_tr_b16 v[58:59], v22 offset:10240
  s_waitcnt lgkmcnt(14)
  v_mfma_f32_32x32x16_bf16 v[112:127], v[60:63], v[228:231], v[112:127]
  ds_read_b64_tr_b16 v[60:61], v23 offset:8192
  s_waitcnt lgkmcnt(14)
  ds_read_b64_tr_b16 v[62:63], v23 offset:10240
  s_waitcnt vmcnt(4)
  s_barrier
  v_add_u32 v20, 131072, v15
  v_xor_b32 v21, 64, v20
  v_xor_b32 v22, 128, v20
  v_xor_b32 v23, 192, v20
  s_waitcnt lgkmcnt(14)
  v_mfma_f32_32x32x16_bf16 v[64:79], v[32:35], v[232:235], v[64:79]
  ds_read_b64_tr_b16 v[32:33], v20 offset:0
  s_waitcnt lgkmcnt(14)
  ds_read_b64_tr_b16 v[34:35], v20 offset:2048
  s_waitcnt lgkmcnt(14)
  v_mfma_f32_32x32x16_bf16 v[80:95], v[36:39], v[232:235], v[80:95]
  ds_read_b64_tr_b16 v[36:37], v21 offset:0
  s_waitcnt lgkmcnt(14)
  ds_read_b64_tr_b16 v[38:39], v21 offset:2048
  s_waitcnt lgkmcnt(14)
  v_mfma_f32_32x32x16_bf16 v[96:111], v[40:43], v[232:235], v[96:111]
  ds_read_b64_tr_b16 v[40:41], v22 offset:0
  s_waitcnt lgkmcnt(14)
  ds_read_b64_tr_b16 v[42:43], v22 offset:2048
  s_waitcnt lgkmcnt(14)
  v_mfma_f32_32x32x16_bf16 v[112:127], v[44:47], v[232:235], v[112:127]
  ds_read_b64_tr_b16 v[44:45], v23 offset:0
  s_waitcnt lgkmcnt(14)
  ds_read_b64_tr_b16 v[46:47], v23 offset:2048
  s_waitcnt lgkmcnt(14)
  v_mfma_f32_32x32x16_bf16 v[64:79], v[48:51], v[236:239], v[64:79]
  ds_read_b64_tr_b16 v[48:49], v20 offset:8192
  s_waitcnt lgkmcnt(14)
  ds_read_b64_tr_b16 v[50:51], v20 offset:10240
  s_waitcnt lgkmcnt(14)
  v_mfma_f32_32x32x16_bf16 v[80:95], v[52:55], v[236:239], v[80:95]
  ds_read_b64_tr_b16 v[52:53], v21 offset:8192
  s_waitcnt lgkmcnt(14)
  ds_read_b64_tr_b16 v[54:55], v21 offset:10240
  s_waitcnt lgkmcnt(14)
  v_mfma_f32_32x32x16_bf16 v[96:111], v[56:59], v[236:239], v[96:111]
  ds_read_b64_tr_b16 v[56:57], v22 offset:8192
  s_waitcnt lgkmcnt(14)
  ds_read_b64_tr_b16 v[58:59], v22 offset:10240
  s_waitcnt lgkmcnt(14)
  v_mfma_f32_32x32x16_bf16 v[112:127], v[60:63], v[236:239], v[112:127]
  ds_read_b64_tr_b16 v[60:61], v23 offset:8192
  s_waitcnt lgkmcnt(14)
  ds_read_b64_tr_b16 v[62:63], v23 offset:10240
  s_waitcnt vmcnt(0)
  s_barrier
  v_add_u32 v20, 98304, v15
  v_xor_b32 v21, 64, v20
  v_xor_b32 v22, 128, v20
  v_xor_b32 v23, 192, v20
  s_waitcnt lgkmcnt(14)
  v_mfma_f32_32x32x16_bf16 v[64:79], v[32:35], v[240:243], v[64:79]
  ds_read_b64_tr_b16 v[32:33], v20 offset:0
  s_waitcnt lgkmcnt(14)
  ds_read_b64_tr_b16 v[34:35], v20 offset:2048
  s_waitcnt lgkmcnt(14)
  v_mfma_f32_32x32x16_bf16 v[80:95], v[36:39], v[240:243], v[80:95]
  ds_read_b64_tr_b16 v[36:37], v21 offset:0
  s_waitcnt lgkmcnt(14)
  ds_read_b64_tr_b16 v[38:39], v21 offset:2048
  s_waitcnt lgkmcnt(14)
  v_mfma_f32_32x32x16_bf16 v[96:111], v[40:43], v[240:243], v[96:111]
  ds_read_b64_tr_b16 v[40:41], v22 offset:0
  s_waitcnt lgkmcnt(14)
  ds_read_b64_tr_b16 v[42:43], v22 offset:2048
  s_waitcnt lgkmcnt(14)
  v_mfma_f32_32x32x16_bf16 v[112:127], v[44:47], v[240:243], v[112:127]
  ds_read_b64_tr_b16 v[44:45], v23 offset:0
  s_waitcnt lgkmcnt(14)
  ds_read_b64_tr_b16 v[46:47], v23 offset:2048
  s_waitcnt lgkmcnt(14)
  v_mfma_f32_32x32x16_bf16 v[64:79], v[48:51], v[244:247], v[64:79]
  ds_read_b64_tr_b16 v[48:49], v20 offset:8192
  s_waitcnt lgkmcnt(14)
  ds_read_b64_tr_b16 v[50:51], v20 offset:10240
  s_waitcnt lgkmcnt(14)
  v_mfma_f32_32x32x16_bf16 v[80:95], v[52:55], v[244:247], v[80:95]
  ds_read_b64_tr_b16 v[52:53], v21 offset:8192
  s_waitcnt lgkmcnt(14)
  ds_read_b64_tr_b16 v[54:55], v21 offset:10240
  s_waitcnt lgkmcnt(14)
  v_mfma_f32_32x32x16_bf16 v[96:111], v[56:59], v[244:247], v[96:111]
  ds_read_b64_tr_b16 v[56:57], v22 offset:8192
  s_waitcnt lgkmcnt(14)
  ds_read_b64_tr_b16 v[58:59], v22 offset:10240
  s_waitcnt lgkmcnt(14)
  v_mfma_f32_32x32x16_bf16 v[112:127], v[60:63], v[244:247], v[112:127]
  ds_read_b64_tr_b16 v[60:61], v23 offset:8192
  s_waitcnt lgkmcnt(14)
  ds_read_b64_tr_b16 v[62:63], v23 offset:10240
  s_barrier
  s_waitcnt lgkmcnt(14)
  v_mfma_f32_32x32x16_bf16 v[64:79], v[32:35], v[248:251], v[64:79]
  s_waitcnt lgkmcnt(12)
  v_mfma_f32_32x32x16_bf16 v[80:95], v[36:39], v[248:251], v[80:95]
  s_waitcnt lgkmcnt(10)
  v_mfma_f32_32x32x16_bf16 v[96:111], v[40:43], v[248:251], v[96:111]
  s_waitcnt lgkmcnt(8)
  v_mfma_f32_32x32x16_bf16 v[112:127], v[44:47], v[248:251], v[112:127]
  s_waitcnt lgkmcnt(6)
  v_mfma_f32_32x32x16_bf16 v[64:79], v[48:51], v[252:255], v[64:79]
  s_waitcnt lgkmcnt(4)
  v_mfma_f32_32x32x16_bf16 v[80:95], v[52:55], v[252:255], v[80:95]
  s_waitcnt lgkmcnt(2)
  v_mfma_f32_32x32x16_bf16 v[96:111], v[56:59], v[252:255], v[96:111]
  s_waitcnt lgkmcnt(0)
  v_mfma_f32_32x32x16_bf16 v[112:127], v[60:63], v[252:255], v[112:127]
  s_barrier
  s_lshl_b32 s43, s4, 19
  s_add_u32 s16, s80, s43
  s_addc_u32 s17, s81, 0
  s_and_b32 s17, s17, 0xffff
  s_mov_b32 s18, 0x80000
  s_mov_b32 s19, 0x20000
  s_lshl_b32 s65, s49, 15
  s_add_u32 s65, s65, s34
  v_lshlrev_b32 v19, 3, v18
  s_lshl_b32 s43, s6, 3
  s_add_u32 s43, s43, s4
  s_lshl_b32 s43, s43, 19
  s_bitcmp1_b32 s3, 0
  s_cselect_b32 s60, s76, s74
  s_cselect_b32 s61, s77, s75
  s_add_u32 s60, s60, s43
  s_addc_u32 s61, s61, 0
  s_and_b32 s61, s61, 0xffff
  s_mov_b32 s62, 0x80000
  s_mov_b32 s63, 0x20000
  s_lshl_b32 s64, s46, 17
  s_nop 7
  v_mov_b32 v36, s41
  s_nop 6
  v_pk_mul_f32 v[64:65], v[64:65], v[36:37] op_sel_hi:[1,0]
  v_pk_mul_f32 v[66:67], v[66:67], v[36:37] op_sel_hi:[1,0]
  v_cvt_pk_bf16_f32 v192, v64, v65
  v_pk_mul_f32 v[68:69], v[68:69], v[36:37] op_sel_hi:[1,0]
  v_cvt_pk_bf16_f32 v193, v66, v67
  v_pk_mul_f32 v[70:71], v[70:71], v[36:37] op_sel_hi:[1,0]
  v_cvt_pk_bf16_f32 v194, v68, v69
  v_pk_mul_f32 v[72:73], v[72:73], v[36:37] op_sel_hi:[1,0]
  v_cvt_pk_bf16_f32 v195, v70, v71
  v_pk_mul_f32 v[74:75], v[74:75], v[36:37] op_sel_hi:[1,0]
  v_cvt_pk_bf16_f32 v196, v72, v73
  v_pk_mul_f32 v[76:77], v[76:77], v[36:37] op_sel_hi:[1,0]
  v_cvt_pk_bf16_f32 v197, v74, v75
  v_pk_mul_f32 v[78:79], v[78:79], v[36:37] op_sel_hi:[1,0]
  v_cvt_pk_bf16_f32 v198, v76, v77
  v_pk_mul_f32 v[80:81], v[80:81], v[36:37] op_sel_hi:[1,0]
  v_cvt_pk_bf16_f32 v199, v78, v79
  v_pk_mul_f32 v[82:83], v[82:83], v[36:37] op_sel_hi:[1,0]
  v_cvt_pk_bf16_f32 v200, v80, v81
  v_pk_mul_f32 v[84:85], v[84:85], v[36:37] op_sel_hi:[1,0]
  v_cvt_pk_bf16_f32 v201, v82, v83
  v_pk_mul_f32 v[86:87], v[86:87], v[36:37] op_sel_hi:[1,0]
  v_cvt_pk_bf16_f32 v202, v84, v85
  v_pk_mul_f32 v[88:89], v[88:89], v[36:37] op_sel_hi:[1,0]
  v_cvt_pk_bf16_f32 v203, v86, v87
  v_pk_mul_f32 v[90:91], v[90:91], v[36:37] op_sel_hi:[1,0]
  v_cvt_pk_bf16_f32 v204, v88, v89
  v_pk_mul_f32 v[92:93], v[92:93], v[36:37] op_sel_hi:[1,0]
  v_cvt_pk_bf16_f32 v205, v90, v91
  v_pk_mul_f32 v[94:95], v[94:95], v[36:37] op_sel_hi:[1,0]
  v_cvt_pk_bf16_f32 v206, v92, v93
  v_pk_mul_f32 v[96:97], v[96:97], v[36:37] op_sel_hi:[1,0]
  v_cvt_pk_bf16_f32 v207, v94, v95
  v_pk_mul_f32 v[98:99], v[98:99], v[36:37] op_sel_hi:[1,0]
  v_cvt_pk_bf16_f32 v208, v96, v97
  v_pk_mul_f32 v[100:101], v[100:101], v[36:37] op_sel_hi:[1,0]
  v_cvt_pk_bf16_f32 v209, v98, v99
  v_pk_mul_f32 v[102:103], v[102:103], v[36:37] op_sel_hi:[1,0]
  v_cvt_pk_bf16_f32 v210, v100, v101
  v_pk_mul_f32 v[104:105], v[104:105], v[36:37] op_sel_hi:[1,0]
  v_cvt_pk_bf16_f32 v211, v102, v103
  v_pk_mul_f32 v[106:107], v[106:107], v[36:37] op_sel_hi:[1,0]
  v_cvt_pk_bf16_f32 v212, v104, v105
  v_pk_mul_f32 v[108:109], v[108:109], v[36:37] op_sel_hi:[1,0]
  v_cvt_pk_bf16_f32 v213, v106, v107
  v_pk_mul_f32 v[110:111], v[110:111], v[36:37] op_sel_hi:[1,0]
  v_cvt_pk_bf16_f32 v214, v108, v109
  v_pk_mul_f32 v[112:113], v[112:113], v[36:37] op_sel_hi:[1,0]
  v_cvt_pk_bf16_f32 v215, v110, v111
  v_pk_mul_f32 v[114:115], v[114:115], v[36:37] op_sel_hi:[1,0]
  v_cvt_pk_bf16_f32 v216, v112, v113
  v_pk_mul_f32 v[116:117], v[116:117], v[36:37] op_sel_hi:[1,0]
  v_cvt_pk_bf16_f32 v217, v114, v115
  v_pk_mul_f32 v[118:119], v[118:119], v[36:37] op_sel_hi:[1,0]
  v_cvt_pk_bf16_f32 v218, v116, v117
  v_pk_mul_f32 v[120:121], v[120:121], v[36:37] op_sel_hi:[1,0]
  v_cvt_pk_bf16_f32 v219, v118, v119
  v_pk_mul_f32 v[122:123], v[122:123], v[36:37] op_sel_hi:[1,0]
  v_cvt_pk_bf16_f32 v220, v120, v121
  v_pk_mul_f32 v[124:125], v[124:125], v[36:37] op_sel_hi:[1,0]
  v_cvt_pk_bf16_f32 v221, v122, v123
  v_pk_mul_f32 v[126:127], v[126:127], v[36:37] op_sel_hi:[1,0]
  v_cvt_pk_bf16_f32 v222, v124, v125
  v_cvt_pk_bf16_f32 v223, v126, v127
  v_add_u32 v240, 0, v13
  v_add_u32 v248, 0, v14
  v_xor_b32 v241, 32, v240
  v_xor_b32 v242, 64, v240
  v_xor_b32 v243, 96, v240
  v_xor_b32 v244, 128, v240
  v_xor_b32 v245, 160, v240
  v_xor_b32 v246, 192, v240
  v_xor_b32 v247, 224, v240
  ds_read_b128 v[128:131], v240 offset:0
  ds_read_b128 v[132:135], v241 offset:0
  ds_read_b128 v[136:139], v242 offset:0
  ds_read_b128 v[140:143], v243 offset:0
  ds_read_b128 v[144:147], v244 offset:0
  ds_read_b128 v[148:151], v245 offset:0
  ds_read_b128 v[152:155], v246 offset:0
  ds_read_b128 v[156:159], v247 offset:0
  v_xor_b32 v249, 64, v248
  v_xor_b32 v250, 128, v248
  v_xor_b32 v251, 192, v248
  s_waitcnt lgkmcnt(7)
  v_mfma_f32_32x32x16_bf16 v[40:55], v[128:131], v[192:195], 0
  v_mov_b64 v[64:65], 0
  v_mov_b64 v[66:67], 0
  v_mov_b64 v[68:69], 0
  v_mov_b64 v[70:71], 0
  v_mov_b64 v[72:73], 0
  s_waitcnt lgkmcnt(6)
  v_mfma_f32_32x32x16_bf16 v[40:55], v[132:135], v[196:199], v[40:55]
  v_mov_b64 v[74:75], 0
  v_mov_b64 v[76:77], 0
  v_mov_b64 v[78:79], 0
  v_mov_b64 v[80:81], 0
  v_mov_b64 v[82:83], 0
  s_waitcnt lgkmcnt(5)
  v_mfma_f32_32x32x16_bf16 v[40:55], v[136:139], v[200:203], v[40:55]
  v_mov_b64 v[84:85], 0
  v_mov_b64 v[86:87], 0
  v_mov_b64 v[88:89], 0
  v_mov_b64 v[90:91], 0
  v_mov_b64 v[92:93], 0
  s_waitcnt lgkmcnt(4)
  v_mfma_f32_32x32x16_bf16 v[40:55], v[140:143], v[204:207], v[40:55]
  v_mov_b64 v[94:95], 0
  v_mov_b64 v[96:97], 0
  v_mov_b64 v[98:99], 0
  v_mov_b64 v[100:101], 0
  v_mov_b64 v[102:103], 0
  s_waitcnt lgkmcnt(3)
  v_mfma_f32_32x32x16_bf16 v[40:55], v[144:147], v[208:211], v[40:55]
  v_mov_b64 v[104:105], 0
  v_mov_b64 v[106:107], 0
  v_mov_b64 v[108:109], 0
  v_mov_b64 v[110:111], 0
  v_mov_b64 v[112:113], 0
  s_waitcnt lgkmcnt(2)
  v_mfma_f32_32x32x16_bf16 v[40:55], v[148:151], v[212:215], v[40:55]
  v_mov_b64 v[114:115], 0
  v_mov_b64 v[116:117], 0
  v_mov_b64 v[118:119], 0
  v_mov_b64 v[120:121], 0
  v_mov_b64 v[122:123], 0
  s_waitcnt lgkmcnt(1)
  v_mfma_f32_32x32x16_bf16 v[40:55], v[152:155], v[216:219], v[40:55]
  v_mov_b64 v[124:125], 0
  v_mov_b64 v[126:127], 0
  v_mov_b64 v[252:253], 0
  v_mov_b64 v[254:255], 0
  v_mov_b64 v[56:57], 0
  s_waitcnt lgkmcnt(0)
  v_mfma_f32_32x32x16_bf16 v[40:55], v[156:159], v[220:223], v[40:55]
  v_mov_b64 v[58:59], 0
  v_mov_b64 v[60:61], 0
  v_mov_b64 v[62:63], 0
  v_lshrrev_b32 v36, 2, v1
  v_lshrrev_b32 v37, 4, v1
  v_xor_b32 v36, v36, v37
  v_and_b32 v36, 1, v36
  v_and_b32 v37, 3, v1
  v_or_b32 v36, v36, v37
  v_cmp_eq_u32 vcc, 0, v36
  v_mov_b32 v37, 0x3f803f80
  s_nop 0
  v_cndmask_b32 v176, 0, v37, vcc
  v_cndmask_b32 v177, 0, v37, vcc
  v_cndmask_b32 v178, 0, v37, vcc
  v_cndmask_b32 v179, 0, v37, vcc
  s_nop 1
  v_max3_f32 v36, v40, v41, v42
  v_max3_f32 v37, v43, v44, v45
  v_max3_f32 v36, v36, v46, v47
  v_max3_f32 v37, v37, v48, v49
  v_max3_f32 v36, v36, v50, v51
  v_max3_f32 v37, v37, v52, v53
  v_max3_f32 v36, v36, v54, v55
  v_max_f32 v36, v36, v37
  v_mov_b32 v37, v36
  s_nop 1
  v_permlane32_swap_b32 v36, v37
  s_nop 1
  v_max_f32 v36, v36, v37
  v_sub_f32 v40, v40, v36
  v_sub_f32 v160, 0, v36
  v_sub_f32 v41, v41, v36
  v_sub_f32 v161, 0, v36
  v_sub_f32 v42, v42, v36
  v_sub_f32 v162, 0, v36
  v_sub_f32 v43, v43, v36
  v_sub_f32 v163, 0, v36
  v_sub_f32 v44, v44, v36
  v_sub_f32 v164, 0, v36
  v_sub_f32 v45, v45, v36
  v_sub_f32 v165, 0, v36
  v_sub_f32 v46, v46, v36
  v_sub_f32 v166, 0, v36
  v_sub_f32 v47, v47, v36
  v_sub_f32 v167, 0, v36
  v_sub_f32 v48, v48, v36
  v_sub_f32 v168, 0, v36
  v_sub_f32 v49, v49, v36
  v_sub_f32 v169, 0, v36
  v_sub_f32 v50, v50, v36
  v_sub_f32 v170, 0, v36
  v_sub_f32 v51, v51, v36
  v_sub_f32 v171, 0, v36
  v_sub_f32 v52, v52, v36
  v_sub_f32 v172, 0, v36
  v_sub_f32 v53, v53, v36
  v_sub_f32 v173, 0, v36
  v_sub_f32 v54, v54, v36
  v_sub_f32 v174, 0, v36
  v_sub_f32 v55, v55, v36
  v_sub_f32 v175, 0, v36
  s_waitcnt lgkmcnt(0)
  s_barrier
  s_mov_b32 s32, 0
L_attn_11:
  s_nop 7
  s_waitcnt lgkmcnt(14)
  v_mfma_f32_32x32x16_bf16 v[64:79], v[128:131], v[56:59], v[64:79]
  ds_read_b128 v[128:131], v240 offset:16384
  v_max3_f32 v36, v40, v41, v42
  v_max3_f32 v37, v43, v44, v45
  v_max3_f32 v36, v36, v46, v47
  v_max3_f32 v37, v37, v48, v49
  s_waitcnt lgkmcnt(13)
  v_mfma_f32_32x32x16_bf16 v[80:95], v[132:135], v[56:59], v[80:95]
  ds_read_b128 v[132:135], v241 offset:16384
  v_max3_f32 v36, v36, v50, v51
  v_max3_f32 v37, v37, v52, v53
  v_max3_f32 v36, v36, v54, v55
  v_max_f32 v36, v36, v37
  v_cmp_lt_f32 vcc, s53, v36
  s_cbranch_vccnz L_rare_12
  s_waitcnt lgkmcnt(12)
  v_mfma_f32_32x32x16_bf16 v[96:111], v[136:139], v[56:59], v[96:111]
  ds_read_b128 v[136:139], v242 offset:16384
  v_exp_f32 v224, v40
  v_exp_f32 v225, v41
  s_waitcnt lgkmcnt(11)
  v_mfma_f32_32x32x16_bf16 v[112:127], v[140:143], v[56:59], v[112:127]
  ds_read_b128 v[140:143], v243 offset:16384
  v_exp_f32 v226, v42
  v_exp_f32 v227, v43
  v_exp_f32 v228, v44
  s_waitcnt lgkmcnt(10)
  v_mfma_f32_32x32x16_bf16 v[64:79], v[144:147], v[60:63], v[64:79]
  ds_read_b128 v[144:147], v244 offset:16384
  v_exp_f32 v229, v45
  v_exp_f32 v230, v46
  s_waitcnt lgkmcnt(9)
  v_mfma_f32_32x32x16_bf16 v[80:95], v[148:151], v[60:63], v[80:95]
  ds_read_b128 v[148:151], v245 offset:16384
  v_exp_f32 v231, v47
  v_exp_f32 v232, v48
  v_exp_f32 v233, v49
  s_waitcnt lgkmcnt(8)
  v_mfma_f32_32x32x16_bf16 v[96:111], v[152:155], v[60:63], v[96:111]
  ds_read_b128 v[152:155], v246 offset:16384
  v_exp_f32 v234, v50
  v_exp_f32 v235, v51
  s_waitcnt lgkmcnt(7)
  v_mfma_f32_32x32x16_bf16 v[112:127], v[156:159], v[60:63], v[112:127]
  ds_read_b128 v[156:159], v247 offset:16384
  v_exp_f32 v236, v52
  v_exp_f32 v237, v53
  v_exp_f32 v238, v54
  v_exp_f32 v239, v55
L_back_13:
  s_waitcnt lgkmcnt(7)
  v_mfma_f32_32x32x16_bf16 v[40:55], v[128:131], v[192:195], v[160:175]
  ds_read_b64_tr_b16 v[128:129], v248 offset:24576
  ds_read_b64_tr_b16 v[130:131], v248 offset:26624
  v_cvt_pk_bf16_f32 v56, v224, v225
  v_cvt_pk_bf16_f32 v57, v226, v227
  v_cvt_pk_bf16_f32 v58, v228, v229
  s_waitcnt lgkmcnt(8)
  v_mfma_f32_32x32x16_bf16 v[40:55], v[132:135], v[196:199], v[40:55]
  ds_read_b64_tr_b16 v[132:133], v249 offset:24576
  ds_read_b64_tr_b16 v[134:135], v249 offset:26624
  v_cvt_pk_bf16_f32 v59, v230, v231
  v_cvt_pk_bf16_f32 v60, v232, v233
  v_cvt_pk_bf16_f32 v61, v234, v235
  s_cmp_eq_u32 s32, 4
  s_cbranch_scc0 L_sk_14
  v_lshrrev_b32 v2, 9, v18
  v_lshlrev_b32 v2, 17, v2
  v_xor_b32 v3, 0, v18
  v_add_u32 v8, v3, v2
  v_xor_b32 v3, 64, v18
  v_add_u32 v9, v3, v2
  v_xor_b32 v3, 128, v18
  v_add_u32 v10, v3, v2
  v_xor_b32 v3, 192, v18
  v_add_u32 v11, v3, v2
  s_add_u32 m0, s33, 147456
  s_add_u32 s43, s33, 0
  buffer_load_dwordx4 v8, s[24:27], s43 offen lds
  buffer_load_dwordx4 v9, s[24:27], s43 offen offset:1024 lds
  buffer_load_dwordx4 v10, s[24:27], s43 offen offset:2048 lds
  buffer_load_dwordx4 v11, s[24:27], s43 offen offset:3072 lds
  s_add_u32 m0, s33, 131072
  s_add_u32 s43, s33, 16384
  buffer_load_dwordx4 v8, s[24:27], s43 offen lds
  buffer_load_dwordx4 v9, s[24:27], s43 offen offset:1024 lds
  buffer_load_dwordx4 v10, s[24:27], s43 offen offset:2048 lds
  buffer_load_dwordx4 v11, s[24:27], s43 offen offset:3072 lds
  s_add_u32 m0, s33, 114688
  s_add_u32 s43, s33, 32768
  buffer_load_dwordx4 v8, s[24:27], s43 offen lds
  buffer_load_dwordx4 v9, s[24:27], s43 offen offset:1024 lds
  buffer_load_dwordx4 v10, s[24:27], s43 offen offset:2048 lds
  buffer_load_dwordx4 v11, s[24:27], s43 offen offset:3072 lds
  s_add_u32 m0, s33, 98304
  s_add_u32 s43, s33, 49152
  buffer_load_dwordx4 v8, s[24:27], s43 offen lds
  buffer_load_dwordx4 v9, s[24:27], s43 offen offset:1024 lds
  buffer_load_dwordx4 v10, s[24:27], s43 offen offset:2048 lds
  buffer_load_dwordx4 v11, s[24:27], s43 offen offset:3072 lds
L_sk_14:
  s_waitcnt lgkmcnt(9)
  v_mfma_f32_32x32x16_bf16 v[40:55], v[136:139], v[200:203], v[40:55]
  ds_read_b64_tr_b16 v[136:137], v250 offset:24576
  ds_read_b64_tr_b16 v[138:139], v250 offset:26624
  v_cvt_pk_bf16_f32 v62, v236, v237
  v_cvt_pk_bf16_f32 v63, v238, v239
  s_waitcnt lgkmcnt(10)
  v_mfma_f32_32x32x16_bf16 v[40:55], v[140:143], v[204:207], v[40:55]
  ds_read_b64_tr_b16 v[140:141], v251 offset:24576
  ds_read_b64_tr_b16 v[142:143], v251 offset:26624
  s_waitcnt lgkmcnt(11)
  v_mfma_f32_32x32x16_bf16 v[40:55], v[144:147], v[208:211], v[40:55]
  ds_read_b64_tr_b16 v[144:145], v248 offset:28672
  ds_read_b64_tr_b16 v[146:147], v248 offset:30720
  v_mfma_f32_16x16x32_bf16 v[252:255], v[176:179], v[56:59], v[252:255]
  s_waitcnt lgkmcnt(12)
  v_mfma_f32_32x32x16_bf16 v[40:55], v[148:151], v[212:215], v[40:55]
  ds_read_b64_tr_b16 v[148:149], v249 offset:28672
  ds_read_b64_tr_b16 v[150:151], v249 offset:30720
  s_cmp_eq_u32 s32, 0
  s_cbranch_scc0 L_sk_15
  s_mov_b32 exec_hi, 0
  buffer_load_dword v12, v19, s[16:19], s65 offen
  s_mov_b64 exec, -1
L_sk_15:
  s_waitcnt lgkmcnt(13)
  v_mfma_f32_32x32x16_bf16 v[40:55], v[152:155], v[216:219], v[40:55]
  ds_read_b64_tr_b16 v[152:153], v250 offset:28672
  ds_read_b64_tr_b16 v[154:155], v250 offset:30720
  v_mfma_f32_16x16x32_bf16 v[252:255], v[176:179], v[60:63], v[252:255]
  s_cmp_eq_u32 s32, 1
  s_cbranch_scc0 L_sk_16
  s_mov_b32 exec_hi, 0
  buffer_load_dword v12, v19, s[24:27], s65 offen
  s_mov_b64 exec, -1
L_sk_16:
  s_waitcnt lgkmcnt(14)
  v_mfma_f32_32x32x16_bf16 v[40:55], v[156:159], v[220:223], v[40:55]
  ds_read_b64_tr_b16 v[156:157], v251 offset:28672
  s_waitcnt lgkmcnt(14)
  ds_read_b64_tr_b16 v[158:159], v251 offset:30720
  s_barrier
  s_nop 7
  s_waitcnt lgkmcnt(14)
  v_mfma_f32_32x32x16_bf16 v[64:79], v[128:131], v[56:59], v[64:79]
  ds_read_b128 v[128:131], v240 offset:32768
  v_max3_f32 v36, v40, v41, v42
  v_max3_f32 v37, v43, v44, v45
  v_max3_f32 v36, v36, v46, v47
  v_max3_f32 v37, v37, v48, v49
  s_waitcnt lgkmcnt(13)
  v_mfma_f32_32x32x16_bf16 v[80:95], v[132:135], v[56:59], v[80:95]
  ds_read_b128 v[132:135], v241 offset:32768
  v_max3_f32 v36, v36, v50, v51
  v_max3_f32 v37, v37, v52, v53
  v_max3_f32 v36, v36, v54, v55
  v_max_f32 v36, v36, v37
  v_cmp_lt_f32 vcc, s53, v36
  s_cbranch_vccnz L_rare_17
  s_waitcnt lgkmcnt(12)
  v_mfma_f32_32x32x16_bf16 v[96:111], v[136:139], v[56:59], v[96:111]
  ds_read_b128 v[136:139], v242 offset:32768
  v_exp_f32 v224, v40
  v_exp_f32 v225, v41
  s_waitcnt lgkmcnt(11)
  v_mfma_f32_32x32x16_bf16 v[112:127], v[140:143], v[56:59], v[112:127]
  ds_read_b128 v[140:143], v243 offset:32768
  v_exp_f32 v226, v42
  v_exp_f32 v227, v43
  v_exp_f32 v228, v44
  s_waitcnt lgkmcnt(10)
  v_mfma_f32_32x32x16_bf16 v[64:79], v[144:147], v[60:63], v[64:79]
  ds_read_b128 v[144:147], v244 offset:32768
  v_exp_f32 v229, v45
  v_exp_f32 v230, v46
  s_waitcnt lgkmcnt(9)
  v_mfma_f32_32x32x16_bf16 v[80:95], v[148:151], v[60:63], v[80:95]
  ds_read_b128 v[148:151], v245 offset:32768
  v_exp_f32 v231, v47
  v_exp_f32 v232, v48
  v_exp_f32 v233, v49
  s_waitcnt lgkmcnt(8)
  v_mfma_f32_32x32x16_bf16 v[96:111], v[152:155], v[60:63], v[96:111]
  ds_read_b128 v[152:155], v246 offset:32768
  v_exp_f32 v234, v50
  v_exp_f32 v235, v51
  s_waitcnt lgkmcnt(7)
  v_mfma_f32_32x32x16_bf16 v[112:127], v[156:159], v[60:63], v[112:127]
  ds_read_b128 v[156:159], v247 offset:32768
  v_exp_f32 v236, v52
  v_exp_f32 v237, v53
  v_exp_f32 v238, v54
  v_exp_f32 v239, v55
L_back_18:
  s_waitcnt lgkmcnt(7)
  v_mfma_f32_32x32x16_bf16 v[40:55], v[128:131], v[192:195], v[160:175]
  ds_read_b64_tr_b16 v[128:129], v248 offset:40960
  ds_read_b64_tr_b16 v[130:131], v248 offset:43008
  v_cvt_pk_bf16_f32 v56, v224, v225
  v_cvt_pk_bf16_f32 v57, v226, v227
  v_cvt_pk_bf16_f32 v58, v228, v229
  s_waitcnt lgkmcnt(8)
  v_mfma_f32_32x32x16_bf16 v[40:55], v[132:135], v[196:199], v[40:55]
  ds_read_b64_tr_b16 v[132:133], v249 offset:40960
  ds_read_b64_tr_b16 v[134:135], v249 offset:43008
  v_cvt_pk_bf16_f32 v59, v230, v231
  v_cvt_pk_bf16_f32 v60, v232, v233
  v_cvt_pk_bf16_f32 v61, v234, v235
  s_waitcnt lgkmcnt(9)
  v_mfma_f32_32x32x16_bf16 v[40:55], v[136:139], v[200:203], v[40:55]
  ds_read_b64_tr_b16 v[136:137], v250 offset:40960
  ds_read_b64_tr_b16 v[138:139], v250 offset:43008
  v_cvt_pk_bf16_f32 v62, v236, v237
  v_cvt_pk_bf16_f32 v63, v238, v239
  s_waitcnt lgkmcnt(10)
  v_mfma_f32_32x32x16_bf16 v[40:55], v[140:143], v[204:207], v[40:55]
  ds_read_b64_tr_b16 v[140:141], v251 offset:40960
  ds_read_b64_tr_b16 v[142:143], v251 offset:43008
  s_waitcnt lgkmcnt(11)
  v_mfma_f32_32x32x16_bf16 v[40:55], v[144:147], v[208:211], v[40:55]
  ds_read_b64_tr_b16 v[144:145], v248 offset:45056
  ds_read_b64_tr_b16 v[146:147], v248 offset:47104
  v_mfma_f32_16x16x32_bf16 v[252:255], v[176:179], v[56:59], v[252:255]
  s_waitcnt lgkmcnt(12)
  v_mfma_f32_32x32x16_bf16 v[40:55], v[148:151], v[212:215], v[40:55]
  ds_read_b64_tr_b16 v[148:149], v249 offset:45056
  ds_read_b64_tr_b16 v[150:151], v249 offset:47104
  s_cmp_eq_u32 s32, 0
  s_cbranch_scc0 L_sk_19
  s_mov_b32 exec_lo, 0
  buffer_load_dword v12, v19, s[16:19], s65 offen
  s_mov_b64 exec, -1
L_sk_19:
  s_waitcnt lgkmcnt(13)
  v_mfma_f32_32x32x16_bf16 v[40:55], v[152:155], v[216:219], v[40:55]
  ds_read_b64_tr_b16 v[152:153], v250 offset:45056
  ds_read_b64_tr_b16 v[154:155], v250 offset:47104
  v_mfma_f32_16x16x32_bf16 v[252:255], v[176:179], v[60:63], v[252:255]
  s_cmp_eq_u32 s32, 1
  s_cbranch_scc0 L_sk_20
  s_mov_b32 exec_lo, 0
  buffer_load_dword v12, v19, s[24:27], s65 offen
  s_mov_b64 exec, -1
L_sk_20:
  s_waitcnt lgkmcnt(14)
  v_mfma_f32_32x32x16_bf16 v[40:55], v[156:159], v[220:223], v[40:55]
  ds_read_b64_tr_b16 v[156:157], v251 offset:45056
  s_waitcnt lgkmcnt(14)
  ds_read_b64_tr_b16 v[158:159], v251 offset:47104
  v_xor_b32 v240, 0xc000, v240
  v_xor_b32 v241, 0xc000, v241
  v_xor_b32 v242, 0xc000, v242
  v_xor_b32 v243, 0xc000, v243
  v_xor_b32 v244, 0xc000, v244
  v_xor_b32 v245, 0xc000, v245
  v_xor_b32 v246, 0xc000, v246
  v_xor_b32 v247, 0xc000, v247
  v_xor_b32 v248, 0xc000, v248
  v_xor_b32 v249, 0xc000, v249
  v_xor_b32 v250, 0xc000, v250
  v_xor_b32 v251, 0xc000, v251
  s_cmp_eq_u32 s32, 4
  s_cbranch_scc0 L_sk_21
  s_waitcnt vmcnt(0)
L_sk_21:
  s_barrier
  s_nop 7
  s_waitcnt lgkmcnt(14)
  v_mfma_f32_32x32x16_bf16 v[64:79], v[128:131], v[56:59], v[64:79]
  ds_read_b128 v[128:131], v240 offset:0
  v_max3_f32 v36, v40, v41, v42
  v_max3_f32 v37, v43, v44, v45
  v_max3_f32 v36, v36, v46, v47
  v_max3_f32 v37, v37, v48, v49
  s_waitcnt lgkmcnt(13)
  v_mfma_f32_32x32x16_bf16 v[80:95], v[132:135], v[56:59], v[80:95]
  ds_read_b128 v[132:135], v241 offset:0
  v_max3_f32 v36, v36, v50, v51
  v_max3_f32 v37, v37, v52, v53
  v_max3_f32 v36, v36, v54, v55
  v_max_f32 v36, v36, v37
  v_cmp_lt_f32 vcc, s53, v36
  s_cbranch_vccnz L_rare_22
  s_waitcnt lgkmcnt(12)
  v_mfma_f32_32x32x16_bf16 v[96:111], v[136:139], v[56:59], v[96:111]
  ds_read_b128 v[136:139], v242 offset:0
  v_exp_f32 v224, v40
  v_exp_f32 v225, v41
  s_waitcnt lgkmcnt(11)
  v_mfma_f32_32x32x16_bf16 v[112:127], v[140:143], v[56:59], v[112:127]
  ds_read_b128 v[140:143], v243 offset:0
  v_exp_f32 v226, v42
  v_exp_f32 v227, v43
  v_exp_f32 v228, v44
  s_waitcnt lgkmcnt(10)
  v_mfma_f32_32x32x16_bf16 v[64:79], v[144:147], v[60:63], v[64:79]
  ds_read_b128 v[144:147], v244 offset:0
  v_exp_f32 v229, v45
  v_exp_f32 v230, v46
  s_waitcnt lgkmcnt(9)
  v_mfma_f32_32x32x16_bf16 v[80:95], v[148:151], v[60:63], v[80:95]
  ds_read_b128 v[148:151], v245 offset:0
  v_exp_f32 v231, v47
  v_exp_f32 v232, v48
  v_exp_f32 v233, v49
  s_waitcnt lgkmcnt(8)
  v_mfma_f32_32x32x16_bf16 v[96:111], v[152:155], v[60:63], v[96:111]
  ds_read_b128 v[152:155], v246 offset:0
  v_exp_f32 v234, v50
  v_exp_f32 v235, v51
  s_waitcnt lgkmcnt(7)
  v_mfma_f32_32x32x16_bf16 v[112:127], v[156:159], v[60:63], v[112:127]
  ds_read_b128 v[156:159], v247 offset:0
  v_exp_f32 v236, v52
  v_exp_f32 v237, v53
  v_exp_f32 v238, v54
  v_exp_f32 v239, v55
L_back_23:
  s_waitcnt lgkmcnt(7)
  v_mfma_f32_32x32x16_bf16 v[40:55], v[128:131], v[192:195], v[160:175]
  ds_read_b64_tr_b16 v[128:129], v248 offset:8192
  ds_read_b64_tr_b16 v[130:131], v248 offset:10240
  v_cvt_pk_bf16_f32 v56, v224, v225
  v_cvt_pk_bf16_f32 v57, v226, v227
  v_cvt_pk_bf16_f32 v58, v228, v229
  s_waitcnt lgkmcnt(8)
  v_mfma_f32_32x32x16_bf16 v[40:55], v[132:135], v[196:199], v[40:55]
  ds_read_b64_tr_b16 v[132:133], v249 offset:8192
  ds_read_b64_tr_b16 v[134:135], v249 offset:10240
  v_cvt_pk_bf16_f32 v59, v230, v231
  v_cvt_pk_bf16_f32 v60, v232, v233
  v_cvt_pk_bf16_f32 v61, v234, v235
  s_waitcnt lgkmcnt(9)
  v_mfma_f32_32x32x16_bf16 v[40:55], v[136:139], v[200:203], v[40:55]
  ds_read_b64_tr_b16 v[136:137], v250 offset:8192
  ds_read_b64_tr_b16 v[138:139], v250 offset:10240
  v_cvt_pk_bf16_f32 v62, v236, v237
  v_cvt_pk_bf16_f32 v63, v238, v239
  s_waitcnt lgkmcnt(10)
  v_mfma_f32_32x32x16_bf16 v[40:55], v[140:143], v[204:207], v[40:55]
  ds_read_b64_tr_b16 v[140:141], v251 offset:8192
  ds_read_b64_tr_b16 v[142:143], v251 offset:10240
  s_waitcnt lgkmcnt(11)
  v_mfma_f32_32x32x16_bf16 v[40:55], v[144:147], v[208:211], v[40:55]
  ds_read_b64_tr_b16 v[144:145], v248 offset:12288
  ds_read_b64_tr_b16 v[146:147], v248 offset:14336
  v_mfma_f32_16x16x32_bf16 v[252:255], v[176:179], v[56:59], v[252:255]
  s_waitcnt lgkmcnt(12)
  v_mfma_f32_32x32x16_bf16 v[40:55], v[148:151], v[212:215], v[40:55]
  ds_read_b64_tr_b16 v[148:149], v249 offset:12288
  ds_read_b64_tr_b16 v[150:151], v249 offset:14336
  s_waitcnt lgkmcnt(13)
  v_mfma_f32_32x32x16_bf16 v[40:55], v[152:155], v[216:219], v[40:55]
  ds_read_b64_tr_b16 v[152:153], v250 offset:12288
  ds_read_b64_tr_b16 v[154:155], v250 offset:14336
  v_mfma_f32_16x16x32_bf16 v[252:255], v[176:179], v[60:63], v[252:255]
  s_waitcnt lgkmcnt(14)
  v_mfma_f32_32x32x16_bf16 v[40:55], v[156:159], v[220:223], v[40:55]
  ds_read_b64_tr_b16 v[156:157], v251 offset:12288
  s_waitcnt lgkmcnt(14)
  ds_read_b64_tr_b16 v[158:159], v251 offset:14336
  s_barrier
  s_add_u32 s32, s32, 1
  s_cmp_lt_u32 s32, 5
  s_cbranch_scc1 L_attn_11
  s_add_u32 m0, s33, 32768
  s_add_u32 s43, s33, 65536
  buffer_load_dwordx4 v8, s[24:27], s43 offen lds
  buffer_load_dwordx4 v9, s[24:27], s43 offen offset:1024 lds
  buffer_load_dwordx4 v10, s[24:27], s43 offen offset:2048 lds
  buffer_load_dwordx4 v11, s[24:27], s43 offen offset:3072 lds
  s_nop 7
  s_waitcnt lgkmcnt(14)
  v_mfma_f32_32x32x16_bf16 v[64:79], v[128:131], v[56:59], v[64:79]
  ds_read_b64_tr_b16 v[128:129], v248 offset:24576
  s_waitcnt lgkmcnt(14)
  ds_read_b64_tr_b16 v[130:131], v248 offset:26624
  v_max3_f32 v36, v40, v41, v42
  v_max3_f32 v37, v43, v44, v45
  v_max3_f32 v36, v36, v46, v47
  v_max3_f32 v37, v37, v48, v49
  s_waitcnt lgkmcnt(14)
  v_mfma_f32_32x32x16_bf16 v[80:95], v[132:135], v[56:59], v[80:95]
  ds_read_b64_tr_b16 v[132:133], v249 offset:24576
  s_waitcnt lgkmcnt(14)
  ds_read_b64_tr_b16 v[134:135], v249 offset:26624
  v_max3_f32 v36, v36, v50, v51
  v_max3_f32 v37, v37, v52, v53
  v_max3_f32 v36, v36, v54, v55
  v_max_f32 v36, v36, v37
  v_cmp_lt_f32 vcc, s53, v36
  s_cbranch_vccnz L_rare_24
  s_waitcnt lgkmcnt(14)
  v_mfma_f32_32x32x16_bf16 v[96:111], v[136:139], v[56:59], v[96:111]
  ds_read_b64_tr_b16 v[136:137], v250 offset:24576
  s_waitcnt lgkmcnt(14)
  ds_read_b64_tr_b16 v[138:139], v250 offset:26624
  v_exp_f32 v224, v40
  v_exp_f32 v225, v41
  s_waitcnt lgkmcnt(14)
  v_mfma_f32_32x32x16_bf16 v[112:127], v[140:143], v[56:59], v[112:127]
  ds_read_b64_tr_b16 v[140:141], v251 offset:24576
  s_waitcnt lgkmcnt(14)
  ds_read_b64_tr_b16 v[142:143], v251 offset:26624
  v_exp_f32 v226, v42
  v_exp_f32 v227, v43
  v_exp_f32 v228, v44
  s_waitcnt lgkmcnt(14)
  v_mfma_f32_32x32x16_bf16 v[64:79], v[144:147], v[60:63], v[64:79]
  ds_read_b64_tr_b16 v[144:145], v248 offset:28672
  s_waitcnt lgkmcnt(14)
  ds_read_b64_tr_b16 v[146:147], v248 offset:30720
  v_exp_f32 v229, v45
  v_exp_f32 v230, v46
  s_waitcnt lgkmcnt(14)
  v_mfma_f32_32x32x16_bf16 v[80:95], v[148:151], v[60:63], v[80:95]
  ds_read_b64_tr_b16 v[148:149], v249 offset:28672
  s_waitcnt lgkmcnt(14)
  ds_read_b64_tr_b16 v[150:151], v249 offset:30720
  v_exp_f32 v231, v47
  v_exp_f32 v232, v48
  v_exp_f32 v233, v49
  s_waitcnt lgkmcnt(14)
  v_mfma_f32_32x32x16_bf16 v[96:111], v[152:155], v[60:63], v[96:111]
  ds_read_b64_tr_b16 v[152:153], v250 offset:28672
  s_waitcnt lgkmcnt(14)
  ds_read_b64_tr_b16 v[154:155], v250 offset:30720
  v_exp_f32 v234, v50
  v_exp_f32 v235, v51
  s_waitcnt lgkmcnt(14)
  v_mfma_f32_32x32x16_bf16 v[112:127], v[156:159], v[60:63], v[112:127]
  ds_read_b64_tr_b16 v[156:157], v251 offset:28672
  s_waitcnt lgkmcnt(14)
  ds_read_b64_tr_b16 v[158:159], v251 offset:30720
  v_exp_f32 v236, v52
  v_exp_f32 v237, v53
  v_exp_f32 v238, v54
  v_exp_f32 v239, v55
L_back_25:
  v_cvt_pk_bf16_f32 v56, v224, v225
  v_cvt_pk_bf16_f32 v57, v226, v227
  v_cvt_pk_bf16_f32 v58, v228, v229
  v_cvt_pk_bf16_f32 v59, v230, v231
  v_cvt_pk_bf16_f32 v60, v232, v233
  v_cvt_pk_bf16_f32 v61, v234, v235
  v_cvt_pk_bf16_f32 v62, v236, v237
  v_cvt_pk_bf16_f32 v63, v238, v239
  s_nop 1
  v_mfma_f32_16x16x32_bf16 v[252:255], v[176:179], v[56:59], v[252:255]
  v_mfma_f32_16x16x32_bf16 v[252:255], v[176:179], v[60:63], v[252:255]
  s_waitcnt lgkmcnt(14)
  v_mfma_f32_32x32x16_bf16 v[64:79], v[128:131], v[56:59], v[64:79]
  s_waitcnt lgkmcnt(12)
  v_mfma_f32_32x32x16_bf16 v[80:95], v[132:135], v[56:59], v[80:95]
  s_waitcnt lgkmcnt(10)
  v_mfma_f32_32x32x16_bf16 v[96:111], v[136:139], v[56:59], v[96:111]
  s_waitcnt lgkmcnt(8)
  v_mfma_f32_32x32x16_bf16 v[112:127], v[140:143], v[56:59], v[112:127]
  s_waitcnt lgkmcnt(6)
  v_mfma_f32_32x32x16_bf16 v[64:79], v[144:147], v[60:63], v[64:79]
  s_waitcnt lgkmcnt(4)
  v_mfma_f32_32x32x16_bf16 v[80:95], v[148:151], v[60:63], v[80:95]
  s_waitcnt lgkmcnt(2)
  v_mfma_f32_32x32x16_bf16 v[96:111], v[152:155], v[60:63], v[96:111]
  s_waitcnt lgkmcnt(0)
  v_mfma_f32_32x32x16_bf16 v[112:127], v[156:159], v[60:63], v[112:127]
  s_nop 7
  v_rcp_f32 v36, v252
  s_nop 7
  v_pk_mul_f32 v[64:65], v[64:65], v[36:37] op_sel_hi:[1,0]
  v_pk_mul_f32 v[66:67], v[66:67], v[36:37] op_sel_hi:[1,0]
  v_cvt_pk_bf16_f32 v192, v64, v65
  v_pk_mul_f32 v[68:69], v[68:69], v[36:37] op_sel_hi:[1,0]
  v_cvt_pk_bf16_f32 v193, v66, v67
  v_pk_mul_f32 v[70:71], v[70:71], v[36:37] op_sel_hi:[1,0]
  v_cvt_pk_bf16_f32 v194, v68, v69
  v_pk_mul_f32 v[72:73], v[72:73], v[36:37] op_sel_hi:[1,0]
  v_cvt_pk_bf16_f32 v195, v70, v71
  v_pk_mul_f32 v[74:75], v[74:75], v[36:37] op_sel_hi:[1,0]
  v_cvt_pk_bf16_f32 v196, v72, v73
  v_pk_mul_f32 v[76:77], v[76:77], v[36:37] op_sel_hi:[1,0]
  v_cvt_pk_bf16_f32 v197, v74, v75
  v_pk_mul_f32 v[78:79], v[78:79], v[36:37] op_sel_hi:[1,0]
  v_cvt_pk_bf16_f32 v198, v76, v77
  v_pk_mul_f32 v[80:81], v[80:81], v[36:37] op_sel_hi:[1,0]
  v_cvt_pk_bf16_f32 v199, v78, v79
  v_pk_mul_f32 v[82:83], v[82:83], v[36:37] op_sel_hi:[1,0]
  v_cvt_pk_bf16_f32 v200, v80, v81
  v_pk_mul_f32 v[84:85], v[84:85], v[36:37] op_sel_hi:[1,0]
  v_cvt_pk_bf16_f32 v201, v82, v83
  v_pk_mul_f32 v[86:87], v[86:87], v[36:37] op_sel_hi:[1,0]
  v_cvt_pk_bf16_f32 v202, v84, v85
  v_pk_mul_f32 v[88:89], v[88:89], v[36:37] op_sel_hi:[1,0]
  v_cvt_pk_bf16_f32 v203, v86, v87
  v_pk_mul_f32 v[90:91], v[90:91], v[36:37] op_sel_hi:[1,0]
  v_cvt_pk_bf16_f32 v204, v88, v89
  v_pk_mul_f32 v[92:93], v[92:93], v[36:37] op_sel_hi:[1,0]
  v_cvt_pk_bf16_f32 v205, v90, v91
  v_pk_mul_f32 v[94:95], v[94:95], v[36:37] op_sel_hi:[1,0]
  v_cvt_pk_bf16_f32 v206, v92, v93
  v_pk_mul_f32 v[96:97], v[96:97], v[36:37] op_sel_hi:[1,0]
  v_cvt_pk_bf16_f32 v207, v94, v95
  v_pk_mul_f32 v[98:99], v[98:99], v[36:37] op_sel_hi:[1,0]
  v_cvt_pk_bf16_f32 v208, v96, v97
  v_pk_mul_f32 v[100:101], v[100:101], v[36:37] op_sel_hi:[1,0]
  v_cvt_pk_bf16_f32 v209, v98, v99
  v_pk_mul_f32 v[102:103], v[102:103], v[36:37] op_sel_hi:[1,0]
  v_cvt_pk_bf16_f32 v210, v100, v101
  v_pk_mul_f32 v[104:105], v[104:105], v[36:37] op_sel_hi:[1,0]
  v_cvt_pk_bf16_f32 v211, v102, v103
  v_pk_mul_f32 v[106:107], v[106:107], v[36:37] op_sel_hi:[1,0]
  v_cvt_pk_bf16_f32 v212, v104, v105
  v_pk_mul_f32 v[108:109], v[108:109], v[36:37] op_sel_hi:[1,0]
  v_cvt_pk_bf16_f32 v213, v106, v107
  v_pk_mul_f32 v[110:111], v[110:111], v[36:37] op_sel_hi:[1,0]
  v_cvt_pk_bf16_f32 v214, v108, v109
  v_pk_mul_f32 v[112:113], v[112:113], v[36:37] op_sel_hi:[1,0]
  v_cvt_pk_bf16_f32 v215, v110, v111
  v_pk_mul_f32 v[114:115], v[114:115], v[36:37] op_sel_hi:[1,0]
  v_cvt_pk_bf16_f32 v216, v112, v113
  v_pk_mul_f32 v[116:117], v[116:117], v[36:37] op_sel_hi:[1,0]
  v_cvt_pk_bf16_f32 v217, v114, v115
  v_pk_mul_f32 v[118:119], v[118:119], v[36:37] op_sel_hi:[1,0]
  v_cvt_pk_bf16_f32 v218, v116, v117
  v_pk_mul_f32 v[120:121], v[120:121], v[36:37] op_sel_hi:[1,0]
  v_cvt_pk_bf16_f32 v219, v118, v119
  v_pk_mul_f32 v[122:123], v[122:123], v[36:37] op_sel_hi:[1,0]
  v_cvt_pk_bf16_f32 v220, v120, v121
  v_pk_mul_f32 v[124:125], v[124:125], v[36:37] op_sel_hi:[1,0]
  v_cvt_pk_bf16_f32 v221, v122, v123
  v_pk_mul_f32 v[126:127], v[126:127], v[36:37] op_sel_hi:[1,0]
  v_cvt_pk_bf16_f32 v222, v124, v125
  v_cvt_pk_bf16_f32 v223, v126, v127
  s_waitcnt lgkmcnt(0)
  s_barrier
  v_add_u32 v28, s39, v18
  ds_write_b128 v28, v[192:195] offset:16384
  ds_write_b128 v28, v[196:199] offset:17408
  ds_write_b128 v28, v[200:203] offset:18432
  ds_write_b128 v28, v[204:207] offset:19456
  ds_write_b128 v28, v[208:211] offset:20480
  ds_write_b128 v28, v[212:215] offset:21504
  ds_write_b128 v28, v[216:219] offset:22528
  ds_write_b128 v28, v[220:223] offset:23552
  s_add_u32 m0, s33, 81920
  s_add_u32 s43, s33, 81920
  buffer_load_dwordx4 v8, s[24:27], s43 offen lds
  buffer_load_dwordx4 v9, s[24:27], s43 offen offset:1024 lds
  buffer_load_dwordx4 v10, s[24:27], s43 offen offset:2048 lds
  buffer_load_dwordx4 v11, s[24:27], s43 offen offset:3072 lds
  s_waitcnt lgkmcnt(0)
  s_barrier
  s_add_u32 m0, s33, 147456
  s_add_u32 s43, s33, 98304
  buffer_load_dwordx4 v8, s[24:27], s43 offen lds
  buffer_load_dwordx4 v9, s[24:27], s43 offen offset:1024 lds
  buffer_load_dwordx4 v10, s[24:27], s43 offen offset:2048 lds
  buffer_load_dwordx4 v11, s[24:27], s43 offen offset:3072 lds
  s_waitcnt lgkmcnt(0)
  s_barrier
  s_add_u32 m0, s33, 131072
  s_add_u32 s43, s33, 114688
  buffer_load_dwordx4 v8, s[24:27], s43 offen lds
  buffer_load_dwordx4 v9, s[24:27], s43 offen offset:1024 lds
  buffer_load_dwordx4 v10, s[24:27], s43 offen offset:2048 lds
  buffer_load_dwordx4 v11, s[24:27], s43 offen offset:3072 lds
  v_xor_b32 v8, 0x20000, v8
  v_xor_b32 v9, 0x20000, v9
  v_xor_b32 v10, 0x20000, v10
  v_xor_b32 v11, 0x20000, v11
  s_add_u32 m0, s33, 49152
  s_add_u32 s43, s33, 0
  buffer_load_dwordx4 v8, s[24:27], s43 offen lds
  buffer_load_dwordx4 v9, s[24:27], s43 offen offset:1024 lds
  buffer_load_dwordx4 v10, s[24:27], s43 offen offset:2048 lds
  buffer_load_dwordx4 v11, s[24:27], s43 offen offset:3072 lds
  s_add_u32 m0, s33, 0
  s_add_u32 s43, s33, 16384
  buffer_load_dwordx4 v8, s[24:27], s43 offen lds
  buffer_load_dwordx4 v9, s[24:27], s43 offen offset:1024 lds
  buffer_load_dwordx4 v10, s[24:27], s43 offen offset:2048 lds
  buffer_load_dwordx4 v11, s[24:27], s43 offen offset:3072 lds
  s_waitcnt vmcnt(20) lgkmcnt(0)
  s_barrier
  s_add_u32 m0, s33, 114688
  s_add_u32 s43, s33, 32768
  buffer_load_dwordx4 v8, s[24:27], s43 offen lds
  buffer_load_dwordx4 v9, s[24:27], s43 offen offset:1024 lds
  buffer_load_dwordx4 v10, s[24:27], s43 offen offset:2048 lds
  buffer_load_dwordx4 v11, s[24:27], s43 offen offset:3072 lds
  s_waitcnt vmcnt(20) lgkmcnt(0)
  s_barrier
  s_add_u32 m0, s33, 98304
  s_add_u32 s43, s33, 49152
  buffer_load_dwordx4 v8, s[24:27], s43 offen lds
  buffer_load_dwordx4 v9, s[24:27], s43 offen offset:1024 lds
  buffer_load_dwordx4 v10, s[24:27], s43 offen offset:2048 lds
  buffer_load_dwordx4 v11, s[24:27], s43 offen offset:3072 lds
  s_waitcnt vmcnt(20) lgkmcnt(0)
  s_barrier
  s_add_u32 m0, s33, 32768
  s_add_u32 s43, s33, 65536
  buffer_load_dwordx4 v8, s[24:27], s43 offen lds
  buffer_load_dwordx4 v9, s[24:27], s43 offen offset:1024 lds
  buffer_load_dwordx4 v10, s[24:27], s43 offen offset:2048 lds
  buffer_load_dwordx4 v11, s[24:27], s43 offen offset:3072 lds
  s_waitcnt vmcnt(20) lgkmcnt(0)
  s_barrier
  s_add_u32 m0, s33, 81920
  s_add_u32 s43, s33, 81920
  buffer_load_dwordx4 v8, s[24:27], s43 offen lds
  buffer_load_dwordx4 v9, s[24:27], s43 offen offset:1024 lds
  buffer_load_dwordx4 v10, s[24:27], s43 offen offset:2048 lds
  buffer_load_dwordx4 v11, s[24:27], s43 offen offset:3072 lds
  s_waitcnt vmcnt(20) lgkmcnt(0)
  s_barrier
  s_add_u32 m0, s33, 147456
  s_add_u32 s43, s33, 98304
  buffer_load_dwordx4 v8, s[24:27], s43 offen lds
  buffer_load_dwordx4 v9, s[24:27], s43 offen offset:1024 lds
  buffer_load_dwordx4 v10, s[24:27], s43 offen offset:2048 lds
  buffer_load_dwordx4 v11, s[24:27], s43 offen offset:3072 lds
  s_waitcnt vmcnt(20) lgkmcnt(0)
  s_barrier
  s_add_u32 m0, s33, 131072
  s_add_u32 s43, s33, 114688
  buffer_load_dwordx4 v8, s[24:27], s43 offen lds
  buffer_load_dwordx4 v9, s[24:27], s43 offen offset:1024 lds
  buffer_load_dwordx4 v10, s[24:27], s43 offen offset:2048 lds
  buffer_load_dwordx4 v11, s[24:27], s43 offen offset:3072 lds
  s_waitcnt vmcnt(20) lgkmcnt(0)
  s_barrier
  v_xor_b32 v8, 0x20000, v8
  v_xor_b32 v9, 0x20000, v9
  v_xor_b32 v10, 0x20000, v10
  v_xor_b32 v11, 0x20000, v11
  s_add_u32 m0, s33, 49152
  s_add_u32 s43, s33, 262144
  buffer_load_dwordx4 v8, s[24:27], s43 offen lds
  buffer_load_dwordx4 v9, s[24:27], s43 offen offset:1024 lds
  buffer_load_dwordx4 v10, s[24:27], s43 offen offset:2048 lds
  buffer_load_dwordx4 v11, s[24:27], s43 offen offset:3072 lds
  s_waitcnt vmcnt(20) lgkmcnt(0)
  s_barrier
  s_add_u32 m0, s33, 0
  s_add_u32 s43, s33, 278528
  buffer_load_dwordx4 v8, s[24:27], s43 offen lds
  buffer_load_dwordx4 v9, s[24:27], s43 offen offset:1024 lds
  buffer_load_dwordx4 v10, s[24:27], s43 offen offset:2048 lds
  buffer_load_dwordx4 v11, s[24:27], s43 offen offset:3072 lds
  s_waitcnt vmcnt(20) lgkmcnt(0)
  s_barrier
  s_add_u32 m0, s33, 114688
  s_add_u32 s43, s33, 294912
  buffer_load_dwordx4 v8, s[24:27], s43 offen lds
  buffer_load_dwordx4 v9, s[24:27], s43 offen offset:1024 lds
  buffer_load_dwordx4 v10, s[24:27], s43 offen offset:2048 lds
  buffer_load_dwordx4 v11, s[24:27], s43 offen offset:3072 lds
  s_waitcnt vmcnt(20) lgkmcnt(0)
  s_barrier
  s_add_u32 m0, s33, 98304
  s_add_u32 s43, s33, 311296
  buffer_load_dwordx4 v8, s[24:27], s43 offen lds
  buffer_load_dwordx4 v9, s[24:27], s43 offen offset:1024 lds
  buffer_load_dwordx4 v10, s[24:27], s43 offen offset:2048 lds
  buffer_load_dwordx4 v11, s[24:27], s43 offen offset:3072 lds
  s_waitcnt vmcnt(20) lgkmcnt(0)
  s_barrier
  s_add_u32 m0, s33, 32768
  s_add_u32 s43, s33, 327680
  buffer_load_dwordx4 v8, s[24:27], s43 offen lds
  buffer_load_dwordx4 v9, s[24:27], s43 offen offset:1024 lds
  buffer_load_dwordx4 v10, s[24:27], s43 offen offset:2048 lds
  buffer_load_dwordx4 v11, s[24:27], s43 offen offset:3072 lds
  s_waitcnt vmcnt(20) lgkmcnt(0)
  s_barrier
  s_add_u32 m0, s33, 81920
  s_add_u32 s43, s33, 344064
  buffer_load_dwordx4 v8, s[24:27], s43 offen lds
  buffer_load_dwordx4 v9, s[24:27], s43 offen offset:1024 lds
  buffer_load_dwordx4 v10, s[24:27], s43 offen offset:2048 lds
  buffer_load_dwordx4 v11, s[24:27], s43 offen offset:3072 lds
  s_waitcnt vmcnt(20) lgkmcnt(0)
  s_barrier
  s_add_u32 m0, s33, 147456
  s_add_u32 s43, s33, 360448
  buffer_load_dwordx4 v8, s[24:27], s43 offen lds
  buffer_load_dwordx4 v9, s[24:27], s43 offen offset:1024 lds
  buffer_load_dwordx4 v10, s[24:27], s43 offen offset:2048 lds
  buffer_load_dwordx4 v11, s[24:27], s43 offen offset:3072 lds
  s_waitcnt vmcnt(20) lgkmcnt(0)
  s_barrier
  s_add_u32 m0, s33, 131072
  s_add_u32 s43, s33, 376832
  buffer_load_dwordx4 v8, s[24:27], s43 offen lds
  buffer_load_dwordx4 v9, s[24:27], s43 offen offset:1024 lds
  buffer_load_dwordx4 v10, s[24:27], s43 offen offset:2048 lds
  buffer_load_dwordx4 v11, s[24:27], s43 offen offset:3072 lds
  s_waitcnt vmcnt(20) lgkmcnt(0)
  s_barrier
  v_xor_b32 v8, 0x20000, v8
  v_xor_b32 v9, 0x20000, v9
  v_xor_b32 v10, 0x20000, v10
  v_xor_b32 v11, 0x20000, v11
  s_add_u32 m0, s33, 65536
  s_add_u32 s43, s33, 262144
  buffer_load_dwordx4 v8, s[24:27], s43 offen lds
  buffer_load_dwordx4 v9, s[24:27], s43 offen offset:1024 lds
  buffer_load_dwordx4 v10, s[24:27], s43 offen offset:2048 lds
  buffer_load_dwordx4 v11, s[24:27], s43 offen offset:3072 lds
  s_add_u32 m0, s33, 49152
  s_add_u32 s43, s33, 278528
  buffer_load_dwordx4 v8, s[24:27], s43 offen lds
  buffer_load_dwordx4 v9, s[24:27], s43 offen offset:1024 lds
  buffer_load_dwordx4 v10, s[24:27], s43 offen offset:2048 lds
  buffer_load_dwordx4 v11, s[24:27], s43 offen offset:3072 lds
  s_add_u32 m0, s33, 16384
  s_add_u32 s43, s33, 294912
  buffer_load_dwordx4 v8, s[24:27], s43 offen lds
  buffer_load_dwordx4 v9, s[24:27], s43 offen offset:1024 lds
  buffer_load_dwordx4 v10, s[24:27], s43 offen offset:2048 lds
  buffer_load_dwordx4 v11, s[24:27], s43 offen offset:3072 lds
  s_waitcnt vmcnt(28) lgkmcnt(0)
  s_barrier
  s_add_u32 m0, s33, 0
  s_add_u32 s43, s33, 311296
  buffer_load_dwordx4 v8, s[24:27], s43 offen lds
  buffer_load_dwordx4 v9, s[24:27], s43 offen offset:1024 lds
  buffer_load_dwordx4 v10, s[24:27], s43 offen offset:2048 lds
  buffer_load_dwordx4 v11, s[24:27], s43 offen offset:3072 lds
  s_waitcnt vmcnt(28) lgkmcnt(0)
  s_barrier
  s_add_u32 m0, s33, 114688
  s_add_u32 s43, s33, 327680
  buffer_load_dwordx4 v8, s[24:27], s43 offen lds
  buffer_load_dwordx4 v9, s[24:27], s43 offen offset:1024 lds
  buffer_load_dwordx4 v10, s[24:27], s43 offen offset:2048 lds
  buffer_load_dwordx4 v11, s[24:27], s43 offen offset:3072 lds
  s_waitcnt vmcnt(28) lgkmcnt(0)
  s_barrier
  s_add_u32 m0, s33, 98304
  s_add_u32 s43, s33, 344064
  buffer_load_dwordx4 v8, s[24:27], s43 offen lds
  buffer_load_dwordx4 v9, s[24:27], s43 offen offset:1024 lds
  buffer_load_dwordx4 v10, s[24:27], s43 offen offset:2048 lds
  buffer_load_dwordx4 v11, s[24:27], s43 offen offset:3072 lds
  s_waitcnt vmcnt(28) lgkmcnt(0)
  s_barrier
  s_add_u32 m0, s33, 32768
  s_add_u32 s43, s33, 360448
  buffer_load_dwordx4 v8, s[24:27], s43 offen lds
  buffer_load_dwordx4 v9, s[24:27], s43 offen offset:1024 lds
  buffer_load_dwordx4 v10, s[24:27], s43 offen offset:2048 lds
  buffer_load_dwordx4 v11, s[24:27], s43 offen offset:3072 lds
  s_waitcnt vmcnt(28) lgkmcnt(0)
  s_barrier
  s_add_u32 m0, s33, 81920
  s_add_u32 s43, s33, 376832
  buffer_load_dwordx4 v8, s[24:27], s43 offen lds
  buffer_load_dwordx4 v9, s[24:27], s43 offen offset:1024 lds
  buffer_load_dwordx4 v10, s[24:27], s43 offen offset:2048 lds
  buffer_load_dwordx4 v11, s[24:27], s43 offen offset:3072 lds
  s_waitcnt vmcnt(28) lgkmcnt(0)
  s_barrier
  s_waitcnt vmcnt(0) lgkmcnt(0)
  s_barrier
  s_branch L_final
L_rare_12:
  s_waitcnt lgkmcnt(0)
  v_mfma_f32_32x32x16_bf16 v[96:111], v[136:139], v[56:59], v[96:111]
  ds_read_b128 v[136:139], v242 offset:16384
  v_mfma_f32_32x32x16_bf16 v[112:127], v[140:143], v[56:59], v[112:127]
  ds_read_b128 v[140:143], v243 offset:16384
  v_mfma_f32_32x32x16_bf16 v[64:79], v[144:147], v[60:63], v[64:79]
  ds_read_b128 v[144:147], v244 offset:16384
  v_mfma_f32_32x32x16_bf16 v[80:95], v[148:151], v[60:63], v[80:95]
  ds_read_b128 v[148:151], v245 offset:16384
  v_mfma_f32_32x32x16_bf16 v[96:111], v[152:155], v[60:63], v[96:111]
  ds_read_b128 v[152:155], v246 offset:16384
  v_mfma_f32_32x32x16_bf16 v[112:127], v[156:159], v[60:63], v[112:127]
  ds_read_b128 v[156:159], v247 offset:16384
  v_mov_b32 v37, v36
  s_nop 1
  v_permlane32_swap_b32 v36, v37
  s_nop 1
  v_max3_f32 v36, v36, v37, 0
  v_sub_f32 v37, 0, v36
  v_exp_f32 v37, v37
  v_sub_f32 v224, v40, v36
  v_sub_f32 v160, v160, v36
  v_sub_f32 v225, v41, v36
  v_sub_f32 v161, v161, v36
  v_sub_f32 v226, v42, v36
  v_sub_f32 v162, v162, v36
  v_sub_f32 v227, v43, v36
  v_sub_f32 v163, v163, v36
  v_sub_f32 v228, v44, v36
  v_sub_f32 v164, v164, v36
  v_sub_f32 v229, v45, v36
  v_sub_f32 v165, v165, v36
  v_sub_f32 v230, v46, v36
  v_sub_f32 v166, v166, v36
  v_sub_f32 v231, v47, v36
  v_sub_f32 v167, v167, v36
  v_sub_f32 v232, v48, v36
  v_sub_f32 v168, v168, v36
  v_sub_f32 v233, v49, v36
  v_sub_f32 v169, v169, v36
  v_sub_f32 v234, v50, v36
  v_sub_f32 v170, v170, v36
  v_sub_f32 v235, v51, v36
  v_sub_f32 v171, v171, v36
  v_sub_f32 v236, v52, v36
  v_sub_f32 v172, v172, v36
  v_sub_f32 v237, v53, v36
  v_sub_f32 v173, v173, v36
  v_sub_f32 v238, v54, v36
  v_sub_f32 v174, v174, v36
  v_sub_f32 v239, v55, v36
  v_sub_f32 v175, v175, v36
  v_exp_f32 v224, v224
  v_exp_f32 v225, v225
  v_exp_f32 v226, v226
  v_exp_f32 v227, v227
  v_exp_f32 v228, v228
  v_exp_f32 v229, v229
  v_exp_f32 v230, v230
  v_exp_f32 v231, v231
  v_exp_f32 v232, v232
  v_exp_f32 v233, v233
  v_exp_f32 v234, v234
  v_exp_f32 v235, v235
  v_exp_f32 v236, v236
  v_exp_f32 v237, v237
  v_exp_f32 v238, v238
  v_exp_f32 v239, v239
  v_mul_f32 v252, v252, v37
  v_mul_f32 v64, v64, v37
  v_mul_f32 v65, v65, v37
  v_mul_f32 v66, v66, v37
  v_mul_f32 v67, v67, v37
  v_mul_f32 v68, v68, v37
  v_mul_f32 v69, v69, v37
  v_mul_f32 v70, v70, v37
  v_mul_f32 v71, v71, v37
  v_mul_f32 v72, v72, v37
  v_mul_f32 v73, v73, v37
  v_mul_f32 v74, v74, v37
  v_mul_f32 v75, v75, v37
  v_mul_f32 v76, v76, v37
  v_mul_f32 v77, v77, v37
  v_mul_f32 v78, v78, v37
  v_mul_f32 v79, v79, v37
  v_mul_f32 v80, v80, v37
  v_mul_f32 v81, v81, v37
  v_mul_f32 v82, v82, v37
  v_mul_f32 v83, v83, v37
  v_mul_f32 v84, v84, v37
  v_mul_f32 v85, v85, v37
  v_mul_f32 v86, v86, v37
  v_mul_f32 v87, v87, v37
  v_mul_f32 v88, v88, v37
  v_mul_f32 v89, v89, v37
  v_mul_f32 v90, v90, v37
  v_mul_f32 v91, v91, v37
  v_mul_f32 v92, v92, v37
  v_mul_f32 v93, v93, v37
  v_mul_f32 v94, v94, v37
  v_mul_f32 v95, v95, v37
  v_mul_f32 v96, v96, v37
  v_mul_f32 v97, v97, v37
  v_mul_f32 v98, v98, v37
  v_mul_f32 v99, v99, v37
  v_mul_f32 v100, v100, v37
  v_mul_f32 v101, v101, v37
  v_mul_f32 v102, v102, v37
  v_mul_f32 v103, v103, v37
  v_mul_f32 v104, v104, v37
  v_mul_f32 v105, v105, v37
  v_mul_f32 v106, v106, v37
  v_mul_f32 v107, v107, v37
  v_mul_f32 v108, v108, v37
  v_mul_f32 v109, v109, v37
  v_mul_f32 v110, v110, v37
  v_mul_f32 v111, v111, v37
  v_mul_f32 v112, v112, v37
  v_mul_f32 v113, v113, v37
  v_mul_f32 v114, v114, v37
  v_mul_f32 v115, v115, v37
  v_mul_f32 v116, v116, v37
  v_mul_f32 v117, v117, v37
  v_mul_f32 v118, v118, v37
  v_mul_f32 v119, v119, v37
  v_mul_f32 v120, v120, v37
  v_mul_f32 v121, v121, v37
  v_mul_f32 v122, v122, v37
  v_mul_f32 v123, v123, v37
  v_mul_f32 v124, v124, v37
  v_mul_f32 v125, v125, v37
  v_mul_f32 v126, v126, v37
  v_mul_f32 v127, v127, v37
  s_waitcnt lgkmcnt(0)
  s_branch L_back_13
L_rare_17:
  s_waitcnt lgkmcnt(0)
  v_mfma_f32_32x32x16_bf16 v[96:111], v[136:139], v[56:59], v[96:111]
  ds_read_b128 v[136:139], v242 offset:32768
  v_mfma_f32_32x32x16_bf16 v[112:127], v[140:143], v[56:59], v[112:127]
  ds_read_b128 v[140:143], v243 offset:32768
  v_mfma_f32_32x32x16_bf16 v[64:79], v[144:147], v[60:63], v[64:79]
  ds_read_b128 v[144:147], v244 offset:32768
  v_mfma_f32_32x32x16_bf16 v[80:95], v[148:151], v[60:63], v[80:95]
  ds_read_b128 v[148:151], v245 offset:32768
  v_mfma_f32_32x32x16_bf16 v[96:111], v[152:155], v[60:63], v[96:111]
  ds_read_b128 v[152:155], v246 offset:32768
  v_mfma_f32_32x32x16_bf16 v[112:127], v[156:159], v[60:63], v[112:127]
  ds_read_b128 v[156:159], v247 offset:32768
  v_mov_b32 v37, v36
  s_nop 1
  v_permlane32_swap_b32 v36, v37
  s_nop 1
  v_max3_f32 v36, v36, v37, 0
  v_sub_f32 v37, 0, v36
  v_exp_f32 v37, v37
  v_sub_f32 v224, v40, v36
  v_sub_f32 v160, v160, v36
  v_sub_f32 v225, v41, v36
  v_sub_f32 v161, v161, v36
  v_sub_f32 v226, v42, v36
  v_sub_f32 v162, v162, v36
  v_sub_f32 v227, v43, v36
  v_sub_f32 v163, v163, v36
  v_sub_f32 v228, v44, v36
  v_sub_f32 v164, v164, v36
  v_sub_f32 v229, v45, v36
  v_sub_f32 v165, v165, v36
  v_sub_f32 v230, v46, v36
  v_sub_f32 v166, v166, v36
  v_sub_f32 v231, v47, v36
  v_sub_f32 v167, v167, v36
  v_sub_f32 v232, v48, v36
  v_sub_f32 v168, v168, v36
  v_sub_f32 v233, v49, v36
  v_sub_f32 v169, v169, v36
  v_sub_f32 v234, v50, v36
  v_sub_f32 v170, v170, v36
  v_sub_f32 v235, v51, v36
  v_sub_f32 v171, v171, v36
  v_sub_f32 v236, v52, v36
  v_sub_f32 v172, v172, v36
  v_sub_f32 v237, v53, v36
  v_sub_f32 v173, v173, v36
  v_sub_f32 v238, v54, v36
  v_sub_f32 v174, v174, v36
  v_sub_f32 v239, v55, v36
  v_sub_f32 v175, v175, v36
  v_exp_f32 v224, v224
  v_exp_f32 v225, v225
  v_exp_f32 v226, v226
  v_exp_f32 v227, v227
  v_exp_f32 v228, v228
  v_exp_f32 v229, v229
  v_exp_f32 v230, v230
  v_exp_f32 v231, v231
  v_exp_f32 v232, v232
  v_exp_f32 v233, v233
  v_exp_f32 v234, v234
  v_exp_f32 v235, v235
  v_exp_f32 v236, v236
  v_exp_f32 v237, v237
  v_exp_f32 v238, v238
  v_exp_f32 v239, v239
  v_mul_f32 v252, v252, v37
  v_mul_f32 v64, v64, v37
  v_mul_f32 v65, v65, v37
  v_mul_f32 v66, v66, v37
  v_mul_f32 v67, v67, v37
  v_mul_f32 v68, v68, v37
  v_mul_f32 v69, v69, v37
  v_mul_f32 v70, v70, v37
  v_mul_f32 v71, v71, v37
  v_mul_f32 v72, v72, v37
  v_mul_f32 v73, v73, v37
  v_mul_f32 v74, v74, v37
  v_mul_f32 v75, v75, v37
  v_mul_f32 v76, v76, v37
  v_mul_f32 v77, v77, v37
  v_mul_f32 v78, v78, v37
  v_mul_f32 v79, v79, v37
  v_mul_f32 v80, v80, v37
  v_mul_f32 v81, v81, v37
  v_mul_f32 v82, v82, v37
  v_mul_f32 v83, v83, v37
  v_mul_f32 v84, v84, v37
  v_mul_f32 v85, v85, v37
  v_mul_f32 v86, v86, v37
  v_mul_f32 v87, v87, v37
  v_mul_f32 v88, v88, v37
  v_mul_f32 v89, v89, v37
  v_mul_f32 v90, v90, v37
  v_mul_f32 v91, v91, v37
  v_mul_f32 v92, v92, v37
  v_mul_f32 v93, v93, v37
  v_mul_f32 v94, v94, v37
  v_mul_f32 v95, v95, v37
  v_mul_f32 v96, v96, v37
  v_mul_f32 v97, v97, v37
  v_mul_f32 v98, v98, v37
  v_mul_f32 v99, v99, v37
  v_mul_f32 v100, v100, v37
  v_mul_f32 v101, v101, v37
  v_mul_f32 v102, v102, v37
  v_mul_f32 v103, v103, v37
  v_mul_f32 v104, v104, v37
  v_mul_f32 v105, v105, v37
  v_mul_f32 v106, v106, v37
  v_mul_f32 v107, v107, v37
  v_mul_f32 v108, v108, v37
  v_mul_f32 v109, v109, v37
  v_mul_f32 v110, v110, v37
  v_mul_f32 v111, v111, v37
  v_mul_f32 v112, v112, v37
  v_mul_f32 v113, v113, v37
  v_mul_f32 v114, v114, v37
  v_mul_f32 v115, v115, v37
  v_mul_f32 v116, v116, v37
  v_mul_f32 v117, v117, v37
  v_mul_f32 v118, v118, v37
  v_mul_f32 v119, v119, v37
  v_mul_f32 v120, v120, v37
  v_mul_f32 v121, v121, v37
  v_mul_f32 v122, v122, v37
  v_mul_f32 v123, v123, v37
  v_mul_f32 v124, v124, v37
  v_mul_f32 v125, v125, v37
  v_mul_f32 v126, v126, v37
  v_mul_f32 v127, v127, v37
  s_waitcnt lgkmcnt(0)
  s_branch L_back_18
L_rare_22:
  s_waitcnt lgkmcnt(0)
  v_mfma_f32_32x32x16_bf16 v[96:111], v[136:139], v[56:59], v[96:111]
  ds_read_b128 v[136:139], v242 offset:0
  v_mfma_f32_32x32x16_bf16 v[112:127], v[140:143], v[56:59], v[112:127]
  ds_read_b128 v[140:143], v243 offset:0
  v_mfma_f32_32x32x16_bf16 v[64:79], v[144:147], v[60:63], v[64:79]
  ds_read_b128 v[144:147], v244 offset:0
  v_mfma_f32_32x32x16_bf16 v[80:95], v[148:151], v[60:63], v[80:95]
  ds_read_b128 v[148:151], v245 offset:0
  v_mfma_f32_32x32x16_bf16 v[96:111], v[152:155], v[60:63], v[96:111]
  ds_read_b128 v[152:155], v246 offset:0
  v_mfma_f32_32x32x16_bf16 v[112:127], v[156:159], v[60:63], v[112:127]
  ds_read_b128 v[156:159], v247 offset:0
  v_mov_b32 v37, v36
  s_nop 1
  v_permlane32_swap_b32 v36, v37
  s_nop 1
  v_max3_f32 v36, v36, v37, 0
  v_sub_f32 v37, 0, v36
  v_exp_f32 v37, v37
  v_sub_f32 v224, v40, v36
  v_sub_f32 v160, v160, v36
  v_sub_f32 v225, v41, v36
  v_sub_f32 v161, v161, v36
  v_sub_f32 v226, v42, v36
  v_sub_f32 v162, v162, v36
  v_sub_f32 v227, v43, v36
  v_sub_f32 v163, v163, v36
  v_sub_f32 v228, v44, v36
  v_sub_f32 v164, v164, v36
  v_sub_f32 v229, v45, v36
  v_sub_f32 v165, v165, v36
  v_sub_f32 v230, v46, v36
  v_sub_f32 v166, v166, v36
  v_sub_f32 v231, v47, v36
  v_sub_f32 v167, v167, v36
  v_sub_f32 v232, v48, v36
  v_sub_f32 v168, v168, v36
  v_sub_f32 v233, v49, v36
  v_sub_f32 v169, v169, v36
  v_sub_f32 v234, v50, v36
  v_sub_f32 v170, v170, v36
  v_sub_f32 v235, v51, v36
  v_sub_f32 v171, v171, v36
  v_sub_f32 v236, v52, v36
  v_sub_f32 v172, v172, v36
  v_sub_f32 v237, v53, v36
  v_sub_f32 v173, v173, v36
  v_sub_f32 v238, v54, v36
  v_sub_f32 v174, v174, v36
  v_sub_f32 v239, v55, v36
  v_sub_f32 v175, v175, v36
  v_exp_f32 v224, v224
  v_exp_f32 v225, v225
  v_exp_f32 v226, v226
  v_exp_f32 v227, v227
  v_exp_f32 v228, v228
  v_exp_f32 v229, v229
  v_exp_f32 v230, v230
  v_exp_f32 v231, v231
  v_exp_f32 v232, v232
  v_exp_f32 v233, v233
  v_exp_f32 v234, v234
  v_exp_f32 v235, v235
  v_exp_f32 v236, v236
  v_exp_f32 v237, v237
  v_exp_f32 v238, v238
  v_exp_f32 v239, v239
  v_mul_f32 v252, v252, v37
  v_mul_f32 v64, v64, v37
  v_mul_f32 v65, v65, v37
  v_mul_f32 v66, v66, v37
  v_mul_f32 v67, v67, v37
  v_mul_f32 v68, v68, v37
  v_mul_f32 v69, v69, v37
  v_mul_f32 v70, v70, v37
  v_mul_f32 v71, v71, v37
  v_mul_f32 v72, v72, v37
  v_mul_f32 v73, v73, v37
  v_mul_f32 v74, v74, v37
  v_mul_f32 v75, v75, v37
  v_mul_f32 v76, v76, v37
  v_mul_f32 v77, v77, v37
  v_mul_f32 v78, v78, v37
  v_mul_f32 v79, v79, v37
  v_mul_f32 v80, v80, v37
  v_mul_f32 v81, v81, v37
  v_mul_f32 v82, v82, v37
  v_mul_f32 v83, v83, v37
  v_mul_f32 v84, v84, v37
  v_mul_f32 v85, v85, v37
  v_mul_f32 v86, v86, v37
  v_mul_f32 v87, v87, v37
  v_mul_f32 v88, v88, v37
  v_mul_f32 v89, v89, v37
  v_mul_f32 v90, v90, v37
  v_mul_f32 v91, v91, v37
  v_mul_f32 v92, v92, v37
  v_mul_f32 v93, v93, v37
  v_mul_f32 v94, v94, v37
  v_mul_f32 v95, v95, v37
  v_mul_f32 v96, v96, v37
  v_mul_f32 v97, v97, v37
  v_mul_f32 v98, v98, v37
  v_mul_f32 v99, v99, v37
  v_mul_f32 v100, v100, v37
  v_mul_f32 v101, v101, v37
  v_mul_f32 v102, v102, v37
  v_mul_f32 v103, v103, v37
  v_mul_f32 v104, v104, v37
  v_mul_f32 v105, v105, v37
  v_mul_f32 v106, v106, v37
  v_mul_f32 v107, v107, v37
  v_mul_f32 v108, v108, v37
  v_mul_f32 v109, v109, v37
  v_mul_f32 v110, v110, v37
  v_mul_f32 v111, v111, v37
  v_mul_f32 v112, v112, v37
  v_mul_f32 v113, v113, v37
  v_mul_f32 v114, v114, v37
  v_mul_f32 v115, v115, v37
  v_mul_f32 v116, v116, v37
  v_mul_f32 v117, v117, v37
  v_mul_f32 v118, v118, v37
  v_mul_f32 v119, v119, v37
  v_mul_f32 v120, v120, v37
  v_mul_f32 v121, v121, v37
  v_mul_f32 v122, v122, v37
  v_mul_f32 v123, v123, v37
  v_mul_f32 v124, v124, v37
  v_mul_f32 v125, v125, v37
  v_mul_f32 v126, v126, v37
  v_mul_f32 v127, v127, v37
  s_waitcnt lgkmcnt(0)
  s_branch L_back_23
L_rare_24:
  s_waitcnt lgkmcnt(0)
  v_mfma_f32_32x32x16_bf16 v[96:111], v[136:139], v[56:59], v[96:111]
  ds_read_b64_tr_b16 v[136:137], v250 offset:24576
  ds_read_b64_tr_b16 v[138:139], v250 offset:26624
  v_mfma_f32_32x32x16_bf16 v[112:127], v[140:143], v[56:59], v[112:127]
  ds_read_b64_tr_b16 v[140:141], v251 offset:24576
  ds_read_b64_tr_b16 v[142:143], v251 offset:26624
  v_mfma_f32_32x32x16_bf16 v[64:79], v[144:147], v[60:63], v[64:79]
  ds_read_b64_tr_b16 v[144:145], v248 offset:28672
  ds_read_b64_tr_b16 v[146:147], v248 offset:30720
  v_mfma_f32_32x32x16_bf16 v[80:95], v[148:151], v[60:63], v[80:95]
  ds_read_b64_tr_b16 v[148:149], v249 offset:28672
  ds_read_b64_tr_b16 v[150:151], v249 offset:30720
  v_mfma_f32_32x32x16_bf16 v[96:111], v[152:155], v[60:63], v[96:111]
  ds_read_b64_tr_b16 v[152:153], v250 offset:28672
  ds_read_b64_tr_b16 v[154:155], v250 offset:30720
  v_mfma_f32_32x32x16_bf16 v[112:127], v[156:159], v[60:63], v[112:127]
  ds_read_b64_tr_b16 v[156:157], v251 offset:28672
  ds_read_b64_tr_b16 v[158:159], v251 offset:30720
  v_mov_b32 v37, v36
  s_nop 1
  v_permlane32_swap_b32 v36, v37
  s_nop 1
  v_max3_f32 v36, v36, v37, 0
  v_sub_f32 v37, 0, v36
  v_exp_f32 v37, v37
  v_sub_f32 v224, v40, v36
  v_sub_f32 v160, v160, v36
  v_sub_f32 v225, v41, v36
  v_sub_f32 v161, v161, v36
  v_sub_f32 v226, v42, v36
  v_sub_f32 v162, v162, v36
  v_sub_f32 v227, v43, v36
  v_sub_f32 v163, v163, v36
  v_sub_f32 v228, v44, v36
  v_sub_f32 v164, v164, v36
  v_sub_f32 v229, v45, v36
  v_sub_f32 v165, v165, v36
  v_sub_f32 v230, v46, v36
  v_sub_f32 v166, v166, v36
  v_sub_f32 v231, v47, v36
  v_sub_f32 v167, v167, v36
  v_sub_f32 v232, v48, v36
  v_sub_f32 v168, v168, v36
  v_sub_f32 v233, v49, v36
  v_sub_f32 v169, v169, v36
  v_sub_f32 v234, v50, v36
  v_sub_f32 v170, v170, v36
  v_sub_f32 v235, v51, v36
  v_sub_f32 v171, v171, v36
  v_sub_f32 v236, v52, v36
  v_sub_f32 v172, v172, v36
  v_sub_f32 v237, v53, v36
  v_sub_f32 v173, v173, v36
  v_sub_f32 v238, v54, v36
  v_sub_f32 v174, v174, v36
  v_sub_f32 v239, v55, v36
  v_sub_f32 v175, v175, v36
  v_exp_f32 v224, v224
  v_exp_f32 v225, v225
  v_exp_f32 v226, v226
  v_exp_f32 v227, v227
  v_exp_f32 v228, v228
  v_exp_f32 v229, v229
  v_exp_f32 v230, v230
  v_exp_f32 v231, v231
  v_exp_f32 v232, v232
  v_exp_f32 v233, v233
  v_exp_f32 v234, v234
  v_exp_f32 v235, v235
  v_exp_f32 v236, v236
  v_exp_f32 v237, v237
  v_exp_f32 v238, v238
  v_exp_f32 v239, v239
  v_mul_f32 v252, v252, v37
  v_mul_f32 v64, v64, v37
  v_mul_f32 v65, v65, v37
  v_mul_f32 v66, v66, v37
  v_mul_f32 v67, v67, v37
  v_mul_f32 v68, v68, v37
  v_mul_f32 v69, v69, v37
  v_mul_f32 v70, v70, v37
  v_mul_f32 v71, v71, v37
  v_mul_f32 v72, v72, v37
  v_mul_f32 v73, v73, v37
  v_mul_f32 v74, v74, v37
  v_mul_f32 v75, v75, v37
  v_mul_f32 v76, v76, v37
  v_mul_f32 v77, v77, v37
  v_mul_f32 v78, v78, v37
  v_mul_f32 v79, v79, v37
  v_mul_f32 v80, v80, v37
  v_mul_f32 v81, v81, v37
  v_mul_f32 v82, v82, v37
  v_mul_f32 v83, v83, v37
  v_mul_f32 v84, v84, v37
  v_mul_f32 v85, v85, v37
  v_mul_f32 v86, v86, v37
  v_mul_f32 v87, v87, v37
  v_mul_f32 v88, v88, v37
  v_mul_f32 v89, v89, v37
  v_mul_f32 v90, v90, v37
  v_mul_f32 v91, v91, v37
  v_mul_f32 v92, v92, v37
  v_mul_f32 v93, v93, v37
  v_mul_f32 v94, v94, v37
  v_mul_f32 v95, v95, v37
  v_mul_f32 v96, v96, v37
  v_mul_f32 v97, v97, v37
  v_mul_f32 v98, v98, v37
  v_mul_f32 v99, v99, v37
  v_mul_f32 v100, v100, v37
  v_mul_f32 v101, v101, v37
  v_mul_f32 v102, v102, v37
  v_mul_f32 v103, v103, v37
  v_mul_f32 v104, v104, v37
  v_mul_f32 v105, v105, v37
  v_mul_f32 v106, v106, v37
  v_mul_f32 v107, v107, v37
  v_mul_f32 v108, v108, v37
  v_mul_f32 v109, v109, v37
  v_mul_f32 v110, v110, v37
  v_mul_f32 v111, v111, v37
  v_mul_f32 v112, v112, v37
  v_mul_f32 v113, v113, v37
  v_mul_f32 v114, v114, v37
  v_mul_f32 v115, v115, v37
  v_mul_f32 v116, v116, v37
  v_mul_f32 v117, v117, v37
  v_mul_f32 v118, v118, v37
  v_mul_f32 v119, v119, v37
  v_mul_f32 v120, v120, v37
  v_mul_f32 v121, v121, v37
  v_mul_f32 v122, v122, v37
  v_mul_f32 v123, v123, v37
  v_mul_f32 v124, v124, v37
  v_mul_f32 v125, v125, v37
  v_mul_f32 v126, v126, v37
  v_mul_f32 v127, v127, v37
  s_waitcnt lgkmcnt(0)
  s_branch L_back_25
L_final:
  s_load_dwordx4 s[68:71], s[0:1], 80
  s_lshr_b32 s72, s2, 3
  s_lshl_b32 s43, s5, 4
  s_add_u32 s43, s43, s6
  s_lshl_b32 s43, s43, 19
  s_add_u32 s16, s82, s43
  s_addc_u32 s17, s83, 0
  s_and_b32 s17, s17, 0xffff
  s_mov_b32 s18, 0x80000
  s_mov_b32 s19, 0x20000
  s_lshl_b32 s73, s4, 3
  s_add_u32 s73, s73, s3
  s_lshl_b32 s73, s73, 10
  v_and_b32 v2, 31, v1
  v_lshrrev_b32 v3, 5, v1
  v_lshlrev_b32 v2, 11, v2
  v_lshl_add_u32 v2, v3, 5, v2
  s_lshl_b32 s74, s6, 17
  s_lshl_b32 s43, s5, 10
  s_add_u32 s74, s74, s43
  s_bfe_u32 s43, s4, 0x10001
  s_lshl_b32 s43, s43, 16
  s_add_u32 s74, s74, s43
  s_lshr_b32 s43, s4, 2
  s_lshl_b32 s43, s43, 9
  s_add_u32 s74, s74, s43
  s_and_b32 s43, s4, 1
  s_lshl_b32 s43, s43, 8
  s_add_u32 s74, s74, s43
  s_lshr_b32 s43, s3, 1
  s_lshl_b32 s43, s43, 6
  s_add_u32 s74, s74, s43
  s_lshl_b32 s43, s47, 4
  s_add_u32 s74, s74, s43
  s_mov_b32 s75, 0xffff0000
  s_lshl_b32 s76, s72, 11
  s_lshl_b32 s43, s4, 2
  s_add_u32 s76, s76, s43
  s_add_u32 s76, s76, 33554432
  v_lshlrev_b32 v7, 8, v1
  v_add_u32 v7, s76, v7
  s_lshl_b32 s76, s2, 8
  s_add_u32 s76, s76, 33554432
  v_and_b32 v8, 7, v1
  v_lshlrev_b32 v8, 2, v8
  v_add_u32 v8, s76, v8
  s_lshl_b32 s72, s72, 2
  v_mov_b32 v4, s72
  v_mov_b32 v5, 1
  s_mov_b32 s76, 0
  s_waitcnt lgkmcnt(0)
  s_mov_b32 s20, s68
  s_and_b32 s21, s69, 0xffff
  s_mov_b32 s22, 0x200000
  s_mov_b32 s23, 0x20000
  s_cmp_eq_u32 s3, 5
  s_cbranch_scc0 L_fin_t1
L_fin_clr:
  global_load_dword v6, v4, s[70:71] sc1
  s_add_u32 s76, s76, 1
  s_waitcnt vmcnt(0)
  v_readfirstlane_b32 s77, v6
  s_cmp_gt_u32 s76, 0x40000
  s_cbranch_scc1 L_fin_t1
  s_cmp_ge_u32 s77, 8
  s_cbranch_scc1 L_fin_t1
  s_sleep 16
  s_branch L_fin_clr
L_fin_t1:
  s_cmp_eq_u32 s5, 0
  s_cselect_b32 s43, 8, 8
  s_lshl_b32 s43, s43, 14
  v_mov_b32 v9, s43
  v_mov_b32 v6, 0
  s_cmp_eq_u32 s3, 7
  s_cbranch_scc0 L_fin_nz
  ds_write_b32 v9, v6
L_fin_nz:
  s_waitcnt vmcnt(0) lgkmcnt(0)
  s_barrier
  s_cmp_eq_u32 s3, 0
  s_cbranch_scc0 L_fin_nosig
  s_mov_b64 exec, 0xff
  global_store_dword v7, v5, s[82:83] sc1
  s_mov_b64 exec, -1
L_fin_nosig:
  s_mov_b32 s76, 0
  s_mov_b32 s78, 0
L_fin_poll:
  s_cmp_eq_u32 s3, 7
  s_cbranch_scc1 L_fin_pg
  s_sleep 1
  ds_read_b32 v6, v9
  s_waitcnt lgkmcnt(0)
  v_readfirstlane_b32 s77, v6
  s_branch L_fin_pj
L_fin_pg:
  global_load_dword v6, v8, s[82:83] sc1
  s_add_u32 s76, s76, 1
  s_waitcnt vmcnt(0)
  v_cmp_eq_u32 vcc, 1, v6
  s_cmp_gt_u32 s76, 0x40000
  s_cselect_b32 s77, 0xff, 0
  s_or_b32 s77, s77, vcc_lo
  s_and_b32 s77, s77, 0xff
  v_mov_b32 v6, s77
  ds_write_b32 v9, v6
L_fin_pj:
  s_andn2_b32 s79, s77, s78
  s_or_b32 s78, s78, s77
  s_bitcmp1_b32 s79, 0
  s_cbranch_scc0 L_fin_s0
  s_add_u32 s43, s73, 0
  buffer_load_dwordx4 v[80:83], v18, s[16:19], s43 offen sc1
L_fin_s0:
  s_bitcmp1_b32 s79, 1
  s_cbranch_scc0 L_fin_s1
  s_add_u32 s43, s73, 65536
  buffer_load_dwordx4 v[84:87], v18, s[16:19], s43 offen sc1
L_fin_s1:
  s_bitcmp1_b32 s79, 2
  s_cbranch_scc0 L_fin_s2
  s_add_u32 s43, s73, 131072
  buffer_load_dwordx4 v[88:91], v18, s[16:19], s43 offen sc1
L_fin_s2:
  s_bitcmp1_b32 s79, 3
  s_cbranch_scc0 L_fin_s3
  s_add_u32 s43, s73, 196608
  buffer_load_dwordx4 v[92:95], v18, s[16:19], s43 offen sc1
L_fin_s3:
  s_bitcmp1_b32 s79, 4
  s_cbranch_scc0 L_fin_s4
  s_add_u32 s43, s73, 262144
  buffer_load_dwordx4 v[96:99], v18, s[16:19], s43 offen sc1
L_fin_s4:
  s_bitcmp1_b32 s79, 5
  s_cbranch_scc0 L_fin_s5
  s_add_u32 s43, s73, 327680
  buffer_load_dwordx4 v[100:103], v18, s[16:19], s43 offen sc1
L_fin_s5:
  s_bitcmp1_b32 s79, 6
  s_cbranch_scc0 L_fin_s6
  s_add_u32 s43, s73, 393216
  buffer_load_dwordx4 v[104:107], v18, s[16:19], s43 offen sc1
L_fin_s6:
  s_bitcmp1_b32 s79, 7
  s_cbranch_scc0 L_fin_s7
  s_add_u32 s43, s73, 458752
  buffer_load_dwordx4 v[108:111], v18, s[16:19], s43 offen sc1
L_fin_s7:
  s_cmp_eq_u32 s78, 0xff
  s_cbranch_scc0 L_fin_poll
  s_waitcnt vmcnt(0)
  v_lshlrev_b32 v64, 16, v80
  v_and_b32 v65, s75, v80
  v_lshlrev_b32 v66, 16, v81
  v_and_b32 v67, s75, v81
  v_lshlrev_b32 v68, 16, v82
  v_and_b32 v69, s75, v82
  v_lshlrev_b32 v70, 16, v83
  v_and_b32 v71, s75, v83
  v_lshlrev_b32 v72, 16, v84
  v_and_b32 v73, s75, v84
  v_add_f32 v64, v64, v72
  v_add_f32 v65, v65, v73
  v_lshlrev_b32 v72, 16, v85
  v_and_b32 v73, s75, v85
  v_add_f32 v66, v66, v72
  v_add_f32 v67, v67, v73
  v_lshlrev_b32 v72, 16, v86
  v_and_b32 v73, s75, v86
  v_add_f32 v68, v68, v72
  v_add_f32 v69, v69, v73
  v_lshlrev_b32 v72, 16, v87
  v_and_b32 v73, s75, v87
  v_add_f32 v70, v70, v72
  v_add_f32 v71, v71, v73
  v_lshlrev_b32 v72, 16, v88
  v_and_b32 v73, s75, v88
  v_add_f32 v64, v64, v72
  v_add_f32 v65, v65, v73
  v_lshlrev_b32 v72, 16, v89
  v_and_b32 v73, s75, v89
  v_add_f32 v66, v66, v72
  v_add_f32 v67, v67, v73
  v_lshlrev_b32 v72, 16, v90
  v_and_b32 v73, s75, v90
  v_add_f32 v68, v68, v72
  v_add_f32 v69, v69, v73
  v_lshlrev_b32 v72, 16, v91
  v_and_b32 v73, s75, v91
  v_add_f32 v70, v70, v72
  v_add_f32 v71, v71, v73
  v_lshlrev_b32 v72, 16, v92
  v_and_b32 v73, s75, v92
  v_add_f32 v64, v64, v72
  v_add_f32 v65, v65, v73
  v_lshlrev_b32 v72, 16, v93
  v_and_b32 v73, s75, v93
  v_add_f32 v66, v66, v72
  v_add_f32 v67, v67, v73
  v_lshlrev_b32 v72, 16, v94
  v_and_b32 v73, s75, v94
  v_add_f32 v68, v68, v72
  v_add_f32 v69, v69, v73
  v_lshlrev_b32 v72, 16, v95
  v_and_b32 v73, s75, v95
  v_add_f32 v70, v70, v72
  v_add_f32 v71, v71, v73
  v_lshlrev_b32 v72, 16, v96
  v_and_b32 v73, s75, v96
  v_add_f32 v64, v64, v72
  v_add_f32 v65, v65, v73
  v_lshlrev_b32 v72, 16, v97
  v_and_b32 v73, s75, v97
  v_add_f32 v66, v66, v72
  v_add_f32 v67, v67, v73
  v_lshlrev_b32 v72, 16, v98
  v_and_b32 v73, s75, v98
  v_add_f32 v68, v68, v72
  v_add_f32 v69, v69, v73
  v_lshlrev_b32 v72, 16, v99
  v_and_b32 v73, s75, v99
  v_add_f32 v70, v70, v72
  v_add_f32 v71, v71, v73
  v_lshlrev_b32 v72, 16, v100
  v_and_b32 v73, s75, v100
  v_add_f32 v64, v64, v72
  v_add_f32 v65, v65, v73
  v_lshlrev_b32 v72, 16, v101
  v_and_b32 v73, s75, v101
  v_add_f32 v66, v66, v72
  v_add_f32 v67, v67, v73
  v_lshlrev_b32 v72, 16, v102
  v_and_b32 v73, s75, v102
  v_add_f32 v68, v68, v72
  v_add_f32 v69, v69, v73
  v_lshlrev_b32 v72, 16, v103
  v_and_b32 v73, s75, v103
  v_add_f32 v70, v70, v72
  v_add_f32 v71, v71, v73
  v_lshlrev_b32 v72, 16, v104
  v_and_b32 v73, s75, v104
  v_add_f32 v64, v64, v72
  v_add_f32 v65, v65, v73
  v_lshlrev_b32 v72, 16, v105
  v_and_b32 v73, s75, v105
  v_add_f32 v66, v66, v72
  v_add_f32 v67, v67, v73
  v_lshlrev_b32 v72, 16, v106
  v_and_b32 v73, s75, v106
  v_add_f32 v68, v68, v72
  v_add_f32 v69, v69, v73
  v_lshlrev_b32 v72, 16, v107
  v_and_b32 v73, s75, v107
  v_add_f32 v70, v70, v72
  v_add_f32 v71, v71, v73
  v_lshlrev_b32 v72, 16, v108
  v_and_b32 v73, s75, v108
  v_add_f32 v64, v64, v72
  v_add_f32 v65, v65, v73
  v_lshlrev_b32 v72, 16, v109
  v_and_b32 v73, s75, v109
  v_add_f32 v66, v66, v72
  v_add_f32 v67, v67, v73
  v_lshlrev_b32 v72, 16, v110
  v_and_b32 v73, s75, v110
  v_add_f32 v68, v68, v72
  v_add_f32 v69, v69, v73
  v_lshlrev_b32 v72, 16, v111
  v_and_b32 v73, s75, v111
  v_add_f32 v70, v70, v72
  v_add_f32 v71, v71, v73
  v_cvt_pk_bf16_f32 v76, v64, v65
  v_cvt_pk_bf16_f32 v77, v66, v67
  v_cvt_pk_bf16_f32 v78, v68, v69
  v_cvt_pk_bf16_f32 v79, v70, v71
  buffer_store_dwordx4 v[76:79], v2, s[20:23], s74 offen
  s_endpgm
L_exit:
  s_endpgm
.section .rodata,"a"
.p2align 6
.amdhsa_kernel concat_heads__gqa_block_cached__mha_block_cached__near_ridge_kernel
  .amdhsa_next_free_vgpr 256
  .amdhsa_next_free_sgpr 102
  .amdhsa_accum_offset 256
  .amdhsa_group_segment_fixed_size 0
  .amdhsa_kernarg_size 104
  .amdhsa_user_sgpr_count 2
  .amdhsa_user_sgpr_kernarg_segment_ptr 1
  .amdhsa_system_sgpr_workgroup_id_x 1
.end_amdhsa_kernel
```
